```python
import torch

def _softmax(x, axis=-1):
    return torch.softmax(x, dim=axis)

def _gelu(x):
    return torch.nn.functional.gelu(x, approximate='tanh')

def _silu(x):
    return torch.nn.functional.silu(x)

def _sigmoid(x):
    return torch.sigmoid(x)

def _layernorm(x, axis=-1, eps=1e-05):
    m = x.mean(dim=axis, keepdim=True)
    v = x.var(dim=axis, keepdim=True, unbiased=False)
    return (x - m) / torch.sqrt(v + eps)

def _scatter_add(tgt, idx, src, axis=0):
    return tgt.clone().index_add_(axis, idx, src)

def _segment_sum(src, seg, n):
    out = torch.zeros((n,) + src.shape[1:], dtype=src.dtype)
    return out.index_add_(0, seg, src)

def _pad(x, pw):
    flat = tuple((v for pair in reversed(pw) for v in pair))
    return torch.nn.functional.pad(x, flat)
kernel_name = 'interleave_layers__ssm_conv_s4d__memory_aug_recurrent_mem_tr__prompt'

def setup_inputs():

    _w = lambda a: (lambda t: t.to(torch.bfloat16) if t.is_floating_point() else t)(torch.as_tensor(a))

    def _A_setup():
        Bsz, L, D, N = (1, 2048, 512, 128)
        return {'u': _w((lambda *s: torch.randn(*s, dtype=torch.bfloat16) * 0.05)(Bsz, L, D)), 'log_A_real': _w((lambda *s: torch.randn(*s, dtype=torch.bfloat16) * 3.2)(D, N) * 0.5), 'A_imag': _w((lambda *s: torch.randn(*s, dtype=torch.bfloat16) * 0.05)(D, N) * 3.14), 'C_real': _w((lambda *s: torch.randn(*s, dtype=torch.bfloat16) * 0.05)(D, N) / N ** 0.5), 'C_imag': _w((lambda *s: torch.randn(*s, dtype=torch.bfloat16) * 0.05)(D, N) / N ** 0.5), 'log_dt': _w((lambda *s: torch.randn(*s, dtype=torch.bfloat16) * 0.05)(D) * 0.5 - 4.0), 'D_skip': _w((lambda *s: torch.randn(*s, dtype=torch.bfloat16) * 0.05)(D))}
    _A_in = _A_setup()

    def _B_setup():
        B, S, Dm = (1, 2048, 512)
        H, Dh = (32, 128)
        M, seg = (8, 32)
        seg = min(seg, S)
        S = S // seg * seg
        return {'x': _w((lambda *s: torch.randn(*s, dtype=torch.bfloat16) * 0.05)(B, S, Dm)), 'mem0': _w((lambda *s: torch.randn(*s, dtype=torch.bfloat16) * 0.8)(B, M, Dm)), 'Wq': _w((lambda *s: torch.randn(*s, dtype=torch.bfloat16) * 1.6)(Dm, H, Dh) * Dm ** (-0.5)), 'Wk': _w((lambda *s: torch.randn(*s, dtype=torch.bfloat16) * 1.6)(Dm, H, Dh) * Dm ** (-0.5)), 'Wv': _w((lambda *s: torch.randn(*s, dtype=torch.bfloat16) * 0.8)(Dm, H, Dh) * Dm ** (-0.5)), 'Wo': _w((lambda *s: torch.randn(*s, dtype=torch.bfloat16) * 0.8)(H, Dh, Dm) * (H * Dh) ** (-0.5)), 'seg_len': seg}
    _B_in = _B_setup()
    return {'A_u': _A_in['u'], 'A_log_A_real': _A_in['log_A_real'], 'A_A_imag': _A_in['A_imag'], 'A_C_real': _A_in['C_real'], 'A_C_imag': _A_in['C_imag'], 'A_log_dt': _A_in['log_dt'], 'A_D_skip': _A_in['D_skip'], 'B_x': _B_in['x'], 'B_mem0': _B_in['mem0'], 'B_Wq': _B_in['Wq'], 'B_Wk': _B_in['Wk'], 'B_Wv': _B_in['Wv'], 'B_Wo': _B_in['Wo'], 'B_seg_len': _B_in['seg_len']}

def reference(A_u, A_log_A_real, A_A_imag, A_C_real, A_C_imag, A_log_dt, A_D_skip, B_x, B_mem0, B_Wq, B_Wk, B_Wv, B_Wo, B_seg_len):

    def _A_ref(u, log_A_real, A_imag, C_real, C_imag, log_dt, D_skip):
        L = u.shape[1]
        dt = torch.exp(log_dt)
        A = -torch.exp(log_A_real) + 1j * A_imag
        C = (C_real + 1j * C_imag) * dt[:, None]
        pos = (lambda x, dt: x.to(dt))(torch.arange(L), log_dt.dtype)
        P = torch.exp((A * dt[:, None])[:, :, None] * pos[None, None, :])
        K = 2.0 * torch.einsum('dn,dnl->dl', C, P).real
        L2 = 2 * L
        u_t = (lambda x, *d: x.permute(*d))(u, 0, 2, 1)
        Kf = (lambda x, *a, **k: torch.fft.rfft(x.float(), *a, **k))(K, L2)
        Uf = (lambda x, *a, **k: torch.fft.rfft(x.float(), *a, **k))(u_t, L2)
        y = (lambda x, *a, **k: torch.fft.irfft(x, *a, **k).to(torch.bfloat16))(Uf * Kf[None, :, :], L2)[:, :, :L]
        y = (lambda x, *d: x.permute(*d))(y, 0, 2, 1)
        return y + u * D_skip[None, None, :]

    def _B_ref(x, mem0, Wq, Wk, Wv, Wo, seg_len):
        B, S, Dm = x.shape
        H, Dh = (Wq.shape[1], Wq.shape[2])
        M = mem0.shape[1]
        scale = Dh ** (-0.5)
        n_seg = S // seg_len
        L = M + seg_len
        idx = torch.arange(L)
        mask = (idx[:, None] < M) | (idx[:, None] >= idx[None, :])
        mem = mem0
        outs = []
        for s in range(n_seg):
            xs = x[:, s * seg_len:(s + 1) * seg_len, :].clone()
            h = torch.concatenate([mem, xs], axis=1)
            q = torch.einsum('btd,dhe->bhte', h, Wq)
            k = torch.einsum('btd,dhe->bhte', h, Wk)
            v = torch.einsum('btd,dhe->bhte', h, Wv)
            scores = torch.einsum('bhqe,bhke->bhqk', q, k) * scale
            scores = torch.where(mask[None, None], scores, -1000000000.0)
            p = _softmax(scores, axis=-1)
            o = torch.einsum('bhqk,bhke->bhqe', p, v)
            o = torch.einsum('bhte,hed->btd', o, Wo)
            mem = o[:, :M, :].clone()
            outs.append(o[:, M:, :])
        return torch.concatenate(outs, axis=1)
    x = A_u
    x = x + _A_ref(_layernorm(x, axis=-1), A_log_A_real, A_A_imag, A_C_real, A_C_imag, A_log_dt, A_D_skip)
    x = x + _B_ref(_layernorm(x, axis=-1), B_mem0, B_Wq, B_Wk, B_Wv, B_Wo, B_seg_len)
    x = x + _A_ref(_layernorm(x, axis=-1), A_log_A_real, A_A_imag, A_C_real, A_C_imag, A_log_dt, A_D_skip)
    x = x + _B_ref(_layernorm(x, axis=-1), B_mem0, B_Wq, B_Wk, B_Wv, B_Wo, B_seg_len)
    return x
```

```asm
; @launch kernel=interleave_layers__ssm_conv_s4d__memory_aug_recurrent_mem_tr__prompt_kernel grid=(256,1,1) block=(256,1,1) lds=163840
.amdgcn_target "amdgcn-amd-amdhsa--gfx950"
.text
.globl interleave_layers__ssm_conv_s4d__memory_aug_recurrent_mem_tr__prompt_kernel
.p2align 8
.type interleave_layers__ssm_conv_s4d__memory_aug_recurrent_mem_tr__prompt_kernel,@function
interleave_layers__ssm_conv_s4d__memory_aug_recurrent_mem_tr__prompt_kernel:
    s_mov_b32 s7, 65287
    s_branch L_common
L_common:
    s_cmp_ge_u32 s2, 256
    s_cbranch_scc1 L_end
    s_load_dwordx16 s[64:79], s[0:1], 0
    s_load_dwordx16 s[80:95], s[0:1], 64
    s_load_dwordx2 s[96:97], s[0:1], 128
    v_lshrrev_b32 v1, 6, v0
    s_and_b32 s4, s2, 7
    s_lshr_b32 s5, s2, 3
    v_readfirstlane_b32 s3, v1
    s_getreg_b32 s32, hwreg(HW_REG_XCC_ID)
    s_mov_b32 s62, 400000
    s_not_b32 s63, s4
    s_and_b32 s32, s32, 15
    s_min_u32 s32, s32, 14
    s_add_u32 s32, s32, 1
    s_lshl_b32 s34, s32, 4
    v_mov_b32 v9, s34
    v_or_b32 v10, s2, v0
    v_cmp_eq_u32 vcc, 0, v10
    s_waitcnt lgkmcnt(0)
    s_mov_b32 s12, s94
    s_and_b32 s13, s95, 0xffff
    s_mov_b32 s14, 256
    s_mov_b32 s15, 0x20000
    s_mov_b64 exec, vcc
    buffer_store_byte v9, off, s[12:15], 0 sc1
    s_mov_b64 exec, -1
    s_mov_b32 s8, s96
    s_and_b32 s9, s97, 0xffff
    s_mov_b32 s10, 268435456
    s_mov_b32 s11, 0x20000
    s_bitcmp1_b32 s7, 0
    s_cbranch_scc0 L_noinit
    v_mov_b32 v4, 0
    v_mov_b32 v5, 0
    v_mov_b32 v6, 0
    v_mov_b32 v7, 0
    v_mov_b32 v8, -1
    v_lshlrev_b32 v2, 3, v0
    s_lshl_b32 s33, s2, 11
    s_add_u32 s33, s33, 5242880
    buffer_store_dwordx2 v[4:5], v2, s[8:11], s33 offen sc1
    v_lshlrev_b32 v2, 4, v0
    s_lshl_b32 s33, s2, 12
    s_add_u32 s33, s33, 1048576
    buffer_store_dwordx4 v[4:7], v2, s[8:11], s33 offen sc1
    s_add_u32 s33, s33, 3145728
    buffer_store_dwordx4 v[4:7], v2, s[8:11], s33 offen sc1
    s_lshl_b32 s33, s2, 8
    s_add_u32 s33, s33, 2097152
    buffer_store_byte v8, v0, s[8:11], s33 offen sc1
L_noinit:
    s_waitcnt vmcnt(0)
    s_barrier
    s_mul_i32 s32, s32, 0x11
    s_lshl_b32 s33, s4, 5
    s_add_u32 s33, s33, s5
    v_mov_b32 v2, s32
    v_mov_b32 v3, s33
    v_cmp_eq_u32 vcc, 0, v0
    s_nop 0
    s_and_saveexec_b64 s[34:35], vcc
    s_cbranch_execz L_ann_skip
    buffer_store_byte v2, v3, s[12:15], 0 offen sc1
L_ann_skip:
    s_mov_b64 exec, s[34:35]
    s_lshl_b32 s4, s4, 2
    s_lshr_b32 s4, 1159946353, s4
    s_and_b32 s4, s4, 7
    s_lshl_b32 s2, s5, 3
    s_add_u32 s2, s2, s4
    s_bitcmp1_b32 s4, 0
    s_cbranch_scc0 L_nokg
    s_bitcmp1_b32 s7, 1
    s_cbranch_scc0 L_nokg
    s_lshr_b32 s32, s4, 1
    s_lshl_b32 s32, s32, 5
    s_add_u32 s32, s32, s5
    s_lshl_b32 s32, s32, 2
    s_add_u32 s32, s32, s3
    s_lshl_b32 s33, s32, 8
    s_lshl_b32 s34, s32, 1
    s_lshl_b32 s35, s3, 13
    v_and_b32 v9, 63, v0
    v_lshlrev_b32 v10, 2, v9
    v_mov_b32 v11, 0
    s_mov_b32 s16, s74
    s_and_b32 s17, s75, 0xffff
    s_mov_b32 s18, 1024
    s_mov_b32 s19, 0x20000
    buffer_load_ushort v20, v11, s[16:19], s34 offen
    s_mov_b32 s16, s66
    s_and_b32 s17, s67, 0xffff
    s_mov_b32 s18, 131072
    s_mov_b32 s19, 0x20000
    buffer_load_dword v16, v10, s[16:19], s33 offen
    s_mov_b32 s20, s68
    s_and_b32 s21, s69, 0xffff
    s_mov_b32 s22, 131072
    s_mov_b32 s23, 0x20000
    buffer_load_dword v17, v10, s[20:23], s33 offen
    s_mov_b32 s24, s70
    s_and_b32 s25, s71, 0xffff
    s_mov_b32 s26, 131072
    s_mov_b32 s27, 0x20000
    buffer_load_dword v18, v10, s[24:27], s33 offen
    s_mov_b32 s28, s72
    s_and_b32 s29, s73, 0xffff
    s_mov_b32 s30, 131072
    s_mov_b32 s31, 0x20000
    buffer_load_dword v19, v10, s[28:31], s33 offen
    s_mul_i32 s36, s32, 4160
    s_add_u32 s36, s36, 167772160
    v_min_u32 v2, 33, v9
    v_lshlrev_b32 v2, 7, v2
    v_min_u32 v2, 4156, v2
    buffer_load_dword v1, v2, s[8:11], s36 offen sc1
    s_lshl_b32 s37, s32, 2
    s_add_u32 s37, s37, 170917888
    buffer_load_dword v8, v11, s[8:11], s37 offen sc1
    s_add_u32 s37, s35, 4096
    v_lshlrev_b32 v26, 3, v9
    v_add_u32 v128, 0, v26
    v_cvt_f32_u32 v96, v128
    v_add_u32 v129, 1, v26
    v_cvt_f32_u32 v97, v129
    v_add_u32 v130, 2, v26
    v_cvt_f32_u32 v98, v130
    v_add_u32 v131, 3, v26
    v_cvt_f32_u32 v99, v131
    v_add_u32 v132, 4, v26
    v_cvt_f32_u32 v100, v132
    v_add_u32 v133, 5, v26
    v_cvt_f32_u32 v101, v133
    v_add_u32 v134, 6, v26
    v_cvt_f32_u32 v102, v134
    v_add_u32 v135, 7, v26
    v_cvt_f32_u32 v103, v135
    v_cvt_pk_bf16_f32 v104, v96, v97
    v_and_b32 v96, 0xffff, v104
    v_lshrrev_b32 v97, 16, v104
    v_cvt_pk_bf16_f32 v104, v98, v99
    v_and_b32 v98, 0xffff, v104
    v_lshrrev_b32 v99, 16, v104
    v_cvt_pk_bf16_f32 v104, v100, v101
    v_and_b32 v100, 0xffff, v104
    v_lshrrev_b32 v101, 16, v104
    v_cvt_pk_bf16_f32 v104, v102, v103
    v_and_b32 v102, 0xffff, v104
    v_lshrrev_b32 v103, 16, v104
    v_subrev_u32 v96, 17024, v96
    v_cmp_gt_u32 vcc, 256, v128
    s_nop 1
    v_cndmask_b32 v96, v96, v128, vcc
    v_lshl_add_u32 v128, v96, 2, s37
    v_subrev_u32 v97, 17024, v97
    v_cmp_gt_u32 vcc, 256, v129
    s_nop 1
    v_cndmask_b32 v97, v97, v129, vcc
    v_lshl_add_u32 v129, v97, 2, s37
    v_subrev_u32 v98, 17024, v98
    v_cmp_gt_u32 vcc, 256, v130
    s_nop 1
    v_cndmask_b32 v98, v98, v130, vcc
    v_lshl_add_u32 v130, v98, 2, s37
    v_subrev_u32 v99, 17024, v99
    v_cmp_gt_u32 vcc, 256, v131
    s_nop 1
    v_cndmask_b32 v99, v99, v131, vcc
    v_lshl_add_u32 v131, v99, 2, s37
    v_subrev_u32 v100, 17024, v100
    v_cmp_gt_u32 vcc, 256, v132
    s_nop 1
    v_cndmask_b32 v100, v100, v132, vcc
    v_lshl_add_u32 v132, v100, 2, s37
    v_subrev_u32 v101, 17024, v101
    v_cmp_gt_u32 vcc, 256, v133
    s_nop 1
    v_cndmask_b32 v101, v101, v133, vcc
    v_lshl_add_u32 v133, v101, 2, s37
    v_subrev_u32 v102, 17024, v102
    v_cmp_gt_u32 vcc, 256, v134
    s_nop 1
    v_cndmask_b32 v102, v102, v134, vcc
    v_lshl_add_u32 v134, v102, 2, s37
    v_subrev_u32 v103, 17024, v103
    v_cmp_gt_u32 vcc, 256, v135
    s_nop 1
    v_cndmask_b32 v103, v103, v135, vcc
    v_lshl_add_u32 v135, v103, 2, s37
    v_add_u32 v136, 512, v26
    v_cvt_f32_u32 v96, v136
    v_add_u32 v137, 513, v26
    v_cvt_f32_u32 v97, v137
    v_add_u32 v138, 514, v26
    v_cvt_f32_u32 v98, v138
    v_add_u32 v139, 515, v26
    v_cvt_f32_u32 v99, v139
    v_add_u32 v140, 516, v26
    v_cvt_f32_u32 v100, v140
    v_add_u32 v141, 517, v26
    v_cvt_f32_u32 v101, v141
    v_add_u32 v142, 518, v26
    v_cvt_f32_u32 v102, v142
    v_add_u32 v143, 519, v26
    v_cvt_f32_u32 v103, v143
    v_cvt_pk_bf16_f32 v104, v96, v97
    v_and_b32 v96, 0xffff, v104
    v_lshrrev_b32 v97, 16, v104
    v_cvt_pk_bf16_f32 v104, v98, v99
    v_and_b32 v98, 0xffff, v104
    v_lshrrev_b32 v99, 16, v104
    v_cvt_pk_bf16_f32 v104, v100, v101
    v_and_b32 v100, 0xffff, v104
    v_lshrrev_b32 v101, 16, v104
    v_cvt_pk_bf16_f32 v104, v102, v103
    v_and_b32 v102, 0xffff, v104
    v_lshrrev_b32 v103, 16, v104
    v_subrev_u32 v96, 17024, v96
    v_lshl_add_u32 v136, v96, 2, s37
    v_subrev_u32 v97, 17024, v97
    v_lshl_add_u32 v137, v97, 2, s37
    v_subrev_u32 v98, 17024, v98
    v_lshl_add_u32 v138, v98, 2, s37
    v_subrev_u32 v99, 17024, v99
    v_lshl_add_u32 v139, v99, 2, s37
    v_subrev_u32 v100, 17024, v100
    v_lshl_add_u32 v140, v100, 2, s37
    v_subrev_u32 v101, 17024, v101
    v_lshl_add_u32 v141, v101, 2, s37
    v_subrev_u32 v102, 17024, v102
    v_lshl_add_u32 v142, v102, 2, s37
    v_subrev_u32 v103, 17024, v103
    v_lshl_add_u32 v143, v103, 2, s37
    v_add_u32 v144, 1024, v26
    v_cvt_f32_u32 v96, v144
    v_add_u32 v145, 1025, v26
    v_cvt_f32_u32 v97, v145
    v_add_u32 v146, 1026, v26
    v_cvt_f32_u32 v98, v146
    v_add_u32 v147, 1027, v26
    v_cvt_f32_u32 v99, v147
    v_add_u32 v148, 1028, v26
    v_cvt_f32_u32 v100, v148
    v_add_u32 v149, 1029, v26
    v_cvt_f32_u32 v101, v149
    v_add_u32 v150, 1030, v26
    v_cvt_f32_u32 v102, v150
    v_add_u32 v151, 1031, v26
    v_cvt_f32_u32 v103, v151
    v_cvt_pk_bf16_f32 v104, v96, v97
    v_and_b32 v96, 0xffff, v104
    v_lshrrev_b32 v97, 16, v104
    v_cvt_pk_bf16_f32 v104, v98, v99
    v_and_b32 v98, 0xffff, v104
    v_lshrrev_b32 v99, 16, v104
    v_cvt_pk_bf16_f32 v104, v100, v101
    v_and_b32 v100, 0xffff, v104
    v_lshrrev_b32 v101, 16, v104
    v_cvt_pk_bf16_f32 v104, v102, v103
    v_and_b32 v102, 0xffff, v104
    v_lshrrev_b32 v103, 16, v104
    v_subrev_u32 v96, 17024, v96
    v_lshl_add_u32 v144, v96, 2, s37
    v_subrev_u32 v97, 17024, v97
    v_lshl_add_u32 v145, v97, 2, s37
    v_subrev_u32 v98, 17024, v98
    v_lshl_add_u32 v146, v98, 2, s37
    v_subrev_u32 v99, 17024, v99
    v_lshl_add_u32 v147, v99, 2, s37
    v_subrev_u32 v100, 17024, v100
    v_lshl_add_u32 v148, v100, 2, s37
    v_subrev_u32 v101, 17024, v101
    v_lshl_add_u32 v149, v101, 2, s37
    v_subrev_u32 v102, 17024, v102
    v_lshl_add_u32 v150, v102, 2, s37
    v_subrev_u32 v103, 17024, v103
    v_lshl_add_u32 v151, v103, 2, s37
    v_add_u32 v152, 1536, v26
    v_cvt_f32_u32 v96, v152
    v_add_u32 v153, 1537, v26
    v_cvt_f32_u32 v97, v153
    v_add_u32 v154, 1538, v26
    v_cvt_f32_u32 v98, v154
    v_add_u32 v155, 1539, v26
    v_cvt_f32_u32 v99, v155
    v_add_u32 v156, 1540, v26
    v_cvt_f32_u32 v100, v156
    v_add_u32 v157, 1541, v26
    v_cvt_f32_u32 v101, v157
    v_add_u32 v158, 1542, v26
    v_cvt_f32_u32 v102, v158
    v_add_u32 v159, 1543, v26
    v_cvt_f32_u32 v103, v159
    v_cvt_pk_bf16_f32 v104, v96, v97
    v_and_b32 v96, 0xffff, v104
    v_lshrrev_b32 v97, 16, v104
    v_cvt_pk_bf16_f32 v104, v98, v99
    v_and_b32 v98, 0xffff, v104
    v_lshrrev_b32 v99, 16, v104
    v_cvt_pk_bf16_f32 v104, v100, v101
    v_and_b32 v100, 0xffff, v104
    v_lshrrev_b32 v101, 16, v104
    v_cvt_pk_bf16_f32 v104, v102, v103
    v_and_b32 v102, 0xffff, v104
    v_lshrrev_b32 v103, 16, v104
    v_subrev_u32 v96, 17024, v96
    v_lshl_add_u32 v152, v96, 2, s37
    v_subrev_u32 v97, 17024, v97
    v_lshl_add_u32 v153, v97, 2, s37
    v_subrev_u32 v98, 17024, v98
    v_lshl_add_u32 v154, v98, 2, s37
    v_subrev_u32 v99, 17024, v99
    v_lshl_add_u32 v155, v99, 2, s37
    v_subrev_u32 v100, 17024, v100
    v_lshl_add_u32 v156, v100, 2, s37
    v_subrev_u32 v101, 17024, v101
    v_lshl_add_u32 v157, v101, 2, s37
    v_subrev_u32 v102, 17024, v102
    v_lshl_add_u32 v158, v102, 2, s37
    v_subrev_u32 v103, 17024, v103
    v_lshl_add_u32 v159, v103, 2, s37
    v_mov_b32 v64, 0
    v_mov_b32 v65, 0
    v_mov_b32 v66, 0
    v_mov_b32 v67, 0
    v_mov_b32 v68, 0
    v_mov_b32 v69, 0
    v_mov_b32 v70, 0
    v_mov_b32 v71, 0
    v_mov_b32 v72, 0
    v_mov_b32 v73, 0
    v_mov_b32 v74, 0
    v_mov_b32 v75, 0
    v_mov_b32 v76, 0
    v_mov_b32 v77, 0
    v_mov_b32 v78, 0
    v_mov_b32 v79, 0
    v_mov_b32 v192, 0
    v_mov_b32 v193, 0
    v_mov_b32 v194, 0
    v_mov_b32 v195, 0
    v_mov_b32 v196, 0
    v_mov_b32 v197, 0
    v_mov_b32 v198, 0
    v_mov_b32 v199, 0
    v_mov_b32 v200, 0
    v_mov_b32 v201, 0
    v_mov_b32 v202, 0
    v_mov_b32 v203, 0
    v_mov_b32 v204, 0
    v_mov_b32 v205, 0
    v_mov_b32 v206, 0
    v_mov_b32 v207, 0
    v_mov_b32 v208, 0
    v_mov_b32 v209, 0
    v_mov_b32 v210, 0
    v_mov_b32 v211, 0
    v_mov_b32 v212, 0
    v_mov_b32 v213, 0
    v_mov_b32 v214, 0
    v_mov_b32 v215, 0
    v_mov_b32 v216, 0
    v_mov_b32 v217, 0
    v_mov_b32 v218, 0
    v_mov_b32 v219, 0
    v_mov_b32 v220, 0
    v_mov_b32 v221, 0
    v_mov_b32 v222, 0
    v_mov_b32 v223, 0
    v_mov_b32 v224, 0
    v_mov_b32 v225, 0
    v_mov_b32 v226, 0
    v_mov_b32 v227, 0
    v_mov_b32 v228, 0
    v_mov_b32 v229, 0
    v_mov_b32 v230, 0
    v_mov_b32 v231, 0
    v_lshlrev_b32 v10, 5, v9
    v_add_u32 v10, s35, v10
    v_and_b32 v12, 15, v9
    v_lshrrev_b32 v13, 4, v9
    v_lshlrev_b32 v14, 4, v13
    v_add_u32 v14, s35, v14
    v_cvt_f32_u32 v30, v12
    v_lshlrev_b32 v15, 8, v13
    v_lshl_add_u32 v15, v12, 2, v15
    v_add_u32 v15, s35, v15
    v_and_b32 v2, 3, v9
    v_mul_u32_u24 v2, 1040, v2
    v_lshrrev_b32 v3, 2, v9
    v_lshl_add_u32 v3, v3, 4, v2
    v_mov_b32 v4, 0
    v_mov_b32 v5, 0
    v_mov_b32 v6, 0
    v_mov_b32 v7, 0
    s_mul_i32 s36, s32, 4160
    s_add_u32 s36, s36, 167772160
    s_mov_b64 exec, 15
    buffer_store_dwordx4 v[4:7], v2, s[8:11], s36 offen sc1
    s_mov_b64 exec, -1
    s_waitcnt vmcnt(7)
    v_lshlrev_b32 v20, 16, v20
    v_mul_f32 v22, 1069066811, v20
    v_mov_b32 v21, 1069066811
    v_fma_f32 v23, v20, v21, -v22
    v_mov_b32 v21, 849703008
    v_fmac_f32 v23, v20, v21
    v_exp_f32 v21, v22
    v_mul_f32 v23, 1060205080, v23
    v_fmac_f32 v21, v21, v23
    v_cvt_pk_bf16_f32 v21, v21, v21
    v_lshlrev_b32 v21, 16, v21
    s_waitcnt vmcnt(6)
    v_lshlrev_b32 v24, 16, v16
    s_waitcnt vmcnt(5)
    v_lshlrev_b32 v25, 16, v17
    s_waitcnt vmcnt(4)
    v_lshlrev_b32 v26, 16, v18
    s_waitcnt vmcnt(3)
    v_lshlrev_b32 v27, 16, v19
    v_mul_f32 v22, 1069066811, v24
    v_mov_b32 v28, 1069066811
    v_fma_f32 v23, v24, v28, -v22
    v_mov_b32 v28, 849703008
    v_fmac_f32 v23, v24, v28
    v_exp_f32 v28, v22
    v_mul_f32 v23, 1060205080, v23
    v_fmac_f32 v28, v28, v23
    v_cvt_pk_bf16_f32 v28, v28, v28
    v_lshlrev_b32 v28, 16, v28
    v_mul_f32 v28, v28, v21
    v_mul_f32 v32, 3216550459, v28
    v_mul_f32 v25, v25, v21
    v_mul_f32 v33, 1042479491, v25
    v_mul_f32 v26, v26, v21
    v_add_f32 v34, v26, v26
    v_mul_f32 v27, v27, v21
    v_add_f32 v35, v27, v27
    v_and_b32 v24, 0xffff0000, v16
    v_and_b32 v25, 0xffff0000, v17
    v_and_b32 v26, 0xffff0000, v18
    v_and_b32 v27, 0xffff0000, v19
    v_mul_f32 v22, 1069066811, v24
    v_mov_b32 v28, 1069066811
    v_fma_f32 v23, v24, v28, -v22
    v_mov_b32 v28, 849703008
    v_fmac_f32 v23, v24, v28
    v_exp_f32 v28, v22
    v_mul_f32 v23, 1060205080, v23
    v_fmac_f32 v28, v28, v23
    v_cvt_pk_bf16_f32 v28, v28, v28
    v_lshlrev_b32 v28, 16, v28
    v_mul_f32 v28, v28, v21
    v_mul_f32 v36, 3216550459, v28
    v_mul_f32 v25, v25, v21
    v_mul_f32 v37, 1042479491, v25
    v_mul_f32 v26, v26, v21
    v_add_f32 v38, v26, v26
    v_mul_f32 v27, v27, v21
    v_add_f32 v39, v27, v27
    ds_write_b128 v10, v[32:35]
    ds_write_b128 v10, v[36:39] offset:16
    s_mov_b32 s38, 0
    s_mov_b32 s39, 0x0000bf80
    s_mov_b32 s61, 0xbf800000
    ds_read_b128 v[40:43], v14
    ds_read_b128 v[44:47], v14 offset:64
L_kg_loop:
    ds_read_b128 v[48:51], v14 offset:128
    ds_read_b128 v[52:55], v14 offset:192
    s_waitcnt lgkmcnt(3)
    v_pk_mul_f32 v[108:109], v[40:41], v[30:31] op_sel:[0,0] op_sel_hi:[1,0]
    v_mfma_f32_16x16x32_bf16 v[64:67], v[192:195], v[216:219], v[64:67]
    s_waitcnt lgkmcnt(2)
    v_pk_mul_f32 v[124:125], v[44:45], v[30:31] op_sel:[0,0] op_sel_hi:[1,0]
    v_mfma_f32_16x16x32_bf16 v[68:71], v[196:199], v[220:223], v[68:71]
    v_cos_f32 v110, v109
    v_mfma_f32_16x16x32_bf16 v[72:75], v[196:199], v[224:227], v[72:75]
    v_cos_f32 v126, v125
    v_mfma_f32_16x16x32_bf16 v[76:79], v[200:203], v[228:231], v[76:79]
    v_sin_f32 v111, v109
    v_mfma_f32_16x16x32_bf16 v[64:67], v[204:207], v[216:219], v[64:67]
    v_sin_f32 v127, v125
    v_mfma_f32_16x16x32_bf16 v[68:71], v[208:211], v[220:223], v[68:71]
    v_exp_f32 v108, v108
    v_mfma_f32_16x16x32_bf16 v[72:75], v[208:211], v[224:227], v[72:75]
    v_exp_f32 v124, v124
    v_mfma_f32_16x16x32_bf16 v[76:79], v[212:215], v[228:231], v[76:79]
    v_pk_mul_f32 v[96:97], v[110:111], v[108:109] op_sel:[0,0] op_sel_hi:[1,0]
    v_pk_mul_f32 v[112:113], v[126:127], v[124:125] op_sel:[0,0] op_sel_hi:[1,0]
    v_pk_mul_f32 v[98:99], v[96:97], v[96:97] op_sel:[0,0] op_sel_hi:[0,1]
    v_pk_mul_f32 v[114:115], v[112:113], v[112:113] op_sel:[0,0] op_sel_hi:[0,1]
    v_pk_fma_f32 v[98:99], v[96:97], v[96:97], v[98:99] op_sel:[1,1,0] op_sel_hi:[1,0,1] neg_lo:[1,0,0]
    v_pk_fma_f32 v[114:115], v[112:113], v[112:113], v[114:115] op_sel:[1,1,0] op_sel_hi:[1,0,1] neg_lo:[1,0,0]
    v_pk_mul_f32 v[100:101], v[98:99], v[98:99] op_sel:[0,0] op_sel_hi:[0,1]
    v_pk_mul_f32 v[116:117], v[114:115], v[114:115] op_sel:[0,0] op_sel_hi:[0,1]
    v_cvt_pk_bf16_f32 v216, v96, v97
    v_cvt_pk_bf16_f32 v218, v112, v113
    v_pk_fma_f32 v[100:101], v[98:99], v[98:99], v[100:101] op_sel:[1,1,0] op_sel_hi:[1,0,1] neg_lo:[1,0,0]
    v_pk_fma_f32 v[116:117], v[114:115], v[114:115], v[116:117] op_sel:[1,1,0] op_sel_hi:[1,0,1] neg_lo:[1,0,0]
    v_dot2_f32_bf16 v96, v216, s39, v96
    v_dot2_f32_bf16 v112, v218, s39, v112
    v_dot2_f32_bf16 v97, v216, s61, v97
    v_dot2_f32_bf16 v113, v218, s61, v113
    v_pk_mul_f32 v[102:103], v[100:101], v[100:101] op_sel:[0,0] op_sel_hi:[0,1]
    v_pk_mul_f32 v[118:119], v[116:117], v[116:117] op_sel:[0,0] op_sel_hi:[0,1]
    v_cvt_pk_bf16_f32 v220, v98, v99
    v_cvt_pk_bf16_f32 v222, v114, v115
    v_pk_fma_f32 v[102:103], v[100:101], v[100:101], v[102:103] op_sel:[1,1,0] op_sel_hi:[1,0,1] neg_lo:[1,0,0]
    v_pk_fma_f32 v[118:119], v[116:117], v[116:117], v[118:119] op_sel:[1,1,0] op_sel_hi:[1,0,1] neg_lo:[1,0,0]
    v_dot2_f32_bf16 v98, v220, s39, v98
    v_dot2_f32_bf16 v114, v222, s39, v114
    v_dot2_f32_bf16 v99, v220, s61, v99
    v_dot2_f32_bf16 v115, v222, s61, v115
    v_cvt_pk_bf16_f32 v217, v96, v97
    v_cvt_pk_bf16_f32 v219, v112, v113
    v_pk_mul_f32 v[104:105], v[102:103], v[102:103] op_sel:[0,0] op_sel_hi:[0,1]
    v_pk_mul_f32 v[120:121], v[118:119], v[118:119] op_sel:[0,0] op_sel_hi:[0,1]
    v_cvt_pk_bf16_f32 v224, v100, v101
    v_cvt_pk_bf16_f32 v226, v116, v117
    v_pk_fma_f32 v[104:105], v[102:103], v[102:103], v[104:105] op_sel:[1,1,0] op_sel_hi:[1,0,1] neg_lo:[1,0,0]
    v_pk_fma_f32 v[120:121], v[118:119], v[118:119], v[120:121] op_sel:[1,1,0] op_sel_hi:[1,0,1] neg_lo:[1,0,0]
    v_dot2_f32_bf16 v100, v224, s39, v100
    v_dot2_f32_bf16 v116, v226, s39, v116
    v_dot2_f32_bf16 v101, v224, s61, v101
    v_dot2_f32_bf16 v117, v226, s61, v117
    v_cvt_pk_bf16_f32 v221, v98, v99
    v_cvt_pk_bf16_f32 v223, v114, v115
    v_pk_mul_f32 v[106:107], v[104:105], v[104:105] op_sel:[0,0] op_sel_hi:[0,1]
    v_pk_mul_f32 v[122:123], v[120:121], v[120:121] op_sel:[0,0] op_sel_hi:[0,1]
    v_cvt_pk_bf16_f32 v228, v102, v103
    v_cvt_pk_bf16_f32 v230, v118, v119
    v_pk_fma_f32 v[106:107], v[104:105], v[104:105], v[106:107] op_sel:[1,1,0] op_sel_hi:[1,0,1] neg_lo:[1,0,0]
    v_pk_fma_f32 v[122:123], v[120:121], v[120:121], v[122:123] op_sel:[1,1,0] op_sel_hi:[1,0,1] neg_lo:[1,0,0]
    v_dot2_f32_bf16 v102, v228, s39, v102
    v_dot2_f32_bf16 v118, v230, s39, v118
    v_dot2_f32_bf16 v103, v228, s61, v103
    v_dot2_f32_bf16 v119, v230, s61, v119
    v_cvt_pk_bf16_f32 v225, v100, v101
    v_cvt_pk_bf16_f32 v227, v116, v117
    v_pk_mov_b32 v[108:109], v[106:107], v[106:107] op_sel:[0,1]
    v_pk_mov_b32 v[124:125], v[122:123], v[122:123] op_sel:[0,1]
    v_pk_mul_f32 v[96:97], v[42:43], v[104:105] op_sel:[0,0] op_sel_hi:[0,1] neg_hi:[1,0]
    v_pk_mul_f32 v[112:113], v[46:47], v[120:121] op_sel:[0,0] op_sel_hi:[0,1] neg_hi:[1,0]
    v_cvt_pk_bf16_f32 v229, v102, v103
    v_cvt_pk_bf16_f32 v231, v118, v119
    v_mov_b32_dpp v108, v106 row_newbcast:8 row_mask:0xf bank_mask:0x3
    v_mov_b32_dpp v124, v122 row_newbcast:8 row_mask:0xf bank_mask:0x3
    v_mov_b32_dpp v109, v107 row_newbcast:8 row_mask:0xf bank_mask:0x3
    v_mov_b32_dpp v125, v123 row_newbcast:8 row_mask:0xf bank_mask:0x3
    v_pk_fma_f32 v[96:97], v[42:43], v[104:105], v[96:97] op_sel:[1,1,0] op_sel_hi:[1,0,1] neg_lo:[1,0,0] neg_hi:[1,0,0]
    v_pk_fma_f32 v[112:113], v[46:47], v[120:121], v[112:113] op_sel:[1,1,0] op_sel_hi:[1,0,1] neg_lo:[1,0,0] neg_hi:[1,0,0]
    v_pk_mul_f32 v[110:111], v[106:107], v[108:109] op_sel:[0,0] op_sel_hi:[0,1]
    v_pk_mul_f32 v[126:127], v[122:123], v[124:125] op_sel:[0,0] op_sel_hi:[0,1]
    v_cvt_pk_bf16_f32 v192, v96, v97
    v_cvt_pk_bf16_f32 v194, v112, v113
    v_pk_fma_f32 v[110:111], v[106:107], v[108:109], v[110:111] op_sel:[1,1,0] op_sel_hi:[1,0,1] neg_lo:[1,0,0]
    v_pk_fma_f32 v[126:127], v[122:123], v[124:125], v[126:127] op_sel:[1,1,0] op_sel_hi:[1,0,1] neg_lo:[1,0,0]
    v_dot2_f32_bf16 v96, v192, s39, v96
    v_dot2_f32_bf16 v112, v194, s39, v112
    v_dot2_f32_bf16 v97, v192, s61, v97
    v_dot2_f32_bf16 v113, v194, s61, v113
    v_pk_mul_f32 v[106:107], v[110:111], v[110:111] op_sel:[0,0] op_sel_hi:[0,1]
    v_pk_mul_f32 v[122:123], v[126:127], v[126:127] op_sel:[0,0] op_sel_hi:[0,1]
    v_pk_mul_f32 v[98:99], v[42:43], v[110:111] op_sel:[0,0] op_sel_hi:[0,1] neg_hi:[1,0]
    v_pk_mul_f32 v[114:115], v[46:47], v[126:127] op_sel:[0,0] op_sel_hi:[0,1] neg_hi:[1,0]
    v_pk_fma_f32 v[106:107], v[110:111], v[110:111], v[106:107] op_sel:[1,1,0] op_sel_hi:[1,0,1] neg_lo:[1,0,0]
    v_pk_fma_f32 v[122:123], v[126:127], v[126:127], v[122:123] op_sel:[1,1,0] op_sel_hi:[1,0,1] neg_lo:[1,0,0]
    v_pk_fma_f32 v[98:99], v[42:43], v[110:111], v[98:99] op_sel:[1,1,0] op_sel_hi:[1,0,1] neg_lo:[1,0,0] neg_hi:[1,0,0]
    v_pk_fma_f32 v[114:115], v[46:47], v[126:127], v[114:115] op_sel:[1,1,0] op_sel_hi:[1,0,1] neg_lo:[1,0,0] neg_hi:[1,0,0]
    v_cvt_pk_bf16_f32 v193, v96, v97
    v_cvt_pk_bf16_f32 v195, v112, v113
    v_pk_mul_f32 v[104:105], v[106:107], v[106:107] op_sel:[0,0] op_sel_hi:[0,1]
    v_pk_mul_f32 v[120:121], v[122:123], v[122:123] op_sel:[0,0] op_sel_hi:[0,1]
    v_cvt_pk_bf16_f32 v196, v98, v99
    v_cvt_pk_bf16_f32 v198, v114, v115
    v_pk_fma_f32 v[104:105], v[106:107], v[106:107], v[104:105] op_sel:[1,1,0] op_sel_hi:[1,0,1] neg_lo:[1,0,0]
    v_pk_fma_f32 v[120:121], v[122:123], v[122:123], v[120:121] op_sel:[1,1,0] op_sel_hi:[1,0,1] neg_lo:[1,0,0]
    v_dot2_f32_bf16 v98, v196, s39, v98
    v_dot2_f32_bf16 v114, v198, s39, v114
    v_dot2_f32_bf16 v99, v196, s61, v99
    v_dot2_f32_bf16 v115, v198, s61, v115
    v_pk_mov_b32 v[204:205], v[192:193], v[192:193] op_sel:[1,0]
    v_pk_mov_b32 v[206:207], v[194:195], v[194:195] op_sel:[1,0]
    v_pk_mul_f32 v[100:101], v[42:43], v[104:105] op_sel:[0,0] op_sel_hi:[0,1] neg_hi:[1,0]
    v_pk_mul_f32 v[116:117], v[46:47], v[120:121] op_sel:[0,0] op_sel_hi:[0,1] neg_hi:[1,0]
    v_cvt_pk_bf16_f32 v197, v98, v99
    v_cvt_pk_bf16_f32 v199, v114, v115
    v_pk_fma_f32 v[100:101], v[42:43], v[104:105], v[100:101] op_sel:[1,1,0] op_sel_hi:[1,0,1] neg_lo:[1,0,0] neg_hi:[1,0,0]
    v_pk_fma_f32 v[116:117], v[46:47], v[120:121], v[116:117] op_sel:[1,1,0] op_sel_hi:[1,0,1] neg_lo:[1,0,0] neg_hi:[1,0,0]
    v_pk_mov_b32 v[208:209], v[196:197], v[196:197] op_sel:[1,0]
    v_pk_mov_b32 v[210:211], v[198:199], v[198:199] op_sel:[1,0]
    v_cvt_pk_bf16_f32 v200, v100, v101
    v_cvt_pk_bf16_f32 v202, v116, v117
    v_dot2_f32_bf16 v100, v200, s39, v100
    v_dot2_f32_bf16 v116, v202, s39, v116
    v_dot2_f32_bf16 v101, v200, s61, v101
    v_dot2_f32_bf16 v117, v202, s61, v117
    s_nop 1
    v_cvt_pk_bf16_f32 v201, v100, v101
    v_cvt_pk_bf16_f32 v203, v116, v117
    v_pk_mov_b32 v[212:213], v[200:201], v[200:201] op_sel:[1,0]
    v_pk_mov_b32 v[214:215], v[202:203], v[202:203] op_sel:[1,0]
    ds_read_b128 v[40:43], v14 offset:256
    ds_read_b128 v[44:47], v14 offset:320
    s_waitcnt lgkmcnt(3)
    v_pk_mul_f32 v[108:109], v[48:49], v[30:31] op_sel:[0,0] op_sel_hi:[1,0]
    v_mfma_f32_16x16x32_bf16 v[64:67], v[192:195], v[216:219], v[64:67]
    s_waitcnt lgkmcnt(2)
    v_pk_mul_f32 v[124:125], v[52:53], v[30:31] op_sel:[0,0] op_sel_hi:[1,0]
    v_mfma_f32_16x16x32_bf16 v[68:71], v[196:199], v[220:223], v[68:71]
    v_cos_f32 v110, v109
    v_mfma_f32_16x16x32_bf16 v[72:75], v[196:199], v[224:227], v[72:75]
    v_cos_f32 v126, v125
    v_mfma_f32_16x16x32_bf16 v[76:79], v[200:203], v[228:231], v[76:79]
    v_sin_f32 v111, v109
    v_mfma_f32_16x16x32_bf16 v[64:67], v[204:207], v[216:219], v[64:67]
    v_sin_f32 v127, v125
    v_mfma_f32_16x16x32_bf16 v[68:71], v[208:211], v[220:223], v[68:71]
    v_exp_f32 v108, v108
    v_mfma_f32_16x16x32_bf16 v[72:75], v[208:211], v[224:227], v[72:75]
    v_exp_f32 v124, v124
    v_mfma_f32_16x16x32_bf16 v[76:79], v[212:215], v[228:231], v[76:79]
    v_pk_mul_f32 v[96:97], v[110:111], v[108:109] op_sel:[0,0] op_sel_hi:[1,0]
    v_pk_mul_f32 v[112:113], v[126:127], v[124:125] op_sel:[0,0] op_sel_hi:[1,0]
    v_pk_mul_f32 v[98:99], v[96:97], v[96:97] op_sel:[0,0] op_sel_hi:[0,1]
    v_pk_mul_f32 v[114:115], v[112:113], v[112:113] op_sel:[0,0] op_sel_hi:[0,1]
    v_pk_fma_f32 v[98:99], v[96:97], v[96:97], v[98:99] op_sel:[1,1,0] op_sel_hi:[1,0,1] neg_lo:[1,0,0]
    v_pk_fma_f32 v[114:115], v[112:113], v[112:113], v[114:115] op_sel:[1,1,0] op_sel_hi:[1,0,1] neg_lo:[1,0,0]
    v_pk_mul_f32 v[100:101], v[98:99], v[98:99] op_sel:[0,0] op_sel_hi:[0,1]
    v_pk_mul_f32 v[116:117], v[114:115], v[114:115] op_sel:[0,0] op_sel_hi:[0,1]
    v_cvt_pk_bf16_f32 v216, v96, v97
    v_cvt_pk_bf16_f32 v218, v112, v113
    v_pk_fma_f32 v[100:101], v[98:99], v[98:99], v[100:101] op_sel:[1,1,0] op_sel_hi:[1,0,1] neg_lo:[1,0,0]
    v_pk_fma_f32 v[116:117], v[114:115], v[114:115], v[116:117] op_sel:[1,1,0] op_sel_hi:[1,0,1] neg_lo:[1,0,0]
    v_dot2_f32_bf16 v96, v216, s39, v96
    v_dot2_f32_bf16 v112, v218, s39, v112
    v_dot2_f32_bf16 v97, v216, s61, v97
    v_dot2_f32_bf16 v113, v218, s61, v113
    v_pk_mul_f32 v[102:103], v[100:101], v[100:101] op_sel:[0,0] op_sel_hi:[0,1]
    v_pk_mul_f32 v[118:119], v[116:117], v[116:117] op_sel:[0,0] op_sel_hi:[0,1]
    v_cvt_pk_bf16_f32 v220, v98, v99
    v_cvt_pk_bf16_f32 v222, v114, v115
    v_pk_fma_f32 v[102:103], v[100:101], v[100:101], v[102:103] op_sel:[1,1,0] op_sel_hi:[1,0,1] neg_lo:[1,0,0]
    v_pk_fma_f32 v[118:119], v[116:117], v[116:117], v[118:119] op_sel:[1,1,0] op_sel_hi:[1,0,1] neg_lo:[1,0,0]
    v_dot2_f32_bf16 v98, v220, s39, v98
    v_dot2_f32_bf16 v114, v222, s39, v114
    v_dot2_f32_bf16 v99, v220, s61, v99
    v_dot2_f32_bf16 v115, v222, s61, v115
    v_cvt_pk_bf16_f32 v217, v96, v97
    v_cvt_pk_bf16_f32 v219, v112, v113
    v_pk_mul_f32 v[104:105], v[102:103], v[102:103] op_sel:[0,0] op_sel_hi:[0,1]
    v_pk_mul_f32 v[120:121], v[118:119], v[118:119] op_sel:[0,0] op_sel_hi:[0,1]
    v_cvt_pk_bf16_f32 v224, v100, v101
    v_cvt_pk_bf16_f32 v226, v116, v117
    v_pk_fma_f32 v[104:105], v[102:103], v[102:103], v[104:105] op_sel:[1,1,0] op_sel_hi:[1,0,1] neg_lo:[1,0,0]
    v_pk_fma_f32 v[120:121], v[118:119], v[118:119], v[120:121] op_sel:[1,1,0] op_sel_hi:[1,0,1] neg_lo:[1,0,0]
    v_dot2_f32_bf16 v100, v224, s39, v100
    v_dot2_f32_bf16 v116, v226, s39, v116
    v_dot2_f32_bf16 v101, v224, s61, v101
    v_dot2_f32_bf16 v117, v226, s61, v117
    v_cvt_pk_bf16_f32 v221, v98, v99
    v_cvt_pk_bf16_f32 v223, v114, v115
    v_pk_mul_f32 v[106:107], v[104:105], v[104:105] op_sel:[0,0] op_sel_hi:[0,1]
    v_pk_mul_f32 v[122:123], v[120:121], v[120:121] op_sel:[0,0] op_sel_hi:[0,1]
    v_cvt_pk_bf16_f32 v228, v102, v103
    v_cvt_pk_bf16_f32 v230, v118, v119
    v_pk_fma_f32 v[106:107], v[104:105], v[104:105], v[106:107] op_sel:[1,1,0] op_sel_hi:[1,0,1] neg_lo:[1,0,0]
    v_pk_fma_f32 v[122:123], v[120:121], v[120:121], v[122:123] op_sel:[1,1,0] op_sel_hi:[1,0,1] neg_lo:[1,0,0]
    v_dot2_f32_bf16 v102, v228, s39, v102
    v_dot2_f32_bf16 v118, v230, s39, v118
    v_dot2_f32_bf16 v103, v228, s61, v103
    v_dot2_f32_bf16 v119, v230, s61, v119
    v_cvt_pk_bf16_f32 v225, v100, v101
    v_cvt_pk_bf16_f32 v227, v116, v117
    v_pk_mov_b32 v[108:109], v[106:107], v[106:107] op_sel:[0,1]
    v_pk_mov_b32 v[124:125], v[122:123], v[122:123] op_sel:[0,1]
    v_pk_mul_f32 v[96:97], v[50:51], v[104:105] op_sel:[0,0] op_sel_hi:[0,1] neg_hi:[1,0]
    v_pk_mul_f32 v[112:113], v[54:55], v[120:121] op_sel:[0,0] op_sel_hi:[0,1] neg_hi:[1,0]
    v_cvt_pk_bf16_f32 v229, v102, v103
    v_cvt_pk_bf16_f32 v231, v118, v119
    v_mov_b32_dpp v108, v106 row_newbcast:8 row_mask:0xf bank_mask:0x3
    v_mov_b32_dpp v124, v122 row_newbcast:8 row_mask:0xf bank_mask:0x3
    v_mov_b32_dpp v109, v107 row_newbcast:8 row_mask:0xf bank_mask:0x3
    v_mov_b32_dpp v125, v123 row_newbcast:8 row_mask:0xf bank_mask:0x3
    v_pk_fma_f32 v[96:97], v[50:51], v[104:105], v[96:97] op_sel:[1,1,0] op_sel_hi:[1,0,1] neg_lo:[1,0,0] neg_hi:[1,0,0]
    v_pk_fma_f32 v[112:113], v[54:55], v[120:121], v[112:113] op_sel:[1,1,0] op_sel_hi:[1,0,1] neg_lo:[1,0,0] neg_hi:[1,0,0]
    v_pk_mul_f32 v[110:111], v[106:107], v[108:109] op_sel:[0,0] op_sel_hi:[0,1]
    v_pk_mul_f32 v[126:127], v[122:123], v[124:125] op_sel:[0,0] op_sel_hi:[0,1]
    v_cvt_pk_bf16_f32 v192, v96, v97
    v_cvt_pk_bf16_f32 v194, v112, v113
    v_pk_fma_f32 v[110:111], v[106:107], v[108:109], v[110:111] op_sel:[1,1,0] op_sel_hi:[1,0,1] neg_lo:[1,0,0]
    v_pk_fma_f32 v[126:127], v[122:123], v[124:125], v[126:127] op_sel:[1,1,0] op_sel_hi:[1,0,1] neg_lo:[1,0,0]
    v_dot2_f32_bf16 v96, v192, s39, v96
    v_dot2_f32_bf16 v112, v194, s39, v112
    v_dot2_f32_bf16 v97, v192, s61, v97
    v_dot2_f32_bf16 v113, v194, s61, v113
    v_pk_mul_f32 v[106:107], v[110:111], v[110:111] op_sel:[0,0] op_sel_hi:[0,1]
    v_pk_mul_f32 v[122:123], v[126:127], v[126:127] op_sel:[0,0] op_sel_hi:[0,1]
    v_pk_mul_f32 v[98:99], v[50:51], v[110:111] op_sel:[0,0] op_sel_hi:[0,1] neg_hi:[1,0]
    v_pk_mul_f32 v[114:115], v[54:55], v[126:127] op_sel:[0,0] op_sel_hi:[0,1] neg_hi:[1,0]
    v_pk_fma_f32 v[106:107], v[110:111], v[110:111], v[106:107] op_sel:[1,1,0] op_sel_hi:[1,0,1] neg_lo:[1,0,0]
    v_pk_fma_f32 v[122:123], v[126:127], v[126:127], v[122:123] op_sel:[1,1,0] op_sel_hi:[1,0,1] neg_lo:[1,0,0]
    v_pk_fma_f32 v[98:99], v[50:51], v[110:111], v[98:99] op_sel:[1,1,0] op_sel_hi:[1,0,1] neg_lo:[1,0,0] neg_hi:[1,0,0]
    v_pk_fma_f32 v[114:115], v[54:55], v[126:127], v[114:115] op_sel:[1,1,0] op_sel_hi:[1,0,1] neg_lo:[1,0,0] neg_hi:[1,0,0]
    v_cvt_pk_bf16_f32 v193, v96, v97
    v_cvt_pk_bf16_f32 v195, v112, v113
    v_pk_mul_f32 v[104:105], v[106:107], v[106:107] op_sel:[0,0] op_sel_hi:[0,1]
    v_pk_mul_f32 v[120:121], v[122:123], v[122:123] op_sel:[0,0] op_sel_hi:[0,1]
    v_cvt_pk_bf16_f32 v196, v98, v99
    v_cvt_pk_bf16_f32 v198, v114, v115
    v_pk_fma_f32 v[104:105], v[106:107], v[106:107], v[104:105] op_sel:[1,1,0] op_sel_hi:[1,0,1] neg_lo:[1,0,0]
    v_pk_fma_f32 v[120:121], v[122:123], v[122:123], v[120:121] op_sel:[1,1,0] op_sel_hi:[1,0,1] neg_lo:[1,0,0]
    v_dot2_f32_bf16 v98, v196, s39, v98
    v_dot2_f32_bf16 v114, v198, s39, v114
    v_dot2_f32_bf16 v99, v196, s61, v99
    v_dot2_f32_bf16 v115, v198, s61, v115
    v_pk_mov_b32 v[204:205], v[192:193], v[192:193] op_sel:[1,0]
    v_pk_mov_b32 v[206:207], v[194:195], v[194:195] op_sel:[1,0]
    v_pk_mul_f32 v[100:101], v[50:51], v[104:105] op_sel:[0,0] op_sel_hi:[0,1] neg_hi:[1,0]
    v_pk_mul_f32 v[116:117], v[54:55], v[120:121] op_sel:[0,0] op_sel_hi:[0,1] neg_hi:[1,0]
    v_cvt_pk_bf16_f32 v197, v98, v99
    v_cvt_pk_bf16_f32 v199, v114, v115
    v_pk_fma_f32 v[100:101], v[50:51], v[104:105], v[100:101] op_sel:[1,1,0] op_sel_hi:[1,0,1] neg_lo:[1,0,0] neg_hi:[1,0,0]
    v_pk_fma_f32 v[116:117], v[54:55], v[120:121], v[116:117] op_sel:[1,1,0] op_sel_hi:[1,0,1] neg_lo:[1,0,0] neg_hi:[1,0,0]
    v_pk_mov_b32 v[208:209], v[196:197], v[196:197] op_sel:[1,0]
    v_pk_mov_b32 v[210:211], v[198:199], v[198:199] op_sel:[1,0]
    v_cvt_pk_bf16_f32 v200, v100, v101
    v_cvt_pk_bf16_f32 v202, v116, v117
    v_dot2_f32_bf16 v100, v200, s39, v100
    v_dot2_f32_bf16 v116, v202, s39, v116
    v_dot2_f32_bf16 v101, v200, s61, v101
    v_dot2_f32_bf16 v117, v202, s61, v117
    s_nop 1
    v_cvt_pk_bf16_f32 v201, v100, v101
    v_cvt_pk_bf16_f32 v203, v116, v117
    v_pk_mov_b32 v[212:213], v[200:201], v[200:201] op_sel:[1,0]
    v_pk_mov_b32 v[214:215], v[202:203], v[202:203] op_sel:[1,0]
    v_add_u32 v14, 256, v14
    s_add_u32 s38, s38, 1
    s_cmp_lt_u32 s38, 8
    s_cbranch_scc1 L_kg_loop
    v_mfma_f32_16x16x32_bf16 v[64:67], v[192:195], v[216:219], v[64:67]
    v_mfma_f32_16x16x32_bf16 v[68:71], v[196:199], v[220:223], v[68:71]
    v_mfma_f32_16x16x32_bf16 v[72:75], v[196:199], v[224:227], v[72:75]
    v_mfma_f32_16x16x32_bf16 v[76:79], v[200:203], v[228:231], v[76:79]
    v_mfma_f32_16x16x32_bf16 v[64:67], v[204:207], v[216:219], v[64:67]
    v_mfma_f32_16x16x32_bf16 v[68:71], v[208:211], v[220:223], v[68:71]
    v_mfma_f32_16x16x32_bf16 v[72:75], v[208:211], v[224:227], v[72:75]
    v_mfma_f32_16x16x32_bf16 v[76:79], v[212:215], v[228:231], v[76:79]
    v_lshlrev_b32 v16, 2, v9
    buffer_load_dword v17, v16, s[12:15], 0 offen sc1
    s_mov_b32 exec_lo, 0
    s_nop 3
    v_mov_b32 v68, v72
    v_mov_b32 v69, v73
    v_mov_b32 v70, v74
    v_mov_b32 v71, v75
    s_mov_b32 exec_lo, -1
    ds_write_b32 v15, v64 offset:4096
    ds_write_b32 v15, v65 offset:4160
    ds_write_b32 v15, v66 offset:4224
    ds_write_b32 v15, v67 offset:4288
    ds_write_b32 v15, v68 offset:5120
    ds_write_b32 v15, v69 offset:5184
    ds_write_b32 v15, v70 offset:5248
    ds_write_b32 v15, v71 offset:5312
    ds_write_b32 v15, v76 offset:6144
    ds_write_b32 v15, v77 offset:6208
    ds_write_b32 v15, v78 offset:6272
    ds_write_b32 v15, v79 offset:6336
    ds_read_b32 v160, v128
    ds_read_b32 v161, v129
    ds_read_b32 v162, v130
    ds_read_b32 v163, v131
    ds_read_b32 v164, v132
    ds_read_b32 v165, v133
    ds_read_b32 v166, v134
    ds_read_b32 v167, v135
    ds_read_b32 v168, v136
    ds_read_b32 v169, v137
    ds_read_b32 v170, v138
    ds_read_b32 v171, v139
    ds_read_b32 v172, v140
    ds_read_b32 v173, v141
    ds_read_b32 v174, v142
    ds_read_b32 v175, v143
    ds_read_b32 v176, v144
    ds_read_b32 v177, v145
    ds_read_b32 v178, v146
    ds_read_b32 v179, v147
    ds_read_b32 v180, v148
    ds_read_b32 v181, v149
    ds_read_b32 v182, v150
    ds_read_b32 v183, v151
    ds_read_b32 v184, v152
    ds_read_b32 v185, v153
    ds_read_b32 v186, v154
    ds_read_b32 v187, v155
    ds_read_b32 v188, v156
    ds_read_b32 v189, v157
    ds_read_b32 v190, v158
    ds_read_b32 v191, v159
    v_cmp_gt_u32 vcc, 33, v9
    s_nop 1
    v_cndmask_b32 v76, 0, v76, vcc
    v_cmp_gt_u32 vcc, 32, v9
    s_nop 1
    v_cndmask_b32 v77, 0, v77, vcc
    v_cndmask_b32 v78, 0, v78, vcc
    v_cndmask_b32 v79, 0, v79, vcc
    v_max3_f32 v20, |v64|, |v65|, |v66|
    v_max3_f32 v20, v20, |v67|, |v68|
    v_max3_f32 v20, v20, |v69|, |v70|
    v_max3_f32 v20, v20, |v71|, |v76|
    v_max3_f32 v20, v20, |v77|, |v78|
    v_max_f32 v20, v20, |v79|
    s_nop 1
    v_max_f32_dpp v20, v20, v20 quad_perm:[1,0,3,2] row_mask:0xf bank_mask:0xf
    s_nop 1
    v_max_f32_dpp v20, v20, v20 quad_perm:[2,3,0,1] row_mask:0xf bank_mask:0xf
    s_nop 1
    v_max_f32_dpp v20, v20, v20 row_half_mirror row_mask:0xf bank_mask:0xf
    s_nop 1
    v_max_f32_dpp v20, v20, v20 row_mirror row_mask:0xf bank_mask:0xf
    v_mov_b32 v21, v20
    s_nop 1
    v_permlane16_swap_b32 v20, v21
    v_max_f32 v20, v20, v21
    v_mov_b32 v21, v20
    s_nop 1
    v_permlane32_swap_b32 v20, v21
    v_max_f32 v20, v20, v21
    v_frexp_exp_i32_f32 v21, v20
    v_max_i32 v21, -100, v21
    v_sub_u32 v22, 15, v21
    v_subrev_u32 v23, 15, v21
    v_mov_b32 v24, 1.0
    v_ldexp_f32 v22, v24, v22
    v_ldexp_f32 v23, v24, v23
    s_lshl_b32 s37, s32, 2
    s_add_u32 s37, s37, 170917888
    s_waitcnt lgkmcnt(15)
    v_pk_mul_f32 v[160:161], v[160:161], v[22:23] op_sel_hi:[1,0]
    v_pk_mul_f32 v[162:163], v[162:163], v[22:23] op_sel_hi:[1,0]
    v_pk_mul_f32 v[164:165], v[164:165], v[22:23] op_sel_hi:[1,0]
    v_pk_mul_f32 v[166:167], v[166:167], v[22:23] op_sel_hi:[1,0]
    v_cvt_pk_f16_f32 v128, v160, v161
    v_cvt_pk_f16_f32 v129, v162, v163
    v_cvt_pk_f16_f32 v130, v164, v165
    v_cvt_pk_f16_f32 v131, v166, v167
    buffer_store_dwordx4 v[128:131], v3, s[8:11], s36 offen offset:16 sc1
    v_pk_mul_f32 v[168:169], v[168:169], v[22:23] op_sel_hi:[1,0]
    v_pk_mul_f32 v[170:171], v[170:171], v[22:23] op_sel_hi:[1,0]
    v_pk_mul_f32 v[172:173], v[172:173], v[22:23] op_sel_hi:[1,0]
    v_pk_mul_f32 v[174:175], v[174:175], v[22:23] op_sel_hi:[1,0]
    v_cvt_pk_f16_f32 v132, v168, v169
    v_cvt_pk_f16_f32 v133, v170, v171
    v_cvt_pk_f16_f32 v134, v172, v173
    v_cvt_pk_f16_f32 v135, v174, v175
    buffer_store_dwordx4 v[132:135], v3, s[8:11], s36 offen offset:272 sc1
    s_waitcnt lgkmcnt(14)
    v_pk_mul_f32 v[176:177], v[176:177], v[22:23] op_sel_hi:[1,0]
    s_waitcnt lgkmcnt(12)
    v_pk_mul_f32 v[178:179], v[178:179], v[22:23] op_sel_hi:[1,0]
    s_waitcnt lgkmcnt(10)
    v_pk_mul_f32 v[180:181], v[180:181], v[22:23] op_sel_hi:[1,0]
    s_waitcnt lgkmcnt(8)
    v_pk_mul_f32 v[182:183], v[182:183], v[22:23] op_sel_hi:[1,0]
    v_cvt_pk_f16_f32 v136, v176, v177
    v_cvt_pk_f16_f32 v137, v178, v179
    v_cvt_pk_f16_f32 v138, v180, v181
    v_cvt_pk_f16_f32 v139, v182, v183
    buffer_store_dwordx4 v[136:139], v3, s[8:11], s36 offen offset:528 sc1
    s_waitcnt lgkmcnt(6)
    v_pk_mul_f32 v[184:185], v[184:185], v[22:23] op_sel_hi:[1,0]
    s_waitcnt lgkmcnt(4)
    v_pk_mul_f32 v[186:187], v[186:187], v[22:23] op_sel_hi:[1,0]
    s_waitcnt lgkmcnt(2)
    v_pk_mul_f32 v[188:189], v[188:189], v[22:23] op_sel_hi:[1,0]
    s_waitcnt lgkmcnt(0)
    v_pk_mul_f32 v[190:191], v[190:191], v[22:23] op_sel_hi:[1,0]
    v_cvt_pk_f16_f32 v140, v184, v185
    v_cvt_pk_f16_f32 v141, v186, v187
    v_cvt_pk_f16_f32 v142, v188, v189
    v_cvt_pk_f16_f32 v143, v190, v191
    buffer_store_dwordx4 v[140:143], v3, s[8:11], s36 offen offset:784 sc1
    s_mov_b64 exec, 1
    buffer_store_dword v23, v11, s[8:11], s37 offen sc1
    s_mov_b64 exec, -1
    s_mov_b32 s38, s32
    s_branch Lannc_4
Lann_1:
    buffer_load_dword v17, v16, s[12:15], 0 offen sc1
Lannc_4:
    s_waitcnt vmcnt(0)
    v_and_b32 v19, 0x0f0f0f0f, v17
    v_subrev_u32 v18, 0x01010101, v19
    v_and_b32 v18, 0x80808080, v18
    v_cmp_ne_u32 vcc, 0, v18
    s_nop 0
    s_cbranch_vccz Lannd_2
    s_sub_u32 s62, s62, 1
    s_cbranch_scc0 Ltok_5
    s_movk_i32 s61, 1
    s_branch L_abort
Ltok_5:
    s_sleep 4
    s_branch Lann_1
Lannd_2:
    s_getreg_b32 s32, hwreg(HW_REG_XCC_ID)
    s_and_b32 s32, s32, 15
    s_min_u32 s32, s32, 14
    s_add_u32 s32, s32, 1
    s_mul_i32 s32, s32, 0x11111111
    v_cmp_ne_u32 vcc, s32, v17
    s_not_b32 s33, s63
    s_lshl_b32 s33, s33, 3
    s_lshr_b64 s[34:35], vcc, s33
    s_and_b32 s34, s34, 0xff
    s_cmp_lg_u32 s34, 0
    s_cselect_b32 s63, 1, 0
Lanns_3:
    s_lshl_b32 s36, s38, 5
    s_add_u32 s36, s36, 5701632
    v_mov_b32 v16, -1
    s_waitcnt vmcnt(0)
    s_mov_b64 exec, 1
    buffer_store_dword v16, v11, s[8:11], s36 offen sc1
    s_mov_b64 exec, -1
    s_barrier
L_nokg:
    s_cmp_eq_u32 s4, 6
    s_cbranch_scc0 L_noln
    s_bitcmp1_b32 s7, 2
    s_cbranch_scc0 L_noln
    s_mov_b32 s16, s64
    s_and_b32 s17, s65, 0xffff
    s_mov_b32 s18, 2097152
    s_mov_b32 s19, 0x20000
    v_and_b32 v9, 63, v0
    v_lshlrev_b32 v10, 4, v9
    s_lshl_b32 s38, s5, 2
    s_add_u32 s38, s38, s3
    s_lshl_b32 s39, s38, 10
    v_add_u32 v10, s39, v10
    v_mov_b32 v11, 0
    v_mov_b32 v12, -1
    s_mov_b32 s39, 0
    buffer_load_dwordx4 v[64:67], v10, s[16:19], s39 offen
    s_mov_b32 s39, 131072
    buffer_load_dwordx4 v[68:71], v10, s[16:19], s39 offen
    s_mov_b32 s39, 262144
    buffer_load_dwordx4 v[72:75], v10, s[16:19], s39 offen
    s_mov_b32 s39, 393216
    buffer_load_dwordx4 v[76:79], v10, s[16:19], s39 offen
    s_mov_b32 s39, 524288
    buffer_load_dwordx4 v[80:83], v10, s[16:19], s39 offen
    s_mov_b32 s39, 655360
    buffer_load_dwordx4 v[84:87], v10, s[16:19], s39 offen
    s_mov_b32 s39, 786432
    buffer_load_dwordx4 v[88:91], v10, s[16:19], s39 offen
    s_mov_b32 s39, 917504
    buffer_load_dwordx4 v[92:95], v10, s[16:19], s39 offen
    s_mov_b32 s39, 1048576
    buffer_load_dwordx4 v[96:99], v10, s[16:19], s39 offen
    s_mov_b32 s39, 1179648
    buffer_load_dwordx4 v[100:103], v10, s[16:19], s39 offen
    s_mov_b32 s39, 1310720
    buffer_load_dwordx4 v[104:107], v10, s[16:19], s39 offen
    s_mov_b32 s39, 1441792
    buffer_load_dwordx4 v[108:111], v10, s[16:19], s39 offen
    s_mov_b32 s39, 1572864
    buffer_load_dwordx4 v[112:115], v10, s[16:19], s39 offen
    s_mov_b32 s39, 1703936
    buffer_load_dwordx4 v[116:119], v10, s[16:19], s39 offen
    s_mov_b32 s39, 1835008
    buffer_load_dwordx4 v[120:123], v10, s[16:19], s39 offen
    s_mov_b32 s39, 1966080
    buffer_load_dwordx4 v[124:127], v10, s[16:19], s39 offen
    s_cmp_ge_i32 s63, 0
    s_cbranch_scc1 Lanns_8
    v_and_b32 v16, 63, v0
    v_lshlrev_b32 v16, 2, v16
Lann_6:
    buffer_load_dword v17, v16, s[12:15], 0 offen sc1
Lannc_9:
    s_waitcnt vmcnt(0)
    v_and_b32 v19, 0x0f0f0f0f, v17
    v_subrev_u32 v18, 0x01010101, v19
    v_and_b32 v18, 0x80808080, v18
    v_cmp_ne_u32 vcc, 0, v18
    s_nop 0
    s_cbranch_vccz Lannd_7
    s_sub_u32 s62, s62, 1
    s_cbranch_scc0 Ltok_10
    s_movk_i32 s61, 1
    s_branch L_abort
Ltok_10:
    s_sleep 4
    s_branch Lann_6
Lannd_7:
    s_getreg_b32 s32, hwreg(HW_REG_XCC_ID)
    s_and_b32 s32, s32, 15
    s_min_u32 s32, s32, 14
    s_add_u32 s32, s32, 1
    s_mul_i32 s32, s32, 0x11111111
    v_cmp_ne_u32 vcc, s32, v17
    s_not_b32 s33, s63
    s_lshl_b32 s33, s33, 3
    s_lshr_b64 s[34:35], vcc, s33
    s_and_b32 s34, s34, 0xff
    s_cmp_lg_u32 s34, 0
    s_cselect_b32 s63, 1, 0
Lanns_8:
    s_lshl_b32 s38, s38, 5
    s_add_u32 s38, s38, 5505024
    s_waitcnt vmcnt(15)
    v_lshlrev_b32 v32, 16, v64
    v_and_b32 v33, 0xffff0000, v64
    v_lshlrev_b32 v34, 16, v65
    v_and_b32 v35, 0xffff0000, v65
    v_lshlrev_b32 v36, 16, v66
    v_and_b32 v37, 0xffff0000, v66
    v_lshlrev_b32 v38, 16, v67
    v_and_b32 v39, 0xffff0000, v67
    v_add_f32 v40, v32, v33
    v_mul_f32 v41, v32, v32
    v_fmac_f32 v41, v33, v33
    v_add_f32 v40, v40, v34
    v_fmac_f32 v41, v34, v34
    v_add_f32 v40, v40, v35
    v_fmac_f32 v41, v35, v35
    v_add_f32 v40, v40, v36
    v_fmac_f32 v41, v36, v36
    v_add_f32 v40, v40, v37
    v_fmac_f32 v41, v37, v37
    v_add_f32 v40, v40, v38
    v_fmac_f32 v41, v38, v38
    v_add_f32 v40, v40, v39
    v_fmac_f32 v41, v39, v39
    s_nop 0
    v_add_f32_dpp v40, v40, v40 quad_perm:[1,0,3,2] row_mask:0xf bank_mask:0xf
    v_add_f32_dpp v41, v41, v41 quad_perm:[1,0,3,2] row_mask:0xf bank_mask:0xf
    s_nop 0
    v_add_f32_dpp v40, v40, v40 quad_perm:[2,3,0,1] row_mask:0xf bank_mask:0xf
    v_add_f32_dpp v41, v41, v41 quad_perm:[2,3,0,1] row_mask:0xf bank_mask:0xf
    s_nop 0
    v_add_f32_dpp v40, v40, v40 row_half_mirror row_mask:0xf bank_mask:0xf
    v_add_f32_dpp v41, v41, v41 row_half_mirror row_mask:0xf bank_mask:0xf
    s_nop 0
    v_add_f32_dpp v40, v40, v40 row_mirror row_mask:0xf bank_mask:0xf
    v_add_f32_dpp v41, v41, v41 row_mirror row_mask:0xf bank_mask:0xf
    v_mov_b32 v42, v40
    v_mov_b32 v43, v41
    s_nop 0
    v_permlane16_swap_b32 v40, v42
    v_permlane16_swap_b32 v41, v43
    v_add_f32 v40, v40, v42
    v_add_f32 v41, v41, v43
    v_mov_b32 v42, v40
    v_mov_b32 v43, v41
    s_nop 0
    v_permlane32_swap_b32 v40, v42
    v_permlane32_swap_b32 v41, v43
    v_add_f32 v40, v40, v42
    v_add_f32 v41, v41, v43
    v_mul_f32 v40, 989855744, v40
    v_mul_f32 v41, 989855744, v41
    v_fma_f32 v41, -v40, v40, v41
    v_max_f32 v41, 0, v41
    v_cvt_pk_bf16_f32 v42, v40, v41
    v_lshlrev_b32 v40, 16, v42
    v_and_b32 v41, 0xffff0000, v42
    v_add_f32 v41, 925353388, v41
    v_cvt_pk_bf16_f32 v42, v41, v41
    v_lshlrev_b32 v41, 16, v42
    v_sqrt_f32 v41, v41
    s_nop 0
    v_cvt_pk_bf16_f32 v42, v41, v41
    v_lshlrev_b32 v41, 16, v42
    v_rcp_f32 v41, v41
    v_sub_f32 v32, v32, v40
    v_sub_f32 v33, v33, v40
    v_cvt_pk_bf16_f32 v42, v32, v33
    v_lshlrev_b32 v32, 16, v42
    v_and_b32 v33, 0xffff0000, v42
    v_mul_f32 v32, v32, v41
    v_mul_f32 v33, v33, v41
    v_cvt_pk_bf16_f32 v42, v32, v33
    v_lshlrev_b32 v32, 16, v42
    v_and_b32 v33, 0xffff0000, v42
    v_cvt_pkrtz_f16_f32 v48, v32, v33
    v_sub_f32 v34, v34, v40
    v_sub_f32 v35, v35, v40
    v_cvt_pk_bf16_f32 v42, v34, v35
    v_lshlrev_b32 v34, 16, v42
    v_and_b32 v35, 0xffff0000, v42
    v_mul_f32 v34, v34, v41
    v_mul_f32 v35, v35, v41
    v_cvt_pk_bf16_f32 v42, v34, v35
    v_lshlrev_b32 v34, 16, v42
    v_and_b32 v35, 0xffff0000, v42
    v_cvt_pkrtz_f16_f32 v49, v34, v35
    v_sub_f32 v36, v36, v40
    v_sub_f32 v37, v37, v40
    v_cvt_pk_bf16_f32 v42, v36, v37
    v_lshlrev_b32 v36, 16, v42
    v_and_b32 v37, 0xffff0000, v42
    v_mul_f32 v36, v36, v41
    v_mul_f32 v37, v37, v41
    v_cvt_pk_bf16_f32 v42, v36, v37
    v_lshlrev_b32 v36, 16, v42
    v_and_b32 v37, 0xffff0000, v42
    v_cvt_pkrtz_f16_f32 v50, v36, v37
    v_sub_f32 v38, v38, v40
    v_sub_f32 v39, v39, v40
    v_cvt_pk_bf16_f32 v42, v38, v39
    v_lshlrev_b32 v38, 16, v42
    v_and_b32 v39, 0xffff0000, v42
    v_mul_f32 v38, v38, v41
    v_mul_f32 v39, v39, v41
    v_cvt_pk_bf16_f32 v42, v38, v39
    v_lshlrev_b32 v38, 16, v42
    v_and_b32 v39, 0xffff0000, v42
    v_cvt_pkrtz_f16_f32 v51, v38, v39
    s_mov_b32 s39, 163577856
    buffer_store_dwordx4 v[48:51], v10, s[8:11], s39 offen sc1
    s_waitcnt vmcnt(15)
    v_lshlrev_b32 v32, 16, v68
    v_and_b32 v33, 0xffff0000, v68
    v_lshlrev_b32 v34, 16, v69
    v_and_b32 v35, 0xffff0000, v69
    v_lshlrev_b32 v36, 16, v70
    v_and_b32 v37, 0xffff0000, v70
    v_lshlrev_b32 v38, 16, v71
    v_and_b32 v39, 0xffff0000, v71
    v_add_f32 v40, v32, v33
    v_mul_f32 v41, v32, v32
    v_fmac_f32 v41, v33, v33
    v_add_f32 v40, v40, v34
    v_fmac_f32 v41, v34, v34
    v_add_f32 v40, v40, v35
    v_fmac_f32 v41, v35, v35
    v_add_f32 v40, v40, v36
    v_fmac_f32 v41, v36, v36
    v_add_f32 v40, v40, v37
    v_fmac_f32 v41, v37, v37
    v_add_f32 v40, v40, v38
    v_fmac_f32 v41, v38, v38
    v_add_f32 v40, v40, v39
    v_fmac_f32 v41, v39, v39
    s_nop 0
    v_add_f32_dpp v40, v40, v40 quad_perm:[1,0,3,2] row_mask:0xf bank_mask:0xf
    v_add_f32_dpp v41, v41, v41 quad_perm:[1,0,3,2] row_mask:0xf bank_mask:0xf
    s_nop 0
    v_add_f32_dpp v40, v40, v40 quad_perm:[2,3,0,1] row_mask:0xf bank_mask:0xf
    v_add_f32_dpp v41, v41, v41 quad_perm:[2,3,0,1] row_mask:0xf bank_mask:0xf
    s_nop 0
    v_add_f32_dpp v40, v40, v40 row_half_mirror row_mask:0xf bank_mask:0xf
    v_add_f32_dpp v41, v41, v41 row_half_mirror row_mask:0xf bank_mask:0xf
    s_nop 0
    v_add_f32_dpp v40, v40, v40 row_mirror row_mask:0xf bank_mask:0xf
    v_add_f32_dpp v41, v41, v41 row_mirror row_mask:0xf bank_mask:0xf
    v_mov_b32 v42, v40
    v_mov_b32 v43, v41
    s_nop 0
    v_permlane16_swap_b32 v40, v42
    v_permlane16_swap_b32 v41, v43
    v_add_f32 v40, v40, v42
    v_add_f32 v41, v41, v43
    v_mov_b32 v42, v40
    v_mov_b32 v43, v41
    s_nop 0
    v_permlane32_swap_b32 v40, v42
    v_permlane32_swap_b32 v41, v43
    v_add_f32 v40, v40, v42
    v_add_f32 v41, v41, v43
    v_mul_f32 v40, 989855744, v40
    v_mul_f32 v41, 989855744, v41
    v_fma_f32 v41, -v40, v40, v41
    v_max_f32 v41, 0, v41
    v_cvt_pk_bf16_f32 v42, v40, v41
    v_lshlrev_b32 v40, 16, v42
    v_and_b32 v41, 0xffff0000, v42
    v_add_f32 v41, 925353388, v41
    v_cvt_pk_bf16_f32 v42, v41, v41
    v_lshlrev_b32 v41, 16, v42
    v_sqrt_f32 v41, v41
    s_nop 0
    v_cvt_pk_bf16_f32 v42, v41, v41
    v_lshlrev_b32 v41, 16, v42
    v_rcp_f32 v41, v41
    v_sub_f32 v32, v32, v40
    v_sub_f32 v33, v33, v40
    v_cvt_pk_bf16_f32 v42, v32, v33
    v_lshlrev_b32 v32, 16, v42
    v_and_b32 v33, 0xffff0000, v42
    v_mul_f32 v32, v32, v41
    v_mul_f32 v33, v33, v41
    v_cvt_pk_bf16_f32 v42, v32, v33
    v_lshlrev_b32 v32, 16, v42
    v_and_b32 v33, 0xffff0000, v42
    v_cvt_pkrtz_f16_f32 v52, v32, v33
    v_sub_f32 v34, v34, v40
    v_sub_f32 v35, v35, v40
    v_cvt_pk_bf16_f32 v42, v34, v35
    v_lshlrev_b32 v34, 16, v42
    v_and_b32 v35, 0xffff0000, v42
    v_mul_f32 v34, v34, v41
    v_mul_f32 v35, v35, v41
    v_cvt_pk_bf16_f32 v42, v34, v35
    v_lshlrev_b32 v34, 16, v42
    v_and_b32 v35, 0xffff0000, v42
    v_cvt_pkrtz_f16_f32 v53, v34, v35
    v_sub_f32 v36, v36, v40
    v_sub_f32 v37, v37, v40
    v_cvt_pk_bf16_f32 v42, v36, v37
    v_lshlrev_b32 v36, 16, v42
    v_and_b32 v37, 0xffff0000, v42
    v_mul_f32 v36, v36, v41
    v_mul_f32 v37, v37, v41
    v_cvt_pk_bf16_f32 v42, v36, v37
    v_lshlrev_b32 v36, 16, v42
    v_and_b32 v37, 0xffff0000, v42
    v_cvt_pkrtz_f16_f32 v54, v36, v37
    v_sub_f32 v38, v38, v40
    v_sub_f32 v39, v39, v40
    v_cvt_pk_bf16_f32 v42, v38, v39
    v_lshlrev_b32 v38, 16, v42
    v_and_b32 v39, 0xffff0000, v42
    v_mul_f32 v38, v38, v41
    v_mul_f32 v39, v39, v41
    v_cvt_pk_bf16_f32 v42, v38, v39
    v_lshlrev_b32 v38, 16, v42
    v_and_b32 v39, 0xffff0000, v42
    v_cvt_pkrtz_f16_f32 v55, v38, v39
    s_mov_b32 s39, 163708928
    buffer_store_dwordx4 v[52:55], v10, s[8:11], s39 offen sc1
    s_waitcnt vmcnt(1)
    s_add_u32 s39, s38, 0
    s_mov_b64 exec, 1
    buffer_store_dword v12, v11, s[8:11], s39 offen sc1
    s_mov_b64 exec, -1
    v_lshlrev_b32 v32, 16, v72
    v_and_b32 v33, 0xffff0000, v72
    v_lshlrev_b32 v34, 16, v73
    v_and_b32 v35, 0xffff0000, v73
    v_lshlrev_b32 v36, 16, v74
    v_and_b32 v37, 0xffff0000, v74
    v_lshlrev_b32 v38, 16, v75
    v_and_b32 v39, 0xffff0000, v75
    v_add_f32 v40, v32, v33
    v_mul_f32 v41, v32, v32
    v_fmac_f32 v41, v33, v33
    v_add_f32 v40, v40, v34
    v_fmac_f32 v41, v34, v34
    v_add_f32 v40, v40, v35
    v_fmac_f32 v41, v35, v35
    v_add_f32 v40, v40, v36
    v_fmac_f32 v41, v36, v36
    v_add_f32 v40, v40, v37
    v_fmac_f32 v41, v37, v37
    v_add_f32 v40, v40, v38
    v_fmac_f32 v41, v38, v38
    v_add_f32 v40, v40, v39
    v_fmac_f32 v41, v39, v39
    s_nop 0
    v_add_f32_dpp v40, v40, v40 quad_perm:[1,0,3,2] row_mask:0xf bank_mask:0xf
    v_add_f32_dpp v41, v41, v41 quad_perm:[1,0,3,2] row_mask:0xf bank_mask:0xf
    s_nop 0
    v_add_f32_dpp v40, v40, v40 quad_perm:[2,3,0,1] row_mask:0xf bank_mask:0xf
    v_add_f32_dpp v41, v41, v41 quad_perm:[2,3,0,1] row_mask:0xf bank_mask:0xf
    s_nop 0
    v_add_f32_dpp v40, v40, v40 row_half_mirror row_mask:0xf bank_mask:0xf
    v_add_f32_dpp v41, v41, v41 row_half_mirror row_mask:0xf bank_mask:0xf
    s_nop 0
    v_add_f32_dpp v40, v40, v40 row_mirror row_mask:0xf bank_mask:0xf
    v_add_f32_dpp v41, v41, v41 row_mirror row_mask:0xf bank_mask:0xf
    v_mov_b32 v42, v40
    v_mov_b32 v43, v41
    s_nop 0
    v_permlane16_swap_b32 v40, v42
    v_permlane16_swap_b32 v41, v43
    v_add_f32 v40, v40, v42
    v_add_f32 v41, v41, v43
    v_mov_b32 v42, v40
    v_mov_b32 v43, v41
    s_nop 0
    v_permlane32_swap_b32 v40, v42
    v_permlane32_swap_b32 v41, v43
    v_add_f32 v40, v40, v42
    v_add_f32 v41, v41, v43
    v_mul_f32 v40, 989855744, v40
    v_mul_f32 v41, 989855744, v41
    v_fma_f32 v41, -v40, v40, v41
    v_max_f32 v41, 0, v41
    v_cvt_pk_bf16_f32 v42, v40, v41
    v_lshlrev_b32 v40, 16, v42
    v_and_b32 v41, 0xffff0000, v42
    v_add_f32 v41, 925353388, v41
    v_cvt_pk_bf16_f32 v42, v41, v41
    v_lshlrev_b32 v41, 16, v42
    v_sqrt_f32 v41, v41
    s_nop 0
    v_cvt_pk_bf16_f32 v42, v41, v41
    v_lshlrev_b32 v41, 16, v42
    v_rcp_f32 v41, v41
    v_sub_f32 v32, v32, v40
    v_sub_f32 v33, v33, v40
    v_cvt_pk_bf16_f32 v42, v32, v33
    v_lshlrev_b32 v32, 16, v42
    v_and_b32 v33, 0xffff0000, v42
    v_mul_f32 v32, v32, v41
    v_mul_f32 v33, v33, v41
    v_cvt_pk_bf16_f32 v42, v32, v33
    v_lshlrev_b32 v32, 16, v42
    v_and_b32 v33, 0xffff0000, v42
    v_cvt_pkrtz_f16_f32 v48, v32, v33
    v_sub_f32 v34, v34, v40
    v_sub_f32 v35, v35, v40
    v_cvt_pk_bf16_f32 v42, v34, v35
    v_lshlrev_b32 v34, 16, v42
    v_and_b32 v35, 0xffff0000, v42
    v_mul_f32 v34, v34, v41
    v_mul_f32 v35, v35, v41
    v_cvt_pk_bf16_f32 v42, v34, v35
    v_lshlrev_b32 v34, 16, v42
    v_and_b32 v35, 0xffff0000, v42
    v_cvt_pkrtz_f16_f32 v49, v34, v35
    v_sub_f32 v36, v36, v40
    v_sub_f32 v37, v37, v40
    v_cvt_pk_bf16_f32 v42, v36, v37
    v_lshlrev_b32 v36, 16, v42
    v_and_b32 v37, 0xffff0000, v42
    v_mul_f32 v36, v36, v41
    v_mul_f32 v37, v37, v41
    v_cvt_pk_bf16_f32 v42, v36, v37
    v_lshlrev_b32 v36, 16, v42
    v_and_b32 v37, 0xffff0000, v42
    v_cvt_pkrtz_f16_f32 v50, v36, v37
    v_sub_f32 v38, v38, v40
    v_sub_f32 v39, v39, v40
    v_cvt_pk_bf16_f32 v42, v38, v39
    v_lshlrev_b32 v38, 16, v42
    v_and_b32 v39, 0xffff0000, v42
    v_mul_f32 v38, v38, v41
    v_mul_f32 v39, v39, v41
    v_cvt_pk_bf16_f32 v42, v38, v39
    v_lshlrev_b32 v38, 16, v42
    v_and_b32 v39, 0xffff0000, v42
    v_cvt_pkrtz_f16_f32 v51, v38, v39
    s_mov_b32 s39, 163840000
    buffer_store_dwordx4 v[48:51], v10, s[8:11], s39 offen sc1
    s_waitcnt vmcnt(1)
    s_add_u32 s39, s38, 4096
    s_mov_b64 exec, 1
    buffer_store_dword v12, v11, s[8:11], s39 offen sc1
    s_mov_b64 exec, -1
    v_lshlrev_b32 v32, 16, v76
    v_and_b32 v33, 0xffff0000, v76
    v_lshlrev_b32 v34, 16, v77
    v_and_b32 v35, 0xffff0000, v77
    v_lshlrev_b32 v36, 16, v78
    v_and_b32 v37, 0xffff0000, v78
    v_lshlrev_b32 v38, 16, v79
    v_and_b32 v39, 0xffff0000, v79
    v_add_f32 v40, v32, v33
    v_mul_f32 v41, v32, v32
    v_fmac_f32 v41, v33, v33
    v_add_f32 v40, v40, v34
    v_fmac_f32 v41, v34, v34
    v_add_f32 v40, v40, v35
    v_fmac_f32 v41, v35, v35
    v_add_f32 v40, v40, v36
    v_fmac_f32 v41, v36, v36
    v_add_f32 v40, v40, v37
    v_fmac_f32 v41, v37, v37
    v_add_f32 v40, v40, v38
    v_fmac_f32 v41, v38, v38
    v_add_f32 v40, v40, v39
    v_fmac_f32 v41, v39, v39
    s_nop 0
    v_add_f32_dpp v40, v40, v40 quad_perm:[1,0,3,2] row_mask:0xf bank_mask:0xf
    v_add_f32_dpp v41, v41, v41 quad_perm:[1,0,3,2] row_mask:0xf bank_mask:0xf
    s_nop 0
    v_add_f32_dpp v40, v40, v40 quad_perm:[2,3,0,1] row_mask:0xf bank_mask:0xf
    v_add_f32_dpp v41, v41, v41 quad_perm:[2,3,0,1] row_mask:0xf bank_mask:0xf
    s_nop 0
    v_add_f32_dpp v40, v40, v40 row_half_mirror row_mask:0xf bank_mask:0xf
    v_add_f32_dpp v41, v41, v41 row_half_mirror row_mask:0xf bank_mask:0xf
    s_nop 0
    v_add_f32_dpp v40, v40, v40 row_mirror row_mask:0xf bank_mask:0xf
    v_add_f32_dpp v41, v41, v41 row_mirror row_mask:0xf bank_mask:0xf
    v_mov_b32 v42, v40
    v_mov_b32 v43, v41
    s_nop 0
    v_permlane16_swap_b32 v40, v42
    v_permlane16_swap_b32 v41, v43
    v_add_f32 v40, v40, v42
    v_add_f32 v41, v41, v43
    v_mov_b32 v42, v40
    v_mov_b32 v43, v41
    s_nop 0
    v_permlane32_swap_b32 v40, v42
    v_permlane32_swap_b32 v41, v43
    v_add_f32 v40, v40, v42
    v_add_f32 v41, v41, v43
    v_mul_f32 v40, 989855744, v40
    v_mul_f32 v41, 989855744, v41
    v_fma_f32 v41, -v40, v40, v41
    v_max_f32 v41, 0, v41
    v_cvt_pk_bf16_f32 v42, v40, v41
    v_lshlrev_b32 v40, 16, v42
    v_and_b32 v41, 0xffff0000, v42
    v_add_f32 v41, 925353388, v41
    v_cvt_pk_bf16_f32 v42, v41, v41
    v_lshlrev_b32 v41, 16, v42
    v_sqrt_f32 v41, v41
    s_nop 0
    v_cvt_pk_bf16_f32 v42, v41, v41
    v_lshlrev_b32 v41, 16, v42
    v_rcp_f32 v41, v41
    v_sub_f32 v32, v32, v40
    v_sub_f32 v33, v33, v40
    v_cvt_pk_bf16_f32 v42, v32, v33
    v_lshlrev_b32 v32, 16, v42
    v_and_b32 v33, 0xffff0000, v42
    v_mul_f32 v32, v32, v41
    v_mul_f32 v33, v33, v41
    v_cvt_pk_bf16_f32 v42, v32, v33
    v_lshlrev_b32 v32, 16, v42
    v_and_b32 v33, 0xffff0000, v42
    v_cvt_pkrtz_f16_f32 v52, v32, v33
    v_sub_f32 v34, v34, v40
    v_sub_f32 v35, v35, v40
    v_cvt_pk_bf16_f32 v42, v34, v35
    v_lshlrev_b32 v34, 16, v42
    v_and_b32 v35, 0xffff0000, v42
    v_mul_f32 v34, v34, v41
    v_mul_f32 v35, v35, v41
    v_cvt_pk_bf16_f32 v42, v34, v35
    v_lshlrev_b32 v34, 16, v42
    v_and_b32 v35, 0xffff0000, v42
    v_cvt_pkrtz_f16_f32 v53, v34, v35
    v_sub_f32 v36, v36, v40
    v_sub_f32 v37, v37, v40
    v_cvt_pk_bf16_f32 v42, v36, v37
    v_lshlrev_b32 v36, 16, v42
    v_and_b32 v37, 0xffff0000, v42
    v_mul_f32 v36, v36, v41
    v_mul_f32 v37, v37, v41
    v_cvt_pk_bf16_f32 v42, v36, v37
    v_lshlrev_b32 v36, 16, v42
    v_and_b32 v37, 0xffff0000, v42
    v_cvt_pkrtz_f16_f32 v54, v36, v37
    v_sub_f32 v38, v38, v40
    v_sub_f32 v39, v39, v40
    v_cvt_pk_bf16_f32 v42, v38, v39
    v_lshlrev_b32 v38, 16, v42
    v_and_b32 v39, 0xffff0000, v42
    v_mul_f32 v38, v38, v41
    v_mul_f32 v39, v39, v41
    v_cvt_pk_bf16_f32 v42, v38, v39
    v_lshlrev_b32 v38, 16, v42
    v_and_b32 v39, 0xffff0000, v42
    v_cvt_pkrtz_f16_f32 v55, v38, v39
    s_mov_b32 s39, 163971072
    buffer_store_dwordx4 v[52:55], v10, s[8:11], s39 offen sc1
    s_waitcnt vmcnt(1)
    s_add_u32 s39, s38, 8192
    s_mov_b64 exec, 1
    buffer_store_dword v12, v11, s[8:11], s39 offen sc1
    s_mov_b64 exec, -1
    v_lshlrev_b32 v32, 16, v80
    v_and_b32 v33, 0xffff0000, v80
    v_lshlrev_b32 v34, 16, v81
    v_and_b32 v35, 0xffff0000, v81
    v_lshlrev_b32 v36, 16, v82
    v_and_b32 v37, 0xffff0000, v82
    v_lshlrev_b32 v38, 16, v83
    v_and_b32 v39, 0xffff0000, v83
    v_add_f32 v40, v32, v33
    v_mul_f32 v41, v32, v32
    v_fmac_f32 v41, v33, v33
    v_add_f32 v40, v40, v34
    v_fmac_f32 v41, v34, v34
    v_add_f32 v40, v40, v35
    v_fmac_f32 v41, v35, v35
    v_add_f32 v40, v40, v36
    v_fmac_f32 v41, v36, v36
    v_add_f32 v40, v40, v37
    v_fmac_f32 v41, v37, v37
    v_add_f32 v40, v40, v38
    v_fmac_f32 v41, v38, v38
    v_add_f32 v40, v40, v39
    v_fmac_f32 v41, v39, v39
    s_nop 0
    v_add_f32_dpp v40, v40, v40 quad_perm:[1,0,3,2] row_mask:0xf bank_mask:0xf
    v_add_f32_dpp v41, v41, v41 quad_perm:[1,0,3,2] row_mask:0xf bank_mask:0xf
    s_nop 0
    v_add_f32_dpp v40, v40, v40 quad_perm:[2,3,0,1] row_mask:0xf bank_mask:0xf
    v_add_f32_dpp v41, v41, v41 quad_perm:[2,3,0,1] row_mask:0xf bank_mask:0xf
    s_nop 0
    v_add_f32_dpp v40, v40, v40 row_half_mirror row_mask:0xf bank_mask:0xf
    v_add_f32_dpp v41, v41, v41 row_half_mirror row_mask:0xf bank_mask:0xf
    s_nop 0
    v_add_f32_dpp v40, v40, v40 row_mirror row_mask:0xf bank_mask:0xf
    v_add_f32_dpp v41, v41, v41 row_mirror row_mask:0xf bank_mask:0xf
    v_mov_b32 v42, v40
    v_mov_b32 v43, v41
    s_nop 0
    v_permlane16_swap_b32 v40, v42
    v_permlane16_swap_b32 v41, v43
    v_add_f32 v40, v40, v42
    v_add_f32 v41, v41, v43
    v_mov_b32 v42, v40
    v_mov_b32 v43, v41
    s_nop 0
    v_permlane32_swap_b32 v40, v42
    v_permlane32_swap_b32 v41, v43
    v_add_f32 v40, v40, v42
    v_add_f32 v41, v41, v43
    v_mul_f32 v40, 989855744, v40
    v_mul_f32 v41, 989855744, v41
    v_fma_f32 v41, -v40, v40, v41
    v_max_f32 v41, 0, v41
    v_cvt_pk_bf16_f32 v42, v40, v41
    v_lshlrev_b32 v40, 16, v42
    v_and_b32 v41, 0xffff0000, v42
    v_add_f32 v41, 925353388, v41
    v_cvt_pk_bf16_f32 v42, v41, v41
    v_lshlrev_b32 v41, 16, v42
    v_sqrt_f32 v41, v41
    s_nop 0
    v_cvt_pk_bf16_f32 v42, v41, v41
    v_lshlrev_b32 v41, 16, v42
    v_rcp_f32 v41, v41
    v_sub_f32 v32, v32, v40
    v_sub_f32 v33, v33, v40
    v_cvt_pk_bf16_f32 v42, v32, v33
    v_lshlrev_b32 v32, 16, v42
    v_and_b32 v33, 0xffff0000, v42
    v_mul_f32 v32, v32, v41
    v_mul_f32 v33, v33, v41
    v_cvt_pk_bf16_f32 v42, v32, v33
    v_lshlrev_b32 v32, 16, v42
    v_and_b32 v33, 0xffff0000, v42
    v_cvt_pkrtz_f16_f32 v48, v32, v33
    v_sub_f32 v34, v34, v40
    v_sub_f32 v35, v35, v40
    v_cvt_pk_bf16_f32 v42, v34, v35
    v_lshlrev_b32 v34, 16, v42
    v_and_b32 v35, 0xffff0000, v42
    v_mul_f32 v34, v34, v41
    v_mul_f32 v35, v35, v41
    v_cvt_pk_bf16_f32 v42, v34, v35
    v_lshlrev_b32 v34, 16, v42
    v_and_b32 v35, 0xffff0000, v42
    v_cvt_pkrtz_f16_f32 v49, v34, v35
    v_sub_f32 v36, v36, v40
    v_sub_f32 v37, v37, v40
    v_cvt_pk_bf16_f32 v42, v36, v37
    v_lshlrev_b32 v36, 16, v42
    v_and_b32 v37, 0xffff0000, v42
    v_mul_f32 v36, v36, v41
    v_mul_f32 v37, v37, v41
    v_cvt_pk_bf16_f32 v42, v36, v37
    v_lshlrev_b32 v36, 16, v42
    v_and_b32 v37, 0xffff0000, v42
    v_cvt_pkrtz_f16_f32 v50, v36, v37
    v_sub_f32 v38, v38, v40
    v_sub_f32 v39, v39, v40
    v_cvt_pk_bf16_f32 v42, v38, v39
    v_lshlrev_b32 v38, 16, v42
    v_and_b32 v39, 0xffff0000, v42
    v_mul_f32 v38, v38, v41
    v_mul_f32 v39, v39, v41
    v_cvt_pk_bf16_f32 v42, v38, v39
    v_lshlrev_b32 v38, 16, v42
    v_and_b32 v39, 0xffff0000, v42
    v_cvt_pkrtz_f16_f32 v51, v38, v39
    s_mov_b32 s39, 164102144
    buffer_store_dwordx4 v[48:51], v10, s[8:11], s39 offen sc1
    s_waitcnt vmcnt(1)
    s_add_u32 s39, s38, 12288
    s_mov_b64 exec, 1
    buffer_store_dword v12, v11, s[8:11], s39 offen sc1
    s_mov_b64 exec, -1
    v_lshlrev_b32 v32, 16, v84
    v_and_b32 v33, 0xffff0000, v84
    v_lshlrev_b32 v34, 16, v85
    v_and_b32 v35, 0xffff0000, v85
    v_lshlrev_b32 v36, 16, v86
    v_and_b32 v37, 0xffff0000, v86
    v_lshlrev_b32 v38, 16, v87
    v_and_b32 v39, 0xffff0000, v87
    v_add_f32 v40, v32, v33
    v_mul_f32 v41, v32, v32
    v_fmac_f32 v41, v33, v33
    v_add_f32 v40, v40, v34
    v_fmac_f32 v41, v34, v34
    v_add_f32 v40, v40, v35
    v_fmac_f32 v41, v35, v35
    v_add_f32 v40, v40, v36
    v_fmac_f32 v41, v36, v36
    v_add_f32 v40, v40, v37
    v_fmac_f32 v41, v37, v37
    v_add_f32 v40, v40, v38
    v_fmac_f32 v41, v38, v38
    v_add_f32 v40, v40, v39
    v_fmac_f32 v41, v39, v39
    s_nop 0
    v_add_f32_dpp v40, v40, v40 quad_perm:[1,0,3,2] row_mask:0xf bank_mask:0xf
    v_add_f32_dpp v41, v41, v41 quad_perm:[1,0,3,2] row_mask:0xf bank_mask:0xf
    s_nop 0
    v_add_f32_dpp v40, v40, v40 quad_perm:[2,3,0,1] row_mask:0xf bank_mask:0xf
    v_add_f32_dpp v41, v41, v41 quad_perm:[2,3,0,1] row_mask:0xf bank_mask:0xf
    s_nop 0
    v_add_f32_dpp v40, v40, v40 row_half_mirror row_mask:0xf bank_mask:0xf
    v_add_f32_dpp v41, v41, v41 row_half_mirror row_mask:0xf bank_mask:0xf
    s_nop 0
    v_add_f32_dpp v40, v40, v40 row_mirror row_mask:0xf bank_mask:0xf
    v_add_f32_dpp v41, v41, v41 row_mirror row_mask:0xf bank_mask:0xf
    v_mov_b32 v42, v40
    v_mov_b32 v43, v41
    s_nop 0
    v_permlane16_swap_b32 v40, v42
    v_permlane16_swap_b32 v41, v43
    v_add_f32 v40, v40, v42
    v_add_f32 v41, v41, v43
    v_mov_b32 v42, v40
    v_mov_b32 v43, v41
    s_nop 0
    v_permlane32_swap_b32 v40, v42
    v_permlane32_swap_b32 v41, v43
    v_add_f32 v40, v40, v42
    v_add_f32 v41, v41, v43
    v_mul_f32 v40, 989855744, v40
    v_mul_f32 v41, 989855744, v41
    v_fma_f32 v41, -v40, v40, v41
    v_max_f32 v41, 0, v41
    v_cvt_pk_bf16_f32 v42, v40, v41
    v_lshlrev_b32 v40, 16, v42
    v_and_b32 v41, 0xffff0000, v42
    v_add_f32 v41, 925353388, v41
    v_cvt_pk_bf16_f32 v42, v41, v41
    v_lshlrev_b32 v41, 16, v42
    v_sqrt_f32 v41, v41
    s_nop 0
    v_cvt_pk_bf16_f32 v42, v41, v41
    v_lshlrev_b32 v41, 16, v42
    v_rcp_f32 v41, v41
    v_sub_f32 v32, v32, v40
    v_sub_f32 v33, v33, v40
    v_cvt_pk_bf16_f32 v42, v32, v33
    v_lshlrev_b32 v32, 16, v42
    v_and_b32 v33, 0xffff0000, v42
    v_mul_f32 v32, v32, v41
    v_mul_f32 v33, v33, v41
    v_cvt_pk_bf16_f32 v42, v32, v33
    v_lshlrev_b32 v32, 16, v42
    v_and_b32 v33, 0xffff0000, v42
    v_cvt_pkrtz_f16_f32 v52, v32, v33
    v_sub_f32 v34, v34, v40
    v_sub_f32 v35, v35, v40
    v_cvt_pk_bf16_f32 v42, v34, v35
    v_lshlrev_b32 v34, 16, v42
    v_and_b32 v35, 0xffff0000, v42
    v_mul_f32 v34, v34, v41
    v_mul_f32 v35, v35, v41
    v_cvt_pk_bf16_f32 v42, v34, v35
    v_lshlrev_b32 v34, 16, v42
    v_and_b32 v35, 0xffff0000, v42
    v_cvt_pkrtz_f16_f32 v53, v34, v35
    v_sub_f32 v36, v36, v40
    v_sub_f32 v37, v37, v40
    v_cvt_pk_bf16_f32 v42, v36, v37
    v_lshlrev_b32 v36, 16, v42
    v_and_b32 v37, 0xffff0000, v42
    v_mul_f32 v36, v36, v41
    v_mul_f32 v37, v37, v41
    v_cvt_pk_bf16_f32 v42, v36, v37
    v_lshlrev_b32 v36, 16, v42
    v_and_b32 v37, 0xffff0000, v42
    v_cvt_pkrtz_f16_f32 v54, v36, v37
    v_sub_f32 v38, v38, v40
    v_sub_f32 v39, v39, v40
    v_cvt_pk_bf16_f32 v42, v38, v39
    v_lshlrev_b32 v38, 16, v42
    v_and_b32 v39, 0xffff0000, v42
    v_mul_f32 v38, v38, v41
    v_mul_f32 v39, v39, v41
    v_cvt_pk_bf16_f32 v42, v38, v39
    v_lshlrev_b32 v38, 16, v42
    v_and_b32 v39, 0xffff0000, v42
    v_cvt_pkrtz_f16_f32 v55, v38, v39
    s_mov_b32 s39, 164233216
    buffer_store_dwordx4 v[52:55], v10, s[8:11], s39 offen sc1
    s_waitcnt vmcnt(1)
    s_add_u32 s39, s38, 16384
    s_mov_b64 exec, 1
    buffer_store_dword v12, v11, s[8:11], s39 offen sc1
    s_mov_b64 exec, -1
    v_lshlrev_b32 v32, 16, v88
    v_and_b32 v33, 0xffff0000, v88
    v_lshlrev_b32 v34, 16, v89
    v_and_b32 v35, 0xffff0000, v89
    v_lshlrev_b32 v36, 16, v90
    v_and_b32 v37, 0xffff0000, v90
    v_lshlrev_b32 v38, 16, v91
    v_and_b32 v39, 0xffff0000, v91
    v_add_f32 v40, v32, v33
    v_mul_f32 v41, v32, v32
    v_fmac_f32 v41, v33, v33
    v_add_f32 v40, v40, v34
    v_fmac_f32 v41, v34, v34
    v_add_f32 v40, v40, v35
    v_fmac_f32 v41, v35, v35
    v_add_f32 v40, v40, v36
    v_fmac_f32 v41, v36, v36
    v_add_f32 v40, v40, v37
    v_fmac_f32 v41, v37, v37
    v_add_f32 v40, v40, v38
    v_fmac_f32 v41, v38, v38
    v_add_f32 v40, v40, v39
    v_fmac_f32 v41, v39, v39
    s_nop 0
    v_add_f32_dpp v40, v40, v40 quad_perm:[1,0,3,2] row_mask:0xf bank_mask:0xf
    v_add_f32_dpp v41, v41, v41 quad_perm:[1,0,3,2] row_mask:0xf bank_mask:0xf
    s_nop 0
    v_add_f32_dpp v40, v40, v40 quad_perm:[2,3,0,1] row_mask:0xf bank_mask:0xf
    v_add_f32_dpp v41, v41, v41 quad_perm:[2,3,0,1] row_mask:0xf bank_mask:0xf
    s_nop 0
    v_add_f32_dpp v40, v40, v40 row_half_mirror row_mask:0xf bank_mask:0xf
    v_add_f32_dpp v41, v41, v41 row_half_mirror row_mask:0xf bank_mask:0xf
    s_nop 0
    v_add_f32_dpp v40, v40, v40 row_mirror row_mask:0xf bank_mask:0xf
    v_add_f32_dpp v41, v41, v41 row_mirror row_mask:0xf bank_mask:0xf
    v_mov_b32 v42, v40
    v_mov_b32 v43, v41
    s_nop 0
    v_permlane16_swap_b32 v40, v42
    v_permlane16_swap_b32 v41, v43
    v_add_f32 v40, v40, v42
    v_add_f32 v41, v41, v43
    v_mov_b32 v42, v40
    v_mov_b32 v43, v41
    s_nop 0
    v_permlane32_swap_b32 v40, v42
    v_permlane32_swap_b32 v41, v43
    v_add_f32 v40, v40, v42
    v_add_f32 v41, v41, v43
    v_mul_f32 v40, 989855744, v40
    v_mul_f32 v41, 989855744, v41
    v_fma_f32 v41, -v40, v40, v41
    v_max_f32 v41, 0, v41
    v_cvt_pk_bf16_f32 v42, v40, v41
    v_lshlrev_b32 v40, 16, v42
    v_and_b32 v41, 0xffff0000, v42
    v_add_f32 v41, 925353388, v41
    v_cvt_pk_bf16_f32 v42, v41, v41
    v_lshlrev_b32 v41, 16, v42
    v_sqrt_f32 v41, v41
    s_nop 0
    v_cvt_pk_bf16_f32 v42, v41, v41
    v_lshlrev_b32 v41, 16, v42
    v_rcp_f32 v41, v41
    v_sub_f32 v32, v32, v40
    v_sub_f32 v33, v33, v40
    v_cvt_pk_bf16_f32 v42, v32, v33
    v_lshlrev_b32 v32, 16, v42
    v_and_b32 v33, 0xffff0000, v42
    v_mul_f32 v32, v32, v41
    v_mul_f32 v33, v33, v41
    v_cvt_pk_bf16_f32 v42, v32, v33
    v_lshlrev_b32 v32, 16, v42
    v_and_b32 v33, 0xffff0000, v42
    v_cvt_pkrtz_f16_f32 v48, v32, v33
    v_sub_f32 v34, v34, v40
    v_sub_f32 v35, v35, v40
    v_cvt_pk_bf16_f32 v42, v34, v35
    v_lshlrev_b32 v34, 16, v42
    v_and_b32 v35, 0xffff0000, v42
    v_mul_f32 v34, v34, v41
    v_mul_f32 v35, v35, v41
    v_cvt_pk_bf16_f32 v42, v34, v35
    v_lshlrev_b32 v34, 16, v42
    v_and_b32 v35, 0xffff0000, v42
    v_cvt_pkrtz_f16_f32 v49, v34, v35
    v_sub_f32 v36, v36, v40
    v_sub_f32 v37, v37, v40
    v_cvt_pk_bf16_f32 v42, v36, v37
    v_lshlrev_b32 v36, 16, v42
    v_and_b32 v37, 0xffff0000, v42
    v_mul_f32 v36, v36, v41
    v_mul_f32 v37, v37, v41
    v_cvt_pk_bf16_f32 v42, v36, v37
    v_lshlrev_b32 v36, 16, v42
    v_and_b32 v37, 0xffff0000, v42
    v_cvt_pkrtz_f16_f32 v50, v36, v37
    v_sub_f32 v38, v38, v40
    v_sub_f32 v39, v39, v40
    v_cvt_pk_bf16_f32 v42, v38, v39
    v_lshlrev_b32 v38, 16, v42
    v_and_b32 v39, 0xffff0000, v42
    v_mul_f32 v38, v38, v41
    v_mul_f32 v39, v39, v41
    v_cvt_pk_bf16_f32 v42, v38, v39
    v_lshlrev_b32 v38, 16, v42
    v_and_b32 v39, 0xffff0000, v42
    v_cvt_pkrtz_f16_f32 v51, v38, v39
    s_mov_b32 s39, 164364288
    buffer_store_dwordx4 v[48:51], v10, s[8:11], s39 offen sc1
    s_waitcnt vmcnt(1)
    s_add_u32 s39, s38, 20480
    s_mov_b64 exec, 1
    buffer_store_dword v12, v11, s[8:11], s39 offen sc1
    s_mov_b64 exec, -1
    v_lshlrev_b32 v32, 16, v92
    v_and_b32 v33, 0xffff0000, v92
    v_lshlrev_b32 v34, 16, v93
    v_and_b32 v35, 0xffff0000, v93
    v_lshlrev_b32 v36, 16, v94
    v_and_b32 v37, 0xffff0000, v94
    v_lshlrev_b32 v38, 16, v95
    v_and_b32 v39, 0xffff0000, v95
    v_add_f32 v40, v32, v33
    v_mul_f32 v41, v32, v32
    v_fmac_f32 v41, v33, v33
    v_add_f32 v40, v40, v34
    v_fmac_f32 v41, v34, v34
    v_add_f32 v40, v40, v35
    v_fmac_f32 v41, v35, v35
    v_add_f32 v40, v40, v36
    v_fmac_f32 v41, v36, v36
    v_add_f32 v40, v40, v37
    v_fmac_f32 v41, v37, v37
    v_add_f32 v40, v40, v38
    v_fmac_f32 v41, v38, v38
    v_add_f32 v40, v40, v39
    v_fmac_f32 v41, v39, v39
    s_nop 0
    v_add_f32_dpp v40, v40, v40 quad_perm:[1,0,3,2] row_mask:0xf bank_mask:0xf
    v_add_f32_dpp v41, v41, v41 quad_perm:[1,0,3,2] row_mask:0xf bank_mask:0xf
    s_nop 0
    v_add_f32_dpp v40, v40, v40 quad_perm:[2,3,0,1] row_mask:0xf bank_mask:0xf
    v_add_f32_dpp v41, v41, v41 quad_perm:[2,3,0,1] row_mask:0xf bank_mask:0xf
    s_nop 0
    v_add_f32_dpp v40, v40, v40 row_half_mirror row_mask:0xf bank_mask:0xf
    v_add_f32_dpp v41, v41, v41 row_half_mirror row_mask:0xf bank_mask:0xf
    s_nop 0
    v_add_f32_dpp v40, v40, v40 row_mirror row_mask:0xf bank_mask:0xf
    v_add_f32_dpp v41, v41, v41 row_mirror row_mask:0xf bank_mask:0xf
    v_mov_b32 v42, v40
    v_mov_b32 v43, v41
    s_nop 0
    v_permlane16_swap_b32 v40, v42
    v_permlane16_swap_b32 v41, v43
    v_add_f32 v40, v40, v42
    v_add_f32 v41, v41, v43
    v_mov_b32 v42, v40
    v_mov_b32 v43, v41
    s_nop 0
    v_permlane32_swap_b32 v40, v42
    v_permlane32_swap_b32 v41, v43
    v_add_f32 v40, v40, v42
    v_add_f32 v41, v41, v43
    v_mul_f32 v40, 989855744, v40
    v_mul_f32 v41, 989855744, v41
    v_fma_f32 v41, -v40, v40, v41
    v_max_f32 v41, 0, v41
    v_cvt_pk_bf16_f32 v42, v40, v41
    v_lshlrev_b32 v40, 16, v42
    v_and_b32 v41, 0xffff0000, v42
    v_add_f32 v41, 925353388, v41
    v_cvt_pk_bf16_f32 v42, v41, v41
    v_lshlrev_b32 v41, 16, v42
    v_sqrt_f32 v41, v41
    s_nop 0
    v_cvt_pk_bf16_f32 v42, v41, v41
    v_lshlrev_b32 v41, 16, v42
    v_rcp_f32 v41, v41
    v_sub_f32 v32, v32, v40
    v_sub_f32 v33, v33, v40
    v_cvt_pk_bf16_f32 v42, v32, v33
    v_lshlrev_b32 v32, 16, v42
    v_and_b32 v33, 0xffff0000, v42
    v_mul_f32 v32, v32, v41
    v_mul_f32 v33, v33, v41
    v_cvt_pk_bf16_f32 v42, v32, v33
    v_lshlrev_b32 v32, 16, v42
    v_and_b32 v33, 0xffff0000, v42
    v_cvt_pkrtz_f16_f32 v52, v32, v33
    v_sub_f32 v34, v34, v40
    v_sub_f32 v35, v35, v40
    v_cvt_pk_bf16_f32 v42, v34, v35
    v_lshlrev_b32 v34, 16, v42
    v_and_b32 v35, 0xffff0000, v42
    v_mul_f32 v34, v34, v41
    v_mul_f32 v35, v35, v41
    v_cvt_pk_bf16_f32 v42, v34, v35
    v_lshlrev_b32 v34, 16, v42
    v_and_b32 v35, 0xffff0000, v42
    v_cvt_pkrtz_f16_f32 v53, v34, v35
    v_sub_f32 v36, v36, v40
    v_sub_f32 v37, v37, v40
    v_cvt_pk_bf16_f32 v42, v36, v37
    v_lshlrev_b32 v36, 16, v42
    v_and_b32 v37, 0xffff0000, v42
    v_mul_f32 v36, v36, v41
    v_mul_f32 v37, v37, v41
    v_cvt_pk_bf16_f32 v42, v36, v37
    v_lshlrev_b32 v36, 16, v42
    v_and_b32 v37, 0xffff0000, v42
    v_cvt_pkrtz_f16_f32 v54, v36, v37
    v_sub_f32 v38, v38, v40
    v_sub_f32 v39, v39, v40
    v_cvt_pk_bf16_f32 v42, v38, v39
    v_lshlrev_b32 v38, 16, v42
    v_and_b32 v39, 0xffff0000, v42
    v_mul_f32 v38, v38, v41
    v_mul_f32 v39, v39, v41
    v_cvt_pk_bf16_f32 v42, v38, v39
    v_lshlrev_b32 v38, 16, v42
    v_and_b32 v39, 0xffff0000, v42
    v_cvt_pkrtz_f16_f32 v55, v38, v39
    s_mov_b32 s39, 164495360
    buffer_store_dwordx4 v[52:55], v10, s[8:11], s39 offen sc1
    s_waitcnt vmcnt(1)
    s_add_u32 s39, s38, 24576
    s_mov_b64 exec, 1
    buffer_store_dword v12, v11, s[8:11], s39 offen sc1
    s_mov_b64 exec, -1
    v_lshlrev_b32 v32, 16, v96
    v_and_b32 v33, 0xffff0000, v96
    v_lshlrev_b32 v34, 16, v97
    v_and_b32 v35, 0xffff0000, v97
    v_lshlrev_b32 v36, 16, v98
    v_and_b32 v37, 0xffff0000, v98
    v_lshlrev_b32 v38, 16, v99
    v_and_b32 v39, 0xffff0000, v99
    v_add_f32 v40, v32, v33
    v_mul_f32 v41, v32, v32
    v_fmac_f32 v41, v33, v33
    v_add_f32 v40, v40, v34
    v_fmac_f32 v41, v34, v34
    v_add_f32 v40, v40, v35
    v_fmac_f32 v41, v35, v35
    v_add_f32 v40, v40, v36
    v_fmac_f32 v41, v36, v36
    v_add_f32 v40, v40, v37
    v_fmac_f32 v41, v37, v37
    v_add_f32 v40, v40, v38
    v_fmac_f32 v41, v38, v38
    v_add_f32 v40, v40, v39
    v_fmac_f32 v41, v39, v39
    s_nop 0
    v_add_f32_dpp v40, v40, v40 quad_perm:[1,0,3,2] row_mask:0xf bank_mask:0xf
    v_add_f32_dpp v41, v41, v41 quad_perm:[1,0,3,2] row_mask:0xf bank_mask:0xf
    s_nop 0
    v_add_f32_dpp v40, v40, v40 quad_perm:[2,3,0,1] row_mask:0xf bank_mask:0xf
    v_add_f32_dpp v41, v41, v41 quad_perm:[2,3,0,1] row_mask:0xf bank_mask:0xf
    s_nop 0
    v_add_f32_dpp v40, v40, v40 row_half_mirror row_mask:0xf bank_mask:0xf
    v_add_f32_dpp v41, v41, v41 row_half_mirror row_mask:0xf bank_mask:0xf
    s_nop 0
    v_add_f32_dpp v40, v40, v40 row_mirror row_mask:0xf bank_mask:0xf
    v_add_f32_dpp v41, v41, v41 row_mirror row_mask:0xf bank_mask:0xf
    v_mov_b32 v42, v40
    v_mov_b32 v43, v41
    s_nop 0
    v_permlane16_swap_b32 v40, v42
    v_permlane16_swap_b32 v41, v43
    v_add_f32 v40, v40, v42
    v_add_f32 v41, v41, v43
    v_mov_b32 v42, v40
    v_mov_b32 v43, v41
    s_nop 0
    v_permlane32_swap_b32 v40, v42
    v_permlane32_swap_b32 v41, v43
    v_add_f32 v40, v40, v42
    v_add_f32 v41, v41, v43
    v_mul_f32 v40, 989855744, v40
    v_mul_f32 v41, 989855744, v41
    v_fma_f32 v41, -v40, v40, v41
    v_max_f32 v41, 0, v41
    v_cvt_pk_bf16_f32 v42, v40, v41
    v_lshlrev_b32 v40, 16, v42
    v_and_b32 v41, 0xffff0000, v42
    v_add_f32 v41, 925353388, v41
    v_cvt_pk_bf16_f32 v42, v41, v41
    v_lshlrev_b32 v41, 16, v42
    v_sqrt_f32 v41, v41
    s_nop 0
    v_cvt_pk_bf16_f32 v42, v41, v41
    v_lshlrev_b32 v41, 16, v42
    v_rcp_f32 v41, v41
    v_sub_f32 v32, v32, v40
    v_sub_f32 v33, v33, v40
    v_cvt_pk_bf16_f32 v42, v32, v33
    v_lshlrev_b32 v32, 16, v42
    v_and_b32 v33, 0xffff0000, v42
    v_mul_f32 v32, v32, v41
    v_mul_f32 v33, v33, v41
    v_cvt_pk_bf16_f32 v42, v32, v33
    v_lshlrev_b32 v32, 16, v42
    v_and_b32 v33, 0xffff0000, v42
    v_cvt_pkrtz_f16_f32 v48, v32, v33
    v_sub_f32 v34, v34, v40
    v_sub_f32 v35, v35, v40
    v_cvt_pk_bf16_f32 v42, v34, v35
    v_lshlrev_b32 v34, 16, v42
    v_and_b32 v35, 0xffff0000, v42
    v_mul_f32 v34, v34, v41
    v_mul_f32 v35, v35, v41
    v_cvt_pk_bf16_f32 v42, v34, v35
    v_lshlrev_b32 v34, 16, v42
    v_and_b32 v35, 0xffff0000, v42
    v_cvt_pkrtz_f16_f32 v49, v34, v35
    v_sub_f32 v36, v36, v40
    v_sub_f32 v37, v37, v40
    v_cvt_pk_bf16_f32 v42, v36, v37
    v_lshlrev_b32 v36, 16, v42
    v_and_b32 v37, 0xffff0000, v42
    v_mul_f32 v36, v36, v41
    v_mul_f32 v37, v37, v41
    v_cvt_pk_bf16_f32 v42, v36, v37
    v_lshlrev_b32 v36, 16, v42
    v_and_b32 v37, 0xffff0000, v42
    v_cvt_pkrtz_f16_f32 v50, v36, v37
    v_sub_f32 v38, v38, v40
    v_sub_f32 v39, v39, v40
    v_cvt_pk_bf16_f32 v42, v38, v39
    v_lshlrev_b32 v38, 16, v42
    v_and_b32 v39, 0xffff0000, v42
    v_mul_f32 v38, v38, v41
    v_mul_f32 v39, v39, v41
    v_cvt_pk_bf16_f32 v42, v38, v39
    v_lshlrev_b32 v38, 16, v42
    v_and_b32 v39, 0xffff0000, v42
    v_cvt_pkrtz_f16_f32 v51, v38, v39
    s_mov_b32 s39, 164626432
    buffer_store_dwordx4 v[48:51], v10, s[8:11], s39 offen sc1
    s_waitcnt vmcnt(1)
    s_add_u32 s39, s38, 28672
    s_mov_b64 exec, 1
    buffer_store_dword v12, v11, s[8:11], s39 offen sc1
    s_mov_b64 exec, -1
    v_lshlrev_b32 v32, 16, v100
    v_and_b32 v33, 0xffff0000, v100
    v_lshlrev_b32 v34, 16, v101
    v_and_b32 v35, 0xffff0000, v101
    v_lshlrev_b32 v36, 16, v102
    v_and_b32 v37, 0xffff0000, v102
    v_lshlrev_b32 v38, 16, v103
    v_and_b32 v39, 0xffff0000, v103
    v_add_f32 v40, v32, v33
    v_mul_f32 v41, v32, v32
    v_fmac_f32 v41, v33, v33
    v_add_f32 v40, v40, v34
    v_fmac_f32 v41, v34, v34
    v_add_f32 v40, v40, v35
    v_fmac_f32 v41, v35, v35
    v_add_f32 v40, v40, v36
    v_fmac_f32 v41, v36, v36
    v_add_f32 v40, v40, v37
    v_fmac_f32 v41, v37, v37
    v_add_f32 v40, v40, v38
    v_fmac_f32 v41, v38, v38
    v_add_f32 v40, v40, v39
    v_fmac_f32 v41, v39, v39
    s_nop 0
    v_add_f32_dpp v40, v40, v40 quad_perm:[1,0,3,2] row_mask:0xf bank_mask:0xf
    v_add_f32_dpp v41, v41, v41 quad_perm:[1,0,3,2] row_mask:0xf bank_mask:0xf
    s_nop 0
    v_add_f32_dpp v40, v40, v40 quad_perm:[2,3,0,1] row_mask:0xf bank_mask:0xf
    v_add_f32_dpp v41, v41, v41 quad_perm:[2,3,0,1] row_mask:0xf bank_mask:0xf
    s_nop 0
    v_add_f32_dpp v40, v40, v40 row_half_mirror row_mask:0xf bank_mask:0xf
    v_add_f32_dpp v41, v41, v41 row_half_mirror row_mask:0xf bank_mask:0xf
    s_nop 0
    v_add_f32_dpp v40, v40, v40 row_mirror row_mask:0xf bank_mask:0xf
    v_add_f32_dpp v41, v41, v41 row_mirror row_mask:0xf bank_mask:0xf
    v_mov_b32 v42, v40
    v_mov_b32 v43, v41
    s_nop 0
    v_permlane16_swap_b32 v40, v42
    v_permlane16_swap_b32 v41, v43
    v_add_f32 v40, v40, v42
    v_add_f32 v41, v41, v43
    v_mov_b32 v42, v40
    v_mov_b32 v43, v41
    s_nop 0
    v_permlane32_swap_b32 v40, v42
    v_permlane32_swap_b32 v41, v43
    v_add_f32 v40, v40, v42
    v_add_f32 v41, v41, v43
    v_mul_f32 v40, 989855744, v40
    v_mul_f32 v41, 989855744, v41
    v_fma_f32 v41, -v40, v40, v41
    v_max_f32 v41, 0, v41
    v_cvt_pk_bf16_f32 v42, v40, v41
    v_lshlrev_b32 v40, 16, v42
    v_and_b32 v41, 0xffff0000, v42
    v_add_f32 v41, 925353388, v41
    v_cvt_pk_bf16_f32 v42, v41, v41
    v_lshlrev_b32 v41, 16, v42
    v_sqrt_f32 v41, v41
    s_nop 0
    v_cvt_pk_bf16_f32 v42, v41, v41
    v_lshlrev_b32 v41, 16, v42
    v_rcp_f32 v41, v41
    v_sub_f32 v32, v32, v40
    v_sub_f32 v33, v33, v40
    v_cvt_pk_bf16_f32 v42, v32, v33
    v_lshlrev_b32 v32, 16, v42
    v_and_b32 v33, 0xffff0000, v42
    v_mul_f32 v32, v32, v41
    v_mul_f32 v33, v33, v41
    v_cvt_pk_bf16_f32 v42, v32, v33
    v_lshlrev_b32 v32, 16, v42
    v_and_b32 v33, 0xffff0000, v42
    v_cvt_pkrtz_f16_f32 v52, v32, v33
    v_sub_f32 v34, v34, v40
    v_sub_f32 v35, v35, v40
    v_cvt_pk_bf16_f32 v42, v34, v35
    v_lshlrev_b32 v34, 16, v42
    v_and_b32 v35, 0xffff0000, v42
    v_mul_f32 v34, v34, v41
    v_mul_f32 v35, v35, v41
    v_cvt_pk_bf16_f32 v42, v34, v35
    v_lshlrev_b32 v34, 16, v42
    v_and_b32 v35, 0xffff0000, v42
    v_cvt_pkrtz_f16_f32 v53, v34, v35
    v_sub_f32 v36, v36, v40
    v_sub_f32 v37, v37, v40
    v_cvt_pk_bf16_f32 v42, v36, v37
    v_lshlrev_b32 v36, 16, v42
    v_and_b32 v37, 0xffff0000, v42
    v_mul_f32 v36, v36, v41
    v_mul_f32 v37, v37, v41
    v_cvt_pk_bf16_f32 v42, v36, v37
    v_lshlrev_b32 v36, 16, v42
    v_and_b32 v37, 0xffff0000, v42
    v_cvt_pkrtz_f16_f32 v54, v36, v37
    v_sub_f32 v38, v38, v40
    v_sub_f32 v39, v39, v40
    v_cvt_pk_bf16_f32 v42, v38, v39
    v_lshlrev_b32 v38, 16, v42
    v_and_b32 v39, 0xffff0000, v42
    v_mul_f32 v38, v38, v41
    v_mul_f32 v39, v39, v41
    v_cvt_pk_bf16_f32 v42, v38, v39
    v_lshlrev_b32 v38, 16, v42
    v_and_b32 v39, 0xffff0000, v42
    v_cvt_pkrtz_f16_f32 v55, v38, v39
    s_mov_b32 s39, 164757504
    buffer_store_dwordx4 v[52:55], v10, s[8:11], s39 offen sc1
    s_waitcnt vmcnt(1)
    s_add_u32 s39, s38, 32768
    s_mov_b64 exec, 1
    buffer_store_dword v12, v11, s[8:11], s39 offen sc1
    s_mov_b64 exec, -1
    v_lshlrev_b32 v32, 16, v104
    v_and_b32 v33, 0xffff0000, v104
    v_lshlrev_b32 v34, 16, v105
    v_and_b32 v35, 0xffff0000, v105
    v_lshlrev_b32 v36, 16, v106
    v_and_b32 v37, 0xffff0000, v106
    v_lshlrev_b32 v38, 16, v107
    v_and_b32 v39, 0xffff0000, v107
    v_add_f32 v40, v32, v33
    v_mul_f32 v41, v32, v32
    v_fmac_f32 v41, v33, v33
    v_add_f32 v40, v40, v34
    v_fmac_f32 v41, v34, v34
    v_add_f32 v40, v40, v35
    v_fmac_f32 v41, v35, v35
    v_add_f32 v40, v40, v36
    v_fmac_f32 v41, v36, v36
    v_add_f32 v40, v40, v37
    v_fmac_f32 v41, v37, v37
    v_add_f32 v40, v40, v38
    v_fmac_f32 v41, v38, v38
    v_add_f32 v40, v40, v39
    v_fmac_f32 v41, v39, v39
    s_nop 0
    v_add_f32_dpp v40, v40, v40 quad_perm:[1,0,3,2] row_mask:0xf bank_mask:0xf
    v_add_f32_dpp v41, v41, v41 quad_perm:[1,0,3,2] row_mask:0xf bank_mask:0xf
    s_nop 0
    v_add_f32_dpp v40, v40, v40 quad_perm:[2,3,0,1] row_mask:0xf bank_mask:0xf
    v_add_f32_dpp v41, v41, v41 quad_perm:[2,3,0,1] row_mask:0xf bank_mask:0xf
    s_nop 0
    v_add_f32_dpp v40, v40, v40 row_half_mirror row_mask:0xf bank_mask:0xf
    v_add_f32_dpp v41, v41, v41 row_half_mirror row_mask:0xf bank_mask:0xf
    s_nop 0
    v_add_f32_dpp v40, v40, v40 row_mirror row_mask:0xf bank_mask:0xf
    v_add_f32_dpp v41, v41, v41 row_mirror row_mask:0xf bank_mask:0xf
    v_mov_b32 v42, v40
    v_mov_b32 v43, v41
    s_nop 0
    v_permlane16_swap_b32 v40, v42
    v_permlane16_swap_b32 v41, v43
    v_add_f32 v40, v40, v42
    v_add_f32 v41, v41, v43
    v_mov_b32 v42, v40
    v_mov_b32 v43, v41
    s_nop 0
    v_permlane32_swap_b32 v40, v42
    v_permlane32_swap_b32 v41, v43
    v_add_f32 v40, v40, v42
    v_add_f32 v41, v41, v43
    v_mul_f32 v40, 989855744, v40
    v_mul_f32 v41, 989855744, v41
    v_fma_f32 v41, -v40, v40, v41
    v_max_f32 v41, 0, v41
    v_cvt_pk_bf16_f32 v42, v40, v41
    v_lshlrev_b32 v40, 16, v42
    v_and_b32 v41, 0xffff0000, v42
    v_add_f32 v41, 925353388, v41
    v_cvt_pk_bf16_f32 v42, v41, v41
    v_lshlrev_b32 v41, 16, v42
    v_sqrt_f32 v41, v41
    s_nop 0
    v_cvt_pk_bf16_f32 v42, v41, v41
    v_lshlrev_b32 v41, 16, v42
    v_rcp_f32 v41, v41
    v_sub_f32 v32, v32, v40
    v_sub_f32 v33, v33, v40
    v_cvt_pk_bf16_f32 v42, v32, v33
    v_lshlrev_b32 v32, 16, v42
    v_and_b32 v33, 0xffff0000, v42
    v_mul_f32 v32, v32, v41
    v_mul_f32 v33, v33, v41
    v_cvt_pk_bf16_f32 v42, v32, v33
    v_lshlrev_b32 v32, 16, v42
    v_and_b32 v33, 0xffff0000, v42
    v_cvt_pkrtz_f16_f32 v48, v32, v33
    v_sub_f32 v34, v34, v40
    v_sub_f32 v35, v35, v40
    v_cvt_pk_bf16_f32 v42, v34, v35
    v_lshlrev_b32 v34, 16, v42
    v_and_b32 v35, 0xffff0000, v42
    v_mul_f32 v34, v34, v41
    v_mul_f32 v35, v35, v41
    v_cvt_pk_bf16_f32 v42, v34, v35
    v_lshlrev_b32 v34, 16, v42
    v_and_b32 v35, 0xffff0000, v42
    v_cvt_pkrtz_f16_f32 v49, v34, v35
    v_sub_f32 v36, v36, v40
    v_sub_f32 v37, v37, v40
    v_cvt_pk_bf16_f32 v42, v36, v37
    v_lshlrev_b32 v36, 16, v42
    v_and_b32 v37, 0xffff0000, v42
    v_mul_f32 v36, v36, v41
    v_mul_f32 v37, v37, v41
    v_cvt_pk_bf16_f32 v42, v36, v37
    v_lshlrev_b32 v36, 16, v42
    v_and_b32 v37, 0xffff0000, v42
    v_cvt_pkrtz_f16_f32 v50, v36, v37
    v_sub_f32 v38, v38, v40
    v_sub_f32 v39, v39, v40
    v_cvt_pk_bf16_f32 v42, v38, v39
    v_lshlrev_b32 v38, 16, v42
    v_and_b32 v39, 0xffff0000, v42
    v_mul_f32 v38, v38, v41
    v_mul_f32 v39, v39, v41
    v_cvt_pk_bf16_f32 v42, v38, v39
    v_lshlrev_b32 v38, 16, v42
    v_and_b32 v39, 0xffff0000, v42
    v_cvt_pkrtz_f16_f32 v51, v38, v39
    s_mov_b32 s39, 164888576
    buffer_store_dwordx4 v[48:51], v10, s[8:11], s39 offen sc1
    s_waitcnt vmcnt(1)
    s_add_u32 s39, s38, 36864
    s_mov_b64 exec, 1
    buffer_store_dword v12, v11, s[8:11], s39 offen sc1
    s_mov_b64 exec, -1
    v_lshlrev_b32 v32, 16, v108
    v_and_b32 v33, 0xffff0000, v108
    v_lshlrev_b32 v34, 16, v109
    v_and_b32 v35, 0xffff0000, v109
    v_lshlrev_b32 v36, 16, v110
    v_and_b32 v37, 0xffff0000, v110
    v_lshlrev_b32 v38, 16, v111
    v_and_b32 v39, 0xffff0000, v111
    v_add_f32 v40, v32, v33
    v_mul_f32 v41, v32, v32
    v_fmac_f32 v41, v33, v33
    v_add_f32 v40, v40, v34
    v_fmac_f32 v41, v34, v34
    v_add_f32 v40, v40, v35
    v_fmac_f32 v41, v35, v35
    v_add_f32 v40, v40, v36
    v_fmac_f32 v41, v36, v36
    v_add_f32 v40, v40, v37
    v_fmac_f32 v41, v37, v37
    v_add_f32 v40, v40, v38
    v_fmac_f32 v41, v38, v38
    v_add_f32 v40, v40, v39
    v_fmac_f32 v41, v39, v39
    s_nop 0
    v_add_f32_dpp v40, v40, v40 quad_perm:[1,0,3,2] row_mask:0xf bank_mask:0xf
    v_add_f32_dpp v41, v41, v41 quad_perm:[1,0,3,2] row_mask:0xf bank_mask:0xf
    s_nop 0
    v_add_f32_dpp v40, v40, v40 quad_perm:[2,3,0,1] row_mask:0xf bank_mask:0xf
    v_add_f32_dpp v41, v41, v41 quad_perm:[2,3,0,1] row_mask:0xf bank_mask:0xf
    s_nop 0
    v_add_f32_dpp v40, v40, v40 row_half_mirror row_mask:0xf bank_mask:0xf
    v_add_f32_dpp v41, v41, v41 row_half_mirror row_mask:0xf bank_mask:0xf
    s_nop 0
    v_add_f32_dpp v40, v40, v40 row_mirror row_mask:0xf bank_mask:0xf
    v_add_f32_dpp v41, v41, v41 row_mirror row_mask:0xf bank_mask:0xf
    v_mov_b32 v42, v40
    v_mov_b32 v43, v41
    s_nop 0
    v_permlane16_swap_b32 v40, v42
    v_permlane16_swap_b32 v41, v43
    v_add_f32 v40, v40, v42
    v_add_f32 v41, v41, v43
    v_mov_b32 v42, v40
    v_mov_b32 v43, v41
    s_nop 0
    v_permlane32_swap_b32 v40, v42
    v_permlane32_swap_b32 v41, v43
    v_add_f32 v40, v40, v42
    v_add_f32 v41, v41, v43
    v_mul_f32 v40, 989855744, v40
    v_mul_f32 v41, 989855744, v41
    v_fma_f32 v41, -v40, v40, v41
    v_max_f32 v41, 0, v41
    v_cvt_pk_bf16_f32 v42, v40, v41
    v_lshlrev_b32 v40, 16, v42
    v_and_b32 v41, 0xffff0000, v42
    v_add_f32 v41, 925353388, v41
    v_cvt_pk_bf16_f32 v42, v41, v41
    v_lshlrev_b32 v41, 16, v42
    v_sqrt_f32 v41, v41
    s_nop 0
    v_cvt_pk_bf16_f32 v42, v41, v41
    v_lshlrev_b32 v41, 16, v42
    v_rcp_f32 v41, v41
    v_sub_f32 v32, v32, v40
    v_sub_f32 v33, v33, v40
    v_cvt_pk_bf16_f32 v42, v32, v33
    v_lshlrev_b32 v32, 16, v42
    v_and_b32 v33, 0xffff0000, v42
    v_mul_f32 v32, v32, v41
    v_mul_f32 v33, v33, v41
    v_cvt_pk_bf16_f32 v42, v32, v33
    v_lshlrev_b32 v32, 16, v42
    v_and_b32 v33, 0xffff0000, v42
    v_cvt_pkrtz_f16_f32 v52, v32, v33
    v_sub_f32 v34, v34, v40
    v_sub_f32 v35, v35, v40
    v_cvt_pk_bf16_f32 v42, v34, v35
    v_lshlrev_b32 v34, 16, v42
    v_and_b32 v35, 0xffff0000, v42
    v_mul_f32 v34, v34, v41
    v_mul_f32 v35, v35, v41
    v_cvt_pk_bf16_f32 v42, v34, v35
    v_lshlrev_b32 v34, 16, v42
    v_and_b32 v35, 0xffff0000, v42
    v_cvt_pkrtz_f16_f32 v53, v34, v35
    v_sub_f32 v36, v36, v40
    v_sub_f32 v37, v37, v40
    v_cvt_pk_bf16_f32 v42, v36, v37
    v_lshlrev_b32 v36, 16, v42
    v_and_b32 v37, 0xffff0000, v42
    v_mul_f32 v36, v36, v41
    v_mul_f32 v37, v37, v41
    v_cvt_pk_bf16_f32 v42, v36, v37
    v_lshlrev_b32 v36, 16, v42
    v_and_b32 v37, 0xffff0000, v42
    v_cvt_pkrtz_f16_f32 v54, v36, v37
    v_sub_f32 v38, v38, v40
    v_sub_f32 v39, v39, v40
    v_cvt_pk_bf16_f32 v42, v38, v39
    v_lshlrev_b32 v38, 16, v42
    v_and_b32 v39, 0xffff0000, v42
    v_mul_f32 v38, v38, v41
    v_mul_f32 v39, v39, v41
    v_cvt_pk_bf16_f32 v42, v38, v39
    v_lshlrev_b32 v38, 16, v42
    v_and_b32 v39, 0xffff0000, v42
    v_cvt_pkrtz_f16_f32 v55, v38, v39
    s_mov_b32 s39, 165019648
    buffer_store_dwordx4 v[52:55], v10, s[8:11], s39 offen sc1
    s_waitcnt vmcnt(1)
    s_add_u32 s39, s38, 40960
    s_mov_b64 exec, 1
    buffer_store_dword v12, v11, s[8:11], s39 offen sc1
    s_mov_b64 exec, -1
    v_lshlrev_b32 v32, 16, v112
    v_and_b32 v33, 0xffff0000, v112
    v_lshlrev_b32 v34, 16, v113
    v_and_b32 v35, 0xffff0000, v113
    v_lshlrev_b32 v36, 16, v114
    v_and_b32 v37, 0xffff0000, v114
    v_lshlrev_b32 v38, 16, v115
    v_and_b32 v39, 0xffff0000, v115
    v_add_f32 v40, v32, v33
    v_mul_f32 v41, v32, v32
    v_fmac_f32 v41, v33, v33
    v_add_f32 v40, v40, v34
    v_fmac_f32 v41, v34, v34
    v_add_f32 v40, v40, v35
    v_fmac_f32 v41, v35, v35
    v_add_f32 v40, v40, v36
    v_fmac_f32 v41, v36, v36
    v_add_f32 v40, v40, v37
    v_fmac_f32 v41, v37, v37
    v_add_f32 v40, v40, v38
    v_fmac_f32 v41, v38, v38
    v_add_f32 v40, v40, v39
    v_fmac_f32 v41, v39, v39
    s_nop 0
    v_add_f32_dpp v40, v40, v40 quad_perm:[1,0,3,2] row_mask:0xf bank_mask:0xf
    v_add_f32_dpp v41, v41, v41 quad_perm:[1,0,3,2] row_mask:0xf bank_mask:0xf
    s_nop 0
    v_add_f32_dpp v40, v40, v40 quad_perm:[2,3,0,1] row_mask:0xf bank_mask:0xf
    v_add_f32_dpp v41, v41, v41 quad_perm:[2,3,0,1] row_mask:0xf bank_mask:0xf
    s_nop 0
    v_add_f32_dpp v40, v40, v40 row_half_mirror row_mask:0xf bank_mask:0xf
    v_add_f32_dpp v41, v41, v41 row_half_mirror row_mask:0xf bank_mask:0xf
    s_nop 0
    v_add_f32_dpp v40, v40, v40 row_mirror row_mask:0xf bank_mask:0xf
    v_add_f32_dpp v41, v41, v41 row_mirror row_mask:0xf bank_mask:0xf
    v_mov_b32 v42, v40
    v_mov_b32 v43, v41
    s_nop 0
    v_permlane16_swap_b32 v40, v42
    v_permlane16_swap_b32 v41, v43
    v_add_f32 v40, v40, v42
    v_add_f32 v41, v41, v43
    v_mov_b32 v42, v40
    v_mov_b32 v43, v41
    s_nop 0
    v_permlane32_swap_b32 v40, v42
    v_permlane32_swap_b32 v41, v43
    v_add_f32 v40, v40, v42
    v_add_f32 v41, v41, v43
    v_mul_f32 v40, 989855744, v40
    v_mul_f32 v41, 989855744, v41
    v_fma_f32 v41, -v40, v40, v41
    v_max_f32 v41, 0, v41
    v_cvt_pk_bf16_f32 v42, v40, v41
    v_lshlrev_b32 v40, 16, v42
    v_and_b32 v41, 0xffff0000, v42
    v_add_f32 v41, 925353388, v41
    v_cvt_pk_bf16_f32 v42, v41, v41
    v_lshlrev_b32 v41, 16, v42
    v_sqrt_f32 v41, v41
    s_nop 0
    v_cvt_pk_bf16_f32 v42, v41, v41
    v_lshlrev_b32 v41, 16, v42
    v_rcp_f32 v41, v41
    v_sub_f32 v32, v32, v40
    v_sub_f32 v33, v33, v40
    v_cvt_pk_bf16_f32 v42, v32, v33
    v_lshlrev_b32 v32, 16, v42
    v_and_b32 v33, 0xffff0000, v42
    v_mul_f32 v32, v32, v41
    v_mul_f32 v33, v33, v41
    v_cvt_pk_bf16_f32 v42, v32, v33
    v_lshlrev_b32 v32, 16, v42
    v_and_b32 v33, 0xffff0000, v42
    v_cvt_pkrtz_f16_f32 v48, v32, v33
    v_sub_f32 v34, v34, v40
    v_sub_f32 v35, v35, v40
    v_cvt_pk_bf16_f32 v42, v34, v35
    v_lshlrev_b32 v34, 16, v42
    v_and_b32 v35, 0xffff0000, v42
    v_mul_f32 v34, v34, v41
    v_mul_f32 v35, v35, v41
    v_cvt_pk_bf16_f32 v42, v34, v35
    v_lshlrev_b32 v34, 16, v42
    v_and_b32 v35, 0xffff0000, v42
    v_cvt_pkrtz_f16_f32 v49, v34, v35
    v_sub_f32 v36, v36, v40
    v_sub_f32 v37, v37, v40
    v_cvt_pk_bf16_f32 v42, v36, v37
    v_lshlrev_b32 v36, 16, v42
    v_and_b32 v37, 0xffff0000, v42
    v_mul_f32 v36, v36, v41
    v_mul_f32 v37, v37, v41
    v_cvt_pk_bf16_f32 v42, v36, v37
    v_lshlrev_b32 v36, 16, v42
    v_and_b32 v37, 0xffff0000, v42
    v_cvt_pkrtz_f16_f32 v50, v36, v37
    v_sub_f32 v38, v38, v40
    v_sub_f32 v39, v39, v40
    v_cvt_pk_bf16_f32 v42, v38, v39
    v_lshlrev_b32 v38, 16, v42
    v_and_b32 v39, 0xffff0000, v42
    v_mul_f32 v38, v38, v41
    v_mul_f32 v39, v39, v41
    v_cvt_pk_bf16_f32 v42, v38, v39
    v_lshlrev_b32 v38, 16, v42
    v_and_b32 v39, 0xffff0000, v42
    v_cvt_pkrtz_f16_f32 v51, v38, v39
    s_mov_b32 s39, 165150720
    buffer_store_dwordx4 v[48:51], v10, s[8:11], s39 offen sc1
    s_waitcnt vmcnt(1)
    s_add_u32 s39, s38, 45056
    s_mov_b64 exec, 1
    buffer_store_dword v12, v11, s[8:11], s39 offen sc1
    s_mov_b64 exec, -1
    v_lshlrev_b32 v32, 16, v116
    v_and_b32 v33, 0xffff0000, v116
    v_lshlrev_b32 v34, 16, v117
    v_and_b32 v35, 0xffff0000, v117
    v_lshlrev_b32 v36, 16, v118
    v_and_b32 v37, 0xffff0000, v118
    v_lshlrev_b32 v38, 16, v119
    v_and_b32 v39, 0xffff0000, v119
    v_add_f32 v40, v32, v33
    v_mul_f32 v41, v32, v32
    v_fmac_f32 v41, v33, v33
    v_add_f32 v40, v40, v34
    v_fmac_f32 v41, v34, v34
    v_add_f32 v40, v40, v35
    v_fmac_f32 v41, v35, v35
    v_add_f32 v40, v40, v36
    v_fmac_f32 v41, v36, v36
    v_add_f32 v40, v40, v37
    v_fmac_f32 v41, v37, v37
    v_add_f32 v40, v40, v38
    v_fmac_f32 v41, v38, v38
    v_add_f32 v40, v40, v39
    v_fmac_f32 v41, v39, v39
    s_nop 0
    v_add_f32_dpp v40, v40, v40 quad_perm:[1,0,3,2] row_mask:0xf bank_mask:0xf
    v_add_f32_dpp v41, v41, v41 quad_perm:[1,0,3,2] row_mask:0xf bank_mask:0xf
    s_nop 0
    v_add_f32_dpp v40, v40, v40 quad_perm:[2,3,0,1] row_mask:0xf bank_mask:0xf
    v_add_f32_dpp v41, v41, v41 quad_perm:[2,3,0,1] row_mask:0xf bank_mask:0xf
    s_nop 0
    v_add_f32_dpp v40, v40, v40 row_half_mirror row_mask:0xf bank_mask:0xf
    v_add_f32_dpp v41, v41, v41 row_half_mirror row_mask:0xf bank_mask:0xf
    s_nop 0
    v_add_f32_dpp v40, v40, v40 row_mirror row_mask:0xf bank_mask:0xf
    v_add_f32_dpp v41, v41, v41 row_mirror row_mask:0xf bank_mask:0xf
    v_mov_b32 v42, v40
    v_mov_b32 v43, v41
    s_nop 0
    v_permlane16_swap_b32 v40, v42
    v_permlane16_swap_b32 v41, v43
    v_add_f32 v40, v40, v42
    v_add_f32 v41, v41, v43
    v_mov_b32 v42, v40
    v_mov_b32 v43, v41
    s_nop 0
    v_permlane32_swap_b32 v40, v42
    v_permlane32_swap_b32 v41, v43
    v_add_f32 v40, v40, v42
    v_add_f32 v41, v41, v43
    v_mul_f32 v40, 989855744, v40
    v_mul_f32 v41, 989855744, v41
    v_fma_f32 v41, -v40, v40, v41
    v_max_f32 v41, 0, v41
    v_cvt_pk_bf16_f32 v42, v40, v41
    v_lshlrev_b32 v40, 16, v42
    v_and_b32 v41, 0xffff0000, v42
    v_add_f32 v41, 925353388, v41
    v_cvt_pk_bf16_f32 v42, v41, v41
    v_lshlrev_b32 v41, 16, v42
    v_sqrt_f32 v41, v41
    s_nop 0
    v_cvt_pk_bf16_f32 v42, v41, v41
    v_lshlrev_b32 v41, 16, v42
    v_rcp_f32 v41, v41
    v_sub_f32 v32, v32, v40
    v_sub_f32 v33, v33, v40
    v_cvt_pk_bf16_f32 v42, v32, v33
    v_lshlrev_b32 v32, 16, v42
    v_and_b32 v33, 0xffff0000, v42
    v_mul_f32 v32, v32, v41
    v_mul_f32 v33, v33, v41
    v_cvt_pk_bf16_f32 v42, v32, v33
    v_lshlrev_b32 v32, 16, v42
    v_and_b32 v33, 0xffff0000, v42
    v_cvt_pkrtz_f16_f32 v52, v32, v33
    v_sub_f32 v34, v34, v40
    v_sub_f32 v35, v35, v40
    v_cvt_pk_bf16_f32 v42, v34, v35
    v_lshlrev_b32 v34, 16, v42
    v_and_b32 v35, 0xffff0000, v42
    v_mul_f32 v34, v34, v41
    v_mul_f32 v35, v35, v41
    v_cvt_pk_bf16_f32 v42, v34, v35
    v_lshlrev_b32 v34, 16, v42
    v_and_b32 v35, 0xffff0000, v42
    v_cvt_pkrtz_f16_f32 v53, v34, v35
    v_sub_f32 v36, v36, v40
    v_sub_f32 v37, v37, v40
    v_cvt_pk_bf16_f32 v42, v36, v37
    v_lshlrev_b32 v36, 16, v42
    v_and_b32 v37, 0xffff0000, v42
    v_mul_f32 v36, v36, v41
    v_mul_f32 v37, v37, v41
    v_cvt_pk_bf16_f32 v42, v36, v37
    v_lshlrev_b32 v36, 16, v42
    v_and_b32 v37, 0xffff0000, v42
    v_cvt_pkrtz_f16_f32 v54, v36, v37
    v_sub_f32 v38, v38, v40
    v_sub_f32 v39, v39, v40
    v_cvt_pk_bf16_f32 v42, v38, v39
    v_lshlrev_b32 v38, 16, v42
    v_and_b32 v39, 0xffff0000, v42
    v_mul_f32 v38, v38, v41
    v_mul_f32 v39, v39, v41
    v_cvt_pk_bf16_f32 v42, v38, v39
    v_lshlrev_b32 v38, 16, v42
    v_and_b32 v39, 0xffff0000, v42
    v_cvt_pkrtz_f16_f32 v55, v38, v39
    s_mov_b32 s39, 165281792
    buffer_store_dwordx4 v[52:55], v10, s[8:11], s39 offen sc1
    s_waitcnt vmcnt(1)
    s_add_u32 s39, s38, 49152
    s_mov_b64 exec, 1
    buffer_store_dword v12, v11, s[8:11], s39 offen sc1
    s_mov_b64 exec, -1
    v_lshlrev_b32 v32, 16, v120
    v_and_b32 v33, 0xffff0000, v120
    v_lshlrev_b32 v34, 16, v121
    v_and_b32 v35, 0xffff0000, v121
    v_lshlrev_b32 v36, 16, v122
    v_and_b32 v37, 0xffff0000, v122
    v_lshlrev_b32 v38, 16, v123
    v_and_b32 v39, 0xffff0000, v123
    v_add_f32 v40, v32, v33
    v_mul_f32 v41, v32, v32
    v_fmac_f32 v41, v33, v33
    v_add_f32 v40, v40, v34
    v_fmac_f32 v41, v34, v34
    v_add_f32 v40, v40, v35
    v_fmac_f32 v41, v35, v35
    v_add_f32 v40, v40, v36
    v_fmac_f32 v41, v36, v36
    v_add_f32 v40, v40, v37
    v_fmac_f32 v41, v37, v37
    v_add_f32 v40, v40, v38
    v_fmac_f32 v41, v38, v38
    v_add_f32 v40, v40, v39
    v_fmac_f32 v41, v39, v39
    s_nop 0
    v_add_f32_dpp v40, v40, v40 quad_perm:[1,0,3,2] row_mask:0xf bank_mask:0xf
    v_add_f32_dpp v41, v41, v41 quad_perm:[1,0,3,2] row_mask:0xf bank_mask:0xf
    s_nop 0
    v_add_f32_dpp v40, v40, v40 quad_perm:[2,3,0,1] row_mask:0xf bank_mask:0xf
    v_add_f32_dpp v41, v41, v41 quad_perm:[2,3,0,1] row_mask:0xf bank_mask:0xf
    s_nop 0
    v_add_f32_dpp v40, v40, v40 row_half_mirror row_mask:0xf bank_mask:0xf
    v_add_f32_dpp v41, v41, v41 row_half_mirror row_mask:0xf bank_mask:0xf
    s_nop 0
    v_add_f32_dpp v40, v40, v40 row_mirror row_mask:0xf bank_mask:0xf
    v_add_f32_dpp v41, v41, v41 row_mirror row_mask:0xf bank_mask:0xf
    v_mov_b32 v42, v40
    v_mov_b32 v43, v41
    s_nop 0
    v_permlane16_swap_b32 v40, v42
    v_permlane16_swap_b32 v41, v43
    v_add_f32 v40, v40, v42
    v_add_f32 v41, v41, v43
    v_mov_b32 v42, v40
    v_mov_b32 v43, v41
    s_nop 0
    v_permlane32_swap_b32 v40, v42
    v_permlane32_swap_b32 v41, v43
    v_add_f32 v40, v40, v42
    v_add_f32 v41, v41, v43
    v_mul_f32 v40, 989855744, v40
    v_mul_f32 v41, 989855744, v41
    v_fma_f32 v41, -v40, v40, v41
    v_max_f32 v41, 0, v41
    v_cvt_pk_bf16_f32 v42, v40, v41
    v_lshlrev_b32 v40, 16, v42
    v_and_b32 v41, 0xffff0000, v42
    v_add_f32 v41, 925353388, v41
    v_cvt_pk_bf16_f32 v42, v41, v41
    v_lshlrev_b32 v41, 16, v42
    v_sqrt_f32 v41, v41
    s_nop 0
    v_cvt_pk_bf16_f32 v42, v41, v41
    v_lshlrev_b32 v41, 16, v42
    v_rcp_f32 v41, v41
    v_sub_f32 v32, v32, v40
    v_sub_f32 v33, v33, v40
    v_cvt_pk_bf16_f32 v42, v32, v33
    v_lshlrev_b32 v32, 16, v42
    v_and_b32 v33, 0xffff0000, v42
    v_mul_f32 v32, v32, v41
    v_mul_f32 v33, v33, v41
    v_cvt_pk_bf16_f32 v42, v32, v33
    v_lshlrev_b32 v32, 16, v42
    v_and_b32 v33, 0xffff0000, v42
    v_cvt_pkrtz_f16_f32 v48, v32, v33
    v_sub_f32 v34, v34, v40
    v_sub_f32 v35, v35, v40
    v_cvt_pk_bf16_f32 v42, v34, v35
    v_lshlrev_b32 v34, 16, v42
    v_and_b32 v35, 0xffff0000, v42
    v_mul_f32 v34, v34, v41
    v_mul_f32 v35, v35, v41
    v_cvt_pk_bf16_f32 v42, v34, v35
    v_lshlrev_b32 v34, 16, v42
    v_and_b32 v35, 0xffff0000, v42
    v_cvt_pkrtz_f16_f32 v49, v34, v35
    v_sub_f32 v36, v36, v40
    v_sub_f32 v37, v37, v40
    v_cvt_pk_bf16_f32 v42, v36, v37
    v_lshlrev_b32 v36, 16, v42
    v_and_b32 v37, 0xffff0000, v42
    v_mul_f32 v36, v36, v41
    v_mul_f32 v37, v37, v41
    v_cvt_pk_bf16_f32 v42, v36, v37
    v_lshlrev_b32 v36, 16, v42
    v_and_b32 v37, 0xffff0000, v42
    v_cvt_pkrtz_f16_f32 v50, v36, v37
    v_sub_f32 v38, v38, v40
    v_sub_f32 v39, v39, v40
    v_cvt_pk_bf16_f32 v42, v38, v39
    v_lshlrev_b32 v38, 16, v42
    v_and_b32 v39, 0xffff0000, v42
    v_mul_f32 v38, v38, v41
    v_mul_f32 v39, v39, v41
    v_cvt_pk_bf16_f32 v42, v38, v39
    v_lshlrev_b32 v38, 16, v42
    v_and_b32 v39, 0xffff0000, v42
    v_cvt_pkrtz_f16_f32 v51, v38, v39
    s_mov_b32 s39, 165412864
    buffer_store_dwordx4 v[48:51], v10, s[8:11], s39 offen sc1
    s_waitcnt vmcnt(1)
    s_add_u32 s39, s38, 53248
    s_mov_b64 exec, 1
    buffer_store_dword v12, v11, s[8:11], s39 offen sc1
    s_mov_b64 exec, -1
    v_lshlrev_b32 v32, 16, v124
    v_and_b32 v33, 0xffff0000, v124
    v_lshlrev_b32 v34, 16, v125
    v_and_b32 v35, 0xffff0000, v125
    v_lshlrev_b32 v36, 16, v126
    v_and_b32 v37, 0xffff0000, v126
    v_lshlrev_b32 v38, 16, v127
    v_and_b32 v39, 0xffff0000, v127
    v_add_f32 v40, v32, v33
    v_mul_f32 v41, v32, v32
    v_fmac_f32 v41, v33, v33
    v_add_f32 v40, v40, v34
    v_fmac_f32 v41, v34, v34
    v_add_f32 v40, v40, v35
    v_fmac_f32 v41, v35, v35
    v_add_f32 v40, v40, v36
    v_fmac_f32 v41, v36, v36
    v_add_f32 v40, v40, v37
    v_fmac_f32 v41, v37, v37
    v_add_f32 v40, v40, v38
    v_fmac_f32 v41, v38, v38
    v_add_f32 v40, v40, v39
    v_fmac_f32 v41, v39, v39
    s_nop 0
    v_add_f32_dpp v40, v40, v40 quad_perm:[1,0,3,2] row_mask:0xf bank_mask:0xf
    v_add_f32_dpp v41, v41, v41 quad_perm:[1,0,3,2] row_mask:0xf bank_mask:0xf
    s_nop 0
    v_add_f32_dpp v40, v40, v40 quad_perm:[2,3,0,1] row_mask:0xf bank_mask:0xf
    v_add_f32_dpp v41, v41, v41 quad_perm:[2,3,0,1] row_mask:0xf bank_mask:0xf
    s_nop 0
    v_add_f32_dpp v40, v40, v40 row_half_mirror row_mask:0xf bank_mask:0xf
    v_add_f32_dpp v41, v41, v41 row_half_mirror row_mask:0xf bank_mask:0xf
    s_nop 0
    v_add_f32_dpp v40, v40, v40 row_mirror row_mask:0xf bank_mask:0xf
    v_add_f32_dpp v41, v41, v41 row_mirror row_mask:0xf bank_mask:0xf
    v_mov_b32 v42, v40
    v_mov_b32 v43, v41
    s_nop 0
    v_permlane16_swap_b32 v40, v42
    v_permlane16_swap_b32 v41, v43
    v_add_f32 v40, v40, v42
    v_add_f32 v41, v41, v43
    v_mov_b32 v42, v40
    v_mov_b32 v43, v41
    s_nop 0
    v_permlane32_swap_b32 v40, v42
    v_permlane32_swap_b32 v41, v43
    v_add_f32 v40, v40, v42
    v_add_f32 v41, v41, v43
    v_mul_f32 v40, 989855744, v40
    v_mul_f32 v41, 989855744, v41
    v_fma_f32 v41, -v40, v40, v41
    v_max_f32 v41, 0, v41
    v_cvt_pk_bf16_f32 v42, v40, v41
    v_lshlrev_b32 v40, 16, v42
    v_and_b32 v41, 0xffff0000, v42
    v_add_f32 v41, 925353388, v41
    v_cvt_pk_bf16_f32 v42, v41, v41
    v_lshlrev_b32 v41, 16, v42
    v_sqrt_f32 v41, v41
    s_nop 0
    v_cvt_pk_bf16_f32 v42, v41, v41
    v_lshlrev_b32 v41, 16, v42
    v_rcp_f32 v41, v41
    v_sub_f32 v32, v32, v40
    v_sub_f32 v33, v33, v40
    v_cvt_pk_bf16_f32 v42, v32, v33
    v_lshlrev_b32 v32, 16, v42
    v_and_b32 v33, 0xffff0000, v42
    v_mul_f32 v32, v32, v41
    v_mul_f32 v33, v33, v41
    v_cvt_pk_bf16_f32 v42, v32, v33
    v_lshlrev_b32 v32, 16, v42
    v_and_b32 v33, 0xffff0000, v42
    v_cvt_pkrtz_f16_f32 v52, v32, v33
    v_sub_f32 v34, v34, v40
    v_sub_f32 v35, v35, v40
    v_cvt_pk_bf16_f32 v42, v34, v35
    v_lshlrev_b32 v34, 16, v42
    v_and_b32 v35, 0xffff0000, v42
    v_mul_f32 v34, v34, v41
    v_mul_f32 v35, v35, v41
    v_cvt_pk_bf16_f32 v42, v34, v35
    v_lshlrev_b32 v34, 16, v42
    v_and_b32 v35, 0xffff0000, v42
    v_cvt_pkrtz_f16_f32 v53, v34, v35
    v_sub_f32 v36, v36, v40
    v_sub_f32 v37, v37, v40
    v_cvt_pk_bf16_f32 v42, v36, v37
    v_lshlrev_b32 v36, 16, v42
    v_and_b32 v37, 0xffff0000, v42
    v_mul_f32 v36, v36, v41
    v_mul_f32 v37, v37, v41
    v_cvt_pk_bf16_f32 v42, v36, v37
    v_lshlrev_b32 v36, 16, v42
    v_and_b32 v37, 0xffff0000, v42
    v_cvt_pkrtz_f16_f32 v54, v36, v37
    v_sub_f32 v38, v38, v40
    v_sub_f32 v39, v39, v40
    v_cvt_pk_bf16_f32 v42, v38, v39
    v_lshlrev_b32 v38, 16, v42
    v_and_b32 v39, 0xffff0000, v42
    v_mul_f32 v38, v38, v41
    v_mul_f32 v39, v39, v41
    v_cvt_pk_bf16_f32 v42, v38, v39
    v_lshlrev_b32 v38, 16, v42
    v_and_b32 v39, 0xffff0000, v42
    v_cvt_pkrtz_f16_f32 v55, v38, v39
    s_mov_b32 s39, 165543936
    buffer_store_dwordx4 v[52:55], v10, s[8:11], s39 offen sc1
    s_waitcnt vmcnt(1)
    s_add_u32 s39, s38, 57344
    s_mov_b64 exec, 1
    buffer_store_dword v12, v11, s[8:11], s39 offen sc1
    s_mov_b64 exec, -1
    s_waitcnt vmcnt(0)
    s_add_u32 s39, s38, 61440
    s_mov_b64 exec, 1
    buffer_store_dword v12, v11, s[8:11], s39 offen sc1
    s_mov_b64 exec, -1
L_noln:
    s_add_u32 s33, s4, 8
    s_bitcmp1_b32 s7, s33
    s_cbranch_scc0 L_end
    s_and_b32 s6, s4, 1
    s_cmp_lt_u32 s4, 2
    s_cbranch_scc1 L_rec
    s_cmp_lt_u32 s4, 2
    s_cbranch_scc1 L_end
    s_cmp_lt_u32 s4, 5
    s_cbranch_scc1 L_proj
    s_cmp_lt_u32 s4, 5
    s_cbranch_scc1 L_end
    s_cmp_lt_u32 s4, 7
    s_cbranch_scc1 L_o
    s_cmp_eq_u32 s4, 7
    s_cbranch_scc1 L_conv
    s_branch L_end
L_rec:
    s_cmp_eq_u32 s6, 0
    s_cbranch_scc1 L_rec_lw
    s_bitcmp1_b32 s7, 15
    s_cbranch_scc0 L_rec_lw
    s_cmp_ge_i32 s63, 0
    s_cbranch_scc1 Lanns_13
    v_and_b32 v16, 63, v0
    v_lshlrev_b32 v16, 2, v16
Lann_11:
    buffer_load_dword v17, v16, s[12:15], 0 offen sc1
Lannc_14:
    s_waitcnt vmcnt(0)
    v_and_b32 v19, 0x0f0f0f0f, v17
    v_subrev_u32 v18, 0x01010101, v19
    v_and_b32 v18, 0x80808080, v18
    v_cmp_ne_u32 vcc, 0, v18
    s_nop 0
    s_cbranch_vccz Lannd_12
    s_sub_u32 s62, s62, 1
    s_cbranch_scc0 Ltok_15
    s_movk_i32 s61, 1
    s_branch L_abort
Ltok_15:
    s_sleep 4
    s_branch Lann_11
Lannd_12:
    s_getreg_b32 s32, hwreg(HW_REG_XCC_ID)
    s_and_b32 s32, s32, 15
    s_min_u32 s32, s32, 14
    s_add_u32 s32, s32, 1
    s_mul_i32 s32, s32, 0x11111111
    v_cmp_ne_u32 vcc, s32, v17
    s_not_b32 s33, s63
    s_lshl_b32 s33, s33, 3
    s_lshr_b64 s[34:35], vcc, s33
    s_and_b32 s34, s34, 0xff
    s_cmp_lg_u32 s34, 0
    s_cselect_b32 s63, 1, 0
Lanns_13:
    v_and_b32 v16, 63, v0
    v_lshlrev_b32 v16, 5, v16
    s_mov_b32 s32, 5242880
L_rec_lwp:
    s_sleep 8
    buffer_load_dword v17, v16, s[8:11], s32 offen sc1
    s_sub_u32 s62, s62, 1
    s_cbranch_scc0 Ltok_16
    s_movk_i32 s61, 6
    s_branch L_abort
Ltok_16:
    s_waitcnt vmcnt(0)
    v_cmp_eq_u32 vcc, 0, v17
    s_nop 0
    s_cbranch_vccnz L_rec_lwp
L_rec_lw:
    s_mov_b32 s16, s82
    s_and_b32 s17, s83, 0xffff
    s_mov_b32 s18, 4194304
    s_mov_b32 s19, 0x20000
    s_mov_b32 s20, s84
    s_and_b32 s21, s85, 0xffff
    s_mov_b32 s22, 4194304
    s_mov_b32 s23, 0x20000
    s_mov_b32 s24, s86
    s_and_b32 s25, s87, 0xffff
    s_mov_b32 s26, 4194304
    s_mov_b32 s27, 0x20000
    s_mov_b32 s28, s88
    s_and_b32 s29, s89, 0xffff
    s_mov_b32 s30, 4194304
    s_mov_b32 s31, 0x20000
    v_and_b32 v9, 63, v0
    v_and_b32 v10, 15, v9
    v_lshrrev_b32 v11, 4, v9
    s_mov_b32 s59, 0x05040100
    s_mov_b32 s60, 0x07060302
    v_and_b32 v12, 1, v11
    v_lshlrev_b32 v12, 17, v12
    v_lshrrev_b32 v13, 1, v11
    v_lshl_add_u32 v12, v13, 14, v12
    v_lshlrev_b32 v13, 2, v10
    v_add_u32 v12, v12, v13
    s_lshl_b32 s32, s5, 8
    s_lshl_b32 s33, s3, 6
    s_add_u32 s32, s32, s33
    v_add_u32 v12, s32, v12
    s_lshl_b32 s34, s3, 20
    v_lshlrev_b32 v13, 12, v11
    v_lshlrev_b32 v14, 4, v10
    v_add_u32 v13, v13, v14
    s_lshl_b32 s32, s5, 17
    s_lshl_b32 s33, s3, 8
    s_add_u32 s32, s32, s33
    v_add_u32 v13, s32, v13
    v_lshlrev_b32 v5, 4, v9
    s_lshl_b32 s32, s3, 15
    s_add_u32 s32, s32, 29696
    v_add_u32 v4, s32, v5
    s_xor_b32 s35, s34, 0
    s_add_u32 s32, s35, 0
    buffer_load_dword v16, v12, s[16:19], s32 offen
    s_add_u32 s32, s35, 8192
    buffer_load_dword v17, v12, s[16:19], s32 offen
    s_add_u32 s32, s35, 65536
    buffer_load_dword v18, v12, s[16:19], s32 offen
    s_add_u32 s32, s35, 73728
    buffer_load_dword v19, v12, s[16:19], s32 offen
    s_add_u32 s32, s35, 32768
    buffer_load_dword v20, v12, s[16:19], s32 offen
    s_add_u32 s32, s35, 40960
    buffer_load_dword v21, v12, s[16:19], s32 offen
    s_add_u32 s32, s35, 98304
    buffer_load_dword v22, v12, s[16:19], s32 offen
    s_add_u32 s32, s35, 106496
    buffer_load_dword v23, v12, s[16:19], s32 offen
    s_add_u32 s32, s35, 262144
    buffer_load_dword v24, v12, s[16:19], s32 offen
    s_add_u32 s32, s35, 270336
    buffer_load_dword v25, v12, s[16:19], s32 offen
    s_add_u32 s32, s35, 327680
    buffer_load_dword v26, v12, s[16:19], s32 offen
    s_add_u32 s32, s35, 335872
    buffer_load_dword v27, v12, s[16:19], s32 offen
    s_add_u32 s32, s35, 294912
    buffer_load_dword v28, v12, s[16:19], s32 offen
    s_add_u32 s32, s35, 303104
    buffer_load_dword v29, v12, s[16:19], s32 offen
    s_add_u32 s32, s35, 360448
    buffer_load_dword v30, v12, s[16:19], s32 offen
    s_add_u32 s32, s35, 368640
    buffer_load_dword v31, v12, s[16:19], s32 offen
    s_add_u32 s32, s35, 524288
    buffer_load_dword v32, v12, s[16:19], s32 offen
    s_add_u32 s32, s35, 532480
    buffer_load_dword v33, v12, s[16:19], s32 offen
    s_add_u32 s32, s35, 589824
    buffer_load_dword v34, v12, s[16:19], s32 offen
    s_add_u32 s32, s35, 598016
    buffer_load_dword v35, v12, s[16:19], s32 offen
    s_add_u32 s32, s35, 557056
    buffer_load_dword v36, v12, s[16:19], s32 offen
    s_add_u32 s32, s35, 565248
    buffer_load_dword v37, v12, s[16:19], s32 offen
    s_add_u32 s32, s35, 622592
    buffer_load_dword v38, v12, s[16:19], s32 offen
    s_add_u32 s32, s35, 630784
    buffer_load_dword v39, v12, s[16:19], s32 offen
    s_add_u32 s32, s35, 786432
    buffer_load_dword v40, v12, s[16:19], s32 offen
    s_add_u32 s32, s35, 794624
    buffer_load_dword v41, v12, s[16:19], s32 offen
    s_add_u32 s32, s35, 851968
    buffer_load_dword v42, v12, s[16:19], s32 offen
    s_add_u32 s32, s35, 860160
    buffer_load_dword v43, v12, s[16:19], s32 offen
    s_add_u32 s32, s35, 819200
    buffer_load_dword v44, v12, s[16:19], s32 offen
    s_add_u32 s32, s35, 827392
    buffer_load_dword v45, v12, s[16:19], s32 offen
    s_add_u32 s32, s35, 884736
    buffer_load_dword v46, v12, s[16:19], s32 offen
    s_add_u32 s32, s35, 892928
    buffer_load_dword v47, v12, s[16:19], s32 offen
    s_xor_b32 s35, s34, 1048576
    s_add_u32 s32, s35, 0
    buffer_load_dword v48, v12, s[16:19], s32 offen
    s_add_u32 s32, s35, 8192
    buffer_load_dword v49, v12, s[16:19], s32 offen
    s_add_u32 s32, s35, 65536
    buffer_load_dword v50, v12, s[16:19], s32 offen
    s_add_u32 s32, s35, 73728
    buffer_load_dword v51, v12, s[16:19], s32 offen
    s_add_u32 s32, s35, 32768
    buffer_load_dword v52, v12, s[16:19], s32 offen
    s_add_u32 s32, s35, 40960
    buffer_load_dword v53, v12, s[16:19], s32 offen
    s_add_u32 s32, s35, 98304
    buffer_load_dword v54, v12, s[16:19], s32 offen
    s_add_u32 s32, s35, 106496
    buffer_load_dword v55, v12, s[16:19], s32 offen
    s_add_u32 s32, s35, 262144
    buffer_load_dword v56, v12, s[16:19], s32 offen
    s_add_u32 s32, s35, 270336
    buffer_load_dword v57, v12, s[16:19], s32 offen
    s_add_u32 s32, s35, 327680
    buffer_load_dword v58, v12, s[16:19], s32 offen
    s_add_u32 s32, s35, 335872
    buffer_load_dword v59, v12, s[16:19], s32 offen
    s_add_u32 s32, s35, 294912
    buffer_load_dword v60, v12, s[16:19], s32 offen
    s_add_u32 s32, s35, 303104
    buffer_load_dword v61, v12, s[16:19], s32 offen
    s_add_u32 s32, s35, 360448
    buffer_load_dword v62, v12, s[16:19], s32 offen
    s_add_u32 s32, s35, 368640
    buffer_load_dword v63, v12, s[16:19], s32 offen
    s_add_u32 s32, s35, 524288
    buffer_load_dword v64, v12, s[16:19], s32 offen
    s_add_u32 s32, s35, 532480
    buffer_load_dword v65, v12, s[16:19], s32 offen
    s_add_u32 s32, s35, 589824
    buffer_load_dword v66, v12, s[16:19], s32 offen
    s_add_u32 s32, s35, 598016
    buffer_load_dword v67, v12, s[16:19], s32 offen
    s_add_u32 s32, s35, 557056
    buffer_load_dword v68, v12, s[16:19], s32 offen
    s_add_u32 s32, s35, 565248
    buffer_load_dword v69, v12, s[16:19], s32 offen
    s_add_u32 s32, s35, 622592
    buffer_load_dword v70, v12, s[16:19], s32 offen
    s_add_u32 s32, s35, 630784
    buffer_load_dword v71, v12, s[16:19], s32 offen
    s_add_u32 s32, s35, 786432
    buffer_load_dword v72, v12, s[16:19], s32 offen
    s_add_u32 s32, s35, 794624
    buffer_load_dword v73, v12, s[16:19], s32 offen
    s_add_u32 s32, s35, 851968
    buffer_load_dword v74, v12, s[16:19], s32 offen
    s_add_u32 s32, s35, 860160
    buffer_load_dword v75, v12, s[16:19], s32 offen
    s_add_u32 s32, s35, 819200
    buffer_load_dword v76, v12, s[16:19], s32 offen
    s_add_u32 s32, s35, 827392
    buffer_load_dword v77, v12, s[16:19], s32 offen
    s_add_u32 s32, s35, 884736
    buffer_load_dword v78, v12, s[16:19], s32 offen
    s_add_u32 s32, s35, 892928
    buffer_load_dword v79, v12, s[16:19], s32 offen
    s_waitcnt vmcnt(62)
    v_perm_b32 v112, v17, v16, s59
    s_waitcnt vmcnt(58)
    v_perm_b32 v113, v21, v20, s59
    v_perm_b32 v114, v19, v18, s59
    s_waitcnt vmcnt(56)
    v_perm_b32 v115, v23, v22, s59
    s_waitcnt vmcnt(54)
    v_perm_b32 v116, v25, v24, s59
    s_waitcnt vmcnt(50)
    v_perm_b32 v117, v29, v28, s59
    v_perm_b32 v118, v27, v26, s59
    s_waitcnt vmcnt(48)
    v_perm_b32 v119, v31, v30, s59
    ds_write_b128 v4, v[112:115] offset:0
    ds_write_b128 v4, v[116:119] offset:1024
    v_perm_b32 v120, v17, v16, s60
    v_perm_b32 v121, v21, v20, s60
    v_perm_b32 v122, v19, v18, s60
    v_perm_b32 v123, v23, v22, s60
    v_perm_b32 v124, v25, v24, s60
    v_perm_b32 v125, v29, v28, s60
    v_perm_b32 v126, v27, v26, s60
    v_perm_b32 v127, v31, v30, s60
    ds_write_b128 v4, v[120:123] offset:2048
    ds_write_b128 v4, v[124:127] offset:3072
    s_waitcnt vmcnt(46)
    v_perm_b32 v112, v33, v32, s59
    s_waitcnt vmcnt(42)
    v_perm_b32 v113, v37, v36, s59
    v_perm_b32 v114, v35, v34, s59
    s_waitcnt vmcnt(40)
    v_perm_b32 v115, v39, v38, s59
    s_waitcnt vmcnt(38)
    v_perm_b32 v116, v41, v40, s59
    s_waitcnt vmcnt(34)
    v_perm_b32 v117, v45, v44, s59
    v_perm_b32 v118, v43, v42, s59
    s_waitcnt vmcnt(32)
    v_perm_b32 v119, v47, v46, s59
    ds_write_b128 v4, v[112:115] offset:12288
    ds_write_b128 v4, v[116:119] offset:13312
    v_perm_b32 v120, v33, v32, s60
    v_perm_b32 v121, v37, v36, s60
    v_perm_b32 v122, v35, v34, s60
    v_perm_b32 v123, v39, v38, s60
    v_perm_b32 v124, v41, v40, s60
    v_perm_b32 v125, v45, v44, s60
    v_perm_b32 v126, v43, v42, s60
    v_perm_b32 v127, v47, v46, s60
    ds_write_b128 v4, v[120:123] offset:14336
    ds_write_b128 v4, v[124:127] offset:15360
    s_xor_b32 s35, s34, 2097152
    s_add_u32 s32, s35, 0
    buffer_load_dword v80, v12, s[16:19], s32 offen
    s_add_u32 s32, s35, 8192
    buffer_load_dword v81, v12, s[16:19], s32 offen
    s_add_u32 s32, s35, 65536
    buffer_load_dword v82, v12, s[16:19], s32 offen
    s_add_u32 s32, s35, 73728
    buffer_load_dword v83, v12, s[16:19], s32 offen
    s_add_u32 s32, s35, 32768
    buffer_load_dword v84, v12, s[16:19], s32 offen
    s_add_u32 s32, s35, 40960
    buffer_load_dword v85, v12, s[16:19], s32 offen
    s_add_u32 s32, s35, 98304
    buffer_load_dword v86, v12, s[16:19], s32 offen
    s_add_u32 s32, s35, 106496
    buffer_load_dword v87, v12, s[16:19], s32 offen
    s_add_u32 s32, s35, 262144
    buffer_load_dword v88, v12, s[16:19], s32 offen
    s_add_u32 s32, s35, 270336
    buffer_load_dword v89, v12, s[16:19], s32 offen
    s_add_u32 s32, s35, 327680
    buffer_load_dword v90, v12, s[16:19], s32 offen
    s_add_u32 s32, s35, 335872
    buffer_load_dword v91, v12, s[16:19], s32 offen
    s_add_u32 s32, s35, 294912
    buffer_load_dword v92, v12, s[16:19], s32 offen
    s_add_u32 s32, s35, 303104
    buffer_load_dword v93, v12, s[16:19], s32 offen
    s_add_u32 s32, s35, 360448
    buffer_load_dword v94, v12, s[16:19], s32 offen
    s_add_u32 s32, s35, 368640
    buffer_load_dword v95, v12, s[16:19], s32 offen
    s_add_u32 s32, s35, 524288
    buffer_load_dword v96, v12, s[16:19], s32 offen
    s_add_u32 s32, s35, 532480
    buffer_load_dword v97, v12, s[16:19], s32 offen
    s_add_u32 s32, s35, 589824
    buffer_load_dword v98, v12, s[16:19], s32 offen
    s_add_u32 s32, s35, 598016
    buffer_load_dword v99, v12, s[16:19], s32 offen
    s_add_u32 s32, s35, 557056
    buffer_load_dword v100, v12, s[16:19], s32 offen
    s_add_u32 s32, s35, 565248
    buffer_load_dword v101, v12, s[16:19], s32 offen
    s_add_u32 s32, s35, 622592
    buffer_load_dword v102, v12, s[16:19], s32 offen
    s_add_u32 s32, s35, 630784
    buffer_load_dword v103, v12, s[16:19], s32 offen
    s_add_u32 s32, s35, 786432
    buffer_load_dword v104, v12, s[16:19], s32 offen
    s_add_u32 s32, s35, 794624
    buffer_load_dword v105, v12, s[16:19], s32 offen
    s_add_u32 s32, s35, 851968
    buffer_load_dword v106, v12, s[16:19], s32 offen
    s_add_u32 s32, s35, 860160
    buffer_load_dword v107, v12, s[16:19], s32 offen
    s_add_u32 s32, s35, 819200
    buffer_load_dword v108, v12, s[16:19], s32 offen
    s_add_u32 s32, s35, 827392
    buffer_load_dword v109, v12, s[16:19], s32 offen
    s_add_u32 s32, s35, 884736
    buffer_load_dword v110, v12, s[16:19], s32 offen
    s_add_u32 s32, s35, 892928
    buffer_load_dword v111, v12, s[16:19], s32 offen
    s_waitcnt vmcnt(62)
    v_perm_b32 v112, v49, v48, s59
    s_waitcnt vmcnt(58)
    v_perm_b32 v113, v53, v52, s59
    v_perm_b32 v114, v51, v50, s59
    s_waitcnt vmcnt(56)
    v_perm_b32 v115, v55, v54, s59
    s_waitcnt vmcnt(54)
    v_perm_b32 v116, v57, v56, s59
    s_waitcnt vmcnt(50)
    v_perm_b32 v117, v61, v60, s59
    v_perm_b32 v118, v59, v58, s59
    s_waitcnt vmcnt(48)
    v_perm_b32 v119, v63, v62, s59
    v_accvgpr_write_b32 a112, v112
    v_accvgpr_write_b32 a113, v113
    v_accvgpr_write_b32 a114, v114
    v_accvgpr_write_b32 a115, v115
    v_accvgpr_write_b32 a116, v116
    v_accvgpr_write_b32 a117, v117
    v_accvgpr_write_b32 a118, v118
    v_accvgpr_write_b32 a119, v119
    v_perm_b32 v120, v49, v48, s60
    v_perm_b32 v121, v53, v52, s60
    v_perm_b32 v122, v51, v50, s60
    v_perm_b32 v123, v55, v54, s60
    v_perm_b32 v124, v57, v56, s60
    v_perm_b32 v125, v61, v60, s60
    v_perm_b32 v126, v59, v58, s60
    v_perm_b32 v127, v63, v62, s60
    v_accvgpr_write_b32 a120, v120
    v_accvgpr_write_b32 a121, v121
    v_accvgpr_write_b32 a122, v122
    v_accvgpr_write_b32 a123, v123
    v_accvgpr_write_b32 a124, v124
    v_accvgpr_write_b32 a125, v125
    v_accvgpr_write_b32 a126, v126
    v_accvgpr_write_b32 a127, v127
    s_waitcnt vmcnt(46)
    v_perm_b32 v112, v65, v64, s59
    s_waitcnt vmcnt(42)
    v_perm_b32 v113, v69, v68, s59
    v_perm_b32 v114, v67, v66, s59
    s_waitcnt vmcnt(40)
    v_perm_b32 v115, v71, v70, s59
    s_waitcnt vmcnt(38)
    v_perm_b32 v116, v73, v72, s59
    s_waitcnt vmcnt(34)
    v_perm_b32 v117, v77, v76, s59
    v_perm_b32 v118, v75, v74, s59
    s_waitcnt vmcnt(32)
    v_perm_b32 v119, v79, v78, s59
    v_accvgpr_write_b32 a128, v112
    v_accvgpr_write_b32 a129, v113
    v_accvgpr_write_b32 a130, v114
    v_accvgpr_write_b32 a131, v115
    v_accvgpr_write_b32 a132, v116
    v_accvgpr_write_b32 a133, v117
    v_accvgpr_write_b32 a134, v118
    v_accvgpr_write_b32 a135, v119
    v_perm_b32 v120, v65, v64, s60
    v_perm_b32 v121, v69, v68, s60
    v_perm_b32 v122, v67, v66, s60
    v_perm_b32 v123, v71, v70, s60
    v_perm_b32 v124, v73, v72, s60
    v_perm_b32 v125, v77, v76, s60
    v_perm_b32 v126, v75, v74, s60
    v_perm_b32 v127, v79, v78, s60
    v_accvgpr_write_b32 a136, v120
    v_accvgpr_write_b32 a137, v121
    v_accvgpr_write_b32 a138, v122
    v_accvgpr_write_b32 a139, v123
    v_accvgpr_write_b32 a140, v124
    v_accvgpr_write_b32 a141, v125
    v_accvgpr_write_b32 a142, v126
    v_accvgpr_write_b32 a143, v127
    s_xor_b32 s35, s34, 3145728
    s_add_u32 s32, s35, 0
    buffer_load_dword v16, v12, s[16:19], s32 offen
    s_add_u32 s32, s35, 8192
    buffer_load_dword v17, v12, s[16:19], s32 offen
    s_add_u32 s32, s35, 65536
    buffer_load_dword v18, v12, s[16:19], s32 offen
    s_add_u32 s32, s35, 73728
    buffer_load_dword v19, v12, s[16:19], s32 offen
    s_add_u32 s32, s35, 32768
    buffer_load_dword v20, v12, s[16:19], s32 offen
    s_add_u32 s32, s35, 40960
    buffer_load_dword v21, v12, s[16:19], s32 offen
    s_add_u32 s32, s35, 98304
    buffer_load_dword v22, v12, s[16:19], s32 offen
    s_add_u32 s32, s35, 106496
    buffer_load_dword v23, v12, s[16:19], s32 offen
    s_add_u32 s32, s35, 262144
    buffer_load_dword v24, v12, s[16:19], s32 offen
    s_add_u32 s32, s35, 270336
    buffer_load_dword v25, v12, s[16:19], s32 offen
    s_add_u32 s32, s35, 327680
    buffer_load_dword v26, v12, s[16:19], s32 offen
    s_add_u32 s32, s35, 335872
    buffer_load_dword v27, v12, s[16:19], s32 offen
    s_add_u32 s32, s35, 294912
    buffer_load_dword v28, v12, s[16:19], s32 offen
    s_add_u32 s32, s35, 303104
    buffer_load_dword v29, v12, s[16:19], s32 offen
    s_add_u32 s32, s35, 360448
    buffer_load_dword v30, v12, s[16:19], s32 offen
    s_add_u32 s32, s35, 368640
    buffer_load_dword v31, v12, s[16:19], s32 offen
    s_add_u32 s32, s35, 524288
    buffer_load_dword v32, v12, s[16:19], s32 offen
    s_add_u32 s32, s35, 532480
    buffer_load_dword v33, v12, s[16:19], s32 offen
    s_add_u32 s32, s35, 589824
    buffer_load_dword v34, v12, s[16:19], s32 offen
    s_add_u32 s32, s35, 598016
    buffer_load_dword v35, v12, s[16:19], s32 offen
    s_add_u32 s32, s35, 557056
    buffer_load_dword v36, v12, s[16:19], s32 offen
    s_add_u32 s32, s35, 565248
    buffer_load_dword v37, v12, s[16:19], s32 offen
    s_add_u32 s32, s35, 622592
    buffer_load_dword v38, v12, s[16:19], s32 offen
    s_add_u32 s32, s35, 630784
    buffer_load_dword v39, v12, s[16:19], s32 offen
    s_add_u32 s32, s35, 786432
    buffer_load_dword v40, v12, s[16:19], s32 offen
    s_add_u32 s32, s35, 794624
    buffer_load_dword v41, v12, s[16:19], s32 offen
    s_add_u32 s32, s35, 851968
    buffer_load_dword v42, v12, s[16:19], s32 offen
    s_add_u32 s32, s35, 860160
    buffer_load_dword v43, v12, s[16:19], s32 offen
    s_add_u32 s32, s35, 819200
    buffer_load_dword v44, v12, s[16:19], s32 offen
    s_add_u32 s32, s35, 827392
    buffer_load_dword v45, v12, s[16:19], s32 offen
    s_add_u32 s32, s35, 884736
    buffer_load_dword v46, v12, s[16:19], s32 offen
    s_add_u32 s32, s35, 892928
    buffer_load_dword v47, v12, s[16:19], s32 offen
    s_waitcnt vmcnt(62)
    v_perm_b32 v112, v81, v80, s59
    s_waitcnt vmcnt(58)
    v_perm_b32 v113, v85, v84, s59
    v_perm_b32 v114, v83, v82, s59
    s_waitcnt vmcnt(56)
    v_perm_b32 v115, v87, v86, s59
    s_waitcnt vmcnt(54)
    v_perm_b32 v116, v89, v88, s59
    s_waitcnt vmcnt(50)
    v_perm_b32 v117, v93, v92, s59
    v_perm_b32 v118, v91, v90, s59
    s_waitcnt vmcnt(48)
    v_perm_b32 v119, v95, v94, s59
    v_accvgpr_write_b32 a144, v112
    v_accvgpr_write_b32 a145, v113
    v_accvgpr_write_b32 a146, v114
    v_accvgpr_write_b32 a147, v115
    v_accvgpr_write_b32 a148, v116
    v_accvgpr_write_b32 a149, v117
    v_accvgpr_write_b32 a150, v118
    v_accvgpr_write_b32 a151, v119
    v_perm_b32 v120, v81, v80, s60
    v_perm_b32 v121, v85, v84, s60
    v_perm_b32 v122, v83, v82, s60
    v_perm_b32 v123, v87, v86, s60
    v_perm_b32 v124, v89, v88, s60
    v_perm_b32 v125, v93, v92, s60
    v_perm_b32 v126, v91, v90, s60
    v_perm_b32 v127, v95, v94, s60
    v_accvgpr_write_b32 a152, v120
    v_accvgpr_write_b32 a153, v121
    v_accvgpr_write_b32 a154, v122
    v_accvgpr_write_b32 a155, v123
    v_accvgpr_write_b32 a156, v124
    v_accvgpr_write_b32 a157, v125
    v_accvgpr_write_b32 a158, v126
    v_accvgpr_write_b32 a159, v127
    s_waitcnt vmcnt(46)
    v_perm_b32 v112, v97, v96, s59
    s_waitcnt vmcnt(42)
    v_perm_b32 v113, v101, v100, s59
    v_perm_b32 v114, v99, v98, s59
    s_waitcnt vmcnt(40)
    v_perm_b32 v115, v103, v102, s59
    s_waitcnt vmcnt(38)
    v_perm_b32 v116, v105, v104, s59
    s_waitcnt vmcnt(34)
    v_perm_b32 v117, v109, v108, s59
    v_perm_b32 v118, v107, v106, s59
    s_waitcnt vmcnt(32)
    v_perm_b32 v119, v111, v110, s59
    v_accvgpr_write_b32 a160, v112
    v_accvgpr_write_b32 a161, v113
    v_accvgpr_write_b32 a162, v114
    v_accvgpr_write_b32 a163, v115
    v_accvgpr_write_b32 a164, v116
    v_accvgpr_write_b32 a165, v117
    v_accvgpr_write_b32 a166, v118
    v_accvgpr_write_b32 a167, v119
    v_perm_b32 v120, v97, v96, s60
    v_perm_b32 v121, v101, v100, s60
    v_perm_b32 v122, v99, v98, s60
    v_perm_b32 v123, v103, v102, s60
    v_perm_b32 v124, v105, v104, s60
    v_perm_b32 v125, v109, v108, s60
    v_perm_b32 v126, v107, v106, s60
    v_perm_b32 v127, v111, v110, s60
    v_accvgpr_write_b32 a168, v120
    v_accvgpr_write_b32 a169, v121
    v_accvgpr_write_b32 a170, v122
    v_accvgpr_write_b32 a171, v123
    v_accvgpr_write_b32 a172, v124
    v_accvgpr_write_b32 a173, v125
    v_accvgpr_write_b32 a174, v126
    v_accvgpr_write_b32 a175, v127
    s_xor_b32 s35, s34, 0
    s_add_u32 s32, s35, 0
    buffer_load_dword v48, v12, s[20:23], s32 offen
    s_add_u32 s32, s35, 8192
    buffer_load_dword v49, v12, s[20:23], s32 offen
    s_add_u32 s32, s35, 65536
    buffer_load_dword v50, v12, s[20:23], s32 offen
    s_add_u32 s32, s35, 73728
    buffer_load_dword v51, v12, s[20:23], s32 offen
    s_add_u32 s32, s35, 32768
    buffer_load_dword v52, v12, s[20:23], s32 offen
    s_add_u32 s32, s35, 40960
    buffer_load_dword v53, v12, s[20:23], s32 offen
    s_add_u32 s32, s35, 98304
    buffer_load_dword v54, v12, s[20:23], s32 offen
    s_add_u32 s32, s35, 106496
    buffer_load_dword v55, v12, s[20:23], s32 offen
    s_add_u32 s32, s35, 262144
    buffer_load_dword v56, v12, s[20:23], s32 offen
    s_add_u32 s32, s35, 270336
    buffer_load_dword v57, v12, s[20:23], s32 offen
    s_add_u32 s32, s35, 327680
    buffer_load_dword v58, v12, s[20:23], s32 offen
    s_add_u32 s32, s35, 335872
    buffer_load_dword v59, v12, s[20:23], s32 offen
    s_add_u32 s32, s35, 294912
    buffer_load_dword v60, v12, s[20:23], s32 offen
    s_add_u32 s32, s35, 303104
    buffer_load_dword v61, v12, s[20:23], s32 offen
    s_add_u32 s32, s35, 360448
    buffer_load_dword v62, v12, s[20:23], s32 offen
    s_add_u32 s32, s35, 368640
    buffer_load_dword v63, v12, s[20:23], s32 offen
    s_add_u32 s32, s35, 524288
    buffer_load_dword v64, v12, s[20:23], s32 offen
    s_add_u32 s32, s35, 532480
    buffer_load_dword v65, v12, s[20:23], s32 offen
    s_add_u32 s32, s35, 589824
    buffer_load_dword v66, v12, s[20:23], s32 offen
    s_add_u32 s32, s35, 598016
    buffer_load_dword v67, v12, s[20:23], s32 offen
    s_add_u32 s32, s35, 557056
    buffer_load_dword v68, v12, s[20:23], s32 offen
    s_add_u32 s32, s35, 565248
    buffer_load_dword v69, v12, s[20:23], s32 offen
    s_add_u32 s32, s35, 622592
    buffer_load_dword v70, v12, s[20:23], s32 offen
    s_add_u32 s32, s35, 630784
    buffer_load_dword v71, v12, s[20:23], s32 offen
    s_add_u32 s32, s35, 786432
    buffer_load_dword v72, v12, s[20:23], s32 offen
    s_add_u32 s32, s35, 794624
    buffer_load_dword v73, v12, s[20:23], s32 offen
    s_add_u32 s32, s35, 851968
    buffer_load_dword v74, v12, s[20:23], s32 offen
    s_add_u32 s32, s35, 860160
    buffer_load_dword v75, v12, s[20:23], s32 offen
    s_add_u32 s32, s35, 819200
    buffer_load_dword v76, v12, s[20:23], s32 offen
    s_add_u32 s32, s35, 827392
    buffer_load_dword v77, v12, s[20:23], s32 offen
    s_add_u32 s32, s35, 884736
    buffer_load_dword v78, v12, s[20:23], s32 offen
    s_add_u32 s32, s35, 892928
    buffer_load_dword v79, v12, s[20:23], s32 offen
    s_waitcnt vmcnt(62)
    v_perm_b32 v112, v17, v16, s59
    s_waitcnt vmcnt(58)
    v_perm_b32 v113, v21, v20, s59
    v_perm_b32 v114, v19, v18, s59
    s_waitcnt vmcnt(56)
    v_perm_b32 v115, v23, v22, s59
    s_waitcnt vmcnt(54)
    v_perm_b32 v116, v25, v24, s59
    s_waitcnt vmcnt(50)
    v_perm_b32 v117, v29, v28, s59
    v_perm_b32 v118, v27, v26, s59
    s_waitcnt vmcnt(48)
    v_perm_b32 v119, v31, v30, s59
    v_accvgpr_write_b32 a176, v112
    v_accvgpr_write_b32 a177, v113
    v_accvgpr_write_b32 a178, v114
    v_accvgpr_write_b32 a179, v115
    v_accvgpr_write_b32 a180, v116
    v_accvgpr_write_b32 a181, v117
    v_accvgpr_write_b32 a182, v118
    v_accvgpr_write_b32 a183, v119
    v_perm_b32 v120, v17, v16, s60
    v_perm_b32 v121, v21, v20, s60
    v_perm_b32 v122, v19, v18, s60
    v_perm_b32 v123, v23, v22, s60
    v_perm_b32 v124, v25, v24, s60
    v_perm_b32 v125, v29, v28, s60
    v_perm_b32 v126, v27, v26, s60
    v_perm_b32 v127, v31, v30, s60
    v_accvgpr_write_b32 a192, v120
    v_accvgpr_write_b32 a193, v121
    v_accvgpr_write_b32 a194, v122
    v_accvgpr_write_b32 a195, v123
    v_accvgpr_write_b32 a196, v124
    v_accvgpr_write_b32 a197, v125
    v_accvgpr_write_b32 a198, v126
    v_accvgpr_write_b32 a199, v127
    s_waitcnt vmcnt(46)
    v_perm_b32 v112, v33, v32, s59
    s_waitcnt vmcnt(42)
    v_perm_b32 v113, v37, v36, s59
    v_perm_b32 v114, v35, v34, s59
    s_waitcnt vmcnt(40)
    v_perm_b32 v115, v39, v38, s59
    s_waitcnt vmcnt(38)
    v_perm_b32 v116, v41, v40, s59
    s_waitcnt vmcnt(34)
    v_perm_b32 v117, v45, v44, s59
    v_perm_b32 v118, v43, v42, s59
    s_waitcnt vmcnt(32)
    v_perm_b32 v119, v47, v46, s59
    v_accvgpr_write_b32 a184, v112
    v_accvgpr_write_b32 a185, v113
    v_accvgpr_write_b32 a186, v114
    v_accvgpr_write_b32 a187, v115
    v_accvgpr_write_b32 a188, v116
    v_accvgpr_write_b32 a189, v117
    v_accvgpr_write_b32 a190, v118
    v_accvgpr_write_b32 a191, v119
    v_perm_b32 v120, v33, v32, s60
    v_perm_b32 v121, v37, v36, s60
    v_perm_b32 v122, v35, v34, s60
    v_perm_b32 v123, v39, v38, s60
    v_perm_b32 v124, v41, v40, s60
    v_perm_b32 v125, v45, v44, s60
    v_perm_b32 v126, v43, v42, s60
    v_perm_b32 v127, v47, v46, s60
    v_accvgpr_write_b32 a200, v120
    v_accvgpr_write_b32 a201, v121
    v_accvgpr_write_b32 a202, v122
    v_accvgpr_write_b32 a203, v123
    v_accvgpr_write_b32 a204, v124
    v_accvgpr_write_b32 a205, v125
    v_accvgpr_write_b32 a206, v126
    v_accvgpr_write_b32 a207, v127
    s_xor_b32 s35, s34, 1048576
    s_add_u32 s32, s35, 0
    buffer_load_dword v80, v12, s[20:23], s32 offen
    s_add_u32 s32, s35, 8192
    buffer_load_dword v81, v12, s[20:23], s32 offen
    s_add_u32 s32, s35, 65536
    buffer_load_dword v82, v12, s[20:23], s32 offen
    s_add_u32 s32, s35, 73728
    buffer_load_dword v83, v12, s[20:23], s32 offen
    s_add_u32 s32, s35, 32768
    buffer_load_dword v84, v12, s[20:23], s32 offen
    s_add_u32 s32, s35, 40960
    buffer_load_dword v85, v12, s[20:23], s32 offen
    s_add_u32 s32, s35, 98304
    buffer_load_dword v86, v12, s[20:23], s32 offen
    s_add_u32 s32, s35, 106496
    buffer_load_dword v87, v12, s[20:23], s32 offen
    s_add_u32 s32, s35, 262144
    buffer_load_dword v88, v12, s[20:23], s32 offen
    s_add_u32 s32, s35, 270336
    buffer_load_dword v89, v12, s[20:23], s32 offen
    s_add_u32 s32, s35, 327680
    buffer_load_dword v90, v12, s[20:23], s32 offen
    s_add_u32 s32, s35, 335872
    buffer_load_dword v91, v12, s[20:23], s32 offen
    s_add_u32 s32, s35, 294912
    buffer_load_dword v92, v12, s[20:23], s32 offen
    s_add_u32 s32, s35, 303104
    buffer_load_dword v93, v12, s[20:23], s32 offen
    s_add_u32 s32, s35, 360448
    buffer_load_dword v94, v12, s[20:23], s32 offen
    s_add_u32 s32, s35, 368640
    buffer_load_dword v95, v12, s[20:23], s32 offen
    s_add_u32 s32, s35, 524288
    buffer_load_dword v96, v12, s[20:23], s32 offen
    s_add_u32 s32, s35, 532480
    buffer_load_dword v97, v12, s[20:23], s32 offen
    s_add_u32 s32, s35, 589824
    buffer_load_dword v98, v12, s[20:23], s32 offen
    s_add_u32 s32, s35, 598016
    buffer_load_dword v99, v12, s[20:23], s32 offen
    s_add_u32 s32, s35, 557056
    buffer_load_dword v100, v12, s[20:23], s32 offen
    s_add_u32 s32, s35, 565248
    buffer_load_dword v101, v12, s[20:23], s32 offen
    s_add_u32 s32, s35, 622592
    buffer_load_dword v102, v12, s[20:23], s32 offen
    s_add_u32 s32, s35, 630784
    buffer_load_dword v103, v12, s[20:23], s32 offen
    s_add_u32 s32, s35, 786432
    buffer_load_dword v104, v12, s[20:23], s32 offen
    s_add_u32 s32, s35, 794624
    buffer_load_dword v105, v12, s[20:23], s32 offen
    s_add_u32 s32, s35, 851968
    buffer_load_dword v106, v12, s[20:23], s32 offen
    s_add_u32 s32, s35, 860160
    buffer_load_dword v107, v12, s[20:23], s32 offen
    s_add_u32 s32, s35, 819200
    buffer_load_dword v108, v12, s[20:23], s32 offen
    s_add_u32 s32, s35, 827392
    buffer_load_dword v109, v12, s[20:23], s32 offen
    s_add_u32 s32, s35, 884736
    buffer_load_dword v110, v12, s[20:23], s32 offen
    s_add_u32 s32, s35, 892928
    buffer_load_dword v111, v12, s[20:23], s32 offen
    s_waitcnt vmcnt(62)
    v_perm_b32 v112, v49, v48, s59
    s_waitcnt vmcnt(58)
    v_perm_b32 v113, v53, v52, s59
    v_perm_b32 v114, v51, v50, s59
    s_waitcnt vmcnt(56)
    v_perm_b32 v115, v55, v54, s59
    s_waitcnt vmcnt(54)
    v_perm_b32 v116, v57, v56, s59
    s_waitcnt vmcnt(50)
    v_perm_b32 v117, v61, v60, s59
    v_perm_b32 v118, v59, v58, s59
    s_waitcnt vmcnt(48)
    v_perm_b32 v119, v63, v62, s59
    ds_write_b128 v4, v[112:115] offset:4096
    ds_write_b128 v4, v[116:119] offset:5120
    v_perm_b32 v120, v49, v48, s60
    v_perm_b32 v121, v53, v52, s60
    v_perm_b32 v122, v51, v50, s60
    v_perm_b32 v123, v55, v54, s60
    v_perm_b32 v124, v57, v56, s60
    v_perm_b32 v125, v61, v60, s60
    v_perm_b32 v126, v59, v58, s60
    v_perm_b32 v127, v63, v62, s60
    ds_write_b128 v4, v[120:123] offset:6144
    ds_write_b128 v4, v[124:127] offset:7168
    s_waitcnt vmcnt(46)
    v_perm_b32 v112, v65, v64, s59
    s_waitcnt vmcnt(42)
    v_perm_b32 v113, v69, v68, s59
    v_perm_b32 v114, v67, v66, s59
    s_waitcnt vmcnt(40)
    v_perm_b32 v115, v71, v70, s59
    s_waitcnt vmcnt(38)
    v_perm_b32 v116, v73, v72, s59
    s_waitcnt vmcnt(34)
    v_perm_b32 v117, v77, v76, s59
    v_perm_b32 v118, v75, v74, s59
    s_waitcnt vmcnt(32)
    v_perm_b32 v119, v79, v78, s59
    ds_write_b128 v4, v[112:115] offset:16384
    ds_write_b128 v4, v[116:119] offset:17408
    v_perm_b32 v120, v65, v64, s60
    v_perm_b32 v121, v69, v68, s60
    v_perm_b32 v122, v67, v66, s60
    v_perm_b32 v123, v71, v70, s60
    v_perm_b32 v124, v73, v72, s60
    v_perm_b32 v125, v77, v76, s60
    v_perm_b32 v126, v75, v74, s60
    v_perm_b32 v127, v79, v78, s60
    ds_write_b128 v4, v[120:123] offset:18432
    ds_write_b128 v4, v[124:127] offset:19456
    s_xor_b32 s35, s34, 2097152
    s_add_u32 s32, s35, 0
    buffer_load_dword v16, v12, s[20:23], s32 offen
    s_add_u32 s32, s35, 8192
    buffer_load_dword v17, v12, s[20:23], s32 offen
    s_add_u32 s32, s35, 65536
    buffer_load_dword v18, v12, s[20:23], s32 offen
    s_add_u32 s32, s35, 73728
    buffer_load_dword v19, v12, s[20:23], s32 offen
    s_add_u32 s32, s35, 32768
    buffer_load_dword v20, v12, s[20:23], s32 offen
    s_add_u32 s32, s35, 40960
    buffer_load_dword v21, v12, s[20:23], s32 offen
    s_add_u32 s32, s35, 98304
    buffer_load_dword v22, v12, s[20:23], s32 offen
    s_add_u32 s32, s35, 106496
    buffer_load_dword v23, v12, s[20:23], s32 offen
    s_add_u32 s32, s35, 262144
    buffer_load_dword v24, v12, s[20:23], s32 offen
    s_add_u32 s32, s35, 270336
    buffer_load_dword v25, v12, s[20:23], s32 offen
    s_add_u32 s32, s35, 327680
    buffer_load_dword v26, v12, s[20:23], s32 offen
    s_add_u32 s32, s35, 335872
    buffer_load_dword v27, v12, s[20:23], s32 offen
    s_add_u32 s32, s35, 294912
    buffer_load_dword v28, v12, s[20:23], s32 offen
    s_add_u32 s32, s35, 303104
    buffer_load_dword v29, v12, s[20:23], s32 offen
    s_add_u32 s32, s35, 360448
    buffer_load_dword v30, v12, s[20:23], s32 offen
    s_add_u32 s32, s35, 368640
    buffer_load_dword v31, v12, s[20:23], s32 offen
    s_add_u32 s32, s35, 524288
    buffer_load_dword v32, v12, s[20:23], s32 offen
    s_add_u32 s32, s35, 532480
    buffer_load_dword v33, v12, s[20:23], s32 offen
    s_add_u32 s32, s35, 589824
    buffer_load_dword v34, v12, s[20:23], s32 offen
    s_add_u32 s32, s35, 598016
    buffer_load_dword v35, v12, s[20:23], s32 offen
    s_add_u32 s32, s35, 557056
    buffer_load_dword v36, v12, s[20:23], s32 offen
    s_add_u32 s32, s35, 565248
    buffer_load_dword v37, v12, s[20:23], s32 offen
    s_add_u32 s32, s35, 622592
    buffer_load_dword v38, v12, s[20:23], s32 offen
    s_add_u32 s32, s35, 630784
    buffer_load_dword v39, v12, s[20:23], s32 offen
    s_add_u32 s32, s35, 786432
    buffer_load_dword v40, v12, s[20:23], s32 offen
    s_add_u32 s32, s35, 794624
    buffer_load_dword v41, v12, s[20:23], s32 offen
    s_add_u32 s32, s35, 851968
    buffer_load_dword v42, v12, s[20:23], s32 offen
    s_add_u32 s32, s35, 860160
    buffer_load_dword v43, v12, s[20:23], s32 offen
    s_add_u32 s32, s35, 819200
    buffer_load_dword v44, v12, s[20:23], s32 offen
    s_add_u32 s32, s35, 827392
    buffer_load_dword v45, v12, s[20:23], s32 offen
    s_add_u32 s32, s35, 884736
    buffer_load_dword v46, v12, s[20:23], s32 offen
    s_add_u32 s32, s35, 892928
    buffer_load_dword v47, v12, s[20:23], s32 offen
    s_waitcnt vmcnt(62)
    v_perm_b32 v112, v81, v80, s59
    s_waitcnt vmcnt(58)
    v_perm_b32 v113, v85, v84, s59
    v_perm_b32 v114, v83, v82, s59
    s_waitcnt vmcnt(56)
    v_perm_b32 v115, v87, v86, s59
    s_waitcnt vmcnt(54)
    v_perm_b32 v116, v89, v88, s59
    s_waitcnt vmcnt(50)
    v_perm_b32 v117, v93, v92, s59
    v_perm_b32 v118, v91, v90, s59
    s_waitcnt vmcnt(48)
    v_perm_b32 v119, v95, v94, s59
    v_accvgpr_write_b32 a16, v112
    v_accvgpr_write_b32 a17, v113
    v_accvgpr_write_b32 a18, v114
    v_accvgpr_write_b32 a19, v115
    v_accvgpr_write_b32 a20, v116
    v_accvgpr_write_b32 a21, v117
    v_accvgpr_write_b32 a22, v118
    v_accvgpr_write_b32 a23, v119
    v_perm_b32 v120, v81, v80, s60
    v_perm_b32 v121, v85, v84, s60
    v_perm_b32 v122, v83, v82, s60
    v_perm_b32 v123, v87, v86, s60
    v_perm_b32 v124, v89, v88, s60
    v_perm_b32 v125, v93, v92, s60
    v_perm_b32 v126, v91, v90, s60
    v_perm_b32 v127, v95, v94, s60
    v_accvgpr_write_b32 a24, v120
    v_accvgpr_write_b32 a25, v121
    v_accvgpr_write_b32 a26, v122
    v_accvgpr_write_b32 a27, v123
    v_accvgpr_write_b32 a28, v124
    v_accvgpr_write_b32 a29, v125
    v_accvgpr_write_b32 a30, v126
    v_accvgpr_write_b32 a31, v127
    s_waitcnt vmcnt(46)
    v_perm_b32 v112, v97, v96, s59
    s_waitcnt vmcnt(42)
    v_perm_b32 v113, v101, v100, s59
    v_perm_b32 v114, v99, v98, s59
    s_waitcnt vmcnt(40)
    v_perm_b32 v115, v103, v102, s59
    s_waitcnt vmcnt(38)
    v_perm_b32 v116, v105, v104, s59
    s_waitcnt vmcnt(34)
    v_perm_b32 v117, v109, v108, s59
    v_perm_b32 v118, v107, v106, s59
    s_waitcnt vmcnt(32)
    v_perm_b32 v119, v111, v110, s59
    v_accvgpr_write_b32 a32, v112
    v_accvgpr_write_b32 a33, v113
    v_accvgpr_write_b32 a34, v114
    v_accvgpr_write_b32 a35, v115
    v_accvgpr_write_b32 a36, v116
    v_accvgpr_write_b32 a37, v117
    v_accvgpr_write_b32 a38, v118
    v_accvgpr_write_b32 a39, v119
    v_perm_b32 v120, v97, v96, s60
    v_perm_b32 v121, v101, v100, s60
    v_perm_b32 v122, v99, v98, s60
    v_perm_b32 v123, v103, v102, s60
    v_perm_b32 v124, v105, v104, s60
    v_perm_b32 v125, v109, v108, s60
    v_perm_b32 v126, v107, v106, s60
    v_perm_b32 v127, v111, v110, s60
    v_accvgpr_write_b32 a40, v120
    v_accvgpr_write_b32 a41, v121
    v_accvgpr_write_b32 a42, v122
    v_accvgpr_write_b32 a43, v123
    v_accvgpr_write_b32 a44, v124
    v_accvgpr_write_b32 a45, v125
    v_accvgpr_write_b32 a46, v126
    v_accvgpr_write_b32 a47, v127
    s_xor_b32 s35, s34, 3145728
    s_add_u32 s32, s35, 0
    buffer_load_dword v48, v12, s[20:23], s32 offen
    s_add_u32 s32, s35, 8192
    buffer_load_dword v49, v12, s[20:23], s32 offen
    s_add_u32 s32, s35, 65536
    buffer_load_dword v50, v12, s[20:23], s32 offen
    s_add_u32 s32, s35, 73728
    buffer_load_dword v51, v12, s[20:23], s32 offen
    s_add_u32 s32, s35, 32768
    buffer_load_dword v52, v12, s[20:23], s32 offen
    s_add_u32 s32, s35, 40960
    buffer_load_dword v53, v12, s[20:23], s32 offen
    s_add_u32 s32, s35, 98304
    buffer_load_dword v54, v12, s[20:23], s32 offen
    s_add_u32 s32, s35, 106496
    buffer_load_dword v55, v12, s[20:23], s32 offen
    s_add_u32 s32, s35, 262144
    buffer_load_dword v56, v12, s[20:23], s32 offen
    s_add_u32 s32, s35, 270336
    buffer_load_dword v57, v12, s[20:23], s32 offen
    s_add_u32 s32, s35, 327680
    buffer_load_dword v58, v12, s[20:23], s32 offen
    s_add_u32 s32, s35, 335872
    buffer_load_dword v59, v12, s[20:23], s32 offen
    s_add_u32 s32, s35, 294912
    buffer_load_dword v60, v12, s[20:23], s32 offen
    s_add_u32 s32, s35, 303104
    buffer_load_dword v61, v12, s[20:23], s32 offen
    s_add_u32 s32, s35, 360448
    buffer_load_dword v62, v12, s[20:23], s32 offen
    s_add_u32 s32, s35, 368640
    buffer_load_dword v63, v12, s[20:23], s32 offen
    s_add_u32 s32, s35, 524288
    buffer_load_dword v64, v12, s[20:23], s32 offen
    s_add_u32 s32, s35, 532480
    buffer_load_dword v65, v12, s[20:23], s32 offen
    s_add_u32 s32, s35, 589824
    buffer_load_dword v66, v12, s[20:23], s32 offen
    s_add_u32 s32, s35, 598016
    buffer_load_dword v67, v12, s[20:23], s32 offen
    s_add_u32 s32, s35, 557056
    buffer_load_dword v68, v12, s[20:23], s32 offen
    s_add_u32 s32, s35, 565248
    buffer_load_dword v69, v12, s[20:23], s32 offen
    s_add_u32 s32, s35, 622592
    buffer_load_dword v70, v12, s[20:23], s32 offen
    s_add_u32 s32, s35, 630784
    buffer_load_dword v71, v12, s[20:23], s32 offen
    s_add_u32 s32, s35, 786432
    buffer_load_dword v72, v12, s[20:23], s32 offen
    s_add_u32 s32, s35, 794624
    buffer_load_dword v73, v12, s[20:23], s32 offen
    s_add_u32 s32, s35, 851968
    buffer_load_dword v74, v12, s[20:23], s32 offen
    s_add_u32 s32, s35, 860160
    buffer_load_dword v75, v12, s[20:23], s32 offen
    s_add_u32 s32, s35, 819200
    buffer_load_dword v76, v12, s[20:23], s32 offen
    s_add_u32 s32, s35, 827392
    buffer_load_dword v77, v12, s[20:23], s32 offen
    s_add_u32 s32, s35, 884736
    buffer_load_dword v78, v12, s[20:23], s32 offen
    s_add_u32 s32, s35, 892928
    buffer_load_dword v79, v12, s[20:23], s32 offen
    s_waitcnt vmcnt(62)
    v_perm_b32 v112, v17, v16, s59
    s_waitcnt vmcnt(58)
    v_perm_b32 v113, v21, v20, s59
    v_perm_b32 v114, v19, v18, s59
    s_waitcnt vmcnt(56)
    v_perm_b32 v115, v23, v22, s59
    s_waitcnt vmcnt(54)
    v_perm_b32 v116, v25, v24, s59
    s_waitcnt vmcnt(50)
    v_perm_b32 v117, v29, v28, s59
    v_perm_b32 v118, v27, v26, s59
    s_waitcnt vmcnt(48)
    v_perm_b32 v119, v31, v30, s59
    v_accvgpr_write_b32 a48, v112
    v_accvgpr_write_b32 a49, v113
    v_accvgpr_write_b32 a50, v114
    v_accvgpr_write_b32 a51, v115
    v_accvgpr_write_b32 a52, v116
    v_accvgpr_write_b32 a53, v117
    v_accvgpr_write_b32 a54, v118
    v_accvgpr_write_b32 a55, v119
    v_perm_b32 v120, v17, v16, s60
    v_perm_b32 v121, v21, v20, s60
    v_perm_b32 v122, v19, v18, s60
    v_perm_b32 v123, v23, v22, s60
    v_perm_b32 v124, v25, v24, s60
    v_perm_b32 v125, v29, v28, s60
    v_perm_b32 v126, v27, v26, s60
    v_perm_b32 v127, v31, v30, s60
    v_accvgpr_write_b32 a56, v120
    v_accvgpr_write_b32 a57, v121
    v_accvgpr_write_b32 a58, v122
    v_accvgpr_write_b32 a59, v123
    v_accvgpr_write_b32 a60, v124
    v_accvgpr_write_b32 a61, v125
    v_accvgpr_write_b32 a62, v126
    v_accvgpr_write_b32 a63, v127
    s_waitcnt vmcnt(46)
    v_perm_b32 v112, v33, v32, s59
    s_waitcnt vmcnt(42)
    v_perm_b32 v113, v37, v36, s59
    v_perm_b32 v114, v35, v34, s59
    s_waitcnt vmcnt(40)
    v_perm_b32 v115, v39, v38, s59
    s_waitcnt vmcnt(38)
    v_perm_b32 v116, v41, v40, s59
    s_waitcnt vmcnt(34)
    v_perm_b32 v117, v45, v44, s59
    v_perm_b32 v118, v43, v42, s59
    s_waitcnt vmcnt(32)
    v_perm_b32 v119, v47, v46, s59
    v_accvgpr_write_b32 a64, v112
    v_accvgpr_write_b32 a65, v113
    v_accvgpr_write_b32 a66, v114
    v_accvgpr_write_b32 a67, v115
    v_accvgpr_write_b32 a68, v116
    v_accvgpr_write_b32 a69, v117
    v_accvgpr_write_b32 a70, v118
    v_accvgpr_write_b32 a71, v119
    v_perm_b32 v120, v33, v32, s60
    v_perm_b32 v121, v37, v36, s60
    v_perm_b32 v122, v35, v34, s60
    v_perm_b32 v123, v39, v38, s60
    v_perm_b32 v124, v41, v40, s60
    v_perm_b32 v125, v45, v44, s60
    v_perm_b32 v126, v43, v42, s60
    v_perm_b32 v127, v47, v46, s60
    v_accvgpr_write_b32 a72, v120
    v_accvgpr_write_b32 a73, v121
    v_accvgpr_write_b32 a74, v122
    v_accvgpr_write_b32 a75, v123
    v_accvgpr_write_b32 a76, v124
    v_accvgpr_write_b32 a77, v125
    v_accvgpr_write_b32 a78, v126
    v_accvgpr_write_b32 a79, v127
    s_xor_b32 s35, s34, 0
    s_add_u32 s32, s35, 0
    buffer_load_dword v80, v12, s[24:27], s32 offen
    s_add_u32 s32, s35, 8192
    buffer_load_dword v81, v12, s[24:27], s32 offen
    s_add_u32 s32, s35, 65536
    buffer_load_dword v82, v12, s[24:27], s32 offen
    s_add_u32 s32, s35, 73728
    buffer_load_dword v83, v12, s[24:27], s32 offen
    s_add_u32 s32, s35, 32768
    buffer_load_dword v84, v12, s[24:27], s32 offen
    s_add_u32 s32, s35, 40960
    buffer_load_dword v85, v12, s[24:27], s32 offen
    s_add_u32 s32, s35, 98304
    buffer_load_dword v86, v12, s[24:27], s32 offen
    s_add_u32 s32, s35, 106496
    buffer_load_dword v87, v12, s[24:27], s32 offen
    s_add_u32 s32, s35, 262144
    buffer_load_dword v88, v12, s[24:27], s32 offen
    s_add_u32 s32, s35, 270336
    buffer_load_dword v89, v12, s[24:27], s32 offen
    s_add_u32 s32, s35, 327680
    buffer_load_dword v90, v12, s[24:27], s32 offen
    s_add_u32 s32, s35, 335872
    buffer_load_dword v91, v12, s[24:27], s32 offen
    s_add_u32 s32, s35, 294912
    buffer_load_dword v92, v12, s[24:27], s32 offen
    s_add_u32 s32, s35, 303104
    buffer_load_dword v93, v12, s[24:27], s32 offen
    s_add_u32 s32, s35, 360448
    buffer_load_dword v94, v12, s[24:27], s32 offen
    s_add_u32 s32, s35, 368640
    buffer_load_dword v95, v12, s[24:27], s32 offen
    s_add_u32 s32, s35, 524288
    buffer_load_dword v96, v12, s[24:27], s32 offen
    s_add_u32 s32, s35, 532480
    buffer_load_dword v97, v12, s[24:27], s32 offen
    s_add_u32 s32, s35, 589824
    buffer_load_dword v98, v12, s[24:27], s32 offen
    s_add_u32 s32, s35, 598016
    buffer_load_dword v99, v12, s[24:27], s32 offen
    s_add_u32 s32, s35, 557056
    buffer_load_dword v100, v12, s[24:27], s32 offen
    s_add_u32 s32, s35, 565248
    buffer_load_dword v101, v12, s[24:27], s32 offen
    s_add_u32 s32, s35, 622592
    buffer_load_dword v102, v12, s[24:27], s32 offen
    s_add_u32 s32, s35, 630784
    buffer_load_dword v103, v12, s[24:27], s32 offen
    s_add_u32 s32, s35, 786432
    buffer_load_dword v104, v12, s[24:27], s32 offen
    s_add_u32 s32, s35, 794624
    buffer_load_dword v105, v12, s[24:27], s32 offen
    s_add_u32 s32, s35, 851968
    buffer_load_dword v106, v12, s[24:27], s32 offen
    s_add_u32 s32, s35, 860160
    buffer_load_dword v107, v12, s[24:27], s32 offen
    s_add_u32 s32, s35, 819200
    buffer_load_dword v108, v12, s[24:27], s32 offen
    s_add_u32 s32, s35, 827392
    buffer_load_dword v109, v12, s[24:27], s32 offen
    s_add_u32 s32, s35, 884736
    buffer_load_dword v110, v12, s[24:27], s32 offen
    s_add_u32 s32, s35, 892928
    buffer_load_dword v111, v12, s[24:27], s32 offen
    s_waitcnt vmcnt(62)
    v_perm_b32 v112, v49, v48, s59
    s_waitcnt vmcnt(58)
    v_perm_b32 v113, v53, v52, s59
    v_perm_b32 v114, v51, v50, s59
    s_waitcnt vmcnt(56)
    v_perm_b32 v115, v55, v54, s59
    s_waitcnt vmcnt(54)
    v_perm_b32 v116, v57, v56, s59
    s_waitcnt vmcnt(50)
    v_perm_b32 v117, v61, v60, s59
    v_perm_b32 v118, v59, v58, s59
    s_waitcnt vmcnt(48)
    v_perm_b32 v119, v63, v62, s59
    v_accvgpr_write_b32 a80, v112
    v_accvgpr_write_b32 a81, v113
    v_accvgpr_write_b32 a82, v114
    v_accvgpr_write_b32 a83, v115
    v_accvgpr_write_b32 a84, v116
    v_accvgpr_write_b32 a85, v117
    v_accvgpr_write_b32 a86, v118
    v_accvgpr_write_b32 a87, v119
    v_perm_b32 v120, v49, v48, s60
    v_perm_b32 v121, v53, v52, s60
    v_perm_b32 v122, v51, v50, s60
    v_perm_b32 v123, v55, v54, s60
    v_perm_b32 v124, v57, v56, s60
    v_perm_b32 v125, v61, v60, s60
    v_perm_b32 v126, v59, v58, s60
    v_perm_b32 v127, v63, v62, s60
    v_accvgpr_write_b32 a88, v120
    v_accvgpr_write_b32 a89, v121
    v_accvgpr_write_b32 a90, v122
    v_accvgpr_write_b32 a91, v123
    v_accvgpr_write_b32 a92, v124
    v_accvgpr_write_b32 a93, v125
    v_accvgpr_write_b32 a94, v126
    v_accvgpr_write_b32 a95, v127
    s_waitcnt vmcnt(46)
    v_perm_b32 v112, v65, v64, s59
    s_waitcnt vmcnt(42)
    v_perm_b32 v113, v69, v68, s59
    v_perm_b32 v114, v67, v66, s59
    s_waitcnt vmcnt(40)
    v_perm_b32 v115, v71, v70, s59
    s_waitcnt vmcnt(38)
    v_perm_b32 v116, v73, v72, s59
    s_waitcnt vmcnt(34)
    v_perm_b32 v117, v77, v76, s59
    v_perm_b32 v118, v75, v74, s59
    s_waitcnt vmcnt(32)
    v_perm_b32 v119, v79, v78, s59
    v_accvgpr_write_b32 a96, v112
    v_accvgpr_write_b32 a97, v113
    v_accvgpr_write_b32 a98, v114
    v_accvgpr_write_b32 a99, v115
    v_accvgpr_write_b32 a100, v116
    v_accvgpr_write_b32 a101, v117
    v_accvgpr_write_b32 a102, v118
    v_accvgpr_write_b32 a103, v119
    v_perm_b32 v120, v65, v64, s60
    v_perm_b32 v121, v69, v68, s60
    v_perm_b32 v122, v67, v66, s60
    v_perm_b32 v123, v71, v70, s60
    v_perm_b32 v124, v73, v72, s60
    v_perm_b32 v125, v77, v76, s60
    v_perm_b32 v126, v75, v74, s60
    v_perm_b32 v127, v79, v78, s60
    v_accvgpr_write_b32 a104, v120
    v_accvgpr_write_b32 a105, v121
    v_accvgpr_write_b32 a106, v122
    v_accvgpr_write_b32 a107, v123
    v_accvgpr_write_b32 a108, v124
    v_accvgpr_write_b32 a109, v125
    v_accvgpr_write_b32 a110, v126
    v_accvgpr_write_b32 a111, v127
    s_xor_b32 s35, s34, 1048576
    s_add_u32 s32, s35, 0
    buffer_load_dword v16, v12, s[24:27], s32 offen
    s_add_u32 s32, s35, 8192
    buffer_load_dword v17, v12, s[24:27], s32 offen
    s_add_u32 s32, s35, 65536
    buffer_load_dword v18, v12, s[24:27], s32 offen
    s_add_u32 s32, s35, 73728
    buffer_load_dword v19, v12, s[24:27], s32 offen
    s_add_u32 s32, s35, 32768
    buffer_load_dword v20, v12, s[24:27], s32 offen
    s_add_u32 s32, s35, 40960
    buffer_load_dword v21, v12, s[24:27], s32 offen
    s_add_u32 s32, s35, 98304
    buffer_load_dword v22, v12, s[24:27], s32 offen
    s_add_u32 s32, s35, 106496
    buffer_load_dword v23, v12, s[24:27], s32 offen
    s_add_u32 s32, s35, 262144
    buffer_load_dword v24, v12, s[24:27], s32 offen
    s_add_u32 s32, s35, 270336
    buffer_load_dword v25, v12, s[24:27], s32 offen
    s_add_u32 s32, s35, 327680
    buffer_load_dword v26, v12, s[24:27], s32 offen
    s_add_u32 s32, s35, 335872
    buffer_load_dword v27, v12, s[24:27], s32 offen
    s_add_u32 s32, s35, 294912
    buffer_load_dword v28, v12, s[24:27], s32 offen
    s_add_u32 s32, s35, 303104
    buffer_load_dword v29, v12, s[24:27], s32 offen
    s_add_u32 s32, s35, 360448
    buffer_load_dword v30, v12, s[24:27], s32 offen
    s_add_u32 s32, s35, 368640
    buffer_load_dword v31, v12, s[24:27], s32 offen
    s_add_u32 s32, s35, 524288
    buffer_load_dword v32, v12, s[24:27], s32 offen
    s_add_u32 s32, s35, 532480
    buffer_load_dword v33, v12, s[24:27], s32 offen
    s_add_u32 s32, s35, 589824
    buffer_load_dword v34, v12, s[24:27], s32 offen
    s_add_u32 s32, s35, 598016
    buffer_load_dword v35, v12, s[24:27], s32 offen
    s_add_u32 s32, s35, 557056
    buffer_load_dword v36, v12, s[24:27], s32 offen
    s_add_u32 s32, s35, 565248
    buffer_load_dword v37, v12, s[24:27], s32 offen
    s_add_u32 s32, s35, 622592
    buffer_load_dword v38, v12, s[24:27], s32 offen
    s_add_u32 s32, s35, 630784
    buffer_load_dword v39, v12, s[24:27], s32 offen
    s_add_u32 s32, s35, 786432
    buffer_load_dword v40, v12, s[24:27], s32 offen
    s_add_u32 s32, s35, 794624
    buffer_load_dword v41, v12, s[24:27], s32 offen
    s_add_u32 s32, s35, 851968
    buffer_load_dword v42, v12, s[24:27], s32 offen
    s_add_u32 s32, s35, 860160
    buffer_load_dword v43, v12, s[24:27], s32 offen
    s_add_u32 s32, s35, 819200
    buffer_load_dword v44, v12, s[24:27], s32 offen
    s_add_u32 s32, s35, 827392
    buffer_load_dword v45, v12, s[24:27], s32 offen
    s_add_u32 s32, s35, 884736
    buffer_load_dword v46, v12, s[24:27], s32 offen
    s_add_u32 s32, s35, 892928
    buffer_load_dword v47, v12, s[24:27], s32 offen
    s_waitcnt vmcnt(62)
    v_perm_b32 v112, v81, v80, s59
    s_waitcnt vmcnt(58)
    v_perm_b32 v113, v85, v84, s59
    v_perm_b32 v114, v83, v82, s59
    s_waitcnt vmcnt(56)
    v_perm_b32 v115, v87, v86, s59
    s_waitcnt vmcnt(54)
    v_perm_b32 v116, v89, v88, s59
    s_waitcnt vmcnt(50)
    v_perm_b32 v117, v93, v92, s59
    v_perm_b32 v118, v91, v90, s59
    s_waitcnt vmcnt(48)
    v_perm_b32 v119, v95, v94, s59
    ds_write_b128 v4, v[112:115] offset:8192
    ds_write_b128 v4, v[116:119] offset:9216
    v_perm_b32 v120, v81, v80, s60
    v_perm_b32 v121, v85, v84, s60
    v_perm_b32 v122, v83, v82, s60
    v_perm_b32 v123, v87, v86, s60
    v_perm_b32 v124, v89, v88, s60
    v_perm_b32 v125, v93, v92, s60
    v_perm_b32 v126, v91, v90, s60
    v_perm_b32 v127, v95, v94, s60
    ds_write_b128 v4, v[120:123] offset:10240
    ds_write_b128 v4, v[124:127] offset:11264
    s_waitcnt vmcnt(46)
    v_perm_b32 v112, v97, v96, s59
    s_waitcnt vmcnt(42)
    v_perm_b32 v113, v101, v100, s59
    v_perm_b32 v114, v99, v98, s59
    s_waitcnt vmcnt(40)
    v_perm_b32 v115, v103, v102, s59
    s_waitcnt vmcnt(38)
    v_perm_b32 v116, v105, v104, s59
    s_waitcnt vmcnt(34)
    v_perm_b32 v117, v109, v108, s59
    v_perm_b32 v118, v107, v106, s59
    s_waitcnt vmcnt(32)
    v_perm_b32 v119, v111, v110, s59
    v_accvgpr_write_b32 a0, v112
    v_accvgpr_write_b32 a1, v113
    v_accvgpr_write_b32 a2, v114
    v_accvgpr_write_b32 a3, v115
    v_accvgpr_write_b32 a4, v116
    v_accvgpr_write_b32 a5, v117
    v_accvgpr_write_b32 a6, v118
    v_accvgpr_write_b32 a7, v119
    v_perm_b32 v120, v97, v96, s60
    v_perm_b32 v121, v101, v100, s60
    v_perm_b32 v122, v99, v98, s60
    v_perm_b32 v123, v103, v102, s60
    v_perm_b32 v124, v105, v104, s60
    v_perm_b32 v125, v109, v108, s60
    v_perm_b32 v126, v107, v106, s60
    v_perm_b32 v127, v111, v110, s60
    v_accvgpr_write_b32 a8, v120
    v_accvgpr_write_b32 a9, v121
    v_accvgpr_write_b32 a10, v122
    v_accvgpr_write_b32 a11, v123
    v_accvgpr_write_b32 a12, v124
    v_accvgpr_write_b32 a13, v125
    v_accvgpr_write_b32 a14, v126
    v_accvgpr_write_b32 a15, v127
    s_xor_b32 s35, s34, 2097152
    s_add_u32 s32, s35, 0
    buffer_load_dword v48, v12, s[24:27], s32 offen
    s_add_u32 s32, s35, 8192
    buffer_load_dword v49, v12, s[24:27], s32 offen
    s_add_u32 s32, s35, 65536
    buffer_load_dword v50, v12, s[24:27], s32 offen
    s_add_u32 s32, s35, 73728
    buffer_load_dword v51, v12, s[24:27], s32 offen
    s_add_u32 s32, s35, 32768
    buffer_load_dword v52, v12, s[24:27], s32 offen
    s_add_u32 s32, s35, 40960
    buffer_load_dword v53, v12, s[24:27], s32 offen
    s_add_u32 s32, s35, 98304
    buffer_load_dword v54, v12, s[24:27], s32 offen
    s_add_u32 s32, s35, 106496
    buffer_load_dword v55, v12, s[24:27], s32 offen
    s_add_u32 s32, s35, 262144
    buffer_load_dword v56, v12, s[24:27], s32 offen
    s_add_u32 s32, s35, 270336
    buffer_load_dword v57, v12, s[24:27], s32 offen
    s_add_u32 s32, s35, 327680
    buffer_load_dword v58, v12, s[24:27], s32 offen
    s_add_u32 s32, s35, 335872
    buffer_load_dword v59, v12, s[24:27], s32 offen
    s_add_u32 s32, s35, 294912
    buffer_load_dword v60, v12, s[24:27], s32 offen
    s_add_u32 s32, s35, 303104
    buffer_load_dword v61, v12, s[24:27], s32 offen
    s_add_u32 s32, s35, 360448
    buffer_load_dword v62, v12, s[24:27], s32 offen
    s_add_u32 s32, s35, 368640
    buffer_load_dword v63, v12, s[24:27], s32 offen
    s_add_u32 s32, s35, 524288
    buffer_load_dword v64, v12, s[24:27], s32 offen
    s_add_u32 s32, s35, 532480
    buffer_load_dword v65, v12, s[24:27], s32 offen
    s_add_u32 s32, s35, 589824
    buffer_load_dword v66, v12, s[24:27], s32 offen
    s_add_u32 s32, s35, 598016
    buffer_load_dword v67, v12, s[24:27], s32 offen
    s_add_u32 s32, s35, 557056
    buffer_load_dword v68, v12, s[24:27], s32 offen
    s_add_u32 s32, s35, 565248
    buffer_load_dword v69, v12, s[24:27], s32 offen
    s_add_u32 s32, s35, 622592
    buffer_load_dword v70, v12, s[24:27], s32 offen
    s_add_u32 s32, s35, 630784
    buffer_load_dword v71, v12, s[24:27], s32 offen
    s_add_u32 s32, s35, 786432
    buffer_load_dword v72, v12, s[24:27], s32 offen
    s_add_u32 s32, s35, 794624
    buffer_load_dword v73, v12, s[24:27], s32 offen
    s_add_u32 s32, s35, 851968
    buffer_load_dword v74, v12, s[24:27], s32 offen
    s_add_u32 s32, s35, 860160
    buffer_load_dword v75, v12, s[24:27], s32 offen
    s_add_u32 s32, s35, 819200
    buffer_load_dword v76, v12, s[24:27], s32 offen
    s_add_u32 s32, s35, 827392
    buffer_load_dword v77, v12, s[24:27], s32 offen
    s_add_u32 s32, s35, 884736
    buffer_load_dword v78, v12, s[24:27], s32 offen
    s_add_u32 s32, s35, 892928
    buffer_load_dword v79, v12, s[24:27], s32 offen
    s_waitcnt vmcnt(62)
    v_perm_b32 v112, v17, v16, s59
    s_waitcnt vmcnt(58)
    v_perm_b32 v113, v21, v20, s59
    v_perm_b32 v114, v19, v18, s59
    s_waitcnt vmcnt(56)
    v_perm_b32 v115, v23, v22, s59
    s_waitcnt vmcnt(54)
    v_perm_b32 v116, v25, v24, s59
    s_waitcnt vmcnt(50)
    v_perm_b32 v117, v29, v28, s59
    v_perm_b32 v118, v27, v26, s59
    s_waitcnt vmcnt(48)
    v_perm_b32 v119, v31, v30, s59
    v_accvgpr_write_b32 a208, v112
    v_accvgpr_write_b32 a209, v113
    v_accvgpr_write_b32 a210, v114
    v_accvgpr_write_b32 a211, v115
    v_accvgpr_write_b32 a212, v116
    v_accvgpr_write_b32 a213, v117
    v_accvgpr_write_b32 a214, v118
    v_accvgpr_write_b32 a215, v119
    v_perm_b32 v120, v17, v16, s60
    v_perm_b32 v121, v21, v20, s60
    v_perm_b32 v122, v19, v18, s60
    v_perm_b32 v123, v23, v22, s60
    v_perm_b32 v124, v25, v24, s60
    v_perm_b32 v125, v29, v28, s60
    v_perm_b32 v126, v27, v26, s60
    v_perm_b32 v127, v31, v30, s60
    v_accvgpr_write_b32 a216, v120
    v_accvgpr_write_b32 a217, v121
    v_accvgpr_write_b32 a218, v122
    v_accvgpr_write_b32 a219, v123
    v_accvgpr_write_b32 a220, v124
    v_accvgpr_write_b32 a221, v125
    v_accvgpr_write_b32 a222, v126
    v_accvgpr_write_b32 a223, v127
    s_waitcnt vmcnt(46)
    v_perm_b32 v112, v33, v32, s59
    s_waitcnt vmcnt(42)
    v_perm_b32 v113, v37, v36, s59
    v_perm_b32 v114, v35, v34, s59
    s_waitcnt vmcnt(40)
    v_perm_b32 v115, v39, v38, s59
    s_waitcnt vmcnt(38)
    v_perm_b32 v116, v41, v40, s59
    s_waitcnt vmcnt(34)
    v_perm_b32 v117, v45, v44, s59
    v_perm_b32 v118, v43, v42, s59
    s_waitcnt vmcnt(32)
    v_perm_b32 v119, v47, v46, s59
    v_accvgpr_write_b32 a224, v112
    v_accvgpr_write_b32 a225, v113
    v_accvgpr_write_b32 a226, v114
    v_accvgpr_write_b32 a227, v115
    v_accvgpr_write_b32 a228, v116
    v_accvgpr_write_b32 a229, v117
    v_accvgpr_write_b32 a230, v118
    v_accvgpr_write_b32 a231, v119
    v_perm_b32 v120, v33, v32, s60
    v_perm_b32 v121, v37, v36, s60
    v_perm_b32 v122, v35, v34, s60
    v_perm_b32 v123, v39, v38, s60
    v_perm_b32 v124, v41, v40, s60
    v_perm_b32 v125, v45, v44, s60
    v_perm_b32 v126, v43, v42, s60
    v_perm_b32 v127, v47, v46, s60
    v_accvgpr_write_b32 a232, v120
    v_accvgpr_write_b32 a233, v121
    v_accvgpr_write_b32 a234, v122
    v_accvgpr_write_b32 a235, v123
    v_accvgpr_write_b32 a236, v124
    v_accvgpr_write_b32 a237, v125
    v_accvgpr_write_b32 a238, v126
    v_accvgpr_write_b32 a239, v127
    s_xor_b32 s35, s34, 3145728
    s_add_u32 s32, s35, 0
    buffer_load_dword v80, v12, s[24:27], s32 offen
    s_add_u32 s32, s35, 8192
    buffer_load_dword v81, v12, s[24:27], s32 offen
    s_add_u32 s32, s35, 65536
    buffer_load_dword v82, v12, s[24:27], s32 offen
    s_add_u32 s32, s35, 73728
    buffer_load_dword v83, v12, s[24:27], s32 offen
    s_add_u32 s32, s35, 32768
    buffer_load_dword v84, v12, s[24:27], s32 offen
    s_add_u32 s32, s35, 40960
    buffer_load_dword v85, v12, s[24:27], s32 offen
    s_add_u32 s32, s35, 98304
    buffer_load_dword v86, v12, s[24:27], s32 offen
    s_add_u32 s32, s35, 106496
    buffer_load_dword v87, v12, s[24:27], s32 offen
    s_add_u32 s32, s35, 262144
    buffer_load_dword v88, v12, s[24:27], s32 offen
    s_add_u32 s32, s35, 270336
    buffer_load_dword v89, v12, s[24:27], s32 offen
    s_add_u32 s32, s35, 327680
    buffer_load_dword v90, v12, s[24:27], s32 offen
    s_add_u32 s32, s35, 335872
    buffer_load_dword v91, v12, s[24:27], s32 offen
    s_add_u32 s32, s35, 294912
    buffer_load_dword v92, v12, s[24:27], s32 offen
    s_add_u32 s32, s35, 303104
    buffer_load_dword v93, v12, s[24:27], s32 offen
    s_add_u32 s32, s35, 360448
    buffer_load_dword v94, v12, s[24:27], s32 offen
    s_add_u32 s32, s35, 368640
    buffer_load_dword v95, v12, s[24:27], s32 offen
    s_add_u32 s32, s35, 524288
    buffer_load_dword v96, v12, s[24:27], s32 offen
    s_add_u32 s32, s35, 532480
    buffer_load_dword v97, v12, s[24:27], s32 offen
    s_add_u32 s32, s35, 589824
    buffer_load_dword v98, v12, s[24:27], s32 offen
    s_add_u32 s32, s35, 598016
    buffer_load_dword v99, v12, s[24:27], s32 offen
    s_add_u32 s32, s35, 557056
    buffer_load_dword v100, v12, s[24:27], s32 offen
    s_add_u32 s32, s35, 565248
    buffer_load_dword v101, v12, s[24:27], s32 offen
    s_add_u32 s32, s35, 622592
    buffer_load_dword v102, v12, s[24:27], s32 offen
    s_add_u32 s32, s35, 630784
    buffer_load_dword v103, v12, s[24:27], s32 offen
    s_add_u32 s32, s35, 786432
    buffer_load_dword v104, v12, s[24:27], s32 offen
    s_add_u32 s32, s35, 794624
    buffer_load_dword v105, v12, s[24:27], s32 offen
    s_add_u32 s32, s35, 851968
    buffer_load_dword v106, v12, s[24:27], s32 offen
    s_add_u32 s32, s35, 860160
    buffer_load_dword v107, v12, s[24:27], s32 offen
    s_add_u32 s32, s35, 819200
    buffer_load_dword v108, v12, s[24:27], s32 offen
    s_add_u32 s32, s35, 827392
    buffer_load_dword v109, v12, s[24:27], s32 offen
    s_add_u32 s32, s35, 884736
    buffer_load_dword v110, v12, s[24:27], s32 offen
    s_add_u32 s32, s35, 892928
    buffer_load_dword v111, v12, s[24:27], s32 offen
    s_waitcnt vmcnt(62)
    v_perm_b32 v112, v49, v48, s59
    s_waitcnt vmcnt(58)
    v_perm_b32 v113, v53, v52, s59
    v_perm_b32 v114, v51, v50, s59
    s_waitcnt vmcnt(56)
    v_perm_b32 v115, v55, v54, s59
    s_waitcnt vmcnt(54)
    v_perm_b32 v116, v57, v56, s59
    s_waitcnt vmcnt(50)
    v_perm_b32 v117, v61, v60, s59
    v_perm_b32 v118, v59, v58, s59
    s_waitcnt vmcnt(48)
    v_perm_b32 v119, v63, v62, s59
    ds_write_b128 v4, v[112:115] offset:20480
    ds_write_b128 v4, v[116:119] offset:21504
    v_perm_b32 v120, v49, v48, s60
    v_perm_b32 v121, v53, v52, s60
    v_perm_b32 v122, v51, v50, s60
    v_perm_b32 v123, v55, v54, s60
    v_perm_b32 v124, v57, v56, s60
    v_perm_b32 v125, v61, v60, s60
    v_perm_b32 v126, v59, v58, s60
    v_perm_b32 v127, v63, v62, s60
    ds_write_b128 v4, v[120:123] offset:22528
    ds_write_b128 v4, v[124:127] offset:23552
    s_waitcnt vmcnt(46)
    v_perm_b32 v112, v65, v64, s59
    s_waitcnt vmcnt(42)
    v_perm_b32 v113, v69, v68, s59
    v_perm_b32 v114, v67, v66, s59
    s_waitcnt vmcnt(40)
    v_perm_b32 v115, v71, v70, s59
    s_waitcnt vmcnt(38)
    v_perm_b32 v116, v73, v72, s59
    s_waitcnt vmcnt(34)
    v_perm_b32 v117, v77, v76, s59
    v_perm_b32 v118, v75, v74, s59
    s_waitcnt vmcnt(32)
    v_perm_b32 v119, v79, v78, s59
    v_accvgpr_write_b32 a240, v112
    v_accvgpr_write_b32 a241, v113
    v_accvgpr_write_b32 a242, v114
    v_accvgpr_write_b32 a243, v115
    v_accvgpr_write_b32 a244, v116
    v_accvgpr_write_b32 a245, v117
    v_accvgpr_write_b32 a246, v118
    v_accvgpr_write_b32 a247, v119
    v_perm_b32 v120, v65, v64, s60
    v_perm_b32 v121, v69, v68, s60
    v_perm_b32 v122, v67, v66, s60
    v_perm_b32 v123, v71, v70, s60
    v_perm_b32 v124, v73, v72, s60
    v_perm_b32 v125, v77, v76, s60
    v_perm_b32 v126, v75, v74, s60
    v_perm_b32 v127, v79, v78, s60
    v_accvgpr_write_b32 a248, v120
    v_accvgpr_write_b32 a249, v121
    v_accvgpr_write_b32 a250, v122
    v_accvgpr_write_b32 a251, v123
    v_accvgpr_write_b32 a252, v124
    v_accvgpr_write_b32 a253, v125
    v_accvgpr_write_b32 a254, v126
    v_accvgpr_write_b32 a255, v127
    s_xor_b32 s35, s3, 0
    s_lshl_b32 s35, s35, 15
    s_add_u32 s32, s35, 0
    buffer_load_dwordx4 v[16:19], v13, s[28:31], s32 offen
    s_add_u32 s32, s35, 1024
    buffer_load_dwordx4 v[20:23], v13, s[28:31], s32 offen
    s_add_u32 s32, s35, 2048
    buffer_load_dwordx4 v[24:27], v13, s[28:31], s32 offen
    s_add_u32 s32, s35, 3072
    buffer_load_dwordx4 v[28:31], v13, s[28:31], s32 offen
    s_add_u32 s32, s35, 16384
    buffer_load_dwordx4 v[32:35], v13, s[28:31], s32 offen
    s_add_u32 s32, s35, 17408
    buffer_load_dwordx4 v[36:39], v13, s[28:31], s32 offen
    s_add_u32 s32, s35, 18432
    buffer_load_dwordx4 v[40:43], v13, s[28:31], s32 offen
    s_add_u32 s32, s35, 19456
    buffer_load_dwordx4 v[44:47], v13, s[28:31], s32 offen
    s_waitcnt vmcnt(38)
    v_perm_b32 v128, v81, v80, s59
    s_waitcnt vmcnt(34)
    v_perm_b32 v129, v85, v84, s59
    v_perm_b32 v130, v83, v82, s59
    s_waitcnt vmcnt(32)
    v_perm_b32 v131, v87, v86, s59
    s_waitcnt vmcnt(30)
    v_perm_b32 v132, v89, v88, s59
    s_waitcnt vmcnt(26)
    v_perm_b32 v133, v93, v92, s59
    v_perm_b32 v134, v91, v90, s59
    s_waitcnt vmcnt(24)
    v_perm_b32 v135, v95, v94, s59
    v_perm_b32 v136, v81, v80, s60
    v_perm_b32 v137, v85, v84, s60
    v_perm_b32 v138, v83, v82, s60
    v_perm_b32 v139, v87, v86, s60
    v_perm_b32 v140, v89, v88, s60
    v_perm_b32 v141, v93, v92, s60
    v_perm_b32 v142, v91, v90, s60
    v_perm_b32 v143, v95, v94, s60
    s_waitcnt vmcnt(22)
    v_perm_b32 v144, v97, v96, s59
    s_waitcnt vmcnt(18)
    v_perm_b32 v145, v101, v100, s59
    v_perm_b32 v146, v99, v98, s59
    s_waitcnt vmcnt(16)
    v_perm_b32 v147, v103, v102, s59
    s_waitcnt vmcnt(14)
    v_perm_b32 v148, v105, v104, s59
    s_waitcnt vmcnt(10)
    v_perm_b32 v149, v109, v108, s59
    v_perm_b32 v150, v107, v106, s59
    s_waitcnt vmcnt(8)
    v_perm_b32 v151, v111, v110, s59
    v_perm_b32 v152, v97, v96, s60
    v_perm_b32 v153, v101, v100, s60
    v_perm_b32 v154, v99, v98, s60
    v_perm_b32 v155, v103, v102, s60
    v_perm_b32 v156, v105, v104, s60
    v_perm_b32 v157, v109, v108, s60
    v_perm_b32 v158, v107, v106, s60
    v_perm_b32 v159, v111, v110, s60
    s_xor_b32 s35, s3, 1
    s_lshl_b32 s35, s35, 15
    s_add_u32 s32, s35, 0
    buffer_load_dwordx4 v[48:51], v13, s[28:31], s32 offen
    s_add_u32 s32, s35, 1024
    buffer_load_dwordx4 v[52:55], v13, s[28:31], s32 offen
    s_add_u32 s32, s35, 2048
    buffer_load_dwordx4 v[56:59], v13, s[28:31], s32 offen
    s_add_u32 s32, s35, 3072
    buffer_load_dwordx4 v[60:63], v13, s[28:31], s32 offen
    s_add_u32 s32, s35, 16384
    buffer_load_dwordx4 v[64:67], v13, s[28:31], s32 offen
    s_add_u32 s32, s35, 17408
    buffer_load_dwordx4 v[68:71], v13, s[28:31], s32 offen
    s_add_u32 s32, s35, 18432
    buffer_load_dwordx4 v[72:75], v13, s[28:31], s32 offen
    s_add_u32 s32, s35, 19456
    buffer_load_dwordx4 v[76:79], v13, s[28:31], s32 offen
    s_waitcnt vmcnt(14)
    v_perm_b32 v160, v20, v16, s59
    v_perm_b32 v161, v21, v17, s59
    s_waitcnt vmcnt(12)
    v_perm_b32 v162, v28, v24, s59
    v_perm_b32 v163, v29, v25, s59
    s_waitcnt vmcnt(10)
    v_perm_b32 v164, v36, v32, s59
    v_perm_b32 v165, v37, v33, s59
    s_waitcnt vmcnt(8)
    v_perm_b32 v166, v44, v40, s59
    v_perm_b32 v167, v45, v41, s59
    v_perm_b32 v168, v20, v16, s60
    v_perm_b32 v169, v21, v17, s60
    v_perm_b32 v170, v28, v24, s60
    v_perm_b32 v171, v29, v25, s60
    v_perm_b32 v172, v36, v32, s60
    v_perm_b32 v173, v37, v33, s60
    v_perm_b32 v174, v44, v40, s60
    v_perm_b32 v175, v45, v41, s60
    v_perm_b32 v176, v22, v18, s59
    v_perm_b32 v177, v23, v19, s59
    v_perm_b32 v178, v30, v26, s59
    v_perm_b32 v179, v31, v27, s59
    v_perm_b32 v180, v38, v34, s59
    v_perm_b32 v181, v39, v35, s59
    v_perm_b32 v182, v46, v42, s59
    v_perm_b32 v183, v47, v43, s59
    v_perm_b32 v184, v22, v18, s60
    v_perm_b32 v185, v23, v19, s60
    v_perm_b32 v186, v30, v26, s60
    v_perm_b32 v187, v31, v27, s60
    v_perm_b32 v188, v38, v34, s60
    v_perm_b32 v189, v39, v35, s60
    v_perm_b32 v190, v46, v42, s60
    v_perm_b32 v191, v47, v43, s60
    s_xor_b32 s35, s3, 2
    s_lshl_b32 s35, s35, 15
    s_add_u32 s32, s35, 0
    buffer_load_dwordx4 v[80:83], v13, s[28:31], s32 offen
    s_add_u32 s32, s35, 1024
    buffer_load_dwordx4 v[84:87], v13, s[28:31], s32 offen
    s_add_u32 s32, s35, 2048
    buffer_load_dwordx4 v[88:91], v13, s[28:31], s32 offen
    s_add_u32 s32, s35, 3072
    buffer_load_dwordx4 v[92:95], v13, s[28:31], s32 offen
    s_add_u32 s32, s35, 16384
    buffer_load_dwordx4 v[96:99], v13, s[28:31], s32 offen
    s_add_u32 s32, s35, 17408
    buffer_load_dwordx4 v[100:103], v13, s[28:31], s32 offen
    s_add_u32 s32, s35, 18432
    buffer_load_dwordx4 v[104:107], v13, s[28:31], s32 offen
    s_add_u32 s32, s35, 19456
    buffer_load_dwordx4 v[108:111], v13, s[28:31], s32 offen
    s_waitcnt vmcnt(14)
    v_perm_b32 v192, v52, v48, s59
    v_perm_b32 v193, v53, v49, s59
    s_waitcnt vmcnt(12)
    v_perm_b32 v194, v60, v56, s59
    v_perm_b32 v195, v61, v57, s59
    s_waitcnt vmcnt(10)
    v_perm_b32 v196, v68, v64, s59
    v_perm_b32 v197, v69, v65, s59
    s_waitcnt vmcnt(8)
    v_perm_b32 v198, v76, v72, s59
    v_perm_b32 v199, v77, v73, s59
    v_perm_b32 v200, v52, v48, s60
    v_perm_b32 v201, v53, v49, s60
    v_perm_b32 v202, v60, v56, s60
    v_perm_b32 v203, v61, v57, s60
    v_perm_b32 v204, v68, v64, s60
    v_perm_b32 v205, v69, v65, s60
    v_perm_b32 v206, v76, v72, s60
    v_perm_b32 v207, v77, v73, s60
    v_perm_b32 v240, v54, v50, s59
    v_perm_b32 v241, v55, v51, s59
    v_perm_b32 v242, v62, v58, s59
    v_perm_b32 v243, v63, v59, s59
    v_perm_b32 v244, v70, v66, s59
    v_perm_b32 v245, v71, v67, s59
    v_perm_b32 v246, v78, v74, s59
    v_perm_b32 v247, v79, v75, s59
    v_perm_b32 v248, v54, v50, s60
    v_perm_b32 v249, v55, v51, s60
    v_perm_b32 v250, v62, v58, s60
    v_perm_b32 v251, v63, v59, s60
    v_perm_b32 v252, v70, v66, s60
    v_perm_b32 v253, v71, v67, s60
    v_perm_b32 v254, v78, v74, s60
    v_perm_b32 v255, v79, v75, s60
    s_xor_b32 s35, s3, 3
    s_lshl_b32 s35, s35, 15
    s_add_u32 s32, s35, 0
    buffer_load_dwordx4 v[16:19], v13, s[28:31], s32 offen
    s_add_u32 s32, s35, 1024
    buffer_load_dwordx4 v[20:23], v13, s[28:31], s32 offen
    s_add_u32 s32, s35, 2048
    buffer_load_dwordx4 v[24:27], v13, s[28:31], s32 offen
    s_add_u32 s32, s35, 3072
    buffer_load_dwordx4 v[28:31], v13, s[28:31], s32 offen
    s_add_u32 s32, s35, 16384
    buffer_load_dwordx4 v[32:35], v13, s[28:31], s32 offen
    s_add_u32 s32, s35, 17408
    buffer_load_dwordx4 v[36:39], v13, s[28:31], s32 offen
    s_add_u32 s32, s35, 18432
    buffer_load_dwordx4 v[40:43], v13, s[28:31], s32 offen
    s_add_u32 s32, s35, 19456
    buffer_load_dwordx4 v[44:47], v13, s[28:31], s32 offen
    s_waitcnt vmcnt(14)
    v_perm_b32 v208, v84, v80, s59
    v_perm_b32 v209, v85, v81, s59
    s_waitcnt vmcnt(12)
    v_perm_b32 v210, v92, v88, s59
    v_perm_b32 v211, v93, v89, s59
    s_waitcnt vmcnt(10)
    v_perm_b32 v212, v100, v96, s59
    v_perm_b32 v213, v101, v97, s59
    s_waitcnt vmcnt(8)
    v_perm_b32 v214, v108, v104, s59
    v_perm_b32 v215, v109, v105, s59
    v_perm_b32 v216, v84, v80, s60
    v_perm_b32 v217, v85, v81, s60
    v_perm_b32 v218, v92, v88, s60
    v_perm_b32 v219, v93, v89, s60
    v_perm_b32 v220, v100, v96, s60
    v_perm_b32 v221, v101, v97, s60
    v_perm_b32 v222, v108, v104, s60
    v_perm_b32 v223, v109, v105, s60
    v_perm_b32 v112, v86, v82, s59
    v_perm_b32 v113, v87, v83, s59
    v_perm_b32 v114, v94, v90, s59
    v_perm_b32 v115, v95, v91, s59
    v_perm_b32 v116, v102, v98, s59
    v_perm_b32 v117, v103, v99, s59
    v_perm_b32 v118, v110, v106, s59
    v_perm_b32 v119, v111, v107, s59
    ds_write_b128 v4, v[112:115] offset:24576
    ds_write_b128 v4, v[116:119] offset:25600
    v_perm_b32 v120, v86, v82, s60
    v_perm_b32 v121, v87, v83, s60
    v_perm_b32 v122, v94, v90, s60
    v_perm_b32 v123, v95, v91, s60
    v_perm_b32 v124, v102, v98, s60
    v_perm_b32 v125, v103, v99, s60
    v_perm_b32 v126, v110, v106, s60
    v_perm_b32 v127, v111, v107, s60
    ds_write_b128 v4, v[120:123] offset:28672
    ds_write_b128 v4, v[124:127] offset:29696
    s_waitcnt vmcnt(6)
    v_perm_b32 v224, v20, v16, s59
    v_perm_b32 v225, v21, v17, s59
    s_waitcnt vmcnt(4)
    v_perm_b32 v226, v28, v24, s59
    v_perm_b32 v227, v29, v25, s59
    s_waitcnt vmcnt(2)
    v_perm_b32 v228, v36, v32, s59
    v_perm_b32 v229, v37, v33, s59
    s_waitcnt vmcnt(0)
    v_perm_b32 v230, v44, v40, s59
    v_perm_b32 v231, v45, v41, s59
    v_perm_b32 v232, v20, v16, s60
    v_perm_b32 v233, v21, v17, s60
    v_perm_b32 v234, v28, v24, s60
    v_perm_b32 v235, v29, v25, s60
    v_perm_b32 v236, v36, v32, s60
    v_perm_b32 v237, v37, v33, s60
    v_perm_b32 v238, v44, v40, s60
    v_perm_b32 v239, v45, v41, s60
    v_perm_b32 v112, v22, v18, s59
    v_perm_b32 v113, v23, v19, s59
    v_perm_b32 v114, v30, v26, s59
    v_perm_b32 v115, v31, v27, s59
    v_perm_b32 v116, v38, v34, s59
    v_perm_b32 v117, v39, v35, s59
    v_perm_b32 v118, v46, v42, s59
    v_perm_b32 v119, v47, v43, s59
    ds_write_b128 v4, v[112:115] offset:26624
    ds_write_b128 v4, v[116:119] offset:27648
    v_perm_b32 v120, v22, v18, s60
    v_perm_b32 v121, v23, v19, s60
    v_perm_b32 v122, v30, v26, s60
    v_perm_b32 v123, v31, v27, s60
    v_perm_b32 v124, v38, v34, s60
    v_perm_b32 v125, v39, v35, s60
    v_perm_b32 v126, v46, v42, s60
    v_perm_b32 v127, v47, v43, s60
    ds_write_b128 v4, v[120:123] offset:30720
    ds_write_b128 v4, v[124:127] offset:31744
    s_cmp_ge_i32 s63, 0
    s_cbranch_scc1 Lanns_19
    v_and_b32 v16, 63, v0
    v_lshlrev_b32 v16, 2, v16
Lann_17:
    buffer_load_dword v17, v16, s[12:15], 0 offen sc1
Lannc_20:
    s_waitcnt vmcnt(0)
    v_and_b32 v19, 0x0f0f0f0f, v17
    v_subrev_u32 v18, 0x01010101, v19
    v_and_b32 v18, 0x80808080, v18
    v_cmp_ne_u32 vcc, 0, v18
    s_nop 0
    s_cbranch_vccz Lannd_18
    s_sub_u32 s62, s62, 1
    s_cbranch_scc0 Ltok_21
    s_movk_i32 s61, 1
    s_branch L_abort
Ltok_21:
    s_sleep 4
    s_branch Lann_17
Lannd_18:
    s_getreg_b32 s32, hwreg(HW_REG_XCC_ID)
    s_and_b32 s32, s32, 15
    s_min_u32 s32, s32, 14
    s_add_u32 s32, s32, 1
    s_mul_i32 s32, s32, 0x11111111
    v_cmp_ne_u32 vcc, s32, v17
    s_not_b32 s33, s63
    s_lshl_b32 s33, s33, 3
    s_lshr_b64 s[34:35], vcc, s33
    s_and_b32 s34, s34, 0xff
    s_cmp_lg_u32 s34, 0
    s_cselect_b32 s63, 1, 0
Lanns_19:
    v_and_b32 v60, 63, v0
    v_and_b32 v61, 15, v60
    v_lshrrev_b32 v62, 4, v60
    s_lshl_b32 s32, s3, 11
    v_add_u32 v0, s32, v5
    v_xor_b32 v1, 0x800, v0
    v_xor_b32 v2, 0x1000, v0
    v_xor_b32 v3, 0x1800, v0
    s_mov_b32 s16, s80
    s_and_b32 s17, s81, 0xffff
    s_mov_b32 s18, 8192
    s_mov_b32 s19, 0x20000
    v_and_b32 v63, 7, v61
    v_lshlrev_b32 v63, 10, v63
    v_lshrrev_b32 v64, 1, v62
    v_lshl_add_u32 v63, v64, 6, v63
    v_lshrrev_b32 v64, 3, v61
    v_lshl_add_u32 v63, v64, 3, v63
    v_and_b32 v64, 1, v62
    v_lshl_add_u32 v63, v64, 2, v63
    s_lshl_b32 s32, s3, 8
    buffer_load_dword v16, v63, s[16:19], s32 offen offset:0
    buffer_load_dword v17, v63, s[16:19], s32 offen offset:16
    buffer_load_dword v18, v63, s[16:19], s32 offen offset:32
    buffer_load_dword v19, v63, s[16:19], s32 offen offset:48
    buffer_load_dword v20, v63, s[16:19], s32 offen offset:128
    buffer_load_dword v21, v63, s[16:19], s32 offen offset:144
    buffer_load_dword v22, v63, s[16:19], s32 offen offset:160
    buffer_load_dword v23, v63, s[16:19], s32 offen offset:176
    v_mov_b32 v65, 0x4444
    v_mov_b32 v66, 0xeeee
    v_cmp_gt_u32 vcc, 8, v61
    s_nop 1
    v_cndmask_b32 v12, v66, v65, vcc
    v_lshrrev_b32 v63, 2, v61
    v_mul_u32_u24 v63, 384, v63
    v_bfe_u32 v64, v61, 1, 1
    v_mul_u32_u24 v64, 144, v64
    v_add_u32 v63, v63, v64
    v_and_b32 v64, 1, v61
    v_lshl_add_u32 v63, v64, 6, v63
    v_lshl_add_u32 v63, v62, 4, v63
    s_mul_i32 s32, s3, 1536
    v_add_u32 v6, s32, v63
    v_mul_u32_u24 v63, 384, v62
    v_lshrrev_b32 v64, 3, v61
    v_lshl_add_u32 v63, v64, 6, v63
    v_and_b32 v64, 3, v61
    v_lshl_add_u32 v63, v64, 4, v63
    v_bfe_u32 v64, v61, 2, 1
    v_lshl_add_u32 v7, v64, 3, v63
    v_mov_b32 v8, -1
    v_lshrrev_b32 v63, 2, v61
    v_lshlrev_b32 v63, 14, v63
    v_lshrrev_b32 v64, 1, v62
    v_lshl_add_u32 v63, v64, 13, v63
    v_and_b32 v64, 1, v62
    v_lshl_add_u32 v63, v64, 11, v63
    v_and_b32 v64, 3, v61
    v_lshl_add_u32 v63, v64, 4, v63
    s_lshl_b32 s32, s3, 16
    s_lshl_b32 s33, s5, 6
    s_add_u32 s32, s32, s33
    v_add_u32 v9, s32, v63
    v_and_b32 v63, 12, v61
    v_add_u32 v63, v63, v62
    v_lshlrev_b32 v63, 7, v63
    v_xor_b32 v9, v9, v63
    s_lshl_b32 s32, s6, 18
    s_add_u32 s41, s32, 1048576
    s_add_u32 s42, s32, 1052672
    s_lshl_b32 s32, s5, 13
    v_add_u32 v10, s32, v0
    v_and_b32 v63, 3, v61
    v_lshlrev_b32 v63, 4, v63
    v_lshl_add_u32 v63, v62, 2, v63
    s_lshl_b32 s32, s5, 8
    s_lshl_b32 s33, s3, 6
    s_add_u32 s32, s32, s33
    v_add_u32 v11, s32, v63
    v_cmp_gt_u32 vcc, 4, v61
    v_bfrev_b32 v63, 1
    s_nop 0
    v_cndmask_b32 v11, v63, v11, vcc
    v_and_b32 v63, 1, v62
    v_lshlrev_b32 v63, 25, v63
    v_lshl_add_u32 v63, v61, 7, v63
    s_lshl_b32 s32, s3, 11
    v_add_u32 v14, s32, v63
    s_add_u32 s43, s32, 8192
    v_and_b32 v63, 1, v61
    v_lshlrev_b32 v63, 4, v63
    v_mov_b32 v64, 0x3f80
    v_lshlrev_b32 v64, v63, v64
    v_bfe_u32 v63, v61, 1, 2
    v_cmp_eq_u32 vcc, 0, v63
    s_nop 1
    v_cndmask_b32 v68, 0, v64, vcc
    v_cmp_eq_u32 vcc, 1, v63
    s_nop 1
    v_cndmask_b32 v69, 0, v64, vcc
    v_cmp_eq_u32 vcc, 2, v63
    s_nop 1
    v_cndmask_b32 v70, 0, v64, vcc
    v_cmp_eq_u32 vcc, 3, v63
    s_nop 1
    v_cndmask_b32 v71, 0, v64, vcc
    ds_write_b128 v5, v[68:71] offset:28672
    s_mov_b32 s44, 0xffffff7f
    s_mov_b32 s48, 1040356334
    s_mov_b32 s49, 1040356334
    s_lshl_b32 s32, s6, 24
    s_lshl_b32 s61, s5, 13
    s_add_u32 s32, s32, s61
    s_add_u32 s33, s32, 16777216
    s_add_u32 s51, s33, 16252928
    s_add_u32 s35, s32, 117440512
    s_lshl_b32 s32, s6, 19
    s_lshl_b32 s61, s5, 8
    s_add_u32 s32, s32, s61
    s_add_u32 s36, s32, 4194304
    s_add_u32 s52, s36, 507904
    s_add_u32 s47, s36, 8192
    s_lshl_b32 s61, s3, 4
    s_add_u32 s32, s32, s61
    s_add_u32 s46, s32, 4194496
    s_add_u32 s37, s32, 4194368
    s_lshl_b32 s32, s6, 15
    s_add_u32 s39, s32, 2097152
    s_add_u32 s38, s32, 2105344
    s_add_u32 s40, s32, 2113536
    s_mov_b32 s32, 0
    s_mov_b32 s37, 0
    v_mov_b32 v13, 1
    s_mov_b32 s50, s33
    s_mov_b32 s53, 0
Lkv0_22:
    s_mov_b64 exec, 63
    buffer_load_dword v13, v5, s[8:11], s36 offen sc1
    s_mov_b64 exec, -1
    s_sub_u32 s62, s62, 1
    s_cbranch_scc0 Ltok_23
    s_movk_i32 s61, 2
    s_branch L_abort
Ltok_23:
    s_waitcnt vmcnt(0)
    v_cmp_eq_u32 vcc, 0, v13
    s_nop 0
    s_cbranch_vccnz Lkv0_22
    buffer_load_dword v15, v14, s[8:11], s50 offen
    s_mov_b32 s36, s47
    s_add_u32 s47, s47, 8192
    s_min_u32 s47, s47, s52
    s_mov_b64 exec, 63
    buffer_load_dword v13, v5, s[8:11], s36 offen sc1
    s_mov_b64 exec, -1
    s_mov_b32 s33, s50
    s_add_u32 s34, s33, 33554432
    s_add_u32 s50, s33, 262144
    s_min_u32 s50, s50, s51
    s_mov_b32 m0, s43
    s_nop 0
    buffer_load_dwordx4 v0, s[8:11], s33 offen lds
    buffer_load_dwordx4 v0, s[8:11], s33 offen offset:1024 lds
    s_waitcnt lgkmcnt(0)
    ds_read_b128 v[24:27], v4 offset:0
    ds_read_b128 v[28:31], v4 offset:1024
    ds_read_b128 v[32:35], v4 offset:2048
    ds_read_b128 v[36:39], v4 offset:3072
    ds_read_b128 v[40:43], v4 offset:4096
    ds_read_b128 v[44:47], v4 offset:5120
    ds_read_b128 v[80:83], v4 offset:6144
    ds_read_b128 v[84:87], v4 offset:7168
    ds_read_b128 v[88:91], v4 offset:8192
    ds_read_b128 v[92:95], v4 offset:9216
    ds_read_b128 v[96:99], v4 offset:10240
    ds_read_b128 v[100:103], v4 offset:11264
    ds_read_b128 v[104:107], v4 offset:12288
    ds_read_b128 v[108:111], v4 offset:13312
    ds_read_b128 v[112:115], v4 offset:14336
    ds_read_b128 v[116:119], v4 offset:15360
    ds_read_b128 v[120:123], v4 offset:16384
    ds_read_b128 v[124:127], v4 offset:17408
    ds_read_b128 v[72:75], v4 offset:18432
    ds_read_b128 v[76:79], v4 offset:19456
    v_mov_b32 v48, 0
    v_mov_b32 v49, 0
    v_mov_b32 v50, 0
    v_mov_b32 v51, 0
    v_mov_b32 v52, 0
    v_mov_b32 v53, 0
    v_mov_b32 v54, 0
    v_mov_b32 v55, 0
    v_mov_b32 v56, 0
    v_mov_b32 v57, 0
    v_mov_b32 v58, 0
    v_mov_b32 v59, 0
    v_mov_b32 v60, 0
    v_mov_b32 v61, 0
    v_mov_b32 v62, 0
    v_mov_b32 v63, 0
    v_mov_b32 v64, 0
    v_mov_b32 v65, 0
    v_mov_b32 v66, 0
    v_mov_b32 v67, 0
    v_mov_b32 v68, 0
    v_mov_b32 v69, 0
    v_mov_b32 v70, 0
    v_mov_b32 v71, 0
    s_waitcnt vmcnt(0) lgkmcnt(0)
    v_min_u32 v16, -2, v16
    v_min_u32 v17, -2, v17
    v_min_u32 v18, -2, v18
    v_min_u32 v19, -2, v19
    v_min_u32 v20, -2, v20
    v_min_u32 v21, -2, v21
    v_min_u32 v22, -2, v22
    v_min_u32 v23, -2, v23
    s_cmp_lg_u32 s63, 0
    s_cbranch_scc1 L_rec_slow_in
    s_branch L_rec_fast_in
L_rec_fast:
Lh2_24:
L_rec_fast_in:
    s_waitcnt vmcnt(2) lgkmcnt(0)
    v_max3_u32 v15, v16, v17, v18
    v_max3_u32 v15, v15, v19, v20
    v_max3_u32 v15, v15, v21, v22
    v_max_u32 v15, v15, v23
    v_cmp_eq_u32 vcc, -1, v15
    ds_write_b128 v0, v[16:19] offset:0
    s_cbranch_vccnz Lh2b_25
    ds_write_b128 v0, v[20:23] offset:1024
    v_smfmac_f32_16x16x64_bf16 v[48:51], v[16:19], v[24:31], v12
    v_smfmac_f32_16x16x64_bf16 v[52:55], v[16:19], v[32:39], v12
    v_smfmac_f32_16x16x64_bf16 v[56:59], v[16:19], v[40:47], v12
    v_smfmac_f32_16x16x64_bf16 v[60:63], v[16:19], v[80:87], v12
    v_smfmac_f32_16x16x64_bf16 v[64:67], v[16:19], v[88:95], v12
    v_smfmac_f32_16x16x64_bf16 v[68:71], v[16:19], v[96:103], v12
    s_waitcnt lgkmcnt(0)
    s_barrier
    ds_read_b128 v[24:27], v1 offset:0
    ds_read_b128 v[28:31], v1 offset:1024
    v_smfmac_f32_16x16x64_bf16 v[48:51], v[20:23], v[104:111], v12
    ds_read_b128 v[32:35], v2 offset:0
    v_smfmac_f32_16x16x64_bf16 v[52:55], v[20:23], v[112:119], v12
    ds_read_b128 v[36:39], v2 offset:1024
    v_smfmac_f32_16x16x64_bf16 v[56:59], v[20:23], v[120:127], v12
    ds_read_b128 v[40:43], v3 offset:0
    v_smfmac_f32_16x16x64_bf16 v[60:63], v[20:23], v[72:79], v12
    ds_read_b128 v[44:47], v3 offset:1024
    v_smfmac_f32_16x16x64_bf16 v[64:67], v[20:23], a[0:7], v12
    buffer_load_dwordx4 v[72:75], v0, s[8:11], s34 offen
    v_smfmac_f32_16x16x64_bf16 v[68:71], v[20:23], a[8:15], v12
    ds_read_b128 v[96:99], v5 offset:8192
    s_waitcnt lgkmcnt(5)
    v_smfmac_f32_16x16x64_bf16 v[56:59], v[24:27], a[16:23], v12
    ds_read_b128 v[100:103], v5 offset:9216
    v_smfmac_f32_16x16x64_bf16 v[60:63], v[24:27], a[24:31], v12
    ds_read_b128 v[104:107], v5 offset:10240
    v_smfmac_f32_16x16x64_bf16 v[56:59], v[28:31], a[32:39], v12
    ds_read_b128 v[108:111], v5 offset:11264
    v_smfmac_f32_16x16x64_bf16 v[60:63], v[28:31], a[40:47], v12
    ds_read_b128 v[112:115], v5 offset:12288
    s_waitcnt lgkmcnt(5)
    v_smfmac_f32_16x16x64_bf16 v[56:59], v[32:35], a[48:55], v12
    ds_read_b128 v[116:119], v5 offset:13312
    v_smfmac_f32_16x16x64_bf16 v[60:63], v[32:35], a[56:63], v12
    ds_read_b128 v[120:123], v5 offset:14336
    v_smfmac_f32_16x16x64_bf16 v[56:59], v[36:39], a[64:71], v12
    ds_read_b128 v[124:127], v5 offset:15360
    v_smfmac_f32_16x16x64_bf16 v[60:63], v[36:39], a[72:79], v12
    buffer_load_dwordx4 v[76:79], v0, s[8:11], s34 offen offset:1024
    v_smfmac_f32_16x16x64_bf16 v[56:59], v[40:43], a[80:87], v12
    v_cmp_eq_u32 vcc, 0, v13
    v_smfmac_f32_16x16x64_bf16 v[60:63], v[40:43], a[88:95], v12
    v_smfmac_f32_16x16x64_bf16 v[56:59], v[44:47], a[96:103], v12
    s_cbranch_vccnz Lkvw_26
    buffer_load_dword v15, v14, s[8:11], s50 offen
Lkvb_27:
    v_smfmac_f32_16x16x64_bf16 v[60:63], v[44:47], a[104:111], v12
    v_smfmac_f32_16x16x64_bf16 v[48:51], v[24:27], a[112:119], v12
    v_smfmac_f32_16x16x64_bf16 v[52:55], v[24:27], a[120:127], v12
    v_smfmac_f32_16x16x64_bf16 v[48:51], v[28:31], a[128:135], v12
    ds_read_b128 v[80:83], v4 offset:20480
    v_smfmac_f32_16x16x64_bf16 v[52:55], v[28:31], a[136:143], v12
    ds_read_b128 v[84:87], v4 offset:21504
    v_smfmac_f32_16x16x64_bf16 v[48:51], v[32:35], a[144:151], v12
    ds_read_b128 v[88:91], v4 offset:22528
    v_smfmac_f32_16x16x64_bf16 v[52:55], v[32:35], a[152:159], v12
    ds_read_b128 v[92:95], v4 offset:23552
    v_smfmac_f32_16x16x64_bf16 v[48:51], v[36:39], a[160:167], v12
    s_waitcnt vmcnt(3)
    v_cvt_pk_bf16_f32 v20, v56, v57
    v_smfmac_f32_16x16x64_bf16 v[52:55], v[36:39], a[168:175], v12
    v_cvt_pk_bf16_f32 v21, v58, v59
    v_smfmac_f32_16x16x64_bf16 v[48:51], v[40:43], a[176:183], v12
    v_cvt_pk_bf16_f32 v22, v60, v61
    v_smfmac_f32_16x16x64_bf16 v[48:51], v[44:47], a[184:191], v12
    v_cvt_pk_bf16_f32 v23, v62, v63
    v_smfmac_f32_16x16x64_bf16 v[52:55], v[40:43], a[192:199], v12
    ds_write_b128 v6, v[20:23] offset:22528
    v_smfmac_f32_16x16x64_bf16 v[52:55], v[44:47], a[200:207], v12
    buffer_store_dword v8, v11, s[8:11], s40 offen
    v_smfmac_f32_16x16x64_bf16 v[64:67], v[24:27], a[208:215], v12
    v_cvt_pk_bf16_f32 v16, v48, v49
    v_cvt_pk_bf16_f32 v17, v50, v51
    v_smfmac_f32_16x16x64_bf16 v[68:71], v[24:27], a[216:223], v12
    v_cvt_pk_bf16_f32 v18, v52, v53
    v_cvt_pk_bf16_f32 v19, v54, v55
    ds_write_b128 v6, v[16:19] offset:16384
    v_smfmac_f32_16x16x64_bf16 v[64:67], v[28:31], a[224:231], v12
    v_smfmac_f32_16x16x64_bf16 v[68:71], v[28:31], a[232:239], v12
    s_waitcnt lgkmcnt(4)
    v_smfmac_f32_16x16x64_bf16 v[64:67], v[32:35], v[80:87], v12
    s_waitcnt lgkmcnt(2)
    v_smfmac_f32_16x16x64_bf16 v[68:71], v[32:35], v[88:95], v12
    v_smfmac_f32_16x16x64_bf16 v[64:67], v[36:39], a[240:247], v12
    v_smfmac_f32_16x16x64_bf16 v[68:71], v[36:39], a[248:255], v12
    v_and_or_b32 v20, v20, -2, s37
    buffer_store_dwordx4 v[20:23], v0, s[8:11], s35 offen sc1
    s_waitcnt lgkmcnt(0)
    s_barrier
    ds_read_b64_tr_b16 v[80:81], v7 offset:16384
    ds_read_b64_tr_b16 v[82:83], v7 offset:16528
    ds_read_b64_tr_b16 v[56:57], v7 offset:22528
    ds_read_b64_tr_b16 v[58:59], v7 offset:22672
    v_smfmac_f32_16x16x64_bf16 v[64:67], v[40:43], v[128:135], v12
    ds_read_b64_tr_b16 v[84:85], v7 offset:17920
    ds_read_b64_tr_b16 v[86:87], v7 offset:18064
    ds_read_b64_tr_b16 v[60:61], v7 offset:24064
    ds_read_b64_tr_b16 v[62:63], v7 offset:24208
    v_smfmac_f32_16x16x64_bf16 v[68:71], v[40:43], v[136:143], v12
    ds_read_b64_tr_b16 v[88:89], v7 offset:19456
    ds_read_b64_tr_b16 v[90:91], v7 offset:19600
    ds_read_b64_tr_b16 v[24:25], v7 offset:25600
    ds_read_b64_tr_b16 v[26:27], v7 offset:25744
    v_smfmac_f32_16x16x64_bf16 v[64:67], v[44:47], v[144:151], v12
    ds_read_b64_tr_b16 v[92:93], v7 offset:20992
    ds_read_b64_tr_b16 v[94:95], v7 offset:21136
    ds_read_b64_tr_b16 v[28:29], v7 offset:27136
    ds_read_b64_tr_b16 v[30:31], v7 offset:27280
    v_smfmac_f32_16x16x64_bf16 v[68:71], v[44:47], v[152:159], v12
    s_waitcnt lgkmcnt(14)
    v_mfma_f32_16x16x32_bf16 v[48:51], v[96:99], v[80:83], 0
    s_waitcnt lgkmcnt(12)
    v_mfma_f32_16x16x32_bf16 v[16:19], v[56:59], v[80:83], 0
    v_mov_b32 v56, 0x3f803f80
    v_mov_b32 v57, 0x3f803f80
    v_mfma_f32_16x16x32_bf16 v[52:55], v[100:103], v[80:83], 0
    v_mov_b32 v58, 0x3f803f80
    s_waitcnt lgkmcnt(8)
    v_mfma_f32_16x16x32_bf16 v[16:19], v[60:63], v[84:87], v[16:19]
    v_mov_b32 v59, 0x3f803f80
    v_mov_b32 v60, 0x3f003f00
    v_mfma_f32_16x16x32_bf16 v[48:51], v[104:107], v[84:87], v[48:51]
    v_mov_b32 v61, 0x3f003f00
    s_waitcnt lgkmcnt(4)
    v_mfma_f32_16x16x32_bf16 v[16:19], v[24:27], v[88:91], v[16:19]
    v_mfma_f32_16x16x32_bf16 v[52:55], v[108:111], v[84:87], v[52:55]
    s_waitcnt lgkmcnt(0)
    v_mfma_f32_16x16x32_bf16 v[16:19], v[28:31], v[92:95], v[16:19]
    s_cmp_lg_u32 s53, 0
    s_cbranch_scc1 Lkvx_28
Lkvy_29:
    ds_read_b128 v[96:99], v4 offset:24576
    ds_read_b128 v[100:103], v4 offset:25600
    v_mfma_f32_16x16x32_bf16 v[48:51], v[112:115], v[88:91], v[48:51]
    ds_read_b128 v[80:83], v4 offset:26624
    ds_read_b128 v[84:87], v4 offset:27648
    v_mfma_f32_16x16x32_bf16 v[48:51], v[120:123], v[92:95], v[48:51]
    ds_read_b128 v[104:107], v4 offset:28672
    ds_read_b128 v[108:111], v4 offset:29696
    v_mfma_f32_16x16x32_bf16 v[52:55], v[116:119], v[88:91], v[52:55]
    v_permlane32_swap_b32 v16, v18
    v_permlane32_swap_b32 v17, v19
    v_mfma_f32_16x16x32_bf16 v[52:55], v[124:127], v[92:95], v[52:55]
    v_add_f32 v16, v16, v18
    v_add_f32 v17, v17, v19
    v_add_f32_dpp v48, v48, v48 row_ror:8 row_mask:0xf bank_mask:0x3
    v_add_f32_dpp v49, v49, v49 row_ror:8 row_mask:0xf bank_mask:0x3
    v_add_f32_dpp v16, v16, v16 row_ror:8 row_mask:0xf bank_mask:0x3
    v_add_f32_dpp v50, v50, v50 row_ror:8 row_mask:0xf bank_mask:0x3
    v_add_f32_dpp v51, v51, v51 row_ror:8 row_mask:0xf bank_mask:0x3
    v_add_f32_dpp v16, v17, v17 row_ror:8 row_mask:0xf bank_mask:0xc
    v_add_f32_dpp v48, v52, v52 row_ror:8 row_mask:0xf bank_mask:0xc
    v_add_f32_dpp v49, v53, v53 row_ror:8 row_mask:0xf bank_mask:0xc
    v_add_f32_dpp v50, v54, v54 row_ror:8 row_mask:0xf bank_mask:0xc
    v_add_f32_dpp v51, v55, v55 row_ror:8 row_mask:0xf bank_mask:0xc
    v_max3_f32 v52, v48, v49, v16
    v_max3_f32 v52, v52, v50, v51
    v_cvt_pk_bf16_f32 v44, v64, v65
    v_cvt_pk_bf16_f32 v45, v66, v67
    v_max_f32_dpp v52, v52, v52 row_ror:8 row_mask:0xf bank_mask:0xf
    v_mov_b32 v53, v52
    v_cvt_pk_bf16_f32 v46, v68, v69
    v_cvt_pk_bf16_f32 v47, v70, v71
    v_permlane16_swap_b32 v52, v53
    v_max_f32 v52, v52, v53
    v_mov_b32 v53, v52
    v_and_or_b32 v44, v44, -2, s37
    buffer_store_dwordx4 v[44:47], v0, s[8:11], s35 offen offset:1024 sc1
    v_permlane32_swap_b32 v52, v53
    v_max_f32 v52, v52, v53
    v_mul_f32 v52, s48, v52
    v_fma_f32 v16, v16, s48, -v52
    v_pk_fma_f32 v[48:49], v[48:49], s[48:49], v[52:53] op_sel_hi:[1,1,0] neg_lo:[0,0,1] neg_hi:[0,0,1]
    v_pk_fma_f32 v[50:51], v[50:51], s[48:49], v[52:53] op_sel_hi:[1,1,0] neg_lo:[0,0,1] neg_hi:[0,0,1]
    v_exp_f32 v48, v48
    v_exp_f32 v49, v49
    v_exp_f32 v50, v50
    v_exp_f32 v51, v51
    v_cvt_pk_bf16_f32 v28, v48, v49
    v_cvt_pk_bf16_f32 v29, v50, v51
    v_exp_f32 v16, v16
    v_mov_b32_dpp v30, v28 row_ror:8 row_mask:0xf bank_mask:0xf
    v_mov_b32_dpp v31, v29 row_ror:8 row_mask:0xf bank_mask:0xf
    v_mov_b32_dpp v17, v16 row_ror:8 row_mask:0xf bank_mask:0xf
    v_cvt_pk_bf16_f32 v62, v16, v17
    v_mfma_f32_16x16x32_bf16 v[40:43], v[56:59], v[28:31], 0
    v_cvt_pk_bf16_f32 v63, v16, v17
    s_nop 0
    s_waitcnt vmcnt(5)
    v_mfma_f32_16x16x32_bf16 v[32:35], v[72:75], v[28:31], 0
    v_permlane32_swap_b32 v62, v63
    s_nop 0
    s_waitcnt vmcnt(4)
    v_mfma_f32_16x16x32_bf16 v[36:39], v[76:79], v[28:31], 0
    s_nop 0
    s_nop 0
    v_mfma_f32_16x16x16_bf16 v[40:43], v[60:61], v[62:63], v[40:43]
    v_mov_b32 v16, 0
    v_mov_b32 v17, 0
    v_mov_b32 v18, 0
    v_mfma_f32_16x16x16_bf16 v[32:35], v[44:45], v[62:63], v[32:35]
    v_mov_b32 v19, 0
    v_mov_b32 v24, 0
    s_cmp_ge_u32 s32, 63
    v_mfma_f32_16x16x16_bf16 v[36:39], v[46:47], v[62:63], v[36:39]
    v_mov_b32 v25, 0
    v_rcp_f32 v40, v40
    v_mov_b32 v26, 0
    v_mov_b32 v27, 0
    v_mov_b32 v28, 0
    v_mov_b32 v29, 0
    v_pk_mul_f32 v[32:33], v[32:33], v[40:41] op_sel_hi:[1,0]
    v_pk_mul_f32 v[34:35], v[34:35], v[40:41] op_sel_hi:[1,0]
    v_pk_mul_f32 v[36:37], v[36:37], v[40:41] op_sel_hi:[1,0]
    v_pk_mul_f32 v[38:39], v[38:39], v[40:41] op_sel_hi:[1,0]
    v_cvt_pk_bf16_f32 v48, v32, v36
    v_cvt_pk_bf16_f32 v49, v33, v37
    v_cvt_pk_bf16_f32 v50, v34, v38
    v_cvt_pk_bf16_f32 v51, v35, v39
    ds_write_b128 v0, v[48:51] offset:0
    v_and_b32 v32, s44, v1
    v_and_b32 v36, s44, v2
    v_and_b32 v40, s44, v3
    s_cbranch_scc1 L_rec_done
    v_mov_b32_dpp v48, v48 row_ror:8 row_mask:0xf bank_mask:0xc
    v_mov_b32_dpp v49, v49 row_ror:8 row_mask:0xf bank_mask:0xc
    v_mov_b32_dpp v50, v50 row_ror:8 row_mask:0xf bank_mask:0xc
    v_mov_b32_dpp v51, v51 row_ror:8 row_mask:0xf bank_mask:0xc
    v_mov_b32 v30, 0
    v_mov_b32 v31, 0
    v_smfmac_f32_16x16x64_bf16 v[16:19], v[48:51], v[160:167], v12
    v_mov_b32 v20, 0
    v_smfmac_f32_16x16x64_bf16 v[24:27], v[48:51], v[176:183], v12
    v_mov_b32 v21, 0
    v_mov_b32 v22, 0
    v_mov_b32 v23, 0
    s_mov_b64 exec, 63
    buffer_load_dword v13, v5, s[8:11], s47 offen sc1
    s_mov_b64 exec, -1
    s_waitcnt lgkmcnt(0)
    s_barrier
    ds_read_b128 v[32:35], v32 offset:0
    ds_read_b128 v[36:39], v36 offset:0
    ds_read_b128 v[40:43], v40 offset:0
    v_smfmac_f32_16x16x64_bf16 v[28:31], v[48:51], v[184:191], v12
    ds_read_b128 v[88:91], v4 offset:30720
    ds_read_b128 v[92:95], v4 offset:31744
    v_smfmac_f32_16x16x64_bf16 v[20:23], v[48:51], v[168:175], v12
    s_waitcnt lgkmcnt(4)
    v_smfmac_f32_16x16x64_bf16 v[16:19], v[32:35], v[192:199], v12
    v_smfmac_f32_16x16x64_bf16 v[20:23], v[32:35], v[200:207], v12
    s_waitcnt lgkmcnt(3)
    v_smfmac_f32_16x16x64_bf16 v[16:19], v[36:39], v[208:215], v12
    v_smfmac_f32_16x16x64_bf16 v[20:23], v[36:39], v[216:223], v12
    s_waitcnt lgkmcnt(2)
    v_smfmac_f32_16x16x64_bf16 v[16:19], v[40:43], v[224:231], v12
    v_smfmac_f32_16x16x64_bf16 v[20:23], v[40:43], v[232:239], v12
    v_smfmac_f32_16x16x64_bf16 v[24:27], v[32:35], v[240:247], v12
    v_smfmac_f32_16x16x64_bf16 v[28:31], v[32:35], v[248:255], v12
    v_cvt_pk_bf16_f32 v56, v16, v17
    v_cvt_pk_bf16_f32 v57, v18, v19
    v_smfmac_f32_16x16x64_bf16 v[24:27], v[36:39], v[96:103], v12
    v_or_b32 v56, 1, v56
    v_smfmac_f32_16x16x64_bf16 v[24:27], v[40:43], v[80:87], v12
    v_cvt_pk_bf16_f32 v58, v20, v21
    v_cvt_pk_bf16_f32 v59, v22, v23
    v_smfmac_f32_16x16x64_bf16 v[28:31], v[36:39], v[104:111], v12
    buffer_store_dwordx4 v[56:59], v9, s[8:11], s41 offen
    s_waitcnt lgkmcnt(0)
    v_smfmac_f32_16x16x64_bf16 v[28:31], v[40:43], v[88:95], v12
    ds_read_b128 v[112:115], v4 offset:14336
    v_cvt_pk_bf16_f32 v60, v24, v25
    v_cvt_pk_bf16_f32 v61, v26, v27
    v_or_b32 v60, 1, v60
    ds_read_b128 v[116:119], v4 offset:15360
    ds_read_b128 v[120:123], v4 offset:16384
    ds_read_b128 v[124:127], v4 offset:17408
    ds_read_b128 v[72:75], v4 offset:18432
    v_cvt_pk_bf16_f32 v62, v28, v29
    v_cvt_pk_bf16_f32 v63, v30, v31
    buffer_store_dwordx4 v[60:63], v9, s[8:11], s42 offen
    ds_read_b128 v[64:67], v5 offset:28672
    ds_read_b128 v[76:79], v4 offset:19456
    ds_read_b128 v[80:83], v4 offset:6144
    ds_read_b128 v[84:87], v4 offset:7168
    ds_read_b128 v[88:91], v4 offset:8192
    ds_read_b128 v[92:95], v4 offset:9216
    ds_read_b128 v[96:99], v4 offset:10240
    ds_read_b128 v[100:103], v4 offset:11264
    ds_read_b128 v[104:107], v4 offset:12288
    ds_read_b128 v[108:111], v4 offset:13312
    ds_read_b128 v[24:27], v4 offset:0
    ds_read_b128 v[28:31], v4 offset:1024
    ds_read_b128 v[32:35], v4 offset:2048
    ds_read_b128 v[36:39], v4 offset:3072
    s_mov_b32 s33, s50
    s_add_u32 s34, s33, 33554432
    s_add_u32 s50, s33, 262144
    s_min_u32 s50, s50, s51
    s_mov_b32 s36, s47
    s_add_u32 s47, s47, 8192
    s_min_u32 s47, s47, s52
    s_nop 15
    s_nop 11
    buffer_load_dwordx4 v[48:51], v10, s[8:11], s41 offen sc1
    buffer_load_dwordx4 v[52:55], v10, s[8:11], s41 offen offset:1024 sc1
    s_nop 15
    s_nop 15
    s_nop 7
    buffer_load_dwordx4 v[56:59], v10, s[8:11], s41 offen sc1
    buffer_load_dwordx4 v[60:63], v10, s[8:11], s41 offen offset:1024 sc1
    ds_read_b128 v[40:43], v4 offset:4096
    ds_read_b128 v[44:47], v4 offset:5120
Lh1_32:
    s_waitcnt vmcnt(3) lgkmcnt(15)
    v_mfma_f32_16x16x32_bf16 v[68:71], v[48:51], v[64:67], 0
    s_waitcnt vmcnt(2)
    v_mfma_f32_16x16x32_bf16 v[68:71], v[52:55], v[64:67], v[68:71]
    v_bitop3_b32 v15, v48, v52, 1 bitop3:0x2a
    v_cmp_ne_u32 vcc, 0, v15
    s_nop 0
    s_cbranch_vccnz Lh1b_33
Lh1j_34:
    s_mov_b32 m0, s43
    s_nop 3
    v_permlane32_swap_b32 v68, v70
    v_permlane32_swap_b32 v69, v71
    v_pk_add_f32 v[68:69], v[68:69], v[70:71]
    s_nop 1
    v_permlane16_swap_b32 v68, v69
    v_add_f32 v68, v68, v69
    s_nop 1
    v_mov_b32_dpp v69, v68 row_shl:4 row_mask:0xf bank_mask:0xf
    v_cvt_pk_bf16_f32 v15, v68, v69
    v_min_u32 v15, -2, v15
    buffer_store_dword v15, v11, s[8:11], s38 offen
    buffer_load_dwordx4 v0, s[8:11], s33 offen lds
    buffer_load_dwordx4 v0, s[8:11], s33 offen offset:1024 lds
    s_mov_b32 s61, s39
    s_mov_b32 s39, s38
    s_mov_b32 s38, s40
    s_mov_b32 s40, s61
    s_add_u32 s32, s32, 1
    s_add_u32 s35, s35, 262144
    s_bitset0_b32 s35, 21
    s_bfe_u32 s37, s32, 0x10003
    v_mov_b32 v64, 0
    v_mov_b32 v65, 0
    v_mov_b32 v66, 0
    v_mov_b32 v67, 0
    v_mov_b32 v68, 0
    v_mov_b32 v69, 0
    v_mov_b32 v70, 0
    v_mov_b32 v71, 0
    s_nop 15
    s_nop 11
    buffer_load_dwordx4 v[16:19], v0, s[8:11], s39 offen sc1
    buffer_load_dwordx4 v[20:23], v0, s[8:11], s39 offen offset:1024 sc1
    s_waitcnt vmcnt(6)
    v_mov_b32 v48, 0
    v_mov_b32 v49, 0
    v_mov_b32 v50, 0
    v_mov_b32 v51, 0
    s_waitcnt vmcnt(5)
    v_mov_b32 v52, 0
    v_mov_b32 v53, 0
    v_mov_b32 v54, 0
    v_mov_b32 v55, 0
    s_waitcnt vmcnt(6)
    v_mov_b32 v56, 0
    v_mov_b32 v57, 0
    v_mov_b32 v58, 0
    v_mov_b32 v59, 0
    s_waitcnt vmcnt(5)
    v_mov_b32 v60, 0
    v_mov_b32 v61, 0
    v_mov_b32 v62, 0
    v_mov_b32 v63, 0
    s_nop 15
    s_nop 7
    buffer_load_dwordx4 v[16:19], v0, s[8:11], s39 offen sc1
    buffer_load_dwordx4 v[20:23], v0, s[8:11], s39 offen offset:1024 sc1
Lh2_35:
    s_waitcnt vmcnt(2) lgkmcnt(0)
    v_max3_u32 v15, v16, v17, v18
    v_max3_u32 v15, v15, v19, v20
    v_max3_u32 v15, v15, v21, v22
    v_max_u32 v15, v15, v23
    v_cmp_eq_u32 vcc, -1, v15
    ds_write_b128 v0, v[16:19] offset:0
    s_cbranch_vccnz Lh2b_36
    ds_write_b128 v0, v[20:23] offset:1024
    v_smfmac_f32_16x16x64_bf16 v[48:51], v[16:19], v[24:31], v12
    v_smfmac_f32_16x16x64_bf16 v[52:55], v[16:19], v[32:39], v12
    v_smfmac_f32_16x16x64_bf16 v[56:59], v[16:19], v[40:47], v12
    v_smfmac_f32_16x16x64_bf16 v[60:63], v[16:19], v[80:87], v12
    v_smfmac_f32_16x16x64_bf16 v[64:67], v[16:19], v[88:95], v12
    v_smfmac_f32_16x16x64_bf16 v[68:71], v[16:19], v[96:103], v12
    s_waitcnt lgkmcnt(0)
    s_barrier
    ds_read_b128 v[24:27], v1 offset:0
    ds_read_b128 v[28:31], v1 offset:1024
    v_smfmac_f32_16x16x64_bf16 v[48:51], v[20:23], v[104:111], v12
    ds_read_b128 v[32:35], v2 offset:0
    v_smfmac_f32_16x16x64_bf16 v[52:55], v[20:23], v[112:119], v12
    ds_read_b128 v[36:39], v2 offset:1024
    v_smfmac_f32_16x16x64_bf16 v[56:59], v[20:23], v[120:127], v12
    ds_read_b128 v[40:43], v3 offset:0
    v_smfmac_f32_16x16x64_bf16 v[60:63], v[20:23], v[72:79], v12
    ds_read_b128 v[44:47], v3 offset:1024
    v_smfmac_f32_16x16x64_bf16 v[64:67], v[20:23], a[0:7], v12
    buffer_load_dwordx4 v[72:75], v0, s[8:11], s34 offen
    v_smfmac_f32_16x16x64_bf16 v[68:71], v[20:23], a[8:15], v12
    ds_read_b128 v[96:99], v5 offset:8192
    s_waitcnt lgkmcnt(5)
    v_smfmac_f32_16x16x64_bf16 v[56:59], v[24:27], a[16:23], v12
    ds_read_b128 v[100:103], v5 offset:9216
    v_smfmac_f32_16x16x64_bf16 v[60:63], v[24:27], a[24:31], v12
    ds_read_b128 v[104:107], v5 offset:10240
    v_smfmac_f32_16x16x64_bf16 v[56:59], v[28:31], a[32:39], v12
    ds_read_b128 v[108:111], v5 offset:11264
    v_smfmac_f32_16x16x64_bf16 v[60:63], v[28:31], a[40:47], v12
    ds_read_b128 v[112:115], v5 offset:12288
    s_waitcnt lgkmcnt(5)
    v_smfmac_f32_16x16x64_bf16 v[56:59], v[32:35], a[48:55], v12
    ds_read_b128 v[116:119], v5 offset:13312
    v_smfmac_f32_16x16x64_bf16 v[60:63], v[32:35], a[56:63], v12
    ds_read_b128 v[120:123], v5 offset:14336
    v_smfmac_f32_16x16x64_bf16 v[56:59], v[36:39], a[64:71], v12
    ds_read_b128 v[124:127], v5 offset:15360
    v_smfmac_f32_16x16x64_bf16 v[60:63], v[36:39], a[72:79], v12
    buffer_load_dwordx4 v[76:79], v0, s[8:11], s34 offen offset:1024
    v_smfmac_f32_16x16x64_bf16 v[56:59], v[40:43], a[80:87], v12
    v_cmp_eq_u32 vcc, 0, v13
    v_smfmac_f32_16x16x64_bf16 v[60:63], v[40:43], a[88:95], v12
    v_smfmac_f32_16x16x64_bf16 v[56:59], v[44:47], a[96:103], v12
    s_cbranch_vccnz Lkvw_37
    buffer_load_dword v15, v14, s[8:11], s50 offen
Lkvb_38:
    v_smfmac_f32_16x16x64_bf16 v[60:63], v[44:47], a[104:111], v12
    v_smfmac_f32_16x16x64_bf16 v[48:51], v[24:27], a[112:119], v12
    v_smfmac_f32_16x16x64_bf16 v[52:55], v[24:27], a[120:127], v12
    v_smfmac_f32_16x16x64_bf16 v[48:51], v[28:31], a[128:135], v12
    ds_read_b128 v[80:83], v4 offset:20480
    v_smfmac_f32_16x16x64_bf16 v[52:55], v[28:31], a[136:143], v12
    ds_read_b128 v[84:87], v4 offset:21504
    v_smfmac_f32_16x16x64_bf16 v[48:51], v[32:35], a[144:151], v12
    ds_read_b128 v[88:91], v4 offset:22528
    v_smfmac_f32_16x16x64_bf16 v[52:55], v[32:35], a[152:159], v12
    ds_read_b128 v[92:95], v4 offset:23552
    v_smfmac_f32_16x16x64_bf16 v[48:51], v[36:39], a[160:167], v12
    s_waitcnt vmcnt(3)
    v_cvt_pk_bf16_f32 v20, v56, v57
    v_smfmac_f32_16x16x64_bf16 v[52:55], v[36:39], a[168:175], v12
    v_cvt_pk_bf16_f32 v21, v58, v59
    v_smfmac_f32_16x16x64_bf16 v[48:51], v[40:43], a[176:183], v12
    v_cvt_pk_bf16_f32 v22, v60, v61
    v_smfmac_f32_16x16x64_bf16 v[48:51], v[44:47], a[184:191], v12
    v_cvt_pk_bf16_f32 v23, v62, v63
    v_smfmac_f32_16x16x64_bf16 v[52:55], v[40:43], a[192:199], v12
    ds_write_b128 v6, v[20:23] offset:22528
    v_smfmac_f32_16x16x64_bf16 v[52:55], v[44:47], a[200:207], v12
    buffer_store_dword v8, v11, s[8:11], s40 offen
    v_smfmac_f32_16x16x64_bf16 v[64:67], v[24:27], a[208:215], v12
    v_cvt_pk_bf16_f32 v16, v48, v49
    v_cvt_pk_bf16_f32 v17, v50, v51
    v_smfmac_f32_16x16x64_bf16 v[68:71], v[24:27], a[216:223], v12
    v_cvt_pk_bf16_f32 v18, v52, v53
    v_cvt_pk_bf16_f32 v19, v54, v55
    ds_write_b128 v6, v[16:19] offset:16384
    v_smfmac_f32_16x16x64_bf16 v[64:67], v[28:31], a[224:231], v12
    v_smfmac_f32_16x16x64_bf16 v[68:71], v[28:31], a[232:239], v12
    s_waitcnt lgkmcnt(4)
    v_smfmac_f32_16x16x64_bf16 v[64:67], v[32:35], v[80:87], v12
    s_waitcnt lgkmcnt(2)
    v_smfmac_f32_16x16x64_bf16 v[68:71], v[32:35], v[88:95], v12
    v_smfmac_f32_16x16x64_bf16 v[64:67], v[36:39], a[240:247], v12
    v_smfmac_f32_16x16x64_bf16 v[68:71], v[36:39], a[248:255], v12
    v_and_or_b32 v20, v20, -2, s37
    buffer_store_dwordx4 v[20:23], v0, s[8:11], s35 offen sc1
    s_waitcnt lgkmcnt(0)
    s_barrier
    ds_read_b64_tr_b16 v[80:81], v7 offset:16384
    ds_read_b64_tr_b16 v[82:83], v7 offset:16528
    ds_read_b64_tr_b16 v[56:57], v7 offset:22528
    ds_read_b64_tr_b16 v[58:59], v7 offset:22672
    v_smfmac_f32_16x16x64_bf16 v[64:67], v[40:43], v[128:135], v12
    ds_read_b64_tr_b16 v[84:85], v7 offset:17920
    ds_read_b64_tr_b16 v[86:87], v7 offset:18064
    ds_read_b64_tr_b16 v[60:61], v7 offset:24064
    ds_read_b64_tr_b16 v[62:63], v7 offset:24208
    v_smfmac_f32_16x16x64_bf16 v[68:71], v[40:43], v[136:143], v12
    ds_read_b64_tr_b16 v[88:89], v7 offset:19456
    ds_read_b64_tr_b16 v[90:91], v7 offset:19600
    ds_read_b64_tr_b16 v[24:25], v7 offset:25600
    ds_read_b64_tr_b16 v[26:27], v7 offset:25744
    v_smfmac_f32_16x16x64_bf16 v[64:67], v[44:47], v[144:151], v12
    ds_read_b64_tr_b16 v[92:93], v7 offset:20992
    ds_read_b64_tr_b16 v[94:95], v7 offset:21136
    ds_read_b64_tr_b16 v[28:29], v7 offset:27136
    ds_read_b64_tr_b16 v[30:31], v7 offset:27280
    v_smfmac_f32_16x16x64_bf16 v[68:71], v[44:47], v[152:159], v12
    s_waitcnt lgkmcnt(14)
    v_mfma_f32_16x16x32_bf16 v[48:51], v[96:99], v[80:83], 0
    s_waitcnt lgkmcnt(12)
    v_mfma_f32_16x16x32_bf16 v[16:19], v[56:59], v[80:83], 0
    v_mov_b32 v56, 0x3f803f80
    v_mov_b32 v57, 0x3f803f80
    v_mfma_f32_16x16x32_bf16 v[52:55], v[100:103], v[80:83], 0
    v_mov_b32 v58, 0x3f803f80
    s_waitcnt lgkmcnt(8)
    v_mfma_f32_16x16x32_bf16 v[16:19], v[60:63], v[84:87], v[16:19]
    v_mov_b32 v59, 0x3f803f80
    v_mov_b32 v60, 0x3f003f00
    v_mfma_f32_16x16x32_bf16 v[48:51], v[104:107], v[84:87], v[48:51]
    v_mov_b32 v61, 0x3f003f00
    s_waitcnt lgkmcnt(4)
    v_mfma_f32_16x16x32_bf16 v[16:19], v[24:27], v[88:91], v[16:19]
    v_mfma_f32_16x16x32_bf16 v[52:55], v[108:111], v[84:87], v[52:55]
    s_waitcnt lgkmcnt(0)
    v_mfma_f32_16x16x32_bf16 v[16:19], v[28:31], v[92:95], v[16:19]
    s_cmp_lg_u32 s53, 0
    s_cbranch_scc1 Lkvx_39
Lkvy_40:
    ds_read_b128 v[96:99], v4 offset:24576
    ds_read_b128 v[100:103], v4 offset:25600
    v_mfma_f32_16x16x32_bf16 v[48:51], v[112:115], v[88:91], v[48:51]
    ds_read_b128 v[80:83], v4 offset:26624
    ds_read_b128 v[84:87], v4 offset:27648
    v_mfma_f32_16x16x32_bf16 v[48:51], v[120:123], v[92:95], v[48:51]
    ds_read_b128 v[104:107], v4 offset:28672
    ds_read_b128 v[108:111], v4 offset:29696
    v_mfma_f32_16x16x32_bf16 v[52:55], v[116:119], v[88:91], v[52:55]
    v_permlane32_swap_b32 v16, v18
    v_permlane32_swap_b32 v17, v19
    v_mfma_f32_16x16x32_bf16 v[52:55], v[124:127], v[92:95], v[52:55]
    v_add_f32 v16, v16, v18
    v_add_f32 v17, v17, v19
    v_add_f32_dpp v48, v48, v48 row_ror:8 row_mask:0xf bank_mask:0x3
    v_add_f32_dpp v49, v49, v49 row_ror:8 row_mask:0xf bank_mask:0x3
    v_add_f32_dpp v16, v16, v16 row_ror:8 row_mask:0xf bank_mask:0x3
    v_add_f32_dpp v50, v50, v50 row_ror:8 row_mask:0xf bank_mask:0x3
    v_add_f32_dpp v51, v51, v51 row_ror:8 row_mask:0xf bank_mask:0x3
    v_add_f32_dpp v16, v17, v17 row_ror:8 row_mask:0xf bank_mask:0xc
    v_add_f32_dpp v48, v52, v52 row_ror:8 row_mask:0xf bank_mask:0xc
    v_add_f32_dpp v49, v53, v53 row_ror:8 row_mask:0xf bank_mask:0xc
    v_add_f32_dpp v50, v54, v54 row_ror:8 row_mask:0xf bank_mask:0xc
    v_add_f32_dpp v51, v55, v55 row_ror:8 row_mask:0xf bank_mask:0xc
    v_max3_f32 v52, v48, v49, v16
    v_max3_f32 v52, v52, v50, v51
    v_cvt_pk_bf16_f32 v44, v64, v65
    v_cvt_pk_bf16_f32 v45, v66, v67
    v_max_f32_dpp v52, v52, v52 row_ror:8 row_mask:0xf bank_mask:0xf
    v_mov_b32 v53, v52
    v_cvt_pk_bf16_f32 v46, v68, v69
    v_cvt_pk_bf16_f32 v47, v70, v71
    v_permlane16_swap_b32 v52, v53
    v_max_f32 v52, v52, v53
    v_mov_b32 v53, v52
    v_and_or_b32 v44, v44, -2, s37
    buffer_store_dwordx4 v[44:47], v0, s[8:11], s35 offen offset:1024 sc1
    v_permlane32_swap_b32 v52, v53
    v_max_f32 v52, v52, v53
    v_mul_f32 v52, s48, v52
    v_fma_f32 v16, v16, s48, -v52
    v_pk_fma_f32 v[48:49], v[48:49], s[48:49], v[52:53] op_sel_hi:[1,1,0] neg_lo:[0,0,1] neg_hi:[0,0,1]
    v_pk_fma_f32 v[50:51], v[50:51], s[48:49], v[52:53] op_sel_hi:[1,1,0] neg_lo:[0,0,1] neg_hi:[0,0,1]
    v_exp_f32 v48, v48
    v_exp_f32 v49, v49
    v_exp_f32 v50, v50
    v_exp_f32 v51, v51
    v_cvt_pk_bf16_f32 v28, v48, v49
    v_cvt_pk_bf16_f32 v29, v50, v51
    v_exp_f32 v16, v16
    v_mov_b32_dpp v30, v28 row_ror:8 row_mask:0xf bank_mask:0xf
    v_mov_b32_dpp v31, v29 row_ror:8 row_mask:0xf bank_mask:0xf
    v_mov_b32_dpp v17, v16 row_ror:8 row_mask:0xf bank_mask:0xf
    v_cvt_pk_bf16_f32 v62, v16, v17
    v_mfma_f32_16x16x32_bf16 v[40:43], v[56:59], v[28:31], 0
    v_cvt_pk_bf16_f32 v63, v16, v17
    s_nop 0
    s_waitcnt vmcnt(5)
    v_mfma_f32_16x16x32_bf16 v[32:35], v[72:75], v[28:31], 0
    v_permlane32_swap_b32 v62, v63
    s_nop 0
    s_waitcnt vmcnt(4)
    v_mfma_f32_16x16x32_bf16 v[36:39], v[76:79], v[28:31], 0
    s_nop 0
    s_nop 0
    v_mfma_f32_16x16x16_bf16 v[40:43], v[60:61], v[62:63], v[40:43]
    v_mov_b32 v16, 0
    v_mov_b32 v17, 0
    v_mov_b32 v18, 0
    v_mfma_f32_16x16x16_bf16 v[32:35], v[44:45], v[62:63], v[32:35]
    v_mov_b32 v19, 0
    v_mov_b32 v24, 0
    s_cmp_ge_u32 s32, 63
    v_mfma_f32_16x16x16_bf16 v[36:39], v[46:47], v[62:63], v[36:39]
    v_mov_b32 v25, 0
    v_rcp_f32 v40, v40
    v_mov_b32 v26, 0
    v_mov_b32 v27, 0
    v_mov_b32 v28, 0
    v_mov_b32 v29, 0
    v_pk_mul_f32 v[32:33], v[32:33], v[40:41] op_sel_hi:[1,0]
    v_pk_mul_f32 v[34:35], v[34:35], v[40:41] op_sel_hi:[1,0]
    v_pk_mul_f32 v[36:37], v[36:37], v[40:41] op_sel_hi:[1,0]
    v_pk_mul_f32 v[38:39], v[38:39], v[40:41] op_sel_hi:[1,0]
    v_cvt_pk_bf16_f32 v48, v32, v36
    v_cvt_pk_bf16_f32 v49, v33, v37
    v_cvt_pk_bf16_f32 v50, v34, v38
    v_cvt_pk_bf16_f32 v51, v35, v39
    ds_write_b128 v0, v[48:51] offset:0
    v_and_b32 v32, s44, v1
    v_and_b32 v36, s44, v2
    v_and_b32 v40, s44, v3
    s_cbranch_scc1 L_rec_done
    v_mov_b32_dpp v48, v48 row_ror:8 row_mask:0xf bank_mask:0xc
    v_mov_b32_dpp v49, v49 row_ror:8 row_mask:0xf bank_mask:0xc
    v_mov_b32_dpp v50, v50 row_ror:8 row_mask:0xf bank_mask:0xc
    v_mov_b32_dpp v51, v51 row_ror:8 row_mask:0xf bank_mask:0xc
    v_mov_b32 v30, 0
    v_mov_b32 v31, 0
    v_smfmac_f32_16x16x64_bf16 v[16:19], v[48:51], v[160:167], v12
    v_mov_b32 v20, 0
    v_smfmac_f32_16x16x64_bf16 v[24:27], v[48:51], v[176:183], v12
    v_mov_b32 v21, 0
    v_mov_b32 v22, 0
    v_mov_b32 v23, 0
    s_mov_b64 exec, 63
    buffer_load_dword v13, v5, s[8:11], s47 offen sc1
    s_mov_b64 exec, -1
    s_waitcnt lgkmcnt(0)
    s_barrier
    ds_read_b128 v[32:35], v32 offset:0
    ds_read_b128 v[36:39], v36 offset:0
    ds_read_b128 v[40:43], v40 offset:0
    v_smfmac_f32_16x16x64_bf16 v[28:31], v[48:51], v[184:191], v12
    ds_read_b128 v[88:91], v4 offset:30720
    ds_read_b128 v[92:95], v4 offset:31744
    v_smfmac_f32_16x16x64_bf16 v[20:23], v[48:51], v[168:175], v12
    s_waitcnt lgkmcnt(4)
    v_smfmac_f32_16x16x64_bf16 v[16:19], v[32:35], v[192:199], v12
    v_smfmac_f32_16x16x64_bf16 v[20:23], v[32:35], v[200:207], v12
    s_waitcnt lgkmcnt(3)
    v_smfmac_f32_16x16x64_bf16 v[16:19], v[36:39], v[208:215], v12
    v_smfmac_f32_16x16x64_bf16 v[20:23], v[36:39], v[216:223], v12
    s_waitcnt lgkmcnt(2)
    v_smfmac_f32_16x16x64_bf16 v[16:19], v[40:43], v[224:231], v12
    v_smfmac_f32_16x16x64_bf16 v[20:23], v[40:43], v[232:239], v12
    v_smfmac_f32_16x16x64_bf16 v[24:27], v[32:35], v[240:247], v12
    v_smfmac_f32_16x16x64_bf16 v[28:31], v[32:35], v[248:255], v12
    v_cvt_pk_bf16_f32 v56, v16, v17
    v_cvt_pk_bf16_f32 v57, v18, v19
    v_smfmac_f32_16x16x64_bf16 v[24:27], v[36:39], v[96:103], v12
    v_and_b32 v56, -2, v56
    v_smfmac_f32_16x16x64_bf16 v[24:27], v[40:43], v[80:87], v12
    v_cvt_pk_bf16_f32 v58, v20, v21
    v_cvt_pk_bf16_f32 v59, v22, v23
    v_smfmac_f32_16x16x64_bf16 v[28:31], v[36:39], v[104:111], v12
    buffer_store_dwordx4 v[56:59], v9, s[8:11], s41 offen
    s_waitcnt lgkmcnt(0)
    v_smfmac_f32_16x16x64_bf16 v[28:31], v[40:43], v[88:95], v12
    ds_read_b128 v[112:115], v4 offset:14336
    v_cvt_pk_bf16_f32 v60, v24, v25
    v_cvt_pk_bf16_f32 v61, v26, v27
    v_and_b32 v60, -2, v60
    ds_read_b128 v[116:119], v4 offset:15360
    ds_read_b128 v[120:123], v4 offset:16384
    ds_read_b128 v[124:127], v4 offset:17408
    ds_read_b128 v[72:75], v4 offset:18432
    v_cvt_pk_bf16_f32 v62, v28, v29
    v_cvt_pk_bf16_f32 v63, v30, v31
    buffer_store_dwordx4 v[60:63], v9, s[8:11], s42 offen
    ds_read_b128 v[64:67], v5 offset:28672
    ds_read_b128 v[76:79], v4 offset:19456
    ds_read_b128 v[80:83], v4 offset:6144
    ds_read_b128 v[84:87], v4 offset:7168
    ds_read_b128 v[88:91], v4 offset:8192
    ds_read_b128 v[92:95], v4 offset:9216
    ds_read_b128 v[96:99], v4 offset:10240
    ds_read_b128 v[100:103], v4 offset:11264
    ds_read_b128 v[104:107], v4 offset:12288
    ds_read_b128 v[108:111], v4 offset:13312
    ds_read_b128 v[24:27], v4 offset:0
    ds_read_b128 v[28:31], v4 offset:1024
    ds_read_b128 v[32:35], v4 offset:2048
    ds_read_b128 v[36:39], v4 offset:3072
    s_mov_b32 s33, s50
    s_add_u32 s34, s33, 33554432
    s_add_u32 s50, s33, 262144
    s_min_u32 s50, s50, s51
    s_mov_b32 s36, s47
    s_add_u32 s47, s47, 8192
    s_min_u32 s47, s47, s52
    s_nop 15
    s_nop 11
    buffer_load_dwordx4 v[48:51], v10, s[8:11], s41 offen sc1
    buffer_load_dwordx4 v[52:55], v10, s[8:11], s41 offen offset:1024 sc1
    s_nop 15
    s_nop 15
    s_nop 7
    buffer_load_dwordx4 v[56:59], v10, s[8:11], s41 offen sc1
    buffer_load_dwordx4 v[60:63], v10, s[8:11], s41 offen offset:1024 sc1
    ds_read_b128 v[40:43], v4 offset:4096
    ds_read_b128 v[44:47], v4 offset:5120
Lh1_43:
    s_waitcnt vmcnt(3) lgkmcnt(15)
    v_mfma_f32_16x16x32_bf16 v[68:71], v[48:51], v[64:67], 0
    s_waitcnt vmcnt(2)
    v_mfma_f32_16x16x32_bf16 v[68:71], v[52:55], v[64:67], v[68:71]
    v_bitop3_b32 v15, v48, v52, 1 bitop3:0xa8
    v_cmp_ne_u32 vcc, 0, v15
    s_nop 0
    s_cbranch_vccnz Lh1b_44
Lh1j_45:
    s_mov_b32 m0, s43
    s_nop 3
    v_permlane32_swap_b32 v68, v70
    v_permlane32_swap_b32 v69, v71
    v_pk_add_f32 v[68:69], v[68:69], v[70:71]
    s_nop 1
    v_permlane16_swap_b32 v68, v69
    v_add_f32 v68, v68, v69
    s_nop 1
    v_mov_b32_dpp v69, v68 row_shl:4 row_mask:0xf bank_mask:0xf
    v_cvt_pk_bf16_f32 v15, v68, v69
    v_min_u32 v15, -2, v15
    buffer_store_dword v15, v11, s[8:11], s38 offen
    buffer_load_dwordx4 v0, s[8:11], s33 offen lds
    buffer_load_dwordx4 v0, s[8:11], s33 offen offset:1024 lds
    s_mov_b32 s61, s39
    s_mov_b32 s39, s38
    s_mov_b32 s38, s40
    s_mov_b32 s40, s61
    s_add_u32 s32, s32, 1
    s_add_u32 s35, s35, 262144
    s_bitset0_b32 s35, 21
    s_bfe_u32 s37, s32, 0x10003
    v_mov_b32 v64, 0
    v_mov_b32 v65, 0
    v_mov_b32 v66, 0
    v_mov_b32 v67, 0
    v_mov_b32 v68, 0
    v_mov_b32 v69, 0
    v_mov_b32 v70, 0
    v_mov_b32 v71, 0
    s_nop 15
    s_nop 11
    buffer_load_dwordx4 v[16:19], v0, s[8:11], s39 offen sc1
    buffer_load_dwordx4 v[20:23], v0, s[8:11], s39 offen offset:1024 sc1
    s_waitcnt vmcnt(6)
    v_mov_b32 v48, 0
    v_mov_b32 v49, 0
    v_mov_b32 v50, 0
    v_mov_b32 v51, 0
    s_waitcnt vmcnt(5)
    v_mov_b32 v52, 0
    v_mov_b32 v53, 0
    v_mov_b32 v54, 0
    v_mov_b32 v55, 0
    s_waitcnt vmcnt(6)
    v_mov_b32 v56, 0
    v_mov_b32 v57, 0
    v_mov_b32 v58, 0
    v_mov_b32 v59, 0
    s_waitcnt vmcnt(5)
    v_mov_b32 v60, 0
    v_mov_b32 v61, 0
    v_mov_b32 v62, 0
    v_mov_b32 v63, 0
    s_nop 15
    s_nop 7
    buffer_load_dwordx4 v[16:19], v0, s[8:11], s39 offen sc1
    buffer_load_dwordx4 v[20:23], v0, s[8:11], s39 offen offset:1024 sc1
    s_branch L_rec_fast
Lh2b_25:
    s_mov_b64 exec, vcc
    buffer_load_dwordx4 v[16:19], v0, s[8:11], s39 offen sc1
    buffer_load_dwordx4 v[20:23], v0, s[8:11], s39 offen offset:1024 sc1
    s_mov_b64 exec, -1
    s_sub_u32 s62, s62, 1
    s_cbranch_scc0 Ltok_5024
    s_movk_i32 s61, 4
    s_branch L_abort
Ltok_5024:
    s_branch Lh2_24
Lkvw_26:
    s_mov_b64 exec, 63
    buffer_load_dword v13, v5, s[8:11], s36 offen sc1
    s_mov_b64 exec, -1
    s_mov_b32 s53, 1
    s_branch Lkvb_27
Lkvx_28:
    s_mov_b32 s53, 0
    s_waitcnt vmcnt(2)
    v_cmp_eq_u32 vcc, 0, v13
    s_nop 0
    s_cbranch_vccz Lkvt_31
Lkvz_30:
    s_mov_b64 exec, 63
    buffer_load_dword v13, v5, s[8:11], s36 offen sc1
    s_mov_b64 exec, -1
    s_sub_u32 s62, s62, 1
    s_cbranch_scc0 Ltok_5025
    s_movk_i32 s61, 2
    s_branch L_abort
Ltok_5025:
    s_waitcnt vmcnt(0)
    v_cmp_eq_u32 vcc, 0, v13
    s_nop 0
    s_cbranch_vccnz Lkvz_30
Lkvt_31:
    buffer_load_dword v15, v14, s[8:11], s50 offen
    s_branch Lkvy_29
Lh1b_33:
    s_mov_b64 exec, vcc
    buffer_load_dwordx4 v[48:51], v10, s[8:11], s41 offen sc1
    buffer_load_dwordx4 v[52:55], v10, s[8:11], s41 offen offset:1024 sc1
    s_mov_b64 exec, -1
    s_waitcnt vmcnt(3)
    v_mfma_f32_16x16x32_bf16 v[68:71], v[56:59], v[64:67], 0
    s_waitcnt vmcnt(2)
    v_mfma_f32_16x16x32_bf16 v[68:71], v[60:63], v[64:67], v[68:71]
    v_bitop3_b32 v15, v56, v60, 1 bitop3:0x2a
    v_cmp_ne_u32 vcc, 0, v15
    s_nop 0
    s_cbranch_vccz Lh1j_34
    s_mov_b64 exec, vcc
    buffer_load_dwordx4 v[56:59], v10, s[8:11], s41 offen sc1
    buffer_load_dwordx4 v[60:63], v10, s[8:11], s41 offen offset:1024 sc1
    s_mov_b64 exec, -1
    s_sub_u32 s62, s62, 1
    s_cbranch_scc0 Ltok_5026
    s_movk_i32 s61, 3
    s_branch L_abort
Ltok_5026:
    s_branch Lh1_32
Lh2b_36:
    s_mov_b64 exec, vcc
    buffer_load_dwordx4 v[16:19], v0, s[8:11], s39 offen sc1
    buffer_load_dwordx4 v[20:23], v0, s[8:11], s39 offen offset:1024 sc1
    s_mov_b64 exec, -1
    s_sub_u32 s62, s62, 1
    s_cbranch_scc0 Ltok_5027
    s_movk_i32 s61, 4
    s_branch L_abort
Ltok_5027:
    s_branch Lh2_35
Lkvw_37:
    s_mov_b64 exec, 63
    buffer_load_dword v13, v5, s[8:11], s36 offen sc1
    s_mov_b64 exec, -1
    s_mov_b32 s53, 1
    s_branch Lkvb_38
Lkvx_39:
    s_mov_b32 s53, 0
    s_waitcnt vmcnt(2)
    v_cmp_eq_u32 vcc, 0, v13
    s_nop 0
    s_cbranch_vccz Lkvt_42
Lkvz_41:
    s_mov_b64 exec, 63
    buffer_load_dword v13, v5, s[8:11], s36 offen sc1
    s_mov_b64 exec, -1
    s_sub_u32 s62, s62, 1
    s_cbranch_scc0 Ltok_5028
    s_movk_i32 s61, 2
    s_branch L_abort
Ltok_5028:
    s_waitcnt vmcnt(0)
    v_cmp_eq_u32 vcc, 0, v13
    s_nop 0
    s_cbranch_vccnz Lkvz_41
Lkvt_42:
    buffer_load_dword v15, v14, s[8:11], s50 offen
    s_branch Lkvy_40
Lh1b_44:
    s_mov_b64 exec, vcc
    buffer_load_dwordx4 v[48:51], v10, s[8:11], s41 offen sc1
    buffer_load_dwordx4 v[52:55], v10, s[8:11], s41 offen offset:1024 sc1
    s_mov_b64 exec, -1
    s_waitcnt vmcnt(3)
    v_mfma_f32_16x16x32_bf16 v[68:71], v[56:59], v[64:67], 0
    s_waitcnt vmcnt(2)
    v_mfma_f32_16x16x32_bf16 v[68:71], v[60:63], v[64:67], v[68:71]
    v_bitop3_b32 v15, v56, v60, 1 bitop3:0xa8
    v_cmp_ne_u32 vcc, 0, v15
    s_nop 0
    s_cbranch_vccz Lh1j_45
    s_mov_b64 exec, vcc
    buffer_load_dwordx4 v[56:59], v10, s[8:11], s41 offen sc1
    buffer_load_dwordx4 v[60:63], v10, s[8:11], s41 offen offset:1024 sc1
    s_mov_b64 exec, -1
    s_sub_u32 s62, s62, 1
    s_cbranch_scc0 Ltok_5029
    s_movk_i32 s61, 3
    s_branch L_abort
Ltok_5029:
    s_branch Lh1_43
L_rec_slow:
Lh2_5030:
L_rec_slow_in:
    s_waitcnt vmcnt(2) lgkmcnt(0)
    v_max3_u32 v15, v16, v17, v18
    v_max3_u32 v15, v15, v19, v20
    v_max3_u32 v15, v15, v21, v22
    v_max_u32 v15, v15, v23
    v_cmp_eq_u32 vcc, -1, v15
    ds_write_b128 v0, v[16:19] offset:0
    s_cbranch_vccnz Lh2b_5031
    ds_write_b128 v0, v[20:23] offset:1024
    v_smfmac_f32_16x16x64_bf16 v[48:51], v[16:19], v[24:31], v12
    v_smfmac_f32_16x16x64_bf16 v[52:55], v[16:19], v[32:39], v12
    v_smfmac_f32_16x16x64_bf16 v[56:59], v[16:19], v[40:47], v12
    v_smfmac_f32_16x16x64_bf16 v[60:63], v[16:19], v[80:87], v12
    v_smfmac_f32_16x16x64_bf16 v[64:67], v[16:19], v[88:95], v12
    v_smfmac_f32_16x16x64_bf16 v[68:71], v[16:19], v[96:103], v12
    s_waitcnt lgkmcnt(0)
    s_barrier
    ds_read_b128 v[24:27], v1 offset:0
    ds_read_b128 v[28:31], v1 offset:1024
    v_smfmac_f32_16x16x64_bf16 v[48:51], v[20:23], v[104:111], v12
    ds_read_b128 v[32:35], v2 offset:0
    v_smfmac_f32_16x16x64_bf16 v[52:55], v[20:23], v[112:119], v12
    ds_read_b128 v[36:39], v2 offset:1024
    v_smfmac_f32_16x16x64_bf16 v[56:59], v[20:23], v[120:127], v12
    ds_read_b128 v[40:43], v3 offset:0
    v_smfmac_f32_16x16x64_bf16 v[60:63], v[20:23], v[72:79], v12
    ds_read_b128 v[44:47], v3 offset:1024
    v_smfmac_f32_16x16x64_bf16 v[64:67], v[20:23], a[0:7], v12
    buffer_load_dwordx4 v[72:75], v0, s[8:11], s34 offen
    v_smfmac_f32_16x16x64_bf16 v[68:71], v[20:23], a[8:15], v12
    ds_read_b128 v[96:99], v5 offset:8192
    s_waitcnt lgkmcnt(5)
    v_smfmac_f32_16x16x64_bf16 v[56:59], v[24:27], a[16:23], v12
    ds_read_b128 v[100:103], v5 offset:9216
    v_smfmac_f32_16x16x64_bf16 v[60:63], v[24:27], a[24:31], v12
    ds_read_b128 v[104:107], v5 offset:10240
    v_smfmac_f32_16x16x64_bf16 v[56:59], v[28:31], a[32:39], v12
    ds_read_b128 v[108:111], v5 offset:11264
    v_smfmac_f32_16x16x64_bf16 v[60:63], v[28:31], a[40:47], v12
    ds_read_b128 v[112:115], v5 offset:12288
    s_waitcnt lgkmcnt(5)
    v_smfmac_f32_16x16x64_bf16 v[56:59], v[32:35], a[48:55], v12
    ds_read_b128 v[116:119], v5 offset:13312
    v_smfmac_f32_16x16x64_bf16 v[60:63], v[32:35], a[56:63], v12
    ds_read_b128 v[120:123], v5 offset:14336
    v_smfmac_f32_16x16x64_bf16 v[56:59], v[36:39], a[64:71], v12
    ds_read_b128 v[124:127], v5 offset:15360
    v_smfmac_f32_16x16x64_bf16 v[60:63], v[36:39], a[72:79], v12
    buffer_load_dwordx4 v[76:79], v0, s[8:11], s34 offen offset:1024
    v_smfmac_f32_16x16x64_bf16 v[56:59], v[40:43], a[80:87], v12
    v_cmp_eq_u32 vcc, 0, v13
    v_smfmac_f32_16x16x64_bf16 v[60:63], v[40:43], a[88:95], v12
    v_smfmac_f32_16x16x64_bf16 v[56:59], v[44:47], a[96:103], v12
    s_cbranch_vccnz Lkvw_5032
    buffer_load_dword v15, v14, s[8:11], s50 offen
Lkvb_5033:
    v_smfmac_f32_16x16x64_bf16 v[60:63], v[44:47], a[104:111], v12
    v_smfmac_f32_16x16x64_bf16 v[48:51], v[24:27], a[112:119], v12
    v_smfmac_f32_16x16x64_bf16 v[52:55], v[24:27], a[120:127], v12
    v_smfmac_f32_16x16x64_bf16 v[48:51], v[28:31], a[128:135], v12
    ds_read_b128 v[80:83], v4 offset:20480
    v_smfmac_f32_16x16x64_bf16 v[52:55], v[28:31], a[136:143], v12
    ds_read_b128 v[84:87], v4 offset:21504
    v_smfmac_f32_16x16x64_bf16 v[48:51], v[32:35], a[144:151], v12
    ds_read_b128 v[88:91], v4 offset:22528
    v_smfmac_f32_16x16x64_bf16 v[52:55], v[32:35], a[152:159], v12
    ds_read_b128 v[92:95], v4 offset:23552
    v_smfmac_f32_16x16x64_bf16 v[48:51], v[36:39], a[160:167], v12
    s_waitcnt vmcnt(3)
    v_cvt_pk_bf16_f32 v20, v56, v57
    v_smfmac_f32_16x16x64_bf16 v[52:55], v[36:39], a[168:175], v12
    v_cvt_pk_bf16_f32 v21, v58, v59
    v_smfmac_f32_16x16x64_bf16 v[48:51], v[40:43], a[176:183], v12
    v_cvt_pk_bf16_f32 v22, v60, v61
    v_smfmac_f32_16x16x64_bf16 v[48:51], v[44:47], a[184:191], v12
    v_cvt_pk_bf16_f32 v23, v62, v63
    v_smfmac_f32_16x16x64_bf16 v[52:55], v[40:43], a[192:199], v12
    ds_write_b128 v6, v[20:23] offset:22528
    v_smfmac_f32_16x16x64_bf16 v[52:55], v[44:47], a[200:207], v12
    buffer_store_dword v8, v11, s[8:11], s40 offen sc1
    v_smfmac_f32_16x16x64_bf16 v[64:67], v[24:27], a[208:215], v12
    v_cvt_pk_bf16_f32 v16, v48, v49
    v_cvt_pk_bf16_f32 v17, v50, v51
    v_smfmac_f32_16x16x64_bf16 v[68:71], v[24:27], a[216:223], v12
    v_cvt_pk_bf16_f32 v18, v52, v53
    v_cvt_pk_bf16_f32 v19, v54, v55
    ds_write_b128 v6, v[16:19] offset:16384
    v_smfmac_f32_16x16x64_bf16 v[64:67], v[28:31], a[224:231], v12
    v_smfmac_f32_16x16x64_bf16 v[68:71], v[28:31], a[232:239], v12
    s_waitcnt lgkmcnt(4)
    v_smfmac_f32_16x16x64_bf16 v[64:67], v[32:35], v[80:87], v12
    s_waitcnt lgkmcnt(2)
    v_smfmac_f32_16x16x64_bf16 v[68:71], v[32:35], v[88:95], v12
    v_smfmac_f32_16x16x64_bf16 v[64:67], v[36:39], a[240:247], v12
    v_smfmac_f32_16x16x64_bf16 v[68:71], v[36:39], a[248:255], v12
    v_and_or_b32 v20, v20, -2, s37
    buffer_store_dwordx4 v[20:23], v0, s[8:11], s35 offen sc1
    s_waitcnt lgkmcnt(0)
    s_barrier
    ds_read_b64_tr_b16 v[80:81], v7 offset:16384
    ds_read_b64_tr_b16 v[82:83], v7 offset:16528
    ds_read_b64_tr_b16 v[56:57], v7 offset:22528
    ds_read_b64_tr_b16 v[58:59], v7 offset:22672
    v_smfmac_f32_16x16x64_bf16 v[64:67], v[40:43], v[128:135], v12
    ds_read_b64_tr_b16 v[84:85], v7 offset:17920
    ds_read_b64_tr_b16 v[86:87], v7 offset:18064
    ds_read_b64_tr_b16 v[60:61], v7 offset:24064
    ds_read_b64_tr_b16 v[62:63], v7 offset:24208
    v_smfmac_f32_16x16x64_bf16 v[68:71], v[40:43], v[136:143], v12
    ds_read_b64_tr_b16 v[88:89], v7 offset:19456
    ds_read_b64_tr_b16 v[90:91], v7 offset:19600
    ds_read_b64_tr_b16 v[24:25], v7 offset:25600
    ds_read_b64_tr_b16 v[26:27], v7 offset:25744
    v_smfmac_f32_16x16x64_bf16 v[64:67], v[44:47], v[144:151], v12
    ds_read_b64_tr_b16 v[92:93], v7 offset:20992
    ds_read_b64_tr_b16 v[94:95], v7 offset:21136
    ds_read_b64_tr_b16 v[28:29], v7 offset:27136
    ds_read_b64_tr_b16 v[30:31], v7 offset:27280
    v_smfmac_f32_16x16x64_bf16 v[68:71], v[44:47], v[152:159], v12
    s_waitcnt lgkmcnt(14)
    v_mfma_f32_16x16x32_bf16 v[48:51], v[96:99], v[80:83], 0
    s_waitcnt lgkmcnt(12)
    v_mfma_f32_16x16x32_bf16 v[16:19], v[56:59], v[80:83], 0
    v_mov_b32 v56, 0x3f803f80
    v_mov_b32 v57, 0x3f803f80
    v_mfma_f32_16x16x32_bf16 v[52:55], v[100:103], v[80:83], 0
    v_mov_b32 v58, 0x3f803f80
    s_waitcnt lgkmcnt(8)
    v_mfma_f32_16x16x32_bf16 v[16:19], v[60:63], v[84:87], v[16:19]
    v_mov_b32 v59, 0x3f803f80
    v_mov_b32 v60, 0x3f003f00
    v_mfma_f32_16x16x32_bf16 v[48:51], v[104:107], v[84:87], v[48:51]
    v_mov_b32 v61, 0x3f003f00
    s_waitcnt lgkmcnt(4)
    v_mfma_f32_16x16x32_bf16 v[16:19], v[24:27], v[88:91], v[16:19]
    v_mfma_f32_16x16x32_bf16 v[52:55], v[108:111], v[84:87], v[52:55]
    s_waitcnt lgkmcnt(0)
    v_mfma_f32_16x16x32_bf16 v[16:19], v[28:31], v[92:95], v[16:19]
    s_cmp_lg_u32 s53, 0
    s_cbranch_scc1 Lkvx_5034
Lkvy_5035:
    ds_read_b128 v[96:99], v4 offset:24576
    ds_read_b128 v[100:103], v4 offset:25600
    v_mfma_f32_16x16x32_bf16 v[48:51], v[112:115], v[88:91], v[48:51]
    ds_read_b128 v[80:83], v4 offset:26624
    ds_read_b128 v[84:87], v4 offset:27648
    v_mfma_f32_16x16x32_bf16 v[48:51], v[120:123], v[92:95], v[48:51]
    ds_read_b128 v[104:107], v4 offset:28672
    ds_read_b128 v[108:111], v4 offset:29696
    v_mfma_f32_16x16x32_bf16 v[52:55], v[116:119], v[88:91], v[52:55]
    v_permlane32_swap_b32 v16, v18
    v_permlane32_swap_b32 v17, v19
    v_mfma_f32_16x16x32_bf16 v[52:55], v[124:127], v[92:95], v[52:55]
    v_add_f32 v16, v16, v18
    v_add_f32 v17, v17, v19
    v_add_f32_dpp v48, v48, v48 row_ror:8 row_mask:0xf bank_mask:0x3
    v_add_f32_dpp v49, v49, v49 row_ror:8 row_mask:0xf bank_mask:0x3
    v_add_f32_dpp v16, v16, v16 row_ror:8 row_mask:0xf bank_mask:0x3
    v_add_f32_dpp v50, v50, v50 row_ror:8 row_mask:0xf bank_mask:0x3
    v_add_f32_dpp v51, v51, v51 row_ror:8 row_mask:0xf bank_mask:0x3
    v_add_f32_dpp v16, v17, v17 row_ror:8 row_mask:0xf bank_mask:0xc
    v_add_f32_dpp v48, v52, v52 row_ror:8 row_mask:0xf bank_mask:0xc
    v_add_f32_dpp v49, v53, v53 row_ror:8 row_mask:0xf bank_mask:0xc
    v_add_f32_dpp v50, v54, v54 row_ror:8 row_mask:0xf bank_mask:0xc
    v_add_f32_dpp v51, v55, v55 row_ror:8 row_mask:0xf bank_mask:0xc
    v_max3_f32 v52, v48, v49, v16
    v_max3_f32 v52, v52, v50, v51
    v_cvt_pk_bf16_f32 v44, v64, v65
    v_cvt_pk_bf16_f32 v45, v66, v67
    v_max_f32_dpp v52, v52, v52 row_ror:8 row_mask:0xf bank_mask:0xf
    v_mov_b32 v53, v52
    v_cvt_pk_bf16_f32 v46, v68, v69
    v_cvt_pk_bf16_f32 v47, v70, v71
    v_permlane16_swap_b32 v52, v53
    v_max_f32 v52, v52, v53
    v_mov_b32 v53, v52
    v_and_or_b32 v44, v44, -2, s37
    buffer_store_dwordx4 v[44:47], v0, s[8:11], s35 offen offset:1024 sc1
    v_permlane32_swap_b32 v52, v53
    v_max_f32 v52, v52, v53
    v_mul_f32 v52, s48, v52
    v_fma_f32 v16, v16, s48, -v52
    v_pk_fma_f32 v[48:49], v[48:49], s[48:49], v[52:53] op_sel_hi:[1,1,0] neg_lo:[0,0,1] neg_hi:[0,0,1]
    v_pk_fma_f32 v[50:51], v[50:51], s[48:49], v[52:53] op_sel_hi:[1,1,0] neg_lo:[0,0,1] neg_hi:[0,0,1]
    v_exp_f32 v48, v48
    v_exp_f32 v49, v49
    v_exp_f32 v50, v50
    v_exp_f32 v51, v51
    v_cvt_pk_bf16_f32 v28, v48, v49
    v_cvt_pk_bf16_f32 v29, v50, v51
    v_exp_f32 v16, v16
    v_mov_b32_dpp v30, v28 row_ror:8 row_mask:0xf bank_mask:0xf
    v_mov_b32_dpp v31, v29 row_ror:8 row_mask:0xf bank_mask:0xf
    v_mov_b32_dpp v17, v16 row_ror:8 row_mask:0xf bank_mask:0xf
    v_cvt_pk_bf16_f32 v62, v16, v17
    v_mfma_f32_16x16x32_bf16 v[40:43], v[56:59], v[28:31], 0
    v_cvt_pk_bf16_f32 v63, v16, v17
    s_nop 0
    s_waitcnt vmcnt(5)
    v_mfma_f32_16x16x32_bf16 v[32:35], v[72:75], v[28:31], 0
    v_permlane32_swap_b32 v62, v63
    s_nop 0
    s_waitcnt vmcnt(4)
    v_mfma_f32_16x16x32_bf16 v[36:39], v[76:79], v[28:31], 0
    s_nop 0
    s_nop 0
    v_mfma_f32_16x16x16_bf16 v[40:43], v[60:61], v[62:63], v[40:43]
    v_mov_b32 v16, 0
    v_mov_b32 v17, 0
    v_mov_b32 v18, 0
    v_mfma_f32_16x16x16_bf16 v[32:35], v[44:45], v[62:63], v[32:35]
    v_mov_b32 v19, 0
    v_mov_b32 v24, 0
    s_cmp_ge_u32 s32, 63
    v_mfma_f32_16x16x16_bf16 v[36:39], v[46:47], v[62:63], v[36:39]
    v_mov_b32 v25, 0
    v_rcp_f32 v40, v40
    v_mov_b32 v26, 0
    v_mov_b32 v27, 0
    v_mov_b32 v28, 0
    v_mov_b32 v29, 0
    v_pk_mul_f32 v[32:33], v[32:33], v[40:41] op_sel_hi:[1,0]
    v_pk_mul_f32 v[34:35], v[34:35], v[40:41] op_sel_hi:[1,0]
    v_pk_mul_f32 v[36:37], v[36:37], v[40:41] op_sel_hi:[1,0]
    v_pk_mul_f32 v[38:39], v[38:39], v[40:41] op_sel_hi:[1,0]
    v_cvt_pk_bf16_f32 v48, v32, v36
    v_cvt_pk_bf16_f32 v49, v33, v37
    v_cvt_pk_bf16_f32 v50, v34, v38
    v_cvt_pk_bf16_f32 v51, v35, v39
    ds_write_b128 v0, v[48:51] offset:0
    v_and_b32 v32, s44, v1
    v_and_b32 v36, s44, v2
    v_and_b32 v40, s44, v3
    s_cbranch_scc1 L_rec_done
    v_mov_b32_dpp v48, v48 row_ror:8 row_mask:0xf bank_mask:0xc
    v_mov_b32_dpp v49, v49 row_ror:8 row_mask:0xf bank_mask:0xc
    v_mov_b32_dpp v50, v50 row_ror:8 row_mask:0xf bank_mask:0xc
    v_mov_b32_dpp v51, v51 row_ror:8 row_mask:0xf bank_mask:0xc
    v_mov_b32 v30, 0
    v_mov_b32 v31, 0
    v_smfmac_f32_16x16x64_bf16 v[16:19], v[48:51], v[160:167], v12
    v_mov_b32 v20, 0
    v_smfmac_f32_16x16x64_bf16 v[24:27], v[48:51], v[176:183], v12
    v_mov_b32 v21, 0
    v_mov_b32 v22, 0
    v_mov_b32 v23, 0
    s_mov_b64 exec, 63
    buffer_load_dword v13, v5, s[8:11], s47 offen sc1
    s_mov_b64 exec, -1
    s_waitcnt lgkmcnt(0)
    s_barrier
    ds_read_b128 v[32:35], v32 offset:0
    ds_read_b128 v[36:39], v36 offset:0
    ds_read_b128 v[40:43], v40 offset:0
    v_smfmac_f32_16x16x64_bf16 v[28:31], v[48:51], v[184:191], v12
    ds_read_b128 v[88:91], v4 offset:30720
    ds_read_b128 v[92:95], v4 offset:31744
    v_smfmac_f32_16x16x64_bf16 v[20:23], v[48:51], v[168:175], v12
    s_waitcnt lgkmcnt(4)
    v_smfmac_f32_16x16x64_bf16 v[16:19], v[32:35], v[192:199], v12
    v_smfmac_f32_16x16x64_bf16 v[20:23], v[32:35], v[200:207], v12
    s_waitcnt lgkmcnt(3)
    v_smfmac_f32_16x16x64_bf16 v[16:19], v[36:39], v[208:215], v12
    v_smfmac_f32_16x16x64_bf16 v[20:23], v[36:39], v[216:223], v12
    s_waitcnt lgkmcnt(2)
    v_smfmac_f32_16x16x64_bf16 v[16:19], v[40:43], v[224:231], v12
    v_smfmac_f32_16x16x64_bf16 v[20:23], v[40:43], v[232:239], v12
    v_smfmac_f32_16x16x64_bf16 v[24:27], v[32:35], v[240:247], v12
    v_smfmac_f32_16x16x64_bf16 v[28:31], v[32:35], v[248:255], v12
    v_cvt_pk_bf16_f32 v56, v16, v17
    v_cvt_pk_bf16_f32 v57, v18, v19
    v_smfmac_f32_16x16x64_bf16 v[24:27], v[36:39], v[96:103], v12
    v_or_b32 v56, 1, v56
    v_smfmac_f32_16x16x64_bf16 v[24:27], v[40:43], v[80:87], v12
    v_cvt_pk_bf16_f32 v58, v20, v21
    v_cvt_pk_bf16_f32 v59, v22, v23
    v_smfmac_f32_16x16x64_bf16 v[28:31], v[36:39], v[104:111], v12
    buffer_store_dwordx4 v[56:59], v9, s[8:11], s41 offen sc1
    s_waitcnt lgkmcnt(0)
    v_smfmac_f32_16x16x64_bf16 v[28:31], v[40:43], v[88:95], v12
    ds_read_b128 v[112:115], v4 offset:14336
    v_cvt_pk_bf16_f32 v60, v24, v25
    v_cvt_pk_bf16_f32 v61, v26, v27
    v_or_b32 v60, 1, v60
    ds_read_b128 v[116:119], v4 offset:15360
    ds_read_b128 v[120:123], v4 offset:16384
    ds_read_b128 v[124:127], v4 offset:17408
    ds_read_b128 v[72:75], v4 offset:18432
    v_cvt_pk_bf16_f32 v62, v28, v29
    v_cvt_pk_bf16_f32 v63, v30, v31
    buffer_store_dwordx4 v[60:63], v9, s[8:11], s42 offen sc1
    ds_read_b128 v[64:67], v5 offset:28672
    ds_read_b128 v[76:79], v4 offset:19456
    ds_read_b128 v[80:83], v4 offset:6144
    ds_read_b128 v[84:87], v4 offset:7168
    ds_read_b128 v[88:91], v4 offset:8192
    ds_read_b128 v[92:95], v4 offset:9216
    ds_read_b128 v[96:99], v4 offset:10240
    ds_read_b128 v[100:103], v4 offset:11264
    ds_read_b128 v[104:107], v4 offset:12288
    ds_read_b128 v[108:111], v4 offset:13312
    ds_read_b128 v[24:27], v4 offset:0
    ds_read_b128 v[28:31], v4 offset:1024
    ds_read_b128 v[32:35], v4 offset:2048
    ds_read_b128 v[36:39], v4 offset:3072
    s_mov_b32 s33, s50
    s_add_u32 s34, s33, 33554432
    s_add_u32 s50, s33, 262144
    s_min_u32 s50, s50, s51
    s_mov_b32 s36, s47
    s_add_u32 s47, s47, 8192
    s_min_u32 s47, s47, s52
    s_nop 15
    s_nop 11
    buffer_load_dwordx4 v[48:51], v10, s[8:11], s41 offen sc1
    buffer_load_dwordx4 v[52:55], v10, s[8:11], s41 offen offset:1024 sc1
    s_nop 15
    s_nop 15
    s_nop 7
    buffer_load_dwordx4 v[56:59], v10, s[8:11], s41 offen sc1
    buffer_load_dwordx4 v[60:63], v10, s[8:11], s41 offen offset:1024 sc1
    ds_read_b128 v[40:43], v4 offset:4096
    ds_read_b128 v[44:47], v4 offset:5120
Lh1_5038:
    s_waitcnt vmcnt(3) lgkmcnt(15)
    v_mfma_f32_16x16x32_bf16 v[68:71], v[48:51], v[64:67], 0
    s_waitcnt vmcnt(2)
    v_mfma_f32_16x16x32_bf16 v[68:71], v[52:55], v[64:67], v[68:71]
    v_bitop3_b32 v15, v48, v52, 1 bitop3:0x2a
    v_cmp_ne_u32 vcc, 0, v15
    s_nop 0
    s_cbranch_vccnz Lh1b_5039
Lh1j_5040:
    s_mov_b32 m0, s43
    s_nop 3
    v_permlane32_swap_b32 v68, v70
    v_permlane32_swap_b32 v69, v71
    v_pk_add_f32 v[68:69], v[68:69], v[70:71]
    s_nop 1
    v_permlane16_swap_b32 v68, v69
    v_add_f32 v68, v68, v69
    s_nop 1
    v_mov_b32_dpp v69, v68 row_shl:4 row_mask:0xf bank_mask:0xf
    v_cvt_pk_bf16_f32 v15, v68, v69
    v_min_u32 v15, -2, v15
    buffer_store_dword v15, v11, s[8:11], s38 offen sc1
    buffer_load_dwordx4 v0, s[8:11], s33 offen lds
    buffer_load_dwordx4 v0, s[8:11], s33 offen offset:1024 lds
    s_mov_b32 s61, s39
    s_mov_b32 s39, s38
    s_mov_b32 s38, s40
    s_mov_b32 s40, s61
    s_add_u32 s32, s32, 1
    s_add_u32 s35, s35, 262144
    s_bitset0_b32 s35, 21
    s_bfe_u32 s37, s32, 0x10003
    v_mov_b32 v64, 0
    v_mov_b32 v65, 0
    v_mov_b32 v66, 0
    v_mov_b32 v67, 0
    v_mov_b32 v68, 0
    v_mov_b32 v69, 0
    v_mov_b32 v70, 0
    v_mov_b32 v71, 0
    s_nop 15
    s_nop 11
    buffer_load_dwordx4 v[16:19], v0, s[8:11], s39 offen sc1
    buffer_load_dwordx4 v[20:23], v0, s[8:11], s39 offen offset:1024 sc1
    s_waitcnt vmcnt(6)
    v_mov_b32 v48, 0
    v_mov_b32 v49, 0
    v_mov_b32 v50, 0
    v_mov_b32 v51, 0
    s_waitcnt vmcnt(5)
    v_mov_b32 v52, 0
    v_mov_b32 v53, 0
    v_mov_b32 v54, 0
    v_mov_b32 v55, 0
    s_waitcnt vmcnt(6)
    v_mov_b32 v56, 0
    v_mov_b32 v57, 0
    v_mov_b32 v58, 0
    v_mov_b32 v59, 0
    s_waitcnt vmcnt(5)
    v_mov_b32 v60, 0
    v_mov_b32 v61, 0
    v_mov_b32 v62, 0
    v_mov_b32 v63, 0
    s_nop 15
    s_nop 7
    buffer_load_dwordx4 v[16:19], v0, s[8:11], s39 offen sc1
    buffer_load_dwordx4 v[20:23], v0, s[8:11], s39 offen offset:1024 sc1
Lh2_5041:
    s_waitcnt vmcnt(2) lgkmcnt(0)
    v_max3_u32 v15, v16, v17, v18
    v_max3_u32 v15, v15, v19, v20
    v_max3_u32 v15, v15, v21, v22
    v_max_u32 v15, v15, v23
    v_cmp_eq_u32 vcc, -1, v15
    ds_write_b128 v0, v[16:19] offset:0
    s_cbranch_vccnz Lh2b_5042
    ds_write_b128 v0, v[20:23] offset:1024
    v_smfmac_f32_16x16x64_bf16 v[48:51], v[16:19], v[24:31], v12
    v_smfmac_f32_16x16x64_bf16 v[52:55], v[16:19], v[32:39], v12
    v_smfmac_f32_16x16x64_bf16 v[56:59], v[16:19], v[40:47], v12
    v_smfmac_f32_16x16x64_bf16 v[60:63], v[16:19], v[80:87], v12
    v_smfmac_f32_16x16x64_bf16 v[64:67], v[16:19], v[88:95], v12
    v_smfmac_f32_16x16x64_bf16 v[68:71], v[16:19], v[96:103], v12
    s_waitcnt lgkmcnt(0)
    s_barrier
    ds_read_b128 v[24:27], v1 offset:0
    ds_read_b128 v[28:31], v1 offset:1024
    v_smfmac_f32_16x16x64_bf16 v[48:51], v[20:23], v[104:111], v12
    ds_read_b128 v[32:35], v2 offset:0
    v_smfmac_f32_16x16x64_bf16 v[52:55], v[20:23], v[112:119], v12
    ds_read_b128 v[36:39], v2 offset:1024
    v_smfmac_f32_16x16x64_bf16 v[56:59], v[20:23], v[120:127], v12
    ds_read_b128 v[40:43], v3 offset:0
    v_smfmac_f32_16x16x64_bf16 v[60:63], v[20:23], v[72:79], v12
    ds_read_b128 v[44:47], v3 offset:1024
    v_smfmac_f32_16x16x64_bf16 v[64:67], v[20:23], a[0:7], v12
    buffer_load_dwordx4 v[72:75], v0, s[8:11], s34 offen
    v_smfmac_f32_16x16x64_bf16 v[68:71], v[20:23], a[8:15], v12
    ds_read_b128 v[96:99], v5 offset:8192
    s_waitcnt lgkmcnt(5)
    v_smfmac_f32_16x16x64_bf16 v[56:59], v[24:27], a[16:23], v12
    ds_read_b128 v[100:103], v5 offset:9216
    v_smfmac_f32_16x16x64_bf16 v[60:63], v[24:27], a[24:31], v12
    ds_read_b128 v[104:107], v5 offset:10240
    v_smfmac_f32_16x16x64_bf16 v[56:59], v[28:31], a[32:39], v12
    ds_read_b128 v[108:111], v5 offset:11264
    v_smfmac_f32_16x16x64_bf16 v[60:63], v[28:31], a[40:47], v12
    ds_read_b128 v[112:115], v5 offset:12288
    s_waitcnt lgkmcnt(5)
    v_smfmac_f32_16x16x64_bf16 v[56:59], v[32:35], a[48:55], v12
    ds_read_b128 v[116:119], v5 offset:13312
    v_smfmac_f32_16x16x64_bf16 v[60:63], v[32:35], a[56:63], v12
    ds_read_b128 v[120:123], v5 offset:14336
    v_smfmac_f32_16x16x64_bf16 v[56:59], v[36:39], a[64:71], v12
    ds_read_b128 v[124:127], v5 offset:15360
    v_smfmac_f32_16x16x64_bf16 v[60:63], v[36:39], a[72:79], v12
    buffer_load_dwordx4 v[76:79], v0, s[8:11], s34 offen offset:1024
    v_smfmac_f32_16x16x64_bf16 v[56:59], v[40:43], a[80:87], v12
    v_cmp_eq_u32 vcc, 0, v13
    v_smfmac_f32_16x16x64_bf16 v[60:63], v[40:43], a[88:95], v12
    v_smfmac_f32_16x16x64_bf16 v[56:59], v[44:47], a[96:103], v12
    s_cbranch_vccnz Lkvw_5043
    buffer_load_dword v15, v14, s[8:11], s50 offen
Lkvb_5044:
    v_smfmac_f32_16x16x64_bf16 v[60:63], v[44:47], a[104:111], v12
    v_smfmac_f32_16x16x64_bf16 v[48:51], v[24:27], a[112:119], v12
    v_smfmac_f32_16x16x64_bf16 v[52:55], v[24:27], a[120:127], v12
    v_smfmac_f32_16x16x64_bf16 v[48:51], v[28:31], a[128:135], v12
    ds_read_b128 v[80:83], v4 offset:20480
    v_smfmac_f32_16x16x64_bf16 v[52:55], v[28:31], a[136:143], v12
    ds_read_b128 v[84:87], v4 offset:21504
    v_smfmac_f32_16x16x64_bf16 v[48:51], v[32:35], a[144:151], v12
    ds_read_b128 v[88:91], v4 offset:22528
    v_smfmac_f32_16x16x64_bf16 v[52:55], v[32:35], a[152:159], v12
    ds_read_b128 v[92:95], v4 offset:23552
    v_smfmac_f32_16x16x64_bf16 v[48:51], v[36:39], a[160:167], v12
    s_waitcnt vmcnt(3)
    v_cvt_pk_bf16_f32 v20, v56, v57
    v_smfmac_f32_16x16x64_bf16 v[52:55], v[36:39], a[168:175], v12
    v_cvt_pk_bf16_f32 v21, v58, v59
    v_smfmac_f32_16x16x64_bf16 v[48:51], v[40:43], a[176:183], v12
    v_cvt_pk_bf16_f32 v22, v60, v61
    v_smfmac_f32_16x16x64_bf16 v[48:51], v[44:47], a[184:191], v12
    v_cvt_pk_bf16_f32 v23, v62, v63
    v_smfmac_f32_16x16x64_bf16 v[52:55], v[40:43], a[192:199], v12
    ds_write_b128 v6, v[20:23] offset:22528
    v_smfmac_f32_16x16x64_bf16 v[52:55], v[44:47], a[200:207], v12
    buffer_store_dword v8, v11, s[8:11], s40 offen sc1
    v_smfmac_f32_16x16x64_bf16 v[64:67], v[24:27], a[208:215], v12
    v_cvt_pk_bf16_f32 v16, v48, v49
    v_cvt_pk_bf16_f32 v17, v50, v51
    v_smfmac_f32_16x16x64_bf16 v[68:71], v[24:27], a[216:223], v12
    v_cvt_pk_bf16_f32 v18, v52, v53
    v_cvt_pk_bf16_f32 v19, v54, v55
    ds_write_b128 v6, v[16:19] offset:16384
    v_smfmac_f32_16x16x64_bf16 v[64:67], v[28:31], a[224:231], v12
    v_smfmac_f32_16x16x64_bf16 v[68:71], v[28:31], a[232:239], v12
    s_waitcnt lgkmcnt(4)
    v_smfmac_f32_16x16x64_bf16 v[64:67], v[32:35], v[80:87], v12
    s_waitcnt lgkmcnt(2)
    v_smfmac_f32_16x16x64_bf16 v[68:71], v[32:35], v[88:95], v12
    v_smfmac_f32_16x16x64_bf16 v[64:67], v[36:39], a[240:247], v12
    v_smfmac_f32_16x16x64_bf16 v[68:71], v[36:39], a[248:255], v12
    v_and_or_b32 v20, v20, -2, s37
    buffer_store_dwordx4 v[20:23], v0, s[8:11], s35 offen sc1
    s_waitcnt lgkmcnt(0)
    s_barrier
    ds_read_b64_tr_b16 v[80:81], v7 offset:16384
    ds_read_b64_tr_b16 v[82:83], v7 offset:16528
    ds_read_b64_tr_b16 v[56:57], v7 offset:22528
    ds_read_b64_tr_b16 v[58:59], v7 offset:22672
    v_smfmac_f32_16x16x64_bf16 v[64:67], v[40:43], v[128:135], v12
    ds_read_b64_tr_b16 v[84:85], v7 offset:17920
    ds_read_b64_tr_b16 v[86:87], v7 offset:18064
    ds_read_b64_tr_b16 v[60:61], v7 offset:24064
    ds_read_b64_tr_b16 v[62:63], v7 offset:24208
    v_smfmac_f32_16x16x64_bf16 v[68:71], v[40:43], v[136:143], v12
    ds_read_b64_tr_b16 v[88:89], v7 offset:19456
    ds_read_b64_tr_b16 v[90:91], v7 offset:19600
    ds_read_b64_tr_b16 v[24:25], v7 offset:25600
    ds_read_b64_tr_b16 v[26:27], v7 offset:25744
    v_smfmac_f32_16x16x64_bf16 v[64:67], v[44:47], v[144:151], v12
    ds_read_b64_tr_b16 v[92:93], v7 offset:20992
    ds_read_b64_tr_b16 v[94:95], v7 offset:21136
    ds_read_b64_tr_b16 v[28:29], v7 offset:27136
    ds_read_b64_tr_b16 v[30:31], v7 offset:27280
    v_smfmac_f32_16x16x64_bf16 v[68:71], v[44:47], v[152:159], v12
    s_waitcnt lgkmcnt(14)
    v_mfma_f32_16x16x32_bf16 v[48:51], v[96:99], v[80:83], 0
    s_waitcnt lgkmcnt(12)
    v_mfma_f32_16x16x32_bf16 v[16:19], v[56:59], v[80:83], 0
    v_mov_b32 v56, 0x3f803f80
    v_mov_b32 v57, 0x3f803f80
    v_mfma_f32_16x16x32_bf16 v[52:55], v[100:103], v[80:83], 0
    v_mov_b32 v58, 0x3f803f80
    s_waitcnt lgkmcnt(8)
    v_mfma_f32_16x16x32_bf16 v[16:19], v[60:63], v[84:87], v[16:19]
    v_mov_b32 v59, 0x3f803f80
    v_mov_b32 v60, 0x3f003f00
    v_mfma_f32_16x16x32_bf16 v[48:51], v[104:107], v[84:87], v[48:51]
    v_mov_b32 v61, 0x3f003f00
    s_waitcnt lgkmcnt(4)
    v_mfma_f32_16x16x32_bf16 v[16:19], v[24:27], v[88:91], v[16:19]
    v_mfma_f32_16x16x32_bf16 v[52:55], v[108:111], v[84:87], v[52:55]
    s_waitcnt lgkmcnt(0)
    v_mfma_f32_16x16x32_bf16 v[16:19], v[28:31], v[92:95], v[16:19]
    s_cmp_lg_u32 s53, 0
    s_cbranch_scc1 Lkvx_5045
Lkvy_5046:
    ds_read_b128 v[96:99], v4 offset:24576
    ds_read_b128 v[100:103], v4 offset:25600
    v_mfma_f32_16x16x32_bf16 v[48:51], v[112:115], v[88:91], v[48:51]
    ds_read_b128 v[80:83], v4 offset:26624
    ds_read_b128 v[84:87], v4 offset:27648
    v_mfma_f32_16x16x32_bf16 v[48:51], v[120:123], v[92:95], v[48:51]
    ds_read_b128 v[104:107], v4 offset:28672
    ds_read_b128 v[108:111], v4 offset:29696
    v_mfma_f32_16x16x32_bf16 v[52:55], v[116:119], v[88:91], v[52:55]
    v_permlane32_swap_b32 v16, v18
    v_permlane32_swap_b32 v17, v19
    v_mfma_f32_16x16x32_bf16 v[52:55], v[124:127], v[92:95], v[52:55]
    v_add_f32 v16, v16, v18
    v_add_f32 v17, v17, v19
    v_add_f32_dpp v48, v48, v48 row_ror:8 row_mask:0xf bank_mask:0x3
    v_add_f32_dpp v49, v49, v49 row_ror:8 row_mask:0xf bank_mask:0x3
    v_add_f32_dpp v16, v16, v16 row_ror:8 row_mask:0xf bank_mask:0x3
    v_add_f32_dpp v50, v50, v50 row_ror:8 row_mask:0xf bank_mask:0x3
    v_add_f32_dpp v51, v51, v51 row_ror:8 row_mask:0xf bank_mask:0x3
    v_add_f32_dpp v16, v17, v17 row_ror:8 row_mask:0xf bank_mask:0xc
    v_add_f32_dpp v48, v52, v52 row_ror:8 row_mask:0xf bank_mask:0xc
    v_add_f32_dpp v49, v53, v53 row_ror:8 row_mask:0xf bank_mask:0xc
    v_add_f32_dpp v50, v54, v54 row_ror:8 row_mask:0xf bank_mask:0xc
    v_add_f32_dpp v51, v55, v55 row_ror:8 row_mask:0xf bank_mask:0xc
    v_max3_f32 v52, v48, v49, v16
    v_max3_f32 v52, v52, v50, v51
    v_cvt_pk_bf16_f32 v44, v64, v65
    v_cvt_pk_bf16_f32 v45, v66, v67
    v_max_f32_dpp v52, v52, v52 row_ror:8 row_mask:0xf bank_mask:0xf
    v_mov_b32 v53, v52
    v_cvt_pk_bf16_f32 v46, v68, v69
    v_cvt_pk_bf16_f32 v47, v70, v71
    v_permlane16_swap_b32 v52, v53
    v_max_f32 v52, v52, v53
    v_mov_b32 v53, v52
    v_and_or_b32 v44, v44, -2, s37
    buffer_store_dwordx4 v[44:47], v0, s[8:11], s35 offen offset:1024 sc1
    v_permlane32_swap_b32 v52, v53
    v_max_f32 v52, v52, v53
    v_mul_f32 v52, s48, v52
    v_fma_f32 v16, v16, s48, -v52
    v_pk_fma_f32 v[48:49], v[48:49], s[48:49], v[52:53] op_sel_hi:[1,1,0] neg_lo:[0,0,1] neg_hi:[0,0,1]
    v_pk_fma_f32 v[50:51], v[50:51], s[48:49], v[52:53] op_sel_hi:[1,1,0] neg_lo:[0,0,1] neg_hi:[0,0,1]
    v_exp_f32 v48, v48
    v_exp_f32 v49, v49
    v_exp_f32 v50, v50
    v_exp_f32 v51, v51
    v_cvt_pk_bf16_f32 v28, v48, v49
    v_cvt_pk_bf16_f32 v29, v50, v51
    v_exp_f32 v16, v16
    v_mov_b32_dpp v30, v28 row_ror:8 row_mask:0xf bank_mask:0xf
    v_mov_b32_dpp v31, v29 row_ror:8 row_mask:0xf bank_mask:0xf
    v_mov_b32_dpp v17, v16 row_ror:8 row_mask:0xf bank_mask:0xf
    v_cvt_pk_bf16_f32 v62, v16, v17
    v_mfma_f32_16x16x32_bf16 v[40:43], v[56:59], v[28:31], 0
    v_cvt_pk_bf16_f32 v63, v16, v17
    s_nop 0
    s_waitcnt vmcnt(5)
    v_mfma_f32_16x16x32_bf16 v[32:35], v[72:75], v[28:31], 0
    v_permlane32_swap_b32 v62, v63
    s_nop 0
    s_waitcnt vmcnt(4)
    v_mfma_f32_16x16x32_bf16 v[36:39], v[76:79], v[28:31], 0
    s_nop 0
    s_nop 0
    v_mfma_f32_16x16x16_bf16 v[40:43], v[60:61], v[62:63], v[40:43]
    v_mov_b32 v16, 0
    v_mov_b32 v17, 0
    v_mov_b32 v18, 0
    v_mfma_f32_16x16x16_bf16 v[32:35], v[44:45], v[62:63], v[32:35]
    v_mov_b32 v19, 0
    v_mov_b32 v24, 0
    s_cmp_ge_u32 s32, 63
    v_mfma_f32_16x16x16_bf16 v[36:39], v[46:47], v[62:63], v[36:39]
    v_mov_b32 v25, 0
    v_rcp_f32 v40, v40
    v_mov_b32 v26, 0
    v_mov_b32 v27, 0
    v_mov_b32 v28, 0
    v_mov_b32 v29, 0
    v_pk_mul_f32 v[32:33], v[32:33], v[40:41] op_sel_hi:[1,0]
    v_pk_mul_f32 v[34:35], v[34:35], v[40:41] op_sel_hi:[1,0]
    v_pk_mul_f32 v[36:37], v[36:37], v[40:41] op_sel_hi:[1,0]
    v_pk_mul_f32 v[38:39], v[38:39], v[40:41] op_sel_hi:[1,0]
    v_cvt_pk_bf16_f32 v48, v32, v36
    v_cvt_pk_bf16_f32 v49, v33, v37
    v_cvt_pk_bf16_f32 v50, v34, v38
    v_cvt_pk_bf16_f32 v51, v35, v39
    ds_write_b128 v0, v[48:51] offset:0
    v_and_b32 v32, s44, v1
    v_and_b32 v36, s44, v2
    v_and_b32 v40, s44, v3
    s_cbranch_scc1 L_rec_done
    v_mov_b32_dpp v48, v48 row_ror:8 row_mask:0xf bank_mask:0xc
    v_mov_b32_dpp v49, v49 row_ror:8 row_mask:0xf bank_mask:0xc
    v_mov_b32_dpp v50, v50 row_ror:8 row_mask:0xf bank_mask:0xc
    v_mov_b32_dpp v51, v51 row_ror:8 row_mask:0xf bank_mask:0xc
    v_mov_b32 v30, 0
    v_mov_b32 v31, 0
    v_smfmac_f32_16x16x64_bf16 v[16:19], v[48:51], v[160:167], v12
    v_mov_b32 v20, 0
    v_smfmac_f32_16x16x64_bf16 v[24:27], v[48:51], v[176:183], v12
    v_mov_b32 v21, 0
    v_mov_b32 v22, 0
    v_mov_b32 v23, 0
    s_mov_b64 exec, 63
    buffer_load_dword v13, v5, s[8:11], s47 offen sc1
    s_mov_b64 exec, -1
    s_waitcnt lgkmcnt(0)
    s_barrier
    ds_read_b128 v[32:35], v32 offset:0
    ds_read_b128 v[36:39], v36 offset:0
    ds_read_b128 v[40:43], v40 offset:0
    v_smfmac_f32_16x16x64_bf16 v[28:31], v[48:51], v[184:191], v12
    ds_read_b128 v[88:91], v4 offset:30720
    ds_read_b128 v[92:95], v4 offset:31744
    v_smfmac_f32_16x16x64_bf16 v[20:23], v[48:51], v[168:175], v12
    s_waitcnt lgkmcnt(4)
    v_smfmac_f32_16x16x64_bf16 v[16:19], v[32:35], v[192:199], v12
    v_smfmac_f32_16x16x64_bf16 v[20:23], v[32:35], v[200:207], v12
    s_waitcnt lgkmcnt(3)
    v_smfmac_f32_16x16x64_bf16 v[16:19], v[36:39], v[208:215], v12
    v_smfmac_f32_16x16x64_bf16 v[20:23], v[36:39], v[216:223], v12
    s_waitcnt lgkmcnt(2)
    v_smfmac_f32_16x16x64_bf16 v[16:19], v[40:43], v[224:231], v12
    v_smfmac_f32_16x16x64_bf16 v[20:23], v[40:43], v[232:239], v12
    v_smfmac_f32_16x16x64_bf16 v[24:27], v[32:35], v[240:247], v12
    v_smfmac_f32_16x16x64_bf16 v[28:31], v[32:35], v[248:255], v12
    v_cvt_pk_bf16_f32 v56, v16, v17
    v_cvt_pk_bf16_f32 v57, v18, v19
    v_smfmac_f32_16x16x64_bf16 v[24:27], v[36:39], v[96:103], v12
    v_and_b32 v56, -2, v56
    v_smfmac_f32_16x16x64_bf16 v[24:27], v[40:43], v[80:87], v12
    v_cvt_pk_bf16_f32 v58, v20, v21
    v_cvt_pk_bf16_f32 v59, v22, v23
    v_smfmac_f32_16x16x64_bf16 v[28:31], v[36:39], v[104:111], v12
    buffer_store_dwordx4 v[56:59], v9, s[8:11], s41 offen sc1
    s_waitcnt lgkmcnt(0)
    v_smfmac_f32_16x16x64_bf16 v[28:31], v[40:43], v[88:95], v12
    ds_read_b128 v[112:115], v4 offset:14336
    v_cvt_pk_bf16_f32 v60, v24, v25
    v_cvt_pk_bf16_f32 v61, v26, v27
    v_and_b32 v60, -2, v60
    ds_read_b128 v[116:119], v4 offset:15360
    ds_read_b128 v[120:123], v4 offset:16384
    ds_read_b128 v[124:127], v4 offset:17408
    ds_read_b128 v[72:75], v4 offset:18432
    v_cvt_pk_bf16_f32 v62, v28, v29
    v_cvt_pk_bf16_f32 v63, v30, v31
    buffer_store_dwordx4 v[60:63], v9, s[8:11], s42 offen sc1
    ds_read_b128 v[64:67], v5 offset:28672
    ds_read_b128 v[76:79], v4 offset:19456
    ds_read_b128 v[80:83], v4 offset:6144
    ds_read_b128 v[84:87], v4 offset:7168
    ds_read_b128 v[88:91], v4 offset:8192
    ds_read_b128 v[92:95], v4 offset:9216
    ds_read_b128 v[96:99], v4 offset:10240
    ds_read_b128 v[100:103], v4 offset:11264
    ds_read_b128 v[104:107], v4 offset:12288
    ds_read_b128 v[108:111], v4 offset:13312
    ds_read_b128 v[24:27], v4 offset:0
    ds_read_b128 v[28:31], v4 offset:1024
    ds_read_b128 v[32:35], v4 offset:2048
    ds_read_b128 v[36:39], v4 offset:3072
    s_mov_b32 s33, s50
    s_add_u32 s34, s33, 33554432
    s_add_u32 s50, s33, 262144
    s_min_u32 s50, s50, s51
    s_mov_b32 s36, s47
    s_add_u32 s47, s47, 8192
    s_min_u32 s47, s47, s52
    s_nop 15
    s_nop 11
    buffer_load_dwordx4 v[48:51], v10, s[8:11], s41 offen sc1
    buffer_load_dwordx4 v[52:55], v10, s[8:11], s41 offen offset:1024 sc1
    s_nop 15
    s_nop 15
    s_nop 7
    buffer_load_dwordx4 v[56:59], v10, s[8:11], s41 offen sc1
    buffer_load_dwordx4 v[60:63], v10, s[8:11], s41 offen offset:1024 sc1
    ds_read_b128 v[40:43], v4 offset:4096
    ds_read_b128 v[44:47], v4 offset:5120
Lh1_5049:
    s_waitcnt vmcnt(3) lgkmcnt(15)
    v_mfma_f32_16x16x32_bf16 v[68:71], v[48:51], v[64:67], 0
    s_waitcnt vmcnt(2)
    v_mfma_f32_16x16x32_bf16 v[68:71], v[52:55], v[64:67], v[68:71]
    v_bitop3_b32 v15, v48, v52, 1 bitop3:0xa8
    v_cmp_ne_u32 vcc, 0, v15
    s_nop 0
    s_cbranch_vccnz Lh1b_5050
Lh1j_5051:
    s_mov_b32 m0, s43
    s_nop 3
    v_permlane32_swap_b32 v68, v70
    v_permlane32_swap_b32 v69, v71
    v_pk_add_f32 v[68:69], v[68:69], v[70:71]
    s_nop 1
    v_permlane16_swap_b32 v68, v69
    v_add_f32 v68, v68, v69
    s_nop 1
    v_mov_b32_dpp v69, v68 row_shl:4 row_mask:0xf bank_mask:0xf
    v_cvt_pk_bf16_f32 v15, v68, v69
    v_min_u32 v15, -2, v15
    buffer_store_dword v15, v11, s[8:11], s38 offen sc1
    buffer_load_dwordx4 v0, s[8:11], s33 offen lds
    buffer_load_dwordx4 v0, s[8:11], s33 offen offset:1024 lds
    s_mov_b32 s61, s39
    s_mov_b32 s39, s38
    s_mov_b32 s38, s40
    s_mov_b32 s40, s61
    s_add_u32 s32, s32, 1
    s_add_u32 s35, s35, 262144
    s_bitset0_b32 s35, 21
    s_bfe_u32 s37, s32, 0x10003
    v_mov_b32 v64, 0
    v_mov_b32 v65, 0
    v_mov_b32 v66, 0
    v_mov_b32 v67, 0
    v_mov_b32 v68, 0
    v_mov_b32 v69, 0
    v_mov_b32 v70, 0
    v_mov_b32 v71, 0
    s_nop 15
    s_nop 11
    buffer_load_dwordx4 v[16:19], v0, s[8:11], s39 offen sc1
    buffer_load_dwordx4 v[20:23], v0, s[8:11], s39 offen offset:1024 sc1
    s_waitcnt vmcnt(6)
    v_mov_b32 v48, 0
    v_mov_b32 v49, 0
    v_mov_b32 v50, 0
    v_mov_b32 v51, 0
    s_waitcnt vmcnt(5)
    v_mov_b32 v52, 0
    v_mov_b32 v53, 0
    v_mov_b32 v54, 0
    v_mov_b32 v55, 0
    s_waitcnt vmcnt(6)
    v_mov_b32 v56, 0
    v_mov_b32 v57, 0
    v_mov_b32 v58, 0
    v_mov_b32 v59, 0
    s_waitcnt vmcnt(5)
    v_mov_b32 v60, 0
    v_mov_b32 v61, 0
    v_mov_b32 v62, 0
    v_mov_b32 v63, 0
    s_nop 15
    s_nop 7
    buffer_load_dwordx4 v[16:19], v0, s[8:11], s39 offen sc1
    buffer_load_dwordx4 v[20:23], v0, s[8:11], s39 offen offset:1024 sc1
    s_branch L_rec_slow
Lh2b_5031:
    s_mov_b64 exec, vcc
    buffer_load_dwordx4 v[16:19], v0, s[8:11], s39 offen sc1
    buffer_load_dwordx4 v[20:23], v0, s[8:11], s39 offen offset:1024 sc1
    s_mov_b64 exec, -1
    s_sub_u32 s62, s62, 1
    s_cbranch_scc0 Ltok_10030
    s_movk_i32 s61, 4
    s_branch L_abort
Ltok_10030:
    s_branch Lh2_5030
Lkvw_5032:
    s_mov_b64 exec, 63
    buffer_load_dword v13, v5, s[8:11], s36 offen sc1
    s_mov_b64 exec, -1
    s_mov_b32 s53, 1
    s_branch Lkvb_5033
Lkvx_5034:
    s_mov_b32 s53, 0
    s_waitcnt vmcnt(2)
    v_cmp_eq_u32 vcc, 0, v13
    s_nop 0
    s_cbranch_vccz Lkvt_5037
Lkvz_5036:
    s_mov_b64 exec, 63
    buffer_load_dword v13, v5, s[8:11], s36 offen sc1
    s_mov_b64 exec, -1
    s_sub_u32 s62, s62, 1
    s_cbranch_scc0 Ltok_10031
    s_movk_i32 s61, 2
    s_branch L_abort
Ltok_10031:
    s_waitcnt vmcnt(0)
    v_cmp_eq_u32 vcc, 0, v13
    s_nop 0
    s_cbranch_vccnz Lkvz_5036
Lkvt_5037:
    buffer_load_dword v15, v14, s[8:11], s50 offen
    s_branch Lkvy_5035
Lh1b_5039:
    s_mov_b64 exec, vcc
    buffer_load_dwordx4 v[48:51], v10, s[8:11], s41 offen sc1
    buffer_load_dwordx4 v[52:55], v10, s[8:11], s41 offen offset:1024 sc1
    s_mov_b64 exec, -1
    s_waitcnt vmcnt(3)
    v_mfma_f32_16x16x32_bf16 v[68:71], v[56:59], v[64:67], 0
    s_waitcnt vmcnt(2)
    v_mfma_f32_16x16x32_bf16 v[68:71], v[60:63], v[64:67], v[68:71]
    v_bitop3_b32 v15, v56, v60, 1 bitop3:0x2a
    v_cmp_ne_u32 vcc, 0, v15
    s_nop 0
    s_cbranch_vccz Lh1j_5040
    s_mov_b64 exec, vcc
    buffer_load_dwordx4 v[56:59], v10, s[8:11], s41 offen sc1
    buffer_load_dwordx4 v[60:63], v10, s[8:11], s41 offen offset:1024 sc1
    s_mov_b64 exec, -1
    s_sub_u32 s62, s62, 1
    s_cbranch_scc0 Ltok_10032
    s_movk_i32 s61, 3
    s_branch L_abort
Ltok_10032:
    s_branch Lh1_5038
Lh2b_5042:
    s_mov_b64 exec, vcc
    buffer_load_dwordx4 v[16:19], v0, s[8:11], s39 offen sc1
    buffer_load_dwordx4 v[20:23], v0, s[8:11], s39 offen offset:1024 sc1
    s_mov_b64 exec, -1
    s_sub_u32 s62, s62, 1
    s_cbranch_scc0 Ltok_10033
    s_movk_i32 s61, 4
    s_branch L_abort
Ltok_10033:
    s_branch Lh2_5041
Lkvw_5043:
    s_mov_b64 exec, 63
    buffer_load_dword v13, v5, s[8:11], s36 offen sc1
    s_mov_b64 exec, -1
    s_mov_b32 s53, 1
    s_branch Lkvb_5044
Lkvx_5045:
    s_mov_b32 s53, 0
    s_waitcnt vmcnt(2)
    v_cmp_eq_u32 vcc, 0, v13
    s_nop 0
    s_cbranch_vccz Lkvt_5048
Lkvz_5047:
    s_mov_b64 exec, 63
    buffer_load_dword v13, v5, s[8:11], s36 offen sc1
    s_mov_b64 exec, -1
    s_sub_u32 s62, s62, 1
    s_cbranch_scc0 Ltok_10034
    s_movk_i32 s61, 2
    s_branch L_abort
Ltok_10034:
    s_waitcnt vmcnt(0)
    v_cmp_eq_u32 vcc, 0, v13
    s_nop 0
    s_cbranch_vccnz Lkvz_5047
Lkvt_5048:
    buffer_load_dword v15, v14, s[8:11], s50 offen
    s_branch Lkvy_5046
Lh1b_5050:
    s_mov_b64 exec, vcc
    buffer_load_dwordx4 v[48:51], v10, s[8:11], s41 offen sc1
    buffer_load_dwordx4 v[52:55], v10, s[8:11], s41 offen offset:1024 sc1
    s_mov_b64 exec, -1
    s_waitcnt vmcnt(3)
    v_mfma_f32_16x16x32_bf16 v[68:71], v[56:59], v[64:67], 0
    s_waitcnt vmcnt(2)
    v_mfma_f32_16x16x32_bf16 v[68:71], v[60:63], v[64:67], v[68:71]
    v_bitop3_b32 v15, v56, v60, 1 bitop3:0xa8
    v_cmp_ne_u32 vcc, 0, v15
    s_nop 0
    s_cbranch_vccz Lh1j_5051
    s_mov_b64 exec, vcc
    buffer_load_dwordx4 v[56:59], v10, s[8:11], s41 offen sc1
    buffer_load_dwordx4 v[60:63], v10, s[8:11], s41 offen offset:1024 sc1
    s_mov_b64 exec, -1
    s_sub_u32 s62, s62, 1
    s_cbranch_scc0 Ltok_10035
    s_movk_i32 s61, 3
    s_branch L_abort
Ltok_10035:
    s_branch Lh1_5049
L_rec_done:
    s_branch L_end
L_proj:
    s_cmp_eq_u32 s4, 4
    s_cbranch_scc1 L_proj_q
    s_mov_b32 s32, s5
    s_lshl_b32 s36, s3, 4
    s_cmp_ge_u32 s3, 2
    s_cbranch_scc1 L_proj_v
    s_mov_b32 s33, 0
    s_mov_b32 s35, 16777216
    s_mov_b32 s16, s84
    s_and_b32 s17, s85, 0xffff
    s_mov_b32 s18, 4194304
    s_mov_b32 s19, 0x20000
    s_branch L_proj_go
L_proj_v:
    s_mov_b32 s33, 1
    s_mov_b32 s35, 50331648
    s_mov_b32 s16, s86
    s_and_b32 s17, s87, 0xffff
    s_mov_b32 s18, 4194304
    s_mov_b32 s19, 0x20000
    s_branch L_proj_go
L_proj_q:
    s_lshr_b32 s6, s5, 4
    s_and_b32 s32, s5, 15
    s_lshl_b32 s32, s32, 1
    s_lshr_b32 s44, s3, 1
    s_add_u32 s32, s32, s44
    s_and_b32 s36, s3, 1
    s_lshl_b32 s36, s36, 4
    s_add_u32 s36, s36, 128
    s_mov_b32 s33, 0
    s_mov_b32 s35, 83886080
    s_mov_b32 s16, s82
    s_and_b32 s17, s83, 0xffff
    s_mov_b32 s18, 4194304
    s_mov_b32 s19, 0x20000
L_proj_go:
    v_and_b32 v9, 63, v0
    v_and_b32 v10, 31, v9
    v_lshrrev_b32 v11, 5, v9
    v_mov_b32 v14, 0x05040100
    v_mov_b32 v15, 0x07060302
    v_lshlrev_b32 v13, 2, v10
    s_cmp_lg_u32 s33, 0
    s_cbranch_scc1 L_proj_wv
    v_and_b32 v13, 0x12, v10
    v_lshlrev_b32 v13, 1, v13
    v_bfe_u32 v12, v10, 2, 1
    v_lshl_add_u32 v13, v12, 4, v13
    v_bfe_u32 v12, v10, 3, 1
    v_lshl_add_u32 v13, v12, 3, v13
    v_and_b32 v12, 1, v10
    v_lshl_add_u32 v13, v12, 6, v13
    v_cmp_eq_u32 vcc, 1, v12
    s_nop 1
    v_cndmask_b32 v8, v14, v15, vcc
    v_cndmask_b32 v15, v15, v14, vcc
    v_mov_b32 v14, v8
L_proj_wv:
    v_lshlrev_b32 v12, 16, v11
    v_add_u32 v12, v12, v13
    s_lshl_b32 s44, s32, 8
    s_and_b32 s45, s3, 1
    s_lshl_b32 s45, s45, 7
    s_add_u32 s44, s44, s45
    v_add_u32 v12, s44, v12
    s_cmp_lg_u32 s33, 0
    s_cbranch_scc1 L_proj_wv2
    s_mov_b32 s44, 0
    buffer_load_dword v16, v12, s[16:19], s44 offen
    s_mov_b32 s44, 8192
    buffer_load_dword v17, v12, s[16:19], s44 offen
    s_mov_b32 s44, 16384
    buffer_load_dword v18, v12, s[16:19], s44 offen
    s_mov_b32 s44, 24576
    buffer_load_dword v19, v12, s[16:19], s44 offen
    s_mov_b32 s44, 32768
    buffer_load_dword v20, v12, s[16:19], s44 offen
    s_mov_b32 s44, 40960
    buffer_load_dword v21, v12, s[16:19], s44 offen
    s_mov_b32 s44, 49152
    buffer_load_dword v22, v12, s[16:19], s44 offen
    s_mov_b32 s44, 57344
    buffer_load_dword v23, v12, s[16:19], s44 offen
    s_mov_b32 s44, 131072
    buffer_load_dword v24, v12, s[16:19], s44 offen
    s_mov_b32 s44, 139264
    buffer_load_dword v25, v12, s[16:19], s44 offen
    s_mov_b32 s44, 147456
    buffer_load_dword v26, v12, s[16:19], s44 offen
    s_mov_b32 s44, 155648
    buffer_load_dword v27, v12, s[16:19], s44 offen
    s_mov_b32 s44, 163840
    buffer_load_dword v28, v12, s[16:19], s44 offen
    s_mov_b32 s44, 172032
    buffer_load_dword v29, v12, s[16:19], s44 offen
    s_mov_b32 s44, 180224
    buffer_load_dword v30, v12, s[16:19], s44 offen
    s_mov_b32 s44, 188416
    buffer_load_dword v31, v12, s[16:19], s44 offen
    s_mov_b32 s44, 262144
    buffer_load_dword v32, v12, s[16:19], s44 offen
    s_mov_b32 s44, 270336
    buffer_load_dword v33, v12, s[16:19], s44 offen
    s_mov_b32 s44, 278528
    buffer_load_dword v34, v12, s[16:19], s44 offen
    s_mov_b32 s44, 286720
    buffer_load_dword v35, v12, s[16:19], s44 offen
    s_mov_b32 s44, 294912
    buffer_load_dword v36, v12, s[16:19], s44 offen
    s_mov_b32 s44, 303104
    buffer_load_dword v37, v12, s[16:19], s44 offen
    s_mov_b32 s44, 311296
    buffer_load_dword v38, v12, s[16:19], s44 offen
    s_mov_b32 s44, 319488
    buffer_load_dword v39, v12, s[16:19], s44 offen
    s_mov_b32 s44, 393216
    buffer_load_dword v40, v12, s[16:19], s44 offen
    s_mov_b32 s44, 401408
    buffer_load_dword v41, v12, s[16:19], s44 offen
    s_mov_b32 s44, 409600
    buffer_load_dword v42, v12, s[16:19], s44 offen
    s_mov_b32 s44, 417792
    buffer_load_dword v43, v12, s[16:19], s44 offen
    s_mov_b32 s44, 425984
    buffer_load_dword v44, v12, s[16:19], s44 offen
    s_mov_b32 s44, 434176
    buffer_load_dword v45, v12, s[16:19], s44 offen
    s_mov_b32 s44, 442368
    buffer_load_dword v46, v12, s[16:19], s44 offen
    s_mov_b32 s44, 450560
    buffer_load_dword v47, v12, s[16:19], s44 offen
    s_mov_b32 s44, 524288
    buffer_load_dword v48, v12, s[16:19], s44 offen
    s_mov_b32 s44, 532480
    buffer_load_dword v49, v12, s[16:19], s44 offen
    s_mov_b32 s44, 540672
    buffer_load_dword v50, v12, s[16:19], s44 offen
    s_mov_b32 s44, 548864
    buffer_load_dword v51, v12, s[16:19], s44 offen
    s_mov_b32 s44, 557056
    buffer_load_dword v52, v12, s[16:19], s44 offen
    s_mov_b32 s44, 565248
    buffer_load_dword v53, v12, s[16:19], s44 offen
    s_mov_b32 s44, 573440
    buffer_load_dword v54, v12, s[16:19], s44 offen
    s_mov_b32 s44, 581632
    buffer_load_dword v55, v12, s[16:19], s44 offen
    s_mov_b32 s44, 655360
    buffer_load_dword v56, v12, s[16:19], s44 offen
    s_mov_b32 s44, 663552
    buffer_load_dword v57, v12, s[16:19], s44 offen
    s_mov_b32 s44, 671744
    buffer_load_dword v58, v12, s[16:19], s44 offen
    s_mov_b32 s44, 679936
    buffer_load_dword v59, v12, s[16:19], s44 offen
    s_mov_b32 s44, 688128
    buffer_load_dword v60, v12, s[16:19], s44 offen
    s_mov_b32 s44, 696320
    buffer_load_dword v61, v12, s[16:19], s44 offen
    s_mov_b32 s44, 704512
    buffer_load_dword v62, v12, s[16:19], s44 offen
    s_mov_b32 s44, 712704
    buffer_load_dword v63, v12, s[16:19], s44 offen
    s_mov_b32 s44, 786432
    buffer_load_dword v64, v12, s[16:19], s44 offen
    s_mov_b32 s44, 794624
    buffer_load_dword v65, v12, s[16:19], s44 offen
    s_mov_b32 s44, 802816
    buffer_load_dword v66, v12, s[16:19], s44 offen
    s_mov_b32 s44, 811008
    buffer_load_dword v67, v12, s[16:19], s44 offen
    s_mov_b32 s44, 819200
    buffer_load_dword v68, v12, s[16:19], s44 offen
    s_mov_b32 s44, 827392
    buffer_load_dword v69, v12, s[16:19], s44 offen
    s_mov_b32 s44, 835584
    buffer_load_dword v70, v12, s[16:19], s44 offen
    s_mov_b32 s44, 843776
    buffer_load_dword v71, v12, s[16:19], s44 offen
    s_mov_b32 s44, 917504
    buffer_load_dword v72, v12, s[16:19], s44 offen
    s_mov_b32 s44, 925696
    buffer_load_dword v73, v12, s[16:19], s44 offen
    s_mov_b32 s44, 933888
    buffer_load_dword v74, v12, s[16:19], s44 offen
    s_mov_b32 s44, 942080
    buffer_load_dword v75, v12, s[16:19], s44 offen
    s_mov_b32 s44, 950272
    buffer_load_dword v76, v12, s[16:19], s44 offen
    s_mov_b32 s44, 958464
    buffer_load_dword v77, v12, s[16:19], s44 offen
    s_mov_b32 s44, 966656
    buffer_load_dword v78, v12, s[16:19], s44 offen
    s_mov_b32 s44, 974848
    buffer_load_dword v79, v12, s[16:19], s44 offen
    s_waitcnt vmcnt(62)
    v_perm_b32 v112, v17, v16, v14
    v_perm_b32 v116, v17, v16, v15
    s_waitcnt vmcnt(60)
    v_perm_b32 v113, v19, v18, v14
    v_perm_b32 v117, v19, v18, v15
    s_waitcnt vmcnt(58)
    v_perm_b32 v114, v21, v20, v14
    v_perm_b32 v118, v21, v20, v15
    s_waitcnt vmcnt(56)
    v_perm_b32 v115, v23, v22, v14
    v_perm_b32 v119, v23, v22, v15
    v_mov_b32_dpp v120, v116 quad_perm:[1,0,3,2] row_mask:0xf bank_mask:0xf
    v_mov_b32_dpp v121, v117 quad_perm:[1,0,3,2] row_mask:0xf bank_mask:0xf
    v_mov_b32_dpp v122, v118 quad_perm:[1,0,3,2] row_mask:0xf bank_mask:0xf
    v_mov_b32_dpp v123, v119 quad_perm:[1,0,3,2] row_mask:0xf bank_mask:0xf
    v_cndmask_b32 v116, v120, v112, vcc
    v_cndmask_b32 v112, v112, v120, vcc
    v_cndmask_b32 v117, v121, v113, vcc
    v_cndmask_b32 v113, v113, v121, vcc
    v_cndmask_b32 v118, v122, v114, vcc
    v_cndmask_b32 v114, v114, v122, vcc
    v_cndmask_b32 v119, v123, v115, vcc
    v_cndmask_b32 v115, v115, v123, vcc
    v_accvgpr_write_b32 a0, v112
    v_accvgpr_write_b32 a1, v113
    v_accvgpr_write_b32 a2, v114
    v_accvgpr_write_b32 a3, v115
    v_accvgpr_write_b32 a4, v116
    v_accvgpr_write_b32 a5, v117
    v_accvgpr_write_b32 a6, v118
    v_accvgpr_write_b32 a7, v119
    s_waitcnt vmcnt(54)
    v_perm_b32 v128, v25, v24, v14
    v_perm_b32 v132, v25, v24, v15
    s_waitcnt vmcnt(52)
    v_perm_b32 v129, v27, v26, v14
    v_perm_b32 v133, v27, v26, v15
    s_waitcnt vmcnt(50)
    v_perm_b32 v130, v29, v28, v14
    v_perm_b32 v134, v29, v28, v15
    s_waitcnt vmcnt(48)
    v_perm_b32 v131, v31, v30, v14
    v_perm_b32 v135, v31, v30, v15
    v_mov_b32_dpp v136, v132 quad_perm:[1,0,3,2] row_mask:0xf bank_mask:0xf
    v_mov_b32_dpp v137, v133 quad_perm:[1,0,3,2] row_mask:0xf bank_mask:0xf
    v_mov_b32_dpp v138, v134 quad_perm:[1,0,3,2] row_mask:0xf bank_mask:0xf
    v_mov_b32_dpp v139, v135 quad_perm:[1,0,3,2] row_mask:0xf bank_mask:0xf
    v_cndmask_b32 v132, v136, v128, vcc
    v_cndmask_b32 v128, v128, v136, vcc
    v_cndmask_b32 v133, v137, v129, vcc
    v_cndmask_b32 v129, v129, v137, vcc
    v_cndmask_b32 v134, v138, v130, vcc
    v_cndmask_b32 v130, v130, v138, vcc
    v_cndmask_b32 v135, v139, v131, vcc
    v_cndmask_b32 v131, v131, v139, vcc
    v_accvgpr_write_b32 a8, v128
    v_accvgpr_write_b32 a9, v129
    v_accvgpr_write_b32 a10, v130
    v_accvgpr_write_b32 a11, v131
    v_accvgpr_write_b32 a12, v132
    v_accvgpr_write_b32 a13, v133
    v_accvgpr_write_b32 a14, v134
    v_accvgpr_write_b32 a15, v135
    s_waitcnt vmcnt(46)
    v_perm_b32 v112, v33, v32, v14
    v_perm_b32 v116, v33, v32, v15
    s_waitcnt vmcnt(44)
    v_perm_b32 v113, v35, v34, v14
    v_perm_b32 v117, v35, v34, v15
    s_waitcnt vmcnt(42)
    v_perm_b32 v114, v37, v36, v14
    v_perm_b32 v118, v37, v36, v15
    s_waitcnt vmcnt(40)
    v_perm_b32 v115, v39, v38, v14
    v_perm_b32 v119, v39, v38, v15
    v_mov_b32_dpp v120, v116 quad_perm:[1,0,3,2] row_mask:0xf bank_mask:0xf
    v_mov_b32_dpp v121, v117 quad_perm:[1,0,3,2] row_mask:0xf bank_mask:0xf
    v_mov_b32_dpp v122, v118 quad_perm:[1,0,3,2] row_mask:0xf bank_mask:0xf
    v_mov_b32_dpp v123, v119 quad_perm:[1,0,3,2] row_mask:0xf bank_mask:0xf
    v_cndmask_b32 v116, v120, v112, vcc
    v_cndmask_b32 v112, v112, v120, vcc
    v_cndmask_b32 v117, v121, v113, vcc
    v_cndmask_b32 v113, v113, v121, vcc
    v_cndmask_b32 v118, v122, v114, vcc
    v_cndmask_b32 v114, v114, v122, vcc
    v_cndmask_b32 v119, v123, v115, vcc
    v_cndmask_b32 v115, v115, v123, vcc
    v_accvgpr_write_b32 a16, v112
    v_accvgpr_write_b32 a17, v113
    v_accvgpr_write_b32 a18, v114
    v_accvgpr_write_b32 a19, v115
    v_accvgpr_write_b32 a20, v116
    v_accvgpr_write_b32 a21, v117
    v_accvgpr_write_b32 a22, v118
    v_accvgpr_write_b32 a23, v119
    s_waitcnt vmcnt(38)
    v_perm_b32 v128, v41, v40, v14
    v_perm_b32 v132, v41, v40, v15
    s_waitcnt vmcnt(36)
    v_perm_b32 v129, v43, v42, v14
    v_perm_b32 v133, v43, v42, v15
    s_waitcnt vmcnt(34)
    v_perm_b32 v130, v45, v44, v14
    v_perm_b32 v134, v45, v44, v15
    s_waitcnt vmcnt(32)
    v_perm_b32 v131, v47, v46, v14
    v_perm_b32 v135, v47, v46, v15
    v_mov_b32_dpp v136, v132 quad_perm:[1,0,3,2] row_mask:0xf bank_mask:0xf
    v_mov_b32_dpp v137, v133 quad_perm:[1,0,3,2] row_mask:0xf bank_mask:0xf
    v_mov_b32_dpp v138, v134 quad_perm:[1,0,3,2] row_mask:0xf bank_mask:0xf
    v_mov_b32_dpp v139, v135 quad_perm:[1,0,3,2] row_mask:0xf bank_mask:0xf
    v_cndmask_b32 v132, v136, v128, vcc
    v_cndmask_b32 v128, v128, v136, vcc
    v_cndmask_b32 v133, v137, v129, vcc
    v_cndmask_b32 v129, v129, v137, vcc
    v_cndmask_b32 v134, v138, v130, vcc
    v_cndmask_b32 v130, v130, v138, vcc
    v_cndmask_b32 v135, v139, v131, vcc
    v_cndmask_b32 v131, v131, v139, vcc
    v_accvgpr_write_b32 a24, v128
    v_accvgpr_write_b32 a25, v129
    v_accvgpr_write_b32 a26, v130
    v_accvgpr_write_b32 a27, v131
    v_accvgpr_write_b32 a28, v132
    v_accvgpr_write_b32 a29, v133
    v_accvgpr_write_b32 a30, v134
    v_accvgpr_write_b32 a31, v135
    s_mov_b32 s44, 1048576
    buffer_load_dword v80, v12, s[16:19], s44 offen
    s_mov_b32 s44, 1056768
    buffer_load_dword v81, v12, s[16:19], s44 offen
    s_mov_b32 s44, 1064960
    buffer_load_dword v82, v12, s[16:19], s44 offen
    s_mov_b32 s44, 1073152
    buffer_load_dword v83, v12, s[16:19], s44 offen
    s_mov_b32 s44, 1081344
    buffer_load_dword v84, v12, s[16:19], s44 offen
    s_mov_b32 s44, 1089536
    buffer_load_dword v85, v12, s[16:19], s44 offen
    s_mov_b32 s44, 1097728
    buffer_load_dword v86, v12, s[16:19], s44 offen
    s_mov_b32 s44, 1105920
    buffer_load_dword v87, v12, s[16:19], s44 offen
    s_mov_b32 s44, 1179648
    buffer_load_dword v88, v12, s[16:19], s44 offen
    s_mov_b32 s44, 1187840
    buffer_load_dword v89, v12, s[16:19], s44 offen
    s_mov_b32 s44, 1196032
    buffer_load_dword v90, v12, s[16:19], s44 offen
    s_mov_b32 s44, 1204224
    buffer_load_dword v91, v12, s[16:19], s44 offen
    s_mov_b32 s44, 1212416
    buffer_load_dword v92, v12, s[16:19], s44 offen
    s_mov_b32 s44, 1220608
    buffer_load_dword v93, v12, s[16:19], s44 offen
    s_mov_b32 s44, 1228800
    buffer_load_dword v94, v12, s[16:19], s44 offen
    s_mov_b32 s44, 1236992
    buffer_load_dword v95, v12, s[16:19], s44 offen
    s_mov_b32 s44, 1310720
    buffer_load_dword v96, v12, s[16:19], s44 offen
    s_mov_b32 s44, 1318912
    buffer_load_dword v97, v12, s[16:19], s44 offen
    s_mov_b32 s44, 1327104
    buffer_load_dword v98, v12, s[16:19], s44 offen
    s_mov_b32 s44, 1335296
    buffer_load_dword v99, v12, s[16:19], s44 offen
    s_mov_b32 s44, 1343488
    buffer_load_dword v100, v12, s[16:19], s44 offen
    s_mov_b32 s44, 1351680
    buffer_load_dword v101, v12, s[16:19], s44 offen
    s_mov_b32 s44, 1359872
    buffer_load_dword v102, v12, s[16:19], s44 offen
    s_mov_b32 s44, 1368064
    buffer_load_dword v103, v12, s[16:19], s44 offen
    s_mov_b32 s44, 1441792
    buffer_load_dword v104, v12, s[16:19], s44 offen
    s_mov_b32 s44, 1449984
    buffer_load_dword v105, v12, s[16:19], s44 offen
    s_mov_b32 s44, 1458176
    buffer_load_dword v106, v12, s[16:19], s44 offen
    s_mov_b32 s44, 1466368
    buffer_load_dword v107, v12, s[16:19], s44 offen
    s_mov_b32 s44, 1474560
    buffer_load_dword v108, v12, s[16:19], s44 offen
    s_mov_b32 s44, 1482752
    buffer_load_dword v109, v12, s[16:19], s44 offen
    s_mov_b32 s44, 1490944
    buffer_load_dword v110, v12, s[16:19], s44 offen
    s_mov_b32 s44, 1499136
    buffer_load_dword v111, v12, s[16:19], s44 offen
    s_waitcnt vmcnt(62)
    v_perm_b32 v112, v49, v48, v14
    v_perm_b32 v116, v49, v48, v15
    s_waitcnt vmcnt(60)
    v_perm_b32 v113, v51, v50, v14
    v_perm_b32 v117, v51, v50, v15
    s_waitcnt vmcnt(58)
    v_perm_b32 v114, v53, v52, v14
    v_perm_b32 v118, v53, v52, v15
    s_waitcnt vmcnt(56)
    v_perm_b32 v115, v55, v54, v14
    v_perm_b32 v119, v55, v54, v15
    v_mov_b32_dpp v120, v116 quad_perm:[1,0,3,2] row_mask:0xf bank_mask:0xf
    v_mov_b32_dpp v121, v117 quad_perm:[1,0,3,2] row_mask:0xf bank_mask:0xf
    v_mov_b32_dpp v122, v118 quad_perm:[1,0,3,2] row_mask:0xf bank_mask:0xf
    v_mov_b32_dpp v123, v119 quad_perm:[1,0,3,2] row_mask:0xf bank_mask:0xf
    v_cndmask_b32 v116, v120, v112, vcc
    v_cndmask_b32 v112, v112, v120, vcc
    v_cndmask_b32 v117, v121, v113, vcc
    v_cndmask_b32 v113, v113, v121, vcc
    v_cndmask_b32 v118, v122, v114, vcc
    v_cndmask_b32 v114, v114, v122, vcc
    v_cndmask_b32 v119, v123, v115, vcc
    v_cndmask_b32 v115, v115, v123, vcc
    v_accvgpr_write_b32 a32, v112
    v_accvgpr_write_b32 a33, v113
    v_accvgpr_write_b32 a34, v114
    v_accvgpr_write_b32 a35, v115
    v_accvgpr_write_b32 a36, v116
    v_accvgpr_write_b32 a37, v117
    v_accvgpr_write_b32 a38, v118
    v_accvgpr_write_b32 a39, v119
    s_waitcnt vmcnt(54)
    v_perm_b32 v128, v57, v56, v14
    v_perm_b32 v132, v57, v56, v15
    s_waitcnt vmcnt(52)
    v_perm_b32 v129, v59, v58, v14
    v_perm_b32 v133, v59, v58, v15
    s_waitcnt vmcnt(50)
    v_perm_b32 v130, v61, v60, v14
    v_perm_b32 v134, v61, v60, v15
    s_waitcnt vmcnt(48)
    v_perm_b32 v131, v63, v62, v14
    v_perm_b32 v135, v63, v62, v15
    v_mov_b32_dpp v136, v132 quad_perm:[1,0,3,2] row_mask:0xf bank_mask:0xf
    v_mov_b32_dpp v137, v133 quad_perm:[1,0,3,2] row_mask:0xf bank_mask:0xf
    v_mov_b32_dpp v138, v134 quad_perm:[1,0,3,2] row_mask:0xf bank_mask:0xf
    v_mov_b32_dpp v139, v135 quad_perm:[1,0,3,2] row_mask:0xf bank_mask:0xf
    v_cndmask_b32 v132, v136, v128, vcc
    v_cndmask_b32 v128, v128, v136, vcc
    v_cndmask_b32 v133, v137, v129, vcc
    v_cndmask_b32 v129, v129, v137, vcc
    v_cndmask_b32 v134, v138, v130, vcc
    v_cndmask_b32 v130, v130, v138, vcc
    v_cndmask_b32 v135, v139, v131, vcc
    v_cndmask_b32 v131, v131, v139, vcc
    v_accvgpr_write_b32 a40, v128
    v_accvgpr_write_b32 a41, v129
    v_accvgpr_write_b32 a42, v130
    v_accvgpr_write_b32 a43, v131
    v_accvgpr_write_b32 a44, v132
    v_accvgpr_write_b32 a45, v133
    v_accvgpr_write_b32 a46, v134
    v_accvgpr_write_b32 a47, v135
    s_waitcnt vmcnt(46)
    v_perm_b32 v112, v65, v64, v14
    v_perm_b32 v116, v65, v64, v15
    s_waitcnt vmcnt(44)
    v_perm_b32 v113, v67, v66, v14
    v_perm_b32 v117, v67, v66, v15
    s_waitcnt vmcnt(42)
    v_perm_b32 v114, v69, v68, v14
    v_perm_b32 v118, v69, v68, v15
    s_waitcnt vmcnt(40)
    v_perm_b32 v115, v71, v70, v14
    v_perm_b32 v119, v71, v70, v15
    v_mov_b32_dpp v120, v116 quad_perm:[1,0,3,2] row_mask:0xf bank_mask:0xf
    v_mov_b32_dpp v121, v117 quad_perm:[1,0,3,2] row_mask:0xf bank_mask:0xf
    v_mov_b32_dpp v122, v118 quad_perm:[1,0,3,2] row_mask:0xf bank_mask:0xf
    v_mov_b32_dpp v123, v119 quad_perm:[1,0,3,2] row_mask:0xf bank_mask:0xf
    v_cndmask_b32 v116, v120, v112, vcc
    v_cndmask_b32 v112, v112, v120, vcc
    v_cndmask_b32 v117, v121, v113, vcc
    v_cndmask_b32 v113, v113, v121, vcc
    v_cndmask_b32 v118, v122, v114, vcc
    v_cndmask_b32 v114, v114, v122, vcc
    v_cndmask_b32 v119, v123, v115, vcc
    v_cndmask_b32 v115, v115, v123, vcc
    v_accvgpr_write_b32 a48, v112
    v_accvgpr_write_b32 a49, v113
    v_accvgpr_write_b32 a50, v114
    v_accvgpr_write_b32 a51, v115
    v_accvgpr_write_b32 a52, v116
    v_accvgpr_write_b32 a53, v117
    v_accvgpr_write_b32 a54, v118
    v_accvgpr_write_b32 a55, v119
    s_waitcnt vmcnt(38)
    v_perm_b32 v128, v73, v72, v14
    v_perm_b32 v132, v73, v72, v15
    s_waitcnt vmcnt(36)
    v_perm_b32 v129, v75, v74, v14
    v_perm_b32 v133, v75, v74, v15
    s_waitcnt vmcnt(34)
    v_perm_b32 v130, v77, v76, v14
    v_perm_b32 v134, v77, v76, v15
    s_waitcnt vmcnt(32)
    v_perm_b32 v131, v79, v78, v14
    v_perm_b32 v135, v79, v78, v15
    v_mov_b32_dpp v136, v132 quad_perm:[1,0,3,2] row_mask:0xf bank_mask:0xf
    v_mov_b32_dpp v137, v133 quad_perm:[1,0,3,2] row_mask:0xf bank_mask:0xf
    v_mov_b32_dpp v138, v134 quad_perm:[1,0,3,2] row_mask:0xf bank_mask:0xf
    v_mov_b32_dpp v139, v135 quad_perm:[1,0,3,2] row_mask:0xf bank_mask:0xf
    v_cndmask_b32 v132, v136, v128, vcc
    v_cndmask_b32 v128, v128, v136, vcc
    v_cndmask_b32 v133, v137, v129, vcc
    v_cndmask_b32 v129, v129, v137, vcc
    v_cndmask_b32 v134, v138, v130, vcc
    v_cndmask_b32 v130, v130, v138, vcc
    v_cndmask_b32 v135, v139, v131, vcc
    v_cndmask_b32 v131, v131, v139, vcc
    v_accvgpr_write_b32 a56, v128
    v_accvgpr_write_b32 a57, v129
    v_accvgpr_write_b32 a58, v130
    v_accvgpr_write_b32 a59, v131
    v_accvgpr_write_b32 a60, v132
    v_accvgpr_write_b32 a61, v133
    v_accvgpr_write_b32 a62, v134
    v_accvgpr_write_b32 a63, v135
    s_mov_b32 s44, 1572864
    buffer_load_dword v16, v12, s[16:19], s44 offen
    s_mov_b32 s44, 1581056
    buffer_load_dword v17, v12, s[16:19], s44 offen
    s_mov_b32 s44, 1589248
    buffer_load_dword v18, v12, s[16:19], s44 offen
    s_mov_b32 s44, 1597440
    buffer_load_dword v19, v12, s[16:19], s44 offen
    s_mov_b32 s44, 1605632
    buffer_load_dword v20, v12, s[16:19], s44 offen
    s_mov_b32 s44, 1613824
    buffer_load_dword v21, v12, s[16:19], s44 offen
    s_mov_b32 s44, 1622016
    buffer_load_dword v22, v12, s[16:19], s44 offen
    s_mov_b32 s44, 1630208
    buffer_load_dword v23, v12, s[16:19], s44 offen
    s_mov_b32 s44, 1703936
    buffer_load_dword v24, v12, s[16:19], s44 offen
    s_mov_b32 s44, 1712128
    buffer_load_dword v25, v12, s[16:19], s44 offen
    s_mov_b32 s44, 1720320
    buffer_load_dword v26, v12, s[16:19], s44 offen
    s_mov_b32 s44, 1728512
    buffer_load_dword v27, v12, s[16:19], s44 offen
    s_mov_b32 s44, 1736704
    buffer_load_dword v28, v12, s[16:19], s44 offen
    s_mov_b32 s44, 1744896
    buffer_load_dword v29, v12, s[16:19], s44 offen
    s_mov_b32 s44, 1753088
    buffer_load_dword v30, v12, s[16:19], s44 offen
    s_mov_b32 s44, 1761280
    buffer_load_dword v31, v12, s[16:19], s44 offen
    s_mov_b32 s44, 1835008
    buffer_load_dword v32, v12, s[16:19], s44 offen
    s_mov_b32 s44, 1843200
    buffer_load_dword v33, v12, s[16:19], s44 offen
    s_mov_b32 s44, 1851392
    buffer_load_dword v34, v12, s[16:19], s44 offen
    s_mov_b32 s44, 1859584
    buffer_load_dword v35, v12, s[16:19], s44 offen
    s_mov_b32 s44, 1867776
    buffer_load_dword v36, v12, s[16:19], s44 offen
    s_mov_b32 s44, 1875968
    buffer_load_dword v37, v12, s[16:19], s44 offen
    s_mov_b32 s44, 1884160
    buffer_load_dword v38, v12, s[16:19], s44 offen
    s_mov_b32 s44, 1892352
    buffer_load_dword v39, v12, s[16:19], s44 offen
    s_mov_b32 s44, 1966080
    buffer_load_dword v40, v12, s[16:19], s44 offen
    s_mov_b32 s44, 1974272
    buffer_load_dword v41, v12, s[16:19], s44 offen
    s_mov_b32 s44, 1982464
    buffer_load_dword v42, v12, s[16:19], s44 offen
    s_mov_b32 s44, 1990656
    buffer_load_dword v43, v12, s[16:19], s44 offen
    s_mov_b32 s44, 1998848
    buffer_load_dword v44, v12, s[16:19], s44 offen
    s_mov_b32 s44, 2007040
    buffer_load_dword v45, v12, s[16:19], s44 offen
    s_mov_b32 s44, 2015232
    buffer_load_dword v46, v12, s[16:19], s44 offen
    s_mov_b32 s44, 2023424
    buffer_load_dword v47, v12, s[16:19], s44 offen
    s_waitcnt vmcnt(62)
    v_perm_b32 v112, v81, v80, v14
    v_perm_b32 v116, v81, v80, v15
    s_waitcnt vmcnt(60)
    v_perm_b32 v113, v83, v82, v14
    v_perm_b32 v117, v83, v82, v15
    s_waitcnt vmcnt(58)
    v_perm_b32 v114, v85, v84, v14
    v_perm_b32 v118, v85, v84, v15
    s_waitcnt vmcnt(56)
    v_perm_b32 v115, v87, v86, v14
    v_perm_b32 v119, v87, v86, v15
    v_mov_b32_dpp v120, v116 quad_perm:[1,0,3,2] row_mask:0xf bank_mask:0xf
    v_mov_b32_dpp v121, v117 quad_perm:[1,0,3,2] row_mask:0xf bank_mask:0xf
    v_mov_b32_dpp v122, v118 quad_perm:[1,0,3,2] row_mask:0xf bank_mask:0xf
    v_mov_b32_dpp v123, v119 quad_perm:[1,0,3,2] row_mask:0xf bank_mask:0xf
    v_cndmask_b32 v116, v120, v112, vcc
    v_cndmask_b32 v112, v112, v120, vcc
    v_cndmask_b32 v117, v121, v113, vcc
    v_cndmask_b32 v113, v113, v121, vcc
    v_cndmask_b32 v118, v122, v114, vcc
    v_cndmask_b32 v114, v114, v122, vcc
    v_cndmask_b32 v119, v123, v115, vcc
    v_cndmask_b32 v115, v115, v123, vcc
    v_accvgpr_write_b32 a64, v112
    v_accvgpr_write_b32 a65, v113
    v_accvgpr_write_b32 a66, v114
    v_accvgpr_write_b32 a67, v115
    v_accvgpr_write_b32 a68, v116
    v_accvgpr_write_b32 a69, v117
    v_accvgpr_write_b32 a70, v118
    v_accvgpr_write_b32 a71, v119
    s_waitcnt vmcnt(54)
    v_perm_b32 v128, v89, v88, v14
    v_perm_b32 v132, v89, v88, v15
    s_waitcnt vmcnt(52)
    v_perm_b32 v129, v91, v90, v14
    v_perm_b32 v133, v91, v90, v15
    s_waitcnt vmcnt(50)
    v_perm_b32 v130, v93, v92, v14
    v_perm_b32 v134, v93, v92, v15
    s_waitcnt vmcnt(48)
    v_perm_b32 v131, v95, v94, v14
    v_perm_b32 v135, v95, v94, v15
    v_mov_b32_dpp v136, v132 quad_perm:[1,0,3,2] row_mask:0xf bank_mask:0xf
    v_mov_b32_dpp v137, v133 quad_perm:[1,0,3,2] row_mask:0xf bank_mask:0xf
    v_mov_b32_dpp v138, v134 quad_perm:[1,0,3,2] row_mask:0xf bank_mask:0xf
    v_mov_b32_dpp v139, v135 quad_perm:[1,0,3,2] row_mask:0xf bank_mask:0xf
    v_cndmask_b32 v132, v136, v128, vcc
    v_cndmask_b32 v128, v128, v136, vcc
    v_cndmask_b32 v133, v137, v129, vcc
    v_cndmask_b32 v129, v129, v137, vcc
    v_cndmask_b32 v134, v138, v130, vcc
    v_cndmask_b32 v130, v130, v138, vcc
    v_cndmask_b32 v135, v139, v131, vcc
    v_cndmask_b32 v131, v131, v139, vcc
    v_accvgpr_write_b32 a72, v128
    v_accvgpr_write_b32 a73, v129
    v_accvgpr_write_b32 a74, v130
    v_accvgpr_write_b32 a75, v131
    v_accvgpr_write_b32 a76, v132
    v_accvgpr_write_b32 a77, v133
    v_accvgpr_write_b32 a78, v134
    v_accvgpr_write_b32 a79, v135
    s_waitcnt vmcnt(46)
    v_perm_b32 v112, v97, v96, v14
    v_perm_b32 v116, v97, v96, v15
    s_waitcnt vmcnt(44)
    v_perm_b32 v113, v99, v98, v14
    v_perm_b32 v117, v99, v98, v15
    s_waitcnt vmcnt(42)
    v_perm_b32 v114, v101, v100, v14
    v_perm_b32 v118, v101, v100, v15
    s_waitcnt vmcnt(40)
    v_perm_b32 v115, v103, v102, v14
    v_perm_b32 v119, v103, v102, v15
    v_mov_b32_dpp v120, v116 quad_perm:[1,0,3,2] row_mask:0xf bank_mask:0xf
    v_mov_b32_dpp v121, v117 quad_perm:[1,0,3,2] row_mask:0xf bank_mask:0xf
    v_mov_b32_dpp v122, v118 quad_perm:[1,0,3,2] row_mask:0xf bank_mask:0xf
    v_mov_b32_dpp v123, v119 quad_perm:[1,0,3,2] row_mask:0xf bank_mask:0xf
    v_cndmask_b32 v116, v120, v112, vcc
    v_cndmask_b32 v112, v112, v120, vcc
    v_cndmask_b32 v117, v121, v113, vcc
    v_cndmask_b32 v113, v113, v121, vcc
    v_cndmask_b32 v118, v122, v114, vcc
    v_cndmask_b32 v114, v114, v122, vcc
    v_cndmask_b32 v119, v123, v115, vcc
    v_cndmask_b32 v115, v115, v123, vcc
    v_accvgpr_write_b32 a80, v112
    v_accvgpr_write_b32 a81, v113
    v_accvgpr_write_b32 a82, v114
    v_accvgpr_write_b32 a83, v115
    v_accvgpr_write_b32 a84, v116
    v_accvgpr_write_b32 a85, v117
    v_accvgpr_write_b32 a86, v118
    v_accvgpr_write_b32 a87, v119
    s_waitcnt vmcnt(38)
    v_perm_b32 v128, v105, v104, v14
    v_perm_b32 v132, v105, v104, v15
    s_waitcnt vmcnt(36)
    v_perm_b32 v129, v107, v106, v14
    v_perm_b32 v133, v107, v106, v15
    s_waitcnt vmcnt(34)
    v_perm_b32 v130, v109, v108, v14
    v_perm_b32 v134, v109, v108, v15
    s_waitcnt vmcnt(32)
    v_perm_b32 v131, v111, v110, v14
    v_perm_b32 v135, v111, v110, v15
    v_mov_b32_dpp v136, v132 quad_perm:[1,0,3,2] row_mask:0xf bank_mask:0xf
    v_mov_b32_dpp v137, v133 quad_perm:[1,0,3,2] row_mask:0xf bank_mask:0xf
    v_mov_b32_dpp v138, v134 quad_perm:[1,0,3,2] row_mask:0xf bank_mask:0xf
    v_mov_b32_dpp v139, v135 quad_perm:[1,0,3,2] row_mask:0xf bank_mask:0xf
    v_cndmask_b32 v132, v136, v128, vcc
    v_cndmask_b32 v128, v128, v136, vcc
    v_cndmask_b32 v133, v137, v129, vcc
    v_cndmask_b32 v129, v129, v137, vcc
    v_cndmask_b32 v134, v138, v130, vcc
    v_cndmask_b32 v130, v130, v138, vcc
    v_cndmask_b32 v135, v139, v131, vcc
    v_cndmask_b32 v131, v131, v139, vcc
    v_accvgpr_write_b32 a88, v128
    v_accvgpr_write_b32 a89, v129
    v_accvgpr_write_b32 a90, v130
    v_accvgpr_write_b32 a91, v131
    v_accvgpr_write_b32 a92, v132
    v_accvgpr_write_b32 a93, v133
    v_accvgpr_write_b32 a94, v134
    v_accvgpr_write_b32 a95, v135
    s_mov_b32 s44, 2097152
    buffer_load_dword v48, v12, s[16:19], s44 offen
    s_mov_b32 s44, 2105344
    buffer_load_dword v49, v12, s[16:19], s44 offen
    s_mov_b32 s44, 2113536
    buffer_load_dword v50, v12, s[16:19], s44 offen
    s_mov_b32 s44, 2121728
    buffer_load_dword v51, v12, s[16:19], s44 offen
    s_mov_b32 s44, 2129920
    buffer_load_dword v52, v12, s[16:19], s44 offen
    s_mov_b32 s44, 2138112
    buffer_load_dword v53, v12, s[16:19], s44 offen
    s_mov_b32 s44, 2146304
    buffer_load_dword v54, v12, s[16:19], s44 offen
    s_mov_b32 s44, 2154496
    buffer_load_dword v55, v12, s[16:19], s44 offen
    s_mov_b32 s44, 2228224
    buffer_load_dword v56, v12, s[16:19], s44 offen
    s_mov_b32 s44, 2236416
    buffer_load_dword v57, v12, s[16:19], s44 offen
    s_mov_b32 s44, 2244608
    buffer_load_dword v58, v12, s[16:19], s44 offen
    s_mov_b32 s44, 2252800
    buffer_load_dword v59, v12, s[16:19], s44 offen
    s_mov_b32 s44, 2260992
    buffer_load_dword v60, v12, s[16:19], s44 offen
    s_mov_b32 s44, 2269184
    buffer_load_dword v61, v12, s[16:19], s44 offen
    s_mov_b32 s44, 2277376
    buffer_load_dword v62, v12, s[16:19], s44 offen
    s_mov_b32 s44, 2285568
    buffer_load_dword v63, v12, s[16:19], s44 offen
    s_mov_b32 s44, 2359296
    buffer_load_dword v64, v12, s[16:19], s44 offen
    s_mov_b32 s44, 2367488
    buffer_load_dword v65, v12, s[16:19], s44 offen
    s_mov_b32 s44, 2375680
    buffer_load_dword v66, v12, s[16:19], s44 offen
    s_mov_b32 s44, 2383872
    buffer_load_dword v67, v12, s[16:19], s44 offen
    s_mov_b32 s44, 2392064
    buffer_load_dword v68, v12, s[16:19], s44 offen
    s_mov_b32 s44, 2400256
    buffer_load_dword v69, v12, s[16:19], s44 offen
    s_mov_b32 s44, 2408448
    buffer_load_dword v70, v12, s[16:19], s44 offen
    s_mov_b32 s44, 2416640
    buffer_load_dword v71, v12, s[16:19], s44 offen
    s_mov_b32 s44, 2490368
    buffer_load_dword v72, v12, s[16:19], s44 offen
    s_mov_b32 s44, 2498560
    buffer_load_dword v73, v12, s[16:19], s44 offen
    s_mov_b32 s44, 2506752
    buffer_load_dword v74, v12, s[16:19], s44 offen
    s_mov_b32 s44, 2514944
    buffer_load_dword v75, v12, s[16:19], s44 offen
    s_mov_b32 s44, 2523136
    buffer_load_dword v76, v12, s[16:19], s44 offen
    s_mov_b32 s44, 2531328
    buffer_load_dword v77, v12, s[16:19], s44 offen
    s_mov_b32 s44, 2539520
    buffer_load_dword v78, v12, s[16:19], s44 offen
    s_mov_b32 s44, 2547712
    buffer_load_dword v79, v12, s[16:19], s44 offen
    s_waitcnt vmcnt(62)
    v_perm_b32 v112, v17, v16, v14
    v_perm_b32 v116, v17, v16, v15
    s_waitcnt vmcnt(60)
    v_perm_b32 v113, v19, v18, v14
    v_perm_b32 v117, v19, v18, v15
    s_waitcnt vmcnt(58)
    v_perm_b32 v114, v21, v20, v14
    v_perm_b32 v118, v21, v20, v15
    s_waitcnt vmcnt(56)
    v_perm_b32 v115, v23, v22, v14
    v_perm_b32 v119, v23, v22, v15
    v_mov_b32_dpp v120, v116 quad_perm:[1,0,3,2] row_mask:0xf bank_mask:0xf
    v_mov_b32_dpp v121, v117 quad_perm:[1,0,3,2] row_mask:0xf bank_mask:0xf
    v_mov_b32_dpp v122, v118 quad_perm:[1,0,3,2] row_mask:0xf bank_mask:0xf
    v_mov_b32_dpp v123, v119 quad_perm:[1,0,3,2] row_mask:0xf bank_mask:0xf
    v_cndmask_b32 v116, v120, v112, vcc
    v_cndmask_b32 v112, v112, v120, vcc
    v_cndmask_b32 v117, v121, v113, vcc
    v_cndmask_b32 v113, v113, v121, vcc
    v_cndmask_b32 v118, v122, v114, vcc
    v_cndmask_b32 v114, v114, v122, vcc
    v_cndmask_b32 v119, v123, v115, vcc
    v_cndmask_b32 v115, v115, v123, vcc
    v_accvgpr_write_b32 a96, v112
    v_accvgpr_write_b32 a97, v113
    v_accvgpr_write_b32 a98, v114
    v_accvgpr_write_b32 a99, v115
    v_accvgpr_write_b32 a100, v116
    v_accvgpr_write_b32 a101, v117
    v_accvgpr_write_b32 a102, v118
    v_accvgpr_write_b32 a103, v119
    s_waitcnt vmcnt(54)
    v_perm_b32 v128, v25, v24, v14
    v_perm_b32 v132, v25, v24, v15
    s_waitcnt vmcnt(52)
    v_perm_b32 v129, v27, v26, v14
    v_perm_b32 v133, v27, v26, v15
    s_waitcnt vmcnt(50)
    v_perm_b32 v130, v29, v28, v14
    v_perm_b32 v134, v29, v28, v15
    s_waitcnt vmcnt(48)
    v_perm_b32 v131, v31, v30, v14
    v_perm_b32 v135, v31, v30, v15
    v_mov_b32_dpp v136, v132 quad_perm:[1,0,3,2] row_mask:0xf bank_mask:0xf
    v_mov_b32_dpp v137, v133 quad_perm:[1,0,3,2] row_mask:0xf bank_mask:0xf
    v_mov_b32_dpp v138, v134 quad_perm:[1,0,3,2] row_mask:0xf bank_mask:0xf
    v_mov_b32_dpp v139, v135 quad_perm:[1,0,3,2] row_mask:0xf bank_mask:0xf
    v_cndmask_b32 v132, v136, v128, vcc
    v_cndmask_b32 v128, v128, v136, vcc
    v_cndmask_b32 v133, v137, v129, vcc
    v_cndmask_b32 v129, v129, v137, vcc
    v_cndmask_b32 v134, v138, v130, vcc
    v_cndmask_b32 v130, v130, v138, vcc
    v_cndmask_b32 v135, v139, v131, vcc
    v_cndmask_b32 v131, v131, v139, vcc
    v_accvgpr_write_b32 a104, v128
    v_accvgpr_write_b32 a105, v129
    v_accvgpr_write_b32 a106, v130
    v_accvgpr_write_b32 a107, v131
    v_accvgpr_write_b32 a108, v132
    v_accvgpr_write_b32 a109, v133
    v_accvgpr_write_b32 a110, v134
    v_accvgpr_write_b32 a111, v135
    s_waitcnt vmcnt(46)
    v_perm_b32 v112, v33, v32, v14
    v_perm_b32 v116, v33, v32, v15
    s_waitcnt vmcnt(44)
    v_perm_b32 v113, v35, v34, v14
    v_perm_b32 v117, v35, v34, v15
    s_waitcnt vmcnt(42)
    v_perm_b32 v114, v37, v36, v14
    v_perm_b32 v118, v37, v36, v15
    s_waitcnt vmcnt(40)
    v_perm_b32 v115, v39, v38, v14
    v_perm_b32 v119, v39, v38, v15
    v_mov_b32_dpp v120, v116 quad_perm:[1,0,3,2] row_mask:0xf bank_mask:0xf
    v_mov_b32_dpp v121, v117 quad_perm:[1,0,3,2] row_mask:0xf bank_mask:0xf
    v_mov_b32_dpp v122, v118 quad_perm:[1,0,3,2] row_mask:0xf bank_mask:0xf
    v_mov_b32_dpp v123, v119 quad_perm:[1,0,3,2] row_mask:0xf bank_mask:0xf
    v_cndmask_b32 v116, v120, v112, vcc
    v_cndmask_b32 v112, v112, v120, vcc
    v_cndmask_b32 v117, v121, v113, vcc
    v_cndmask_b32 v113, v113, v121, vcc
    v_cndmask_b32 v118, v122, v114, vcc
    v_cndmask_b32 v114, v114, v122, vcc
    v_cndmask_b32 v119, v123, v115, vcc
    v_cndmask_b32 v115, v115, v123, vcc
    v_accvgpr_write_b32 a112, v112
    v_accvgpr_write_b32 a113, v113
    v_accvgpr_write_b32 a114, v114
    v_accvgpr_write_b32 a115, v115
    v_accvgpr_write_b32 a116, v116
    v_accvgpr_write_b32 a117, v117
    v_accvgpr_write_b32 a118, v118
    v_accvgpr_write_b32 a119, v119
    s_waitcnt vmcnt(38)
    v_perm_b32 v128, v41, v40, v14
    v_perm_b32 v132, v41, v40, v15
    s_waitcnt vmcnt(36)
    v_perm_b32 v129, v43, v42, v14
    v_perm_b32 v133, v43, v42, v15
    s_waitcnt vmcnt(34)
    v_perm_b32 v130, v45, v44, v14
    v_perm_b32 v134, v45, v44, v15
    s_waitcnt vmcnt(32)
    v_perm_b32 v131, v47, v46, v14
    v_perm_b32 v135, v47, v46, v15
    v_mov_b32_dpp v136, v132 quad_perm:[1,0,3,2] row_mask:0xf bank_mask:0xf
    v_mov_b32_dpp v137, v133 quad_perm:[1,0,3,2] row_mask:0xf bank_mask:0xf
    v_mov_b32_dpp v138, v134 quad_perm:[1,0,3,2] row_mask:0xf bank_mask:0xf
    v_mov_b32_dpp v139, v135 quad_perm:[1,0,3,2] row_mask:0xf bank_mask:0xf
    v_cndmask_b32 v132, v136, v128, vcc
    v_cndmask_b32 v128, v128, v136, vcc
    v_cndmask_b32 v133, v137, v129, vcc
    v_cndmask_b32 v129, v129, v137, vcc
    v_cndmask_b32 v134, v138, v130, vcc
    v_cndmask_b32 v130, v130, v138, vcc
    v_cndmask_b32 v135, v139, v131, vcc
    v_cndmask_b32 v131, v131, v139, vcc
    v_accvgpr_write_b32 a120, v128
    v_accvgpr_write_b32 a121, v129
    v_accvgpr_write_b32 a122, v130
    v_accvgpr_write_b32 a123, v131
    v_accvgpr_write_b32 a124, v132
    v_accvgpr_write_b32 a125, v133
    v_accvgpr_write_b32 a126, v134
    v_accvgpr_write_b32 a127, v135
    s_mov_b32 s44, 2621440
    buffer_load_dword v80, v12, s[16:19], s44 offen
    s_mov_b32 s44, 2629632
    buffer_load_dword v81, v12, s[16:19], s44 offen
    s_mov_b32 s44, 2637824
    buffer_load_dword v82, v12, s[16:19], s44 offen
    s_mov_b32 s44, 2646016
    buffer_load_dword v83, v12, s[16:19], s44 offen
    s_mov_b32 s44, 2654208
    buffer_load_dword v84, v12, s[16:19], s44 offen
    s_mov_b32 s44, 2662400
    buffer_load_dword v85, v12, s[16:19], s44 offen
    s_mov_b32 s44, 2670592
    buffer_load_dword v86, v12, s[16:19], s44 offen
    s_mov_b32 s44, 2678784
    buffer_load_dword v87, v12, s[16:19], s44 offen
    s_mov_b32 s44, 2752512
    buffer_load_dword v88, v12, s[16:19], s44 offen
    s_mov_b32 s44, 2760704
    buffer_load_dword v89, v12, s[16:19], s44 offen
    s_mov_b32 s44, 2768896
    buffer_load_dword v90, v12, s[16:19], s44 offen
    s_mov_b32 s44, 2777088
    buffer_load_dword v91, v12, s[16:19], s44 offen
    s_mov_b32 s44, 2785280
    buffer_load_dword v92, v12, s[16:19], s44 offen
    s_mov_b32 s44, 2793472
    buffer_load_dword v93, v12, s[16:19], s44 offen
    s_mov_b32 s44, 2801664
    buffer_load_dword v94, v12, s[16:19], s44 offen
    s_mov_b32 s44, 2809856
    buffer_load_dword v95, v12, s[16:19], s44 offen
    s_mov_b32 s44, 2883584
    buffer_load_dword v96, v12, s[16:19], s44 offen
    s_mov_b32 s44, 2891776
    buffer_load_dword v97, v12, s[16:19], s44 offen
    s_mov_b32 s44, 2899968
    buffer_load_dword v98, v12, s[16:19], s44 offen
    s_mov_b32 s44, 2908160
    buffer_load_dword v99, v12, s[16:19], s44 offen
    s_mov_b32 s44, 2916352
    buffer_load_dword v100, v12, s[16:19], s44 offen
    s_mov_b32 s44, 2924544
    buffer_load_dword v101, v12, s[16:19], s44 offen
    s_mov_b32 s44, 2932736
    buffer_load_dword v102, v12, s[16:19], s44 offen
    s_mov_b32 s44, 2940928
    buffer_load_dword v103, v12, s[16:19], s44 offen
    s_mov_b32 s44, 3014656
    buffer_load_dword v104, v12, s[16:19], s44 offen
    s_mov_b32 s44, 3022848
    buffer_load_dword v105, v12, s[16:19], s44 offen
    s_mov_b32 s44, 3031040
    buffer_load_dword v106, v12, s[16:19], s44 offen
    s_mov_b32 s44, 3039232
    buffer_load_dword v107, v12, s[16:19], s44 offen
    s_mov_b32 s44, 3047424
    buffer_load_dword v108, v12, s[16:19], s44 offen
    s_mov_b32 s44, 3055616
    buffer_load_dword v109, v12, s[16:19], s44 offen
    s_mov_b32 s44, 3063808
    buffer_load_dword v110, v12, s[16:19], s44 offen
    s_mov_b32 s44, 3072000
    buffer_load_dword v111, v12, s[16:19], s44 offen
    s_waitcnt vmcnt(62)
    v_perm_b32 v112, v49, v48, v14
    v_perm_b32 v116, v49, v48, v15
    s_waitcnt vmcnt(60)
    v_perm_b32 v113, v51, v50, v14
    v_perm_b32 v117, v51, v50, v15
    s_waitcnt vmcnt(58)
    v_perm_b32 v114, v53, v52, v14
    v_perm_b32 v118, v53, v52, v15
    s_waitcnt vmcnt(56)
    v_perm_b32 v115, v55, v54, v14
    v_perm_b32 v119, v55, v54, v15
    v_mov_b32_dpp v120, v116 quad_perm:[1,0,3,2] row_mask:0xf bank_mask:0xf
    v_mov_b32_dpp v121, v117 quad_perm:[1,0,3,2] row_mask:0xf bank_mask:0xf
    v_mov_b32_dpp v122, v118 quad_perm:[1,0,3,2] row_mask:0xf bank_mask:0xf
    v_mov_b32_dpp v123, v119 quad_perm:[1,0,3,2] row_mask:0xf bank_mask:0xf
    v_cndmask_b32 v116, v120, v112, vcc
    v_cndmask_b32 v112, v112, v120, vcc
    v_cndmask_b32 v117, v121, v113, vcc
    v_cndmask_b32 v113, v113, v121, vcc
    v_cndmask_b32 v118, v122, v114, vcc
    v_cndmask_b32 v114, v114, v122, vcc
    v_cndmask_b32 v119, v123, v115, vcc
    v_cndmask_b32 v115, v115, v123, vcc
    v_accvgpr_write_b32 a128, v112
    v_accvgpr_write_b32 a129, v113
    v_accvgpr_write_b32 a130, v114
    v_accvgpr_write_b32 a131, v115
    v_accvgpr_write_b32 a132, v116
    v_accvgpr_write_b32 a133, v117
    v_accvgpr_write_b32 a134, v118
    v_accvgpr_write_b32 a135, v119
    s_waitcnt vmcnt(54)
    v_perm_b32 v128, v57, v56, v14
    v_perm_b32 v132, v57, v56, v15
    s_waitcnt vmcnt(52)
    v_perm_b32 v129, v59, v58, v14
    v_perm_b32 v133, v59, v58, v15
    s_waitcnt vmcnt(50)
    v_perm_b32 v130, v61, v60, v14
    v_perm_b32 v134, v61, v60, v15
    s_waitcnt vmcnt(48)
    v_perm_b32 v131, v63, v62, v14
    v_perm_b32 v135, v63, v62, v15
    v_mov_b32_dpp v136, v132 quad_perm:[1,0,3,2] row_mask:0xf bank_mask:0xf
    v_mov_b32_dpp v137, v133 quad_perm:[1,0,3,2] row_mask:0xf bank_mask:0xf
    v_mov_b32_dpp v138, v134 quad_perm:[1,0,3,2] row_mask:0xf bank_mask:0xf
    v_mov_b32_dpp v139, v135 quad_perm:[1,0,3,2] row_mask:0xf bank_mask:0xf
    v_cndmask_b32 v132, v136, v128, vcc
    v_cndmask_b32 v128, v128, v136, vcc
    v_cndmask_b32 v133, v137, v129, vcc
    v_cndmask_b32 v129, v129, v137, vcc
    v_cndmask_b32 v134, v138, v130, vcc
    v_cndmask_b32 v130, v130, v138, vcc
    v_cndmask_b32 v135, v139, v131, vcc
    v_cndmask_b32 v131, v131, v139, vcc
    v_accvgpr_write_b32 a136, v128
    v_accvgpr_write_b32 a137, v129
    v_accvgpr_write_b32 a138, v130
    v_accvgpr_write_b32 a139, v131
    v_accvgpr_write_b32 a140, v132
    v_accvgpr_write_b32 a141, v133
    v_accvgpr_write_b32 a142, v134
    v_accvgpr_write_b32 a143, v135
    s_waitcnt vmcnt(46)
    v_perm_b32 v112, v65, v64, v14
    v_perm_b32 v116, v65, v64, v15
    s_waitcnt vmcnt(44)
    v_perm_b32 v113, v67, v66, v14
    v_perm_b32 v117, v67, v66, v15
    s_waitcnt vmcnt(42)
    v_perm_b32 v114, v69, v68, v14
    v_perm_b32 v118, v69, v68, v15
    s_waitcnt vmcnt(40)
    v_perm_b32 v115, v71, v70, v14
    v_perm_b32 v119, v71, v70, v15
    v_mov_b32_dpp v120, v116 quad_perm:[1,0,3,2] row_mask:0xf bank_mask:0xf
    v_mov_b32_dpp v121, v117 quad_perm:[1,0,3,2] row_mask:0xf bank_mask:0xf
    v_mov_b32_dpp v122, v118 quad_perm:[1,0,3,2] row_mask:0xf bank_mask:0xf
    v_mov_b32_dpp v123, v119 quad_perm:[1,0,3,2] row_mask:0xf bank_mask:0xf
    v_cndmask_b32 v116, v120, v112, vcc
    v_cndmask_b32 v112, v112, v120, vcc
    v_cndmask_b32 v117, v121, v113, vcc
    v_cndmask_b32 v113, v113, v121, vcc
    v_cndmask_b32 v118, v122, v114, vcc
    v_cndmask_b32 v114, v114, v122, vcc
    v_cndmask_b32 v119, v123, v115, vcc
    v_cndmask_b32 v115, v115, v123, vcc
    v_accvgpr_write_b32 a144, v112
    v_accvgpr_write_b32 a145, v113
    v_accvgpr_write_b32 a146, v114
    v_accvgpr_write_b32 a147, v115
    v_accvgpr_write_b32 a148, v116
    v_accvgpr_write_b32 a149, v117
    v_accvgpr_write_b32 a150, v118
    v_accvgpr_write_b32 a151, v119
    s_waitcnt vmcnt(38)
    v_perm_b32 v128, v73, v72, v14
    v_perm_b32 v132, v73, v72, v15
    s_waitcnt vmcnt(36)
    v_perm_b32 v129, v75, v74, v14
    v_perm_b32 v133, v75, v74, v15
    s_waitcnt vmcnt(34)
    v_perm_b32 v130, v77, v76, v14
    v_perm_b32 v134, v77, v76, v15
    s_waitcnt vmcnt(32)
    v_perm_b32 v131, v79, v78, v14
    v_perm_b32 v135, v79, v78, v15
    v_mov_b32_dpp v136, v132 quad_perm:[1,0,3,2] row_mask:0xf bank_mask:0xf
    v_mov_b32_dpp v137, v133 quad_perm:[1,0,3,2] row_mask:0xf bank_mask:0xf
    v_mov_b32_dpp v138, v134 quad_perm:[1,0,3,2] row_mask:0xf bank_mask:0xf
    v_mov_b32_dpp v139, v135 quad_perm:[1,0,3,2] row_mask:0xf bank_mask:0xf
    v_cndmask_b32 v132, v136, v128, vcc
    v_cndmask_b32 v128, v128, v136, vcc
    v_cndmask_b32 v133, v137, v129, vcc
    v_cndmask_b32 v129, v129, v137, vcc
    v_cndmask_b32 v134, v138, v130, vcc
    v_cndmask_b32 v130, v130, v138, vcc
    v_cndmask_b32 v135, v139, v131, vcc
    v_cndmask_b32 v131, v131, v139, vcc
    v_accvgpr_write_b32 a152, v128
    v_accvgpr_write_b32 a153, v129
    v_accvgpr_write_b32 a154, v130
    v_accvgpr_write_b32 a155, v131
    v_accvgpr_write_b32 a156, v132
    v_accvgpr_write_b32 a157, v133
    v_accvgpr_write_b32 a158, v134
    v_accvgpr_write_b32 a159, v135
    s_mov_b32 s44, 3145728
    buffer_load_dword v16, v12, s[16:19], s44 offen
    s_mov_b32 s44, 3153920
    buffer_load_dword v17, v12, s[16:19], s44 offen
    s_mov_b32 s44, 3162112
    buffer_load_dword v18, v12, s[16:19], s44 offen
    s_mov_b32 s44, 3170304
    buffer_load_dword v19, v12, s[16:19], s44 offen
    s_mov_b32 s44, 3178496
    buffer_load_dword v20, v12, s[16:19], s44 offen
    s_mov_b32 s44, 3186688
    buffer_load_dword v21, v12, s[16:19], s44 offen
    s_mov_b32 s44, 3194880
    buffer_load_dword v22, v12, s[16:19], s44 offen
    s_mov_b32 s44, 3203072
    buffer_load_dword v23, v12, s[16:19], s44 offen
    s_mov_b32 s44, 3276800
    buffer_load_dword v24, v12, s[16:19], s44 offen
    s_mov_b32 s44, 3284992
    buffer_load_dword v25, v12, s[16:19], s44 offen
    s_mov_b32 s44, 3293184
    buffer_load_dword v26, v12, s[16:19], s44 offen
    s_mov_b32 s44, 3301376
    buffer_load_dword v27, v12, s[16:19], s44 offen
    s_mov_b32 s44, 3309568
    buffer_load_dword v28, v12, s[16:19], s44 offen
    s_mov_b32 s44, 3317760
    buffer_load_dword v29, v12, s[16:19], s44 offen
    s_mov_b32 s44, 3325952
    buffer_load_dword v30, v12, s[16:19], s44 offen
    s_mov_b32 s44, 3334144
    buffer_load_dword v31, v12, s[16:19], s44 offen
    s_mov_b32 s44, 3407872
    buffer_load_dword v32, v12, s[16:19], s44 offen
    s_mov_b32 s44, 3416064
    buffer_load_dword v33, v12, s[16:19], s44 offen
    s_mov_b32 s44, 3424256
    buffer_load_dword v34, v12, s[16:19], s44 offen
    s_mov_b32 s44, 3432448
    buffer_load_dword v35, v12, s[16:19], s44 offen
    s_mov_b32 s44, 3440640
    buffer_load_dword v36, v12, s[16:19], s44 offen
    s_mov_b32 s44, 3448832
    buffer_load_dword v37, v12, s[16:19], s44 offen
    s_mov_b32 s44, 3457024
    buffer_load_dword v38, v12, s[16:19], s44 offen
    s_mov_b32 s44, 3465216
    buffer_load_dword v39, v12, s[16:19], s44 offen
    s_mov_b32 s44, 3538944
    buffer_load_dword v40, v12, s[16:19], s44 offen
    s_mov_b32 s44, 3547136
    buffer_load_dword v41, v12, s[16:19], s44 offen
    s_mov_b32 s44, 3555328
    buffer_load_dword v42, v12, s[16:19], s44 offen
    s_mov_b32 s44, 3563520
    buffer_load_dword v43, v12, s[16:19], s44 offen
    s_mov_b32 s44, 3571712
    buffer_load_dword v44, v12, s[16:19], s44 offen
    s_mov_b32 s44, 3579904
    buffer_load_dword v45, v12, s[16:19], s44 offen
    s_mov_b32 s44, 3588096
    buffer_load_dword v46, v12, s[16:19], s44 offen
    s_mov_b32 s44, 3596288
    buffer_load_dword v47, v12, s[16:19], s44 offen
    s_waitcnt vmcnt(62)
    v_perm_b32 v112, v81, v80, v14
    v_perm_b32 v116, v81, v80, v15
    s_waitcnt vmcnt(60)
    v_perm_b32 v113, v83, v82, v14
    v_perm_b32 v117, v83, v82, v15
    s_waitcnt vmcnt(58)
    v_perm_b32 v114, v85, v84, v14
    v_perm_b32 v118, v85, v84, v15
    s_waitcnt vmcnt(56)
    v_perm_b32 v115, v87, v86, v14
    v_perm_b32 v119, v87, v86, v15
    v_mov_b32_dpp v120, v116 quad_perm:[1,0,3,2] row_mask:0xf bank_mask:0xf
    v_mov_b32_dpp v121, v117 quad_perm:[1,0,3,2] row_mask:0xf bank_mask:0xf
    v_mov_b32_dpp v122, v118 quad_perm:[1,0,3,2] row_mask:0xf bank_mask:0xf
    v_mov_b32_dpp v123, v119 quad_perm:[1,0,3,2] row_mask:0xf bank_mask:0xf
    v_cndmask_b32 v116, v120, v112, vcc
    v_cndmask_b32 v112, v112, v120, vcc
    v_cndmask_b32 v117, v121, v113, vcc
    v_cndmask_b32 v113, v113, v121, vcc
    v_cndmask_b32 v118, v122, v114, vcc
    v_cndmask_b32 v114, v114, v122, vcc
    v_cndmask_b32 v119, v123, v115, vcc
    v_cndmask_b32 v115, v115, v123, vcc
    v_accvgpr_write_b32 a160, v112
    v_accvgpr_write_b32 a161, v113
    v_accvgpr_write_b32 a162, v114
    v_accvgpr_write_b32 a163, v115
    v_accvgpr_write_b32 a164, v116
    v_accvgpr_write_b32 a165, v117
    v_accvgpr_write_b32 a166, v118
    v_accvgpr_write_b32 a167, v119
    s_waitcnt vmcnt(54)
    v_perm_b32 v128, v89, v88, v14
    v_perm_b32 v132, v89, v88, v15
    s_waitcnt vmcnt(52)
    v_perm_b32 v129, v91, v90, v14
    v_perm_b32 v133, v91, v90, v15
    s_waitcnt vmcnt(50)
    v_perm_b32 v130, v93, v92, v14
    v_perm_b32 v134, v93, v92, v15
    s_waitcnt vmcnt(48)
    v_perm_b32 v131, v95, v94, v14
    v_perm_b32 v135, v95, v94, v15
    v_mov_b32_dpp v136, v132 quad_perm:[1,0,3,2] row_mask:0xf bank_mask:0xf
    v_mov_b32_dpp v137, v133 quad_perm:[1,0,3,2] row_mask:0xf bank_mask:0xf
    v_mov_b32_dpp v138, v134 quad_perm:[1,0,3,2] row_mask:0xf bank_mask:0xf
    v_mov_b32_dpp v139, v135 quad_perm:[1,0,3,2] row_mask:0xf bank_mask:0xf
    v_cndmask_b32 v132, v136, v128, vcc
    v_cndmask_b32 v128, v128, v136, vcc
    v_cndmask_b32 v133, v137, v129, vcc
    v_cndmask_b32 v129, v129, v137, vcc
    v_cndmask_b32 v134, v138, v130, vcc
    v_cndmask_b32 v130, v130, v138, vcc
    v_cndmask_b32 v135, v139, v131, vcc
    v_cndmask_b32 v131, v131, v139, vcc
    v_accvgpr_write_b32 a168, v128
    v_accvgpr_write_b32 a169, v129
    v_accvgpr_write_b32 a170, v130
    v_accvgpr_write_b32 a171, v131
    v_accvgpr_write_b32 a172, v132
    v_accvgpr_write_b32 a173, v133
    v_accvgpr_write_b32 a174, v134
    v_accvgpr_write_b32 a175, v135
    s_waitcnt vmcnt(46)
    v_perm_b32 v112, v97, v96, v14
    v_perm_b32 v116, v97, v96, v15
    s_waitcnt vmcnt(44)
    v_perm_b32 v113, v99, v98, v14
    v_perm_b32 v117, v99, v98, v15
    s_waitcnt vmcnt(42)
    v_perm_b32 v114, v101, v100, v14
    v_perm_b32 v118, v101, v100, v15
    s_waitcnt vmcnt(40)
    v_perm_b32 v115, v103, v102, v14
    v_perm_b32 v119, v103, v102, v15
    v_mov_b32_dpp v120, v116 quad_perm:[1,0,3,2] row_mask:0xf bank_mask:0xf
    v_mov_b32_dpp v121, v117 quad_perm:[1,0,3,2] row_mask:0xf bank_mask:0xf
    v_mov_b32_dpp v122, v118 quad_perm:[1,0,3,2] row_mask:0xf bank_mask:0xf
    v_mov_b32_dpp v123, v119 quad_perm:[1,0,3,2] row_mask:0xf bank_mask:0xf
    v_cndmask_b32 v116, v120, v112, vcc
    v_cndmask_b32 v112, v112, v120, vcc
    v_cndmask_b32 v117, v121, v113, vcc
    v_cndmask_b32 v113, v113, v121, vcc
    v_cndmask_b32 v118, v122, v114, vcc
    v_cndmask_b32 v114, v114, v122, vcc
    v_cndmask_b32 v119, v123, v115, vcc
    v_cndmask_b32 v115, v115, v123, vcc
    v_accvgpr_write_b32 a176, v112
    v_accvgpr_write_b32 a177, v113
    v_accvgpr_write_b32 a178, v114
    v_accvgpr_write_b32 a179, v115
    v_accvgpr_write_b32 a180, v116
    v_accvgpr_write_b32 a181, v117
    v_accvgpr_write_b32 a182, v118
    v_accvgpr_write_b32 a183, v119
    s_waitcnt vmcnt(38)
    v_perm_b32 v128, v105, v104, v14
    v_perm_b32 v132, v105, v104, v15
    s_waitcnt vmcnt(36)
    v_perm_b32 v129, v107, v106, v14
    v_perm_b32 v133, v107, v106, v15
    s_waitcnt vmcnt(34)
    v_perm_b32 v130, v109, v108, v14
    v_perm_b32 v134, v109, v108, v15
    s_waitcnt vmcnt(32)
    v_perm_b32 v131, v111, v110, v14
    v_perm_b32 v135, v111, v110, v15
    v_mov_b32_dpp v136, v132 quad_perm:[1,0,3,2] row_mask:0xf bank_mask:0xf
    v_mov_b32_dpp v137, v133 quad_perm:[1,0,3,2] row_mask:0xf bank_mask:0xf
    v_mov_b32_dpp v138, v134 quad_perm:[1,0,3,2] row_mask:0xf bank_mask:0xf
    v_mov_b32_dpp v139, v135 quad_perm:[1,0,3,2] row_mask:0xf bank_mask:0xf
    v_cndmask_b32 v132, v136, v128, vcc
    v_cndmask_b32 v128, v128, v136, vcc
    v_cndmask_b32 v133, v137, v129, vcc
    v_cndmask_b32 v129, v129, v137, vcc
    v_cndmask_b32 v134, v138, v130, vcc
    v_cndmask_b32 v130, v130, v138, vcc
    v_cndmask_b32 v135, v139, v131, vcc
    v_cndmask_b32 v131, v131, v139, vcc
    v_accvgpr_write_b32 a184, v128
    v_accvgpr_write_b32 a185, v129
    v_accvgpr_write_b32 a186, v130
    v_accvgpr_write_b32 a187, v131
    v_accvgpr_write_b32 a188, v132
    v_accvgpr_write_b32 a189, v133
    v_accvgpr_write_b32 a190, v134
    v_accvgpr_write_b32 a191, v135
    s_mov_b32 s44, 3670016
    buffer_load_dword v48, v12, s[16:19], s44 offen
    s_mov_b32 s44, 3678208
    buffer_load_dword v49, v12, s[16:19], s44 offen
    s_mov_b32 s44, 3686400
    buffer_load_dword v50, v12, s[16:19], s44 offen
    s_mov_b32 s44, 3694592
    buffer_load_dword v51, v12, s[16:19], s44 offen
    s_mov_b32 s44, 3702784
    buffer_load_dword v52, v12, s[16:19], s44 offen
    s_mov_b32 s44, 3710976
    buffer_load_dword v53, v12, s[16:19], s44 offen
    s_mov_b32 s44, 3719168
    buffer_load_dword v54, v12, s[16:19], s44 offen
    s_mov_b32 s44, 3727360
    buffer_load_dword v55, v12, s[16:19], s44 offen
    s_mov_b32 s44, 3801088
    buffer_load_dword v56, v12, s[16:19], s44 offen
    s_mov_b32 s44, 3809280
    buffer_load_dword v57, v12, s[16:19], s44 offen
    s_mov_b32 s44, 3817472
    buffer_load_dword v58, v12, s[16:19], s44 offen
    s_mov_b32 s44, 3825664
    buffer_load_dword v59, v12, s[16:19], s44 offen
    s_mov_b32 s44, 3833856
    buffer_load_dword v60, v12, s[16:19], s44 offen
    s_mov_b32 s44, 3842048
    buffer_load_dword v61, v12, s[16:19], s44 offen
    s_mov_b32 s44, 3850240
    buffer_load_dword v62, v12, s[16:19], s44 offen
    s_mov_b32 s44, 3858432
    buffer_load_dword v63, v12, s[16:19], s44 offen
    s_mov_b32 s44, 3932160
    buffer_load_dword v64, v12, s[16:19], s44 offen
    s_mov_b32 s44, 3940352
    buffer_load_dword v65, v12, s[16:19], s44 offen
    s_mov_b32 s44, 3948544
    buffer_load_dword v66, v12, s[16:19], s44 offen
    s_mov_b32 s44, 3956736
    buffer_load_dword v67, v12, s[16:19], s44 offen
    s_mov_b32 s44, 3964928
    buffer_load_dword v68, v12, s[16:19], s44 offen
    s_mov_b32 s44, 3973120
    buffer_load_dword v69, v12, s[16:19], s44 offen
    s_mov_b32 s44, 3981312
    buffer_load_dword v70, v12, s[16:19], s44 offen
    s_mov_b32 s44, 3989504
    buffer_load_dword v71, v12, s[16:19], s44 offen
    s_mov_b32 s44, 4063232
    buffer_load_dword v72, v12, s[16:19], s44 offen
    s_mov_b32 s44, 4071424
    buffer_load_dword v73, v12, s[16:19], s44 offen
    s_mov_b32 s44, 4079616
    buffer_load_dword v74, v12, s[16:19], s44 offen
    s_mov_b32 s44, 4087808
    buffer_load_dword v75, v12, s[16:19], s44 offen
    s_mov_b32 s44, 4096000
    buffer_load_dword v76, v12, s[16:19], s44 offen
    s_mov_b32 s44, 4104192
    buffer_load_dword v77, v12, s[16:19], s44 offen
    s_mov_b32 s44, 4112384
    buffer_load_dword v78, v12, s[16:19], s44 offen
    s_mov_b32 s44, 4120576
    buffer_load_dword v79, v12, s[16:19], s44 offen
    s_waitcnt vmcnt(62)
    v_perm_b32 v112, v17, v16, v14
    v_perm_b32 v116, v17, v16, v15
    s_waitcnt vmcnt(60)
    v_perm_b32 v113, v19, v18, v14
    v_perm_b32 v117, v19, v18, v15
    s_waitcnt vmcnt(58)
    v_perm_b32 v114, v21, v20, v14
    v_perm_b32 v118, v21, v20, v15
    s_waitcnt vmcnt(56)
    v_perm_b32 v115, v23, v22, v14
    v_perm_b32 v119, v23, v22, v15
    v_mov_b32_dpp v120, v116 quad_perm:[1,0,3,2] row_mask:0xf bank_mask:0xf
    v_mov_b32_dpp v121, v117 quad_perm:[1,0,3,2] row_mask:0xf bank_mask:0xf
    v_mov_b32_dpp v122, v118 quad_perm:[1,0,3,2] row_mask:0xf bank_mask:0xf
    v_mov_b32_dpp v123, v119 quad_perm:[1,0,3,2] row_mask:0xf bank_mask:0xf
    v_cndmask_b32 v116, v120, v112, vcc
    v_cndmask_b32 v112, v112, v120, vcc
    v_cndmask_b32 v117, v121, v113, vcc
    v_cndmask_b32 v113, v113, v121, vcc
    v_cndmask_b32 v118, v122, v114, vcc
    v_cndmask_b32 v114, v114, v122, vcc
    v_cndmask_b32 v119, v123, v115, vcc
    v_cndmask_b32 v115, v115, v123, vcc
    v_accvgpr_write_b32 a192, v112
    v_accvgpr_write_b32 a193, v113
    v_accvgpr_write_b32 a194, v114
    v_accvgpr_write_b32 a195, v115
    v_accvgpr_write_b32 a196, v116
    v_accvgpr_write_b32 a197, v117
    v_accvgpr_write_b32 a198, v118
    v_accvgpr_write_b32 a199, v119
    s_waitcnt vmcnt(54)
    v_perm_b32 v128, v25, v24, v14
    v_perm_b32 v132, v25, v24, v15
    s_waitcnt vmcnt(52)
    v_perm_b32 v129, v27, v26, v14
    v_perm_b32 v133, v27, v26, v15
    s_waitcnt vmcnt(50)
    v_perm_b32 v130, v29, v28, v14
    v_perm_b32 v134, v29, v28, v15
    s_waitcnt vmcnt(48)
    v_perm_b32 v131, v31, v30, v14
    v_perm_b32 v135, v31, v30, v15
    v_mov_b32_dpp v136, v132 quad_perm:[1,0,3,2] row_mask:0xf bank_mask:0xf
    v_mov_b32_dpp v137, v133 quad_perm:[1,0,3,2] row_mask:0xf bank_mask:0xf
    v_mov_b32_dpp v138, v134 quad_perm:[1,0,3,2] row_mask:0xf bank_mask:0xf
    v_mov_b32_dpp v139, v135 quad_perm:[1,0,3,2] row_mask:0xf bank_mask:0xf
    v_cndmask_b32 v132, v136, v128, vcc
    v_cndmask_b32 v128, v128, v136, vcc
    v_cndmask_b32 v133, v137, v129, vcc
    v_cndmask_b32 v129, v129, v137, vcc
    v_cndmask_b32 v134, v138, v130, vcc
    v_cndmask_b32 v130, v130, v138, vcc
    v_cndmask_b32 v135, v139, v131, vcc
    v_cndmask_b32 v131, v131, v139, vcc
    v_accvgpr_write_b32 a200, v128
    v_accvgpr_write_b32 a201, v129
    v_accvgpr_write_b32 a202, v130
    v_accvgpr_write_b32 a203, v131
    v_accvgpr_write_b32 a204, v132
    v_accvgpr_write_b32 a205, v133
    v_accvgpr_write_b32 a206, v134
    v_accvgpr_write_b32 a207, v135
    s_waitcnt vmcnt(46)
    v_perm_b32 v112, v33, v32, v14
    v_perm_b32 v116, v33, v32, v15
    s_waitcnt vmcnt(44)
    v_perm_b32 v113, v35, v34, v14
    v_perm_b32 v117, v35, v34, v15
    s_waitcnt vmcnt(42)
    v_perm_b32 v114, v37, v36, v14
    v_perm_b32 v118, v37, v36, v15
    s_waitcnt vmcnt(40)
    v_perm_b32 v115, v39, v38, v14
    v_perm_b32 v119, v39, v38, v15
    v_mov_b32_dpp v120, v116 quad_perm:[1,0,3,2] row_mask:0xf bank_mask:0xf
    v_mov_b32_dpp v121, v117 quad_perm:[1,0,3,2] row_mask:0xf bank_mask:0xf
    v_mov_b32_dpp v122, v118 quad_perm:[1,0,3,2] row_mask:0xf bank_mask:0xf
    v_mov_b32_dpp v123, v119 quad_perm:[1,0,3,2] row_mask:0xf bank_mask:0xf
    v_cndmask_b32 v116, v120, v112, vcc
    v_cndmask_b32 v112, v112, v120, vcc
    v_cndmask_b32 v117, v121, v113, vcc
    v_cndmask_b32 v113, v113, v121, vcc
    v_cndmask_b32 v118, v122, v114, vcc
    v_cndmask_b32 v114, v114, v122, vcc
    v_cndmask_b32 v119, v123, v115, vcc
    v_cndmask_b32 v115, v115, v123, vcc
    v_accvgpr_write_b32 a208, v112
    v_accvgpr_write_b32 a209, v113
    v_accvgpr_write_b32 a210, v114
    v_accvgpr_write_b32 a211, v115
    v_accvgpr_write_b32 a212, v116
    v_accvgpr_write_b32 a213, v117
    v_accvgpr_write_b32 a214, v118
    v_accvgpr_write_b32 a215, v119
    s_waitcnt vmcnt(38)
    v_perm_b32 v128, v41, v40, v14
    v_perm_b32 v132, v41, v40, v15
    s_waitcnt vmcnt(36)
    v_perm_b32 v129, v43, v42, v14
    v_perm_b32 v133, v43, v42, v15
    s_waitcnt vmcnt(34)
    v_perm_b32 v130, v45, v44, v14
    v_perm_b32 v134, v45, v44, v15
    s_waitcnt vmcnt(32)
    v_perm_b32 v131, v47, v46, v14
    v_perm_b32 v135, v47, v46, v15
    v_mov_b32_dpp v136, v132 quad_perm:[1,0,3,2] row_mask:0xf bank_mask:0xf
    v_mov_b32_dpp v137, v133 quad_perm:[1,0,3,2] row_mask:0xf bank_mask:0xf
    v_mov_b32_dpp v138, v134 quad_perm:[1,0,3,2] row_mask:0xf bank_mask:0xf
    v_mov_b32_dpp v139, v135 quad_perm:[1,0,3,2] row_mask:0xf bank_mask:0xf
    v_cndmask_b32 v132, v136, v128, vcc
    v_cndmask_b32 v128, v128, v136, vcc
    v_cndmask_b32 v133, v137, v129, vcc
    v_cndmask_b32 v129, v129, v137, vcc
    v_cndmask_b32 v134, v138, v130, vcc
    v_cndmask_b32 v130, v130, v138, vcc
    v_cndmask_b32 v135, v139, v131, vcc
    v_cndmask_b32 v131, v131, v139, vcc
    v_accvgpr_write_b32 a216, v128
    v_accvgpr_write_b32 a217, v129
    v_accvgpr_write_b32 a218, v130
    v_accvgpr_write_b32 a219, v131
    v_accvgpr_write_b32 a220, v132
    v_accvgpr_write_b32 a221, v133
    v_accvgpr_write_b32 a222, v134
    v_accvgpr_write_b32 a223, v135
    s_waitcnt vmcnt(30)
    v_perm_b32 v112, v49, v48, v14
    v_perm_b32 v116, v49, v48, v15
    s_waitcnt vmcnt(28)
    v_perm_b32 v113, v51, v50, v14
    v_perm_b32 v117, v51, v50, v15
    s_waitcnt vmcnt(26)
    v_perm_b32 v114, v53, v52, v14
    v_perm_b32 v118, v53, v52, v15
    s_waitcnt vmcnt(24)
    v_perm_b32 v115, v55, v54, v14
    v_perm_b32 v119, v55, v54, v15
    v_mov_b32_dpp v120, v116 quad_perm:[1,0,3,2] row_mask:0xf bank_mask:0xf
    v_mov_b32_dpp v121, v117 quad_perm:[1,0,3,2] row_mask:0xf bank_mask:0xf
    v_mov_b32_dpp v122, v118 quad_perm:[1,0,3,2] row_mask:0xf bank_mask:0xf
    v_mov_b32_dpp v123, v119 quad_perm:[1,0,3,2] row_mask:0xf bank_mask:0xf
    v_cndmask_b32 v116, v120, v112, vcc
    v_cndmask_b32 v112, v112, v120, vcc
    v_cndmask_b32 v117, v121, v113, vcc
    v_cndmask_b32 v113, v113, v121, vcc
    v_cndmask_b32 v118, v122, v114, vcc
    v_cndmask_b32 v114, v114, v122, vcc
    v_cndmask_b32 v119, v123, v115, vcc
    v_cndmask_b32 v115, v115, v123, vcc
    v_accvgpr_write_b32 a224, v112
    v_accvgpr_write_b32 a225, v113
    v_accvgpr_write_b32 a226, v114
    v_accvgpr_write_b32 a227, v115
    v_accvgpr_write_b32 a228, v116
    v_accvgpr_write_b32 a229, v117
    v_accvgpr_write_b32 a230, v118
    v_accvgpr_write_b32 a231, v119
    s_waitcnt vmcnt(22)
    v_perm_b32 v128, v57, v56, v14
    v_perm_b32 v132, v57, v56, v15
    s_waitcnt vmcnt(20)
    v_perm_b32 v129, v59, v58, v14
    v_perm_b32 v133, v59, v58, v15
    s_waitcnt vmcnt(18)
    v_perm_b32 v130, v61, v60, v14
    v_perm_b32 v134, v61, v60, v15
    s_waitcnt vmcnt(16)
    v_perm_b32 v131, v63, v62, v14
    v_perm_b32 v135, v63, v62, v15
    v_mov_b32_dpp v136, v132 quad_perm:[1,0,3,2] row_mask:0xf bank_mask:0xf
    v_mov_b32_dpp v137, v133 quad_perm:[1,0,3,2] row_mask:0xf bank_mask:0xf
    v_mov_b32_dpp v138, v134 quad_perm:[1,0,3,2] row_mask:0xf bank_mask:0xf
    v_mov_b32_dpp v139, v135 quad_perm:[1,0,3,2] row_mask:0xf bank_mask:0xf
    v_cndmask_b32 v132, v136, v128, vcc
    v_cndmask_b32 v128, v128, v136, vcc
    v_cndmask_b32 v133, v137, v129, vcc
    v_cndmask_b32 v129, v129, v137, vcc
    v_cndmask_b32 v134, v138, v130, vcc
    v_cndmask_b32 v130, v130, v138, vcc
    v_cndmask_b32 v135, v139, v131, vcc
    v_cndmask_b32 v131, v131, v139, vcc
    v_accvgpr_write_b32 a232, v128
    v_accvgpr_write_b32 a233, v129
    v_accvgpr_write_b32 a234, v130
    v_accvgpr_write_b32 a235, v131
    v_accvgpr_write_b32 a236, v132
    v_accvgpr_write_b32 a237, v133
    v_accvgpr_write_b32 a238, v134
    v_accvgpr_write_b32 a239, v135
    s_waitcnt vmcnt(14)
    v_perm_b32 v112, v65, v64, v14
    v_perm_b32 v116, v65, v64, v15
    s_waitcnt vmcnt(12)
    v_perm_b32 v113, v67, v66, v14
    v_perm_b32 v117, v67, v66, v15
    s_waitcnt vmcnt(10)
    v_perm_b32 v114, v69, v68, v14
    v_perm_b32 v118, v69, v68, v15
    s_waitcnt vmcnt(8)
    v_perm_b32 v115, v71, v70, v14
    v_perm_b32 v119, v71, v70, v15
    v_mov_b32_dpp v120, v116 quad_perm:[1,0,3,2] row_mask:0xf bank_mask:0xf
    v_mov_b32_dpp v121, v117 quad_perm:[1,0,3,2] row_mask:0xf bank_mask:0xf
    v_mov_b32_dpp v122, v118 quad_perm:[1,0,3,2] row_mask:0xf bank_mask:0xf
    v_mov_b32_dpp v123, v119 quad_perm:[1,0,3,2] row_mask:0xf bank_mask:0xf
    v_cndmask_b32 v116, v120, v112, vcc
    v_cndmask_b32 v112, v112, v120, vcc
    v_cndmask_b32 v117, v121, v113, vcc
    v_cndmask_b32 v113, v113, v121, vcc
    v_cndmask_b32 v118, v122, v114, vcc
    v_cndmask_b32 v114, v114, v122, vcc
    v_cndmask_b32 v119, v123, v115, vcc
    v_cndmask_b32 v115, v115, v123, vcc
    v_accvgpr_write_b32 a240, v112
    v_accvgpr_write_b32 a241, v113
    v_accvgpr_write_b32 a242, v114
    v_accvgpr_write_b32 a243, v115
    v_accvgpr_write_b32 a244, v116
    v_accvgpr_write_b32 a245, v117
    v_accvgpr_write_b32 a246, v118
    v_accvgpr_write_b32 a247, v119
    s_waitcnt vmcnt(6)
    v_perm_b32 v128, v73, v72, v14
    v_perm_b32 v132, v73, v72, v15
    s_waitcnt vmcnt(4)
    v_perm_b32 v129, v75, v74, v14
    v_perm_b32 v133, v75, v74, v15
    s_waitcnt vmcnt(2)
    v_perm_b32 v130, v77, v76, v14
    v_perm_b32 v134, v77, v76, v15
    s_waitcnt vmcnt(0)
    v_perm_b32 v131, v79, v78, v14
    v_perm_b32 v135, v79, v78, v15
    v_mov_b32_dpp v136, v132 quad_perm:[1,0,3,2] row_mask:0xf bank_mask:0xf
    v_mov_b32_dpp v137, v133 quad_perm:[1,0,3,2] row_mask:0xf bank_mask:0xf
    v_mov_b32_dpp v138, v134 quad_perm:[1,0,3,2] row_mask:0xf bank_mask:0xf
    v_mov_b32_dpp v139, v135 quad_perm:[1,0,3,2] row_mask:0xf bank_mask:0xf
    v_cndmask_b32 v132, v136, v128, vcc
    v_cndmask_b32 v128, v128, v136, vcc
    v_cndmask_b32 v133, v137, v129, vcc
    v_cndmask_b32 v129, v129, v137, vcc
    v_cndmask_b32 v134, v138, v130, vcc
    v_cndmask_b32 v130, v130, v138, vcc
    v_cndmask_b32 v135, v139, v131, vcc
    v_cndmask_b32 v131, v131, v139, vcc
    v_accvgpr_write_b32 a248, v128
    v_accvgpr_write_b32 a249, v129
    v_accvgpr_write_b32 a250, v130
    v_accvgpr_write_b32 a251, v131
    v_accvgpr_write_b32 a252, v132
    v_accvgpr_write_b32 a253, v133
    v_accvgpr_write_b32 a254, v134
    v_accvgpr_write_b32 a255, v135
    s_branch L_proj_we
L_proj_wv2:
    s_mov_b32 s44, 0
    buffer_load_dword v16, v12, s[16:19], s44 offen
    s_mov_b32 s44, 8192
    buffer_load_dword v17, v12, s[16:19], s44 offen
    s_mov_b32 s44, 16384
    buffer_load_dword v18, v12, s[16:19], s44 offen
    s_mov_b32 s44, 24576
    buffer_load_dword v19, v12, s[16:19], s44 offen
    s_mov_b32 s44, 32768
    buffer_load_dword v20, v12, s[16:19], s44 offen
    s_mov_b32 s44, 40960
    buffer_load_dword v21, v12, s[16:19], s44 offen
    s_mov_b32 s44, 49152
    buffer_load_dword v22, v12, s[16:19], s44 offen
    s_mov_b32 s44, 57344
    buffer_load_dword v23, v12, s[16:19], s44 offen
    s_mov_b32 s44, 131072
    buffer_load_dword v24, v12, s[16:19], s44 offen
    s_mov_b32 s44, 139264
    buffer_load_dword v25, v12, s[16:19], s44 offen
    s_mov_b32 s44, 147456
    buffer_load_dword v26, v12, s[16:19], s44 offen
    s_mov_b32 s44, 155648
    buffer_load_dword v27, v12, s[16:19], s44 offen
    s_mov_b32 s44, 163840
    buffer_load_dword v28, v12, s[16:19], s44 offen
    s_mov_b32 s44, 172032
    buffer_load_dword v29, v12, s[16:19], s44 offen
    s_mov_b32 s44, 180224
    buffer_load_dword v30, v12, s[16:19], s44 offen
    s_mov_b32 s44, 188416
    buffer_load_dword v31, v12, s[16:19], s44 offen
    s_mov_b32 s44, 262144
    buffer_load_dword v32, v12, s[16:19], s44 offen
    s_mov_b32 s44, 270336
    buffer_load_dword v33, v12, s[16:19], s44 offen
    s_mov_b32 s44, 278528
    buffer_load_dword v34, v12, s[16:19], s44 offen
    s_mov_b32 s44, 286720
    buffer_load_dword v35, v12, s[16:19], s44 offen
    s_mov_b32 s44, 294912
    buffer_load_dword v36, v12, s[16:19], s44 offen
    s_mov_b32 s44, 303104
    buffer_load_dword v37, v12, s[16:19], s44 offen
    s_mov_b32 s44, 311296
    buffer_load_dword v38, v12, s[16:19], s44 offen
    s_mov_b32 s44, 319488
    buffer_load_dword v39, v12, s[16:19], s44 offen
    s_mov_b32 s44, 393216
    buffer_load_dword v40, v12, s[16:19], s44 offen
    s_mov_b32 s44, 401408
    buffer_load_dword v41, v12, s[16:19], s44 offen
    s_mov_b32 s44, 409600
    buffer_load_dword v42, v12, s[16:19], s44 offen
    s_mov_b32 s44, 417792
    buffer_load_dword v43, v12, s[16:19], s44 offen
    s_mov_b32 s44, 425984
    buffer_load_dword v44, v12, s[16:19], s44 offen
    s_mov_b32 s44, 434176
    buffer_load_dword v45, v12, s[16:19], s44 offen
    s_mov_b32 s44, 442368
    buffer_load_dword v46, v12, s[16:19], s44 offen
    s_mov_b32 s44, 450560
    buffer_load_dword v47, v12, s[16:19], s44 offen
    s_mov_b32 s44, 524288
    buffer_load_dword v48, v12, s[16:19], s44 offen
    s_mov_b32 s44, 532480
    buffer_load_dword v49, v12, s[16:19], s44 offen
    s_mov_b32 s44, 540672
    buffer_load_dword v50, v12, s[16:19], s44 offen
    s_mov_b32 s44, 548864
    buffer_load_dword v51, v12, s[16:19], s44 offen
    s_mov_b32 s44, 557056
    buffer_load_dword v52, v12, s[16:19], s44 offen
    s_mov_b32 s44, 565248
    buffer_load_dword v53, v12, s[16:19], s44 offen
    s_mov_b32 s44, 573440
    buffer_load_dword v54, v12, s[16:19], s44 offen
    s_mov_b32 s44, 581632
    buffer_load_dword v55, v12, s[16:19], s44 offen
    s_mov_b32 s44, 655360
    buffer_load_dword v56, v12, s[16:19], s44 offen
    s_mov_b32 s44, 663552
    buffer_load_dword v57, v12, s[16:19], s44 offen
    s_mov_b32 s44, 671744
    buffer_load_dword v58, v12, s[16:19], s44 offen
    s_mov_b32 s44, 679936
    buffer_load_dword v59, v12, s[16:19], s44 offen
    s_mov_b32 s44, 688128
    buffer_load_dword v60, v12, s[16:19], s44 offen
    s_mov_b32 s44, 696320
    buffer_load_dword v61, v12, s[16:19], s44 offen
    s_mov_b32 s44, 704512
    buffer_load_dword v62, v12, s[16:19], s44 offen
    s_mov_b32 s44, 712704
    buffer_load_dword v63, v12, s[16:19], s44 offen
    s_mov_b32 s44, 786432
    buffer_load_dword v64, v12, s[16:19], s44 offen
    s_mov_b32 s44, 794624
    buffer_load_dword v65, v12, s[16:19], s44 offen
    s_mov_b32 s44, 802816
    buffer_load_dword v66, v12, s[16:19], s44 offen
    s_mov_b32 s44, 811008
    buffer_load_dword v67, v12, s[16:19], s44 offen
    s_mov_b32 s44, 819200
    buffer_load_dword v68, v12, s[16:19], s44 offen
    s_mov_b32 s44, 827392
    buffer_load_dword v69, v12, s[16:19], s44 offen
    s_mov_b32 s44, 835584
    buffer_load_dword v70, v12, s[16:19], s44 offen
    s_mov_b32 s44, 843776
    buffer_load_dword v71, v12, s[16:19], s44 offen
    s_mov_b32 s44, 917504
    buffer_load_dword v72, v12, s[16:19], s44 offen
    s_mov_b32 s44, 925696
    buffer_load_dword v73, v12, s[16:19], s44 offen
    s_mov_b32 s44, 933888
    buffer_load_dword v74, v12, s[16:19], s44 offen
    s_mov_b32 s44, 942080
    buffer_load_dword v75, v12, s[16:19], s44 offen
    s_mov_b32 s44, 950272
    buffer_load_dword v76, v12, s[16:19], s44 offen
    s_mov_b32 s44, 958464
    buffer_load_dword v77, v12, s[16:19], s44 offen
    s_mov_b32 s44, 966656
    buffer_load_dword v78, v12, s[16:19], s44 offen
    s_mov_b32 s44, 974848
    buffer_load_dword v79, v12, s[16:19], s44 offen
    s_waitcnt vmcnt(62)
    v_perm_b32 v112, v17, v16, v14
    v_perm_b32 v116, v17, v16, v15
    s_waitcnt vmcnt(60)
    v_perm_b32 v113, v19, v18, v14
    v_perm_b32 v117, v19, v18, v15
    s_waitcnt vmcnt(58)
    v_perm_b32 v114, v21, v20, v14
    v_perm_b32 v118, v21, v20, v15
    s_waitcnt vmcnt(56)
    v_perm_b32 v115, v23, v22, v14
    v_perm_b32 v119, v23, v22, v15
    v_accvgpr_write_b32 a0, v112
    v_accvgpr_write_b32 a1, v113
    v_accvgpr_write_b32 a2, v114
    v_accvgpr_write_b32 a3, v115
    v_accvgpr_write_b32 a4, v116
    v_accvgpr_write_b32 a5, v117
    v_accvgpr_write_b32 a6, v118
    v_accvgpr_write_b32 a7, v119
    s_waitcnt vmcnt(54)
    v_perm_b32 v128, v25, v24, v14
    v_perm_b32 v132, v25, v24, v15
    s_waitcnt vmcnt(52)
    v_perm_b32 v129, v27, v26, v14
    v_perm_b32 v133, v27, v26, v15
    s_waitcnt vmcnt(50)
    v_perm_b32 v130, v29, v28, v14
    v_perm_b32 v134, v29, v28, v15
    s_waitcnt vmcnt(48)
    v_perm_b32 v131, v31, v30, v14
    v_perm_b32 v135, v31, v30, v15
    v_accvgpr_write_b32 a8, v128
    v_accvgpr_write_b32 a9, v129
    v_accvgpr_write_b32 a10, v130
    v_accvgpr_write_b32 a11, v131
    v_accvgpr_write_b32 a12, v132
    v_accvgpr_write_b32 a13, v133
    v_accvgpr_write_b32 a14, v134
    v_accvgpr_write_b32 a15, v135
    s_waitcnt vmcnt(46)
    v_perm_b32 v112, v33, v32, v14
    v_perm_b32 v116, v33, v32, v15
    s_waitcnt vmcnt(44)
    v_perm_b32 v113, v35, v34, v14
    v_perm_b32 v117, v35, v34, v15
    s_waitcnt vmcnt(42)
    v_perm_b32 v114, v37, v36, v14
    v_perm_b32 v118, v37, v36, v15
    s_waitcnt vmcnt(40)
    v_perm_b32 v115, v39, v38, v14
    v_perm_b32 v119, v39, v38, v15
    v_accvgpr_write_b32 a16, v112
    v_accvgpr_write_b32 a17, v113
    v_accvgpr_write_b32 a18, v114
    v_accvgpr_write_b32 a19, v115
    v_accvgpr_write_b32 a20, v116
    v_accvgpr_write_b32 a21, v117
    v_accvgpr_write_b32 a22, v118
    v_accvgpr_write_b32 a23, v119
    s_waitcnt vmcnt(38)
    v_perm_b32 v128, v41, v40, v14
    v_perm_b32 v132, v41, v40, v15
    s_waitcnt vmcnt(36)
    v_perm_b32 v129, v43, v42, v14
    v_perm_b32 v133, v43, v42, v15
    s_waitcnt vmcnt(34)
    v_perm_b32 v130, v45, v44, v14
    v_perm_b32 v134, v45, v44, v15
    s_waitcnt vmcnt(32)
    v_perm_b32 v131, v47, v46, v14
    v_perm_b32 v135, v47, v46, v15
    v_accvgpr_write_b32 a24, v128
    v_accvgpr_write_b32 a25, v129
    v_accvgpr_write_b32 a26, v130
    v_accvgpr_write_b32 a27, v131
    v_accvgpr_write_b32 a28, v132
    v_accvgpr_write_b32 a29, v133
    v_accvgpr_write_b32 a30, v134
    v_accvgpr_write_b32 a31, v135
    s_mov_b32 s44, 1048576
    buffer_load_dword v80, v12, s[16:19], s44 offen
    s_mov_b32 s44, 1056768
    buffer_load_dword v81, v12, s[16:19], s44 offen
    s_mov_b32 s44, 1064960
    buffer_load_dword v82, v12, s[16:19], s44 offen
    s_mov_b32 s44, 1073152
    buffer_load_dword v83, v12, s[16:19], s44 offen
    s_mov_b32 s44, 1081344
    buffer_load_dword v84, v12, s[16:19], s44 offen
    s_mov_b32 s44, 1089536
    buffer_load_dword v85, v12, s[16:19], s44 offen
    s_mov_b32 s44, 1097728
    buffer_load_dword v86, v12, s[16:19], s44 offen
    s_mov_b32 s44, 1105920
    buffer_load_dword v87, v12, s[16:19], s44 offen
    s_mov_b32 s44, 1179648
    buffer_load_dword v88, v12, s[16:19], s44 offen
    s_mov_b32 s44, 1187840
    buffer_load_dword v89, v12, s[16:19], s44 offen
    s_mov_b32 s44, 1196032
    buffer_load_dword v90, v12, s[16:19], s44 offen
    s_mov_b32 s44, 1204224
    buffer_load_dword v91, v12, s[16:19], s44 offen
    s_mov_b32 s44, 1212416
    buffer_load_dword v92, v12, s[16:19], s44 offen
    s_mov_b32 s44, 1220608
    buffer_load_dword v93, v12, s[16:19], s44 offen
    s_mov_b32 s44, 1228800
    buffer_load_dword v94, v12, s[16:19], s44 offen
    s_mov_b32 s44, 1236992
    buffer_load_dword v95, v12, s[16:19], s44 offen
    s_mov_b32 s44, 1310720
    buffer_load_dword v96, v12, s[16:19], s44 offen
    s_mov_b32 s44, 1318912
    buffer_load_dword v97, v12, s[16:19], s44 offen
    s_mov_b32 s44, 1327104
    buffer_load_dword v98, v12, s[16:19], s44 offen
    s_mov_b32 s44, 1335296
    buffer_load_dword v99, v12, s[16:19], s44 offen
    s_mov_b32 s44, 1343488
    buffer_load_dword v100, v12, s[16:19], s44 offen
    s_mov_b32 s44, 1351680
    buffer_load_dword v101, v12, s[16:19], s44 offen
    s_mov_b32 s44, 1359872
    buffer_load_dword v102, v12, s[16:19], s44 offen
    s_mov_b32 s44, 1368064
    buffer_load_dword v103, v12, s[16:19], s44 offen
    s_mov_b32 s44, 1441792
    buffer_load_dword v104, v12, s[16:19], s44 offen
    s_mov_b32 s44, 1449984
    buffer_load_dword v105, v12, s[16:19], s44 offen
    s_mov_b32 s44, 1458176
    buffer_load_dword v106, v12, s[16:19], s44 offen
    s_mov_b32 s44, 1466368
    buffer_load_dword v107, v12, s[16:19], s44 offen
    s_mov_b32 s44, 1474560
    buffer_load_dword v108, v12, s[16:19], s44 offen
    s_mov_b32 s44, 1482752
    buffer_load_dword v109, v12, s[16:19], s44 offen
    s_mov_b32 s44, 1490944
    buffer_load_dword v110, v12, s[16:19], s44 offen
    s_mov_b32 s44, 1499136
    buffer_load_dword v111, v12, s[16:19], s44 offen
    s_waitcnt vmcnt(62)
    v_perm_b32 v112, v49, v48, v14
    v_perm_b32 v116, v49, v48, v15
    s_waitcnt vmcnt(60)
    v_perm_b32 v113, v51, v50, v14
    v_perm_b32 v117, v51, v50, v15
    s_waitcnt vmcnt(58)
    v_perm_b32 v114, v53, v52, v14
    v_perm_b32 v118, v53, v52, v15
    s_waitcnt vmcnt(56)
    v_perm_b32 v115, v55, v54, v14
    v_perm_b32 v119, v55, v54, v15
    v_accvgpr_write_b32 a32, v112
    v_accvgpr_write_b32 a33, v113
    v_accvgpr_write_b32 a34, v114
    v_accvgpr_write_b32 a35, v115
    v_accvgpr_write_b32 a36, v116
    v_accvgpr_write_b32 a37, v117
    v_accvgpr_write_b32 a38, v118
    v_accvgpr_write_b32 a39, v119
    s_waitcnt vmcnt(54)
    v_perm_b32 v128, v57, v56, v14
    v_perm_b32 v132, v57, v56, v15
    s_waitcnt vmcnt(52)
    v_perm_b32 v129, v59, v58, v14
    v_perm_b32 v133, v59, v58, v15
    s_waitcnt vmcnt(50)
    v_perm_b32 v130, v61, v60, v14
    v_perm_b32 v134, v61, v60, v15
    s_waitcnt vmcnt(48)
    v_perm_b32 v131, v63, v62, v14
    v_perm_b32 v135, v63, v62, v15
    v_accvgpr_write_b32 a40, v128
    v_accvgpr_write_b32 a41, v129
    v_accvgpr_write_b32 a42, v130
    v_accvgpr_write_b32 a43, v131
    v_accvgpr_write_b32 a44, v132
    v_accvgpr_write_b32 a45, v133
    v_accvgpr_write_b32 a46, v134
    v_accvgpr_write_b32 a47, v135
    s_waitcnt vmcnt(46)
    v_perm_b32 v112, v65, v64, v14
    v_perm_b32 v116, v65, v64, v15
    s_waitcnt vmcnt(44)
    v_perm_b32 v113, v67, v66, v14
    v_perm_b32 v117, v67, v66, v15
    s_waitcnt vmcnt(42)
    v_perm_b32 v114, v69, v68, v14
    v_perm_b32 v118, v69, v68, v15
    s_waitcnt vmcnt(40)
    v_perm_b32 v115, v71, v70, v14
    v_perm_b32 v119, v71, v70, v15
    v_accvgpr_write_b32 a48, v112
    v_accvgpr_write_b32 a49, v113
    v_accvgpr_write_b32 a50, v114
    v_accvgpr_write_b32 a51, v115
    v_accvgpr_write_b32 a52, v116
    v_accvgpr_write_b32 a53, v117
    v_accvgpr_write_b32 a54, v118
    v_accvgpr_write_b32 a55, v119
    s_waitcnt vmcnt(38)
    v_perm_b32 v128, v73, v72, v14
    v_perm_b32 v132, v73, v72, v15
    s_waitcnt vmcnt(36)
    v_perm_b32 v129, v75, v74, v14
    v_perm_b32 v133, v75, v74, v15
    s_waitcnt vmcnt(34)
    v_perm_b32 v130, v77, v76, v14
    v_perm_b32 v134, v77, v76, v15
    s_waitcnt vmcnt(32)
    v_perm_b32 v131, v79, v78, v14
    v_perm_b32 v135, v79, v78, v15
    v_accvgpr_write_b32 a56, v128
    v_accvgpr_write_b32 a57, v129
    v_accvgpr_write_b32 a58, v130
    v_accvgpr_write_b32 a59, v131
    v_accvgpr_write_b32 a60, v132
    v_accvgpr_write_b32 a61, v133
    v_accvgpr_write_b32 a62, v134
    v_accvgpr_write_b32 a63, v135
    s_mov_b32 s44, 1572864
    buffer_load_dword v16, v12, s[16:19], s44 offen
    s_mov_b32 s44, 1581056
    buffer_load_dword v17, v12, s[16:19], s44 offen
    s_mov_b32 s44, 1589248
    buffer_load_dword v18, v12, s[16:19], s44 offen
    s_mov_b32 s44, 1597440
    buffer_load_dword v19, v12, s[16:19], s44 offen
    s_mov_b32 s44, 1605632
    buffer_load_dword v20, v12, s[16:19], s44 offen
    s_mov_b32 s44, 1613824
    buffer_load_dword v21, v12, s[16:19], s44 offen
    s_mov_b32 s44, 1622016
    buffer_load_dword v22, v12, s[16:19], s44 offen
    s_mov_b32 s44, 1630208
    buffer_load_dword v23, v12, s[16:19], s44 offen
    s_mov_b32 s44, 1703936
    buffer_load_dword v24, v12, s[16:19], s44 offen
    s_mov_b32 s44, 1712128
    buffer_load_dword v25, v12, s[16:19], s44 offen
    s_mov_b32 s44, 1720320
    buffer_load_dword v26, v12, s[16:19], s44 offen
    s_mov_b32 s44, 1728512
    buffer_load_dword v27, v12, s[16:19], s44 offen
    s_mov_b32 s44, 1736704
    buffer_load_dword v28, v12, s[16:19], s44 offen
    s_mov_b32 s44, 1744896
    buffer_load_dword v29, v12, s[16:19], s44 offen
    s_mov_b32 s44, 1753088
    buffer_load_dword v30, v12, s[16:19], s44 offen
    s_mov_b32 s44, 1761280
    buffer_load_dword v31, v12, s[16:19], s44 offen
    s_mov_b32 s44, 1835008
    buffer_load_dword v32, v12, s[16:19], s44 offen
    s_mov_b32 s44, 1843200
    buffer_load_dword v33, v12, s[16:19], s44 offen
    s_mov_b32 s44, 1851392
    buffer_load_dword v34, v12, s[16:19], s44 offen
    s_mov_b32 s44, 1859584
    buffer_load_dword v35, v12, s[16:19], s44 offen
    s_mov_b32 s44, 1867776
    buffer_load_dword v36, v12, s[16:19], s44 offen
    s_mov_b32 s44, 1875968
    buffer_load_dword v37, v12, s[16:19], s44 offen
    s_mov_b32 s44, 1884160
    buffer_load_dword v38, v12, s[16:19], s44 offen
    s_mov_b32 s44, 1892352
    buffer_load_dword v39, v12, s[16:19], s44 offen
    s_mov_b32 s44, 1966080
    buffer_load_dword v40, v12, s[16:19], s44 offen
    s_mov_b32 s44, 1974272
    buffer_load_dword v41, v12, s[16:19], s44 offen
    s_mov_b32 s44, 1982464
    buffer_load_dword v42, v12, s[16:19], s44 offen
    s_mov_b32 s44, 1990656
    buffer_load_dword v43, v12, s[16:19], s44 offen
    s_mov_b32 s44, 1998848
    buffer_load_dword v44, v12, s[16:19], s44 offen
    s_mov_b32 s44, 2007040
    buffer_load_dword v45, v12, s[16:19], s44 offen
    s_mov_b32 s44, 2015232
    buffer_load_dword v46, v12, s[16:19], s44 offen
    s_mov_b32 s44, 2023424
    buffer_load_dword v47, v12, s[16:19], s44 offen
    s_waitcnt vmcnt(62)
    v_perm_b32 v112, v81, v80, v14
    v_perm_b32 v116, v81, v80, v15
    s_waitcnt vmcnt(60)
    v_perm_b32 v113, v83, v82, v14
    v_perm_b32 v117, v83, v82, v15
    s_waitcnt vmcnt(58)
    v_perm_b32 v114, v85, v84, v14
    v_perm_b32 v118, v85, v84, v15
    s_waitcnt vmcnt(56)
    v_perm_b32 v115, v87, v86, v14
    v_perm_b32 v119, v87, v86, v15
    v_accvgpr_write_b32 a64, v112
    v_accvgpr_write_b32 a65, v113
    v_accvgpr_write_b32 a66, v114
    v_accvgpr_write_b32 a67, v115
    v_accvgpr_write_b32 a68, v116
    v_accvgpr_write_b32 a69, v117
    v_accvgpr_write_b32 a70, v118
    v_accvgpr_write_b32 a71, v119
    s_waitcnt vmcnt(54)
    v_perm_b32 v128, v89, v88, v14
    v_perm_b32 v132, v89, v88, v15
    s_waitcnt vmcnt(52)
    v_perm_b32 v129, v91, v90, v14
    v_perm_b32 v133, v91, v90, v15
    s_waitcnt vmcnt(50)
    v_perm_b32 v130, v93, v92, v14
    v_perm_b32 v134, v93, v92, v15
    s_waitcnt vmcnt(48)
    v_perm_b32 v131, v95, v94, v14
    v_perm_b32 v135, v95, v94, v15
    v_accvgpr_write_b32 a72, v128
    v_accvgpr_write_b32 a73, v129
    v_accvgpr_write_b32 a74, v130
    v_accvgpr_write_b32 a75, v131
    v_accvgpr_write_b32 a76, v132
    v_accvgpr_write_b32 a77, v133
    v_accvgpr_write_b32 a78, v134
    v_accvgpr_write_b32 a79, v135
    s_waitcnt vmcnt(46)
    v_perm_b32 v112, v97, v96, v14
    v_perm_b32 v116, v97, v96, v15
    s_waitcnt vmcnt(44)
    v_perm_b32 v113, v99, v98, v14
    v_perm_b32 v117, v99, v98, v15
    s_waitcnt vmcnt(42)
    v_perm_b32 v114, v101, v100, v14
    v_perm_b32 v118, v101, v100, v15
    s_waitcnt vmcnt(40)
    v_perm_b32 v115, v103, v102, v14
    v_perm_b32 v119, v103, v102, v15
    v_accvgpr_write_b32 a80, v112
    v_accvgpr_write_b32 a81, v113
    v_accvgpr_write_b32 a82, v114
    v_accvgpr_write_b32 a83, v115
    v_accvgpr_write_b32 a84, v116
    v_accvgpr_write_b32 a85, v117
    v_accvgpr_write_b32 a86, v118
    v_accvgpr_write_b32 a87, v119
    s_waitcnt vmcnt(38)
    v_perm_b32 v128, v105, v104, v14
    v_perm_b32 v132, v105, v104, v15
    s_waitcnt vmcnt(36)
    v_perm_b32 v129, v107, v106, v14
    v_perm_b32 v133, v107, v106, v15
    s_waitcnt vmcnt(34)
    v_perm_b32 v130, v109, v108, v14
    v_perm_b32 v134, v109, v108, v15
    s_waitcnt vmcnt(32)
    v_perm_b32 v131, v111, v110, v14
    v_perm_b32 v135, v111, v110, v15
    v_accvgpr_write_b32 a88, v128
    v_accvgpr_write_b32 a89, v129
    v_accvgpr_write_b32 a90, v130
    v_accvgpr_write_b32 a91, v131
    v_accvgpr_write_b32 a92, v132
    v_accvgpr_write_b32 a93, v133
    v_accvgpr_write_b32 a94, v134
    v_accvgpr_write_b32 a95, v135
    s_mov_b32 s44, 2097152
    buffer_load_dword v48, v12, s[16:19], s44 offen
    s_mov_b32 s44, 2105344
    buffer_load_dword v49, v12, s[16:19], s44 offen
    s_mov_b32 s44, 2113536
    buffer_load_dword v50, v12, s[16:19], s44 offen
    s_mov_b32 s44, 2121728
    buffer_load_dword v51, v12, s[16:19], s44 offen
    s_mov_b32 s44, 2129920
    buffer_load_dword v52, v12, s[16:19], s44 offen
    s_mov_b32 s44, 2138112
    buffer_load_dword v53, v12, s[16:19], s44 offen
    s_mov_b32 s44, 2146304
    buffer_load_dword v54, v12, s[16:19], s44 offen
    s_mov_b32 s44, 2154496
    buffer_load_dword v55, v12, s[16:19], s44 offen
    s_mov_b32 s44, 2228224
    buffer_load_dword v56, v12, s[16:19], s44 offen
    s_mov_b32 s44, 2236416
    buffer_load_dword v57, v12, s[16:19], s44 offen
    s_mov_b32 s44, 2244608
    buffer_load_dword v58, v12, s[16:19], s44 offen
    s_mov_b32 s44, 2252800
    buffer_load_dword v59, v12, s[16:19], s44 offen
    s_mov_b32 s44, 2260992
    buffer_load_dword v60, v12, s[16:19], s44 offen
    s_mov_b32 s44, 2269184
    buffer_load_dword v61, v12, s[16:19], s44 offen
    s_mov_b32 s44, 2277376
    buffer_load_dword v62, v12, s[16:19], s44 offen
    s_mov_b32 s44, 2285568
    buffer_load_dword v63, v12, s[16:19], s44 offen
    s_mov_b32 s44, 2359296
    buffer_load_dword v64, v12, s[16:19], s44 offen
    s_mov_b32 s44, 2367488
    buffer_load_dword v65, v12, s[16:19], s44 offen
    s_mov_b32 s44, 2375680
    buffer_load_dword v66, v12, s[16:19], s44 offen
    s_mov_b32 s44, 2383872
    buffer_load_dword v67, v12, s[16:19], s44 offen
    s_mov_b32 s44, 2392064
    buffer_load_dword v68, v12, s[16:19], s44 offen
    s_mov_b32 s44, 2400256
    buffer_load_dword v69, v12, s[16:19], s44 offen
    s_mov_b32 s44, 2408448
    buffer_load_dword v70, v12, s[16:19], s44 offen
    s_mov_b32 s44, 2416640
    buffer_load_dword v71, v12, s[16:19], s44 offen
    s_mov_b32 s44, 2490368
    buffer_load_dword v72, v12, s[16:19], s44 offen
    s_mov_b32 s44, 2498560
    buffer_load_dword v73, v12, s[16:19], s44 offen
    s_mov_b32 s44, 2506752
    buffer_load_dword v74, v12, s[16:19], s44 offen
    s_mov_b32 s44, 2514944
    buffer_load_dword v75, v12, s[16:19], s44 offen
    s_mov_b32 s44, 2523136
    buffer_load_dword v76, v12, s[16:19], s44 offen
    s_mov_b32 s44, 2531328
    buffer_load_dword v77, v12, s[16:19], s44 offen
    s_mov_b32 s44, 2539520
    buffer_load_dword v78, v12, s[16:19], s44 offen
    s_mov_b32 s44, 2547712
    buffer_load_dword v79, v12, s[16:19], s44 offen
    s_waitcnt vmcnt(62)
    v_perm_b32 v112, v17, v16, v14
    v_perm_b32 v116, v17, v16, v15
    s_waitcnt vmcnt(60)
    v_perm_b32 v113, v19, v18, v14
    v_perm_b32 v117, v19, v18, v15
    s_waitcnt vmcnt(58)
    v_perm_b32 v114, v21, v20, v14
    v_perm_b32 v118, v21, v20, v15
    s_waitcnt vmcnt(56)
    v_perm_b32 v115, v23, v22, v14
    v_perm_b32 v119, v23, v22, v15
    v_accvgpr_write_b32 a96, v112
    v_accvgpr_write_b32 a97, v113
    v_accvgpr_write_b32 a98, v114
    v_accvgpr_write_b32 a99, v115
    v_accvgpr_write_b32 a100, v116
    v_accvgpr_write_b32 a101, v117
    v_accvgpr_write_b32 a102, v118
    v_accvgpr_write_b32 a103, v119
    s_waitcnt vmcnt(54)
    v_perm_b32 v128, v25, v24, v14
    v_perm_b32 v132, v25, v24, v15
    s_waitcnt vmcnt(52)
    v_perm_b32 v129, v27, v26, v14
    v_perm_b32 v133, v27, v26, v15
    s_waitcnt vmcnt(50)
    v_perm_b32 v130, v29, v28, v14
    v_perm_b32 v134, v29, v28, v15
    s_waitcnt vmcnt(48)
    v_perm_b32 v131, v31, v30, v14
    v_perm_b32 v135, v31, v30, v15
    v_accvgpr_write_b32 a104, v128
    v_accvgpr_write_b32 a105, v129
    v_accvgpr_write_b32 a106, v130
    v_accvgpr_write_b32 a107, v131
    v_accvgpr_write_b32 a108, v132
    v_accvgpr_write_b32 a109, v133
    v_accvgpr_write_b32 a110, v134
    v_accvgpr_write_b32 a111, v135
    s_waitcnt vmcnt(46)
    v_perm_b32 v112, v33, v32, v14
    v_perm_b32 v116, v33, v32, v15
    s_waitcnt vmcnt(44)
    v_perm_b32 v113, v35, v34, v14
    v_perm_b32 v117, v35, v34, v15
    s_waitcnt vmcnt(42)
    v_perm_b32 v114, v37, v36, v14
    v_perm_b32 v118, v37, v36, v15
    s_waitcnt vmcnt(40)
    v_perm_b32 v115, v39, v38, v14
    v_perm_b32 v119, v39, v38, v15
    v_accvgpr_write_b32 a112, v112
    v_accvgpr_write_b32 a113, v113
    v_accvgpr_write_b32 a114, v114
    v_accvgpr_write_b32 a115, v115
    v_accvgpr_write_b32 a116, v116
    v_accvgpr_write_b32 a117, v117
    v_accvgpr_write_b32 a118, v118
    v_accvgpr_write_b32 a119, v119
    s_waitcnt vmcnt(38)
    v_perm_b32 v128, v41, v40, v14
    v_perm_b32 v132, v41, v40, v15
    s_waitcnt vmcnt(36)
    v_perm_b32 v129, v43, v42, v14
    v_perm_b32 v133, v43, v42, v15
    s_waitcnt vmcnt(34)
    v_perm_b32 v130, v45, v44, v14
    v_perm_b32 v134, v45, v44, v15
    s_waitcnt vmcnt(32)
    v_perm_b32 v131, v47, v46, v14
    v_perm_b32 v135, v47, v46, v15
    v_accvgpr_write_b32 a120, v128
    v_accvgpr_write_b32 a121, v129
    v_accvgpr_write_b32 a122, v130
    v_accvgpr_write_b32 a123, v131
    v_accvgpr_write_b32 a124, v132
    v_accvgpr_write_b32 a125, v133
    v_accvgpr_write_b32 a126, v134
    v_accvgpr_write_b32 a127, v135
    s_mov_b32 s44, 2621440
    buffer_load_dword v80, v12, s[16:19], s44 offen
    s_mov_b32 s44, 2629632
    buffer_load_dword v81, v12, s[16:19], s44 offen
    s_mov_b32 s44, 2637824
    buffer_load_dword v82, v12, s[16:19], s44 offen
    s_mov_b32 s44, 2646016
    buffer_load_dword v83, v12, s[16:19], s44 offen
    s_mov_b32 s44, 2654208
    buffer_load_dword v84, v12, s[16:19], s44 offen
    s_mov_b32 s44, 2662400
    buffer_load_dword v85, v12, s[16:19], s44 offen
    s_mov_b32 s44, 2670592
    buffer_load_dword v86, v12, s[16:19], s44 offen
    s_mov_b32 s44, 2678784
    buffer_load_dword v87, v12, s[16:19], s44 offen
    s_mov_b32 s44, 2752512
    buffer_load_dword v88, v12, s[16:19], s44 offen
    s_mov_b32 s44, 2760704
    buffer_load_dword v89, v12, s[16:19], s44 offen
    s_mov_b32 s44, 2768896
    buffer_load_dword v90, v12, s[16:19], s44 offen
    s_mov_b32 s44, 2777088
    buffer_load_dword v91, v12, s[16:19], s44 offen
    s_mov_b32 s44, 2785280
    buffer_load_dword v92, v12, s[16:19], s44 offen
    s_mov_b32 s44, 2793472
    buffer_load_dword v93, v12, s[16:19], s44 offen
    s_mov_b32 s44, 2801664
    buffer_load_dword v94, v12, s[16:19], s44 offen
    s_mov_b32 s44, 2809856
    buffer_load_dword v95, v12, s[16:19], s44 offen
    s_mov_b32 s44, 2883584
    buffer_load_dword v96, v12, s[16:19], s44 offen
    s_mov_b32 s44, 2891776
    buffer_load_dword v97, v12, s[16:19], s44 offen
    s_mov_b32 s44, 2899968
    buffer_load_dword v98, v12, s[16:19], s44 offen
    s_mov_b32 s44, 2908160
    buffer_load_dword v99, v12, s[16:19], s44 offen
    s_mov_b32 s44, 2916352
    buffer_load_dword v100, v12, s[16:19], s44 offen
    s_mov_b32 s44, 2924544
    buffer_load_dword v101, v12, s[16:19], s44 offen
    s_mov_b32 s44, 2932736
    buffer_load_dword v102, v12, s[16:19], s44 offen
    s_mov_b32 s44, 2940928
    buffer_load_dword v103, v12, s[16:19], s44 offen
    s_mov_b32 s44, 3014656
    buffer_load_dword v104, v12, s[16:19], s44 offen
    s_mov_b32 s44, 3022848
    buffer_load_dword v105, v12, s[16:19], s44 offen
    s_mov_b32 s44, 3031040
    buffer_load_dword v106, v12, s[16:19], s44 offen
    s_mov_b32 s44, 3039232
    buffer_load_dword v107, v12, s[16:19], s44 offen
    s_mov_b32 s44, 3047424
    buffer_load_dword v108, v12, s[16:19], s44 offen
    s_mov_b32 s44, 3055616
    buffer_load_dword v109, v12, s[16:19], s44 offen
    s_mov_b32 s44, 3063808
    buffer_load_dword v110, v12, s[16:19], s44 offen
    s_mov_b32 s44, 3072000
    buffer_load_dword v111, v12, s[16:19], s44 offen
    s_waitcnt vmcnt(62)
    v_perm_b32 v112, v49, v48, v14
    v_perm_b32 v116, v49, v48, v15
    s_waitcnt vmcnt(60)
    v_perm_b32 v113, v51, v50, v14
    v_perm_b32 v117, v51, v50, v15
    s_waitcnt vmcnt(58)
    v_perm_b32 v114, v53, v52, v14
    v_perm_b32 v118, v53, v52, v15
    s_waitcnt vmcnt(56)
    v_perm_b32 v115, v55, v54, v14
    v_perm_b32 v119, v55, v54, v15
    v_accvgpr_write_b32 a128, v112
    v_accvgpr_write_b32 a129, v113
    v_accvgpr_write_b32 a130, v114
    v_accvgpr_write_b32 a131, v115
    v_accvgpr_write_b32 a132, v116
    v_accvgpr_write_b32 a133, v117
    v_accvgpr_write_b32 a134, v118
    v_accvgpr_write_b32 a135, v119
    s_waitcnt vmcnt(54)
    v_perm_b32 v128, v57, v56, v14
    v_perm_b32 v132, v57, v56, v15
    s_waitcnt vmcnt(52)
    v_perm_b32 v129, v59, v58, v14
    v_perm_b32 v133, v59, v58, v15
    s_waitcnt vmcnt(50)
    v_perm_b32 v130, v61, v60, v14
    v_perm_b32 v134, v61, v60, v15
    s_waitcnt vmcnt(48)
    v_perm_b32 v131, v63, v62, v14
    v_perm_b32 v135, v63, v62, v15
    v_accvgpr_write_b32 a136, v128
    v_accvgpr_write_b32 a137, v129
    v_accvgpr_write_b32 a138, v130
    v_accvgpr_write_b32 a139, v131
    v_accvgpr_write_b32 a140, v132
    v_accvgpr_write_b32 a141, v133
    v_accvgpr_write_b32 a142, v134
    v_accvgpr_write_b32 a143, v135
    s_waitcnt vmcnt(46)
    v_perm_b32 v112, v65, v64, v14
    v_perm_b32 v116, v65, v64, v15
    s_waitcnt vmcnt(44)
    v_perm_b32 v113, v67, v66, v14
    v_perm_b32 v117, v67, v66, v15
    s_waitcnt vmcnt(42)
    v_perm_b32 v114, v69, v68, v14
    v_perm_b32 v118, v69, v68, v15
    s_waitcnt vmcnt(40)
    v_perm_b32 v115, v71, v70, v14
    v_perm_b32 v119, v71, v70, v15
    v_accvgpr_write_b32 a144, v112
    v_accvgpr_write_b32 a145, v113
    v_accvgpr_write_b32 a146, v114
    v_accvgpr_write_b32 a147, v115
    v_accvgpr_write_b32 a148, v116
    v_accvgpr_write_b32 a149, v117
    v_accvgpr_write_b32 a150, v118
    v_accvgpr_write_b32 a151, v119
    s_waitcnt vmcnt(38)
    v_perm_b32 v128, v73, v72, v14
    v_perm_b32 v132, v73, v72, v15
    s_waitcnt vmcnt(36)
    v_perm_b32 v129, v75, v74, v14
    v_perm_b32 v133, v75, v74, v15
    s_waitcnt vmcnt(34)
    v_perm_b32 v130, v77, v76, v14
    v_perm_b32 v134, v77, v76, v15
    s_waitcnt vmcnt(32)
    v_perm_b32 v131, v79, v78, v14
    v_perm_b32 v135, v79, v78, v15
    v_accvgpr_write_b32 a152, v128
    v_accvgpr_write_b32 a153, v129
    v_accvgpr_write_b32 a154, v130
    v_accvgpr_write_b32 a155, v131
    v_accvgpr_write_b32 a156, v132
    v_accvgpr_write_b32 a157, v133
    v_accvgpr_write_b32 a158, v134
    v_accvgpr_write_b32 a159, v135
    s_mov_b32 s44, 3145728
    buffer_load_dword v16, v12, s[16:19], s44 offen
    s_mov_b32 s44, 3153920
    buffer_load_dword v17, v12, s[16:19], s44 offen
    s_mov_b32 s44, 3162112
    buffer_load_dword v18, v12, s[16:19], s44 offen
    s_mov_b32 s44, 3170304
    buffer_load_dword v19, v12, s[16:19], s44 offen
    s_mov_b32 s44, 3178496
    buffer_load_dword v20, v12, s[16:19], s44 offen
    s_mov_b32 s44, 3186688
    buffer_load_dword v21, v12, s[16:19], s44 offen
    s_mov_b32 s44, 3194880
    buffer_load_dword v22, v12, s[16:19], s44 offen
    s_mov_b32 s44, 3203072
    buffer_load_dword v23, v12, s[16:19], s44 offen
    s_mov_b32 s44, 3276800
    buffer_load_dword v24, v12, s[16:19], s44 offen
    s_mov_b32 s44, 3284992
    buffer_load_dword v25, v12, s[16:19], s44 offen
    s_mov_b32 s44, 3293184
    buffer_load_dword v26, v12, s[16:19], s44 offen
    s_mov_b32 s44, 3301376
    buffer_load_dword v27, v12, s[16:19], s44 offen
    s_mov_b32 s44, 3309568
    buffer_load_dword v28, v12, s[16:19], s44 offen
    s_mov_b32 s44, 3317760
    buffer_load_dword v29, v12, s[16:19], s44 offen
    s_mov_b32 s44, 3325952
    buffer_load_dword v30, v12, s[16:19], s44 offen
    s_mov_b32 s44, 3334144
    buffer_load_dword v31, v12, s[16:19], s44 offen
    s_mov_b32 s44, 3407872
    buffer_load_dword v32, v12, s[16:19], s44 offen
    s_mov_b32 s44, 3416064
    buffer_load_dword v33, v12, s[16:19], s44 offen
    s_mov_b32 s44, 3424256
    buffer_load_dword v34, v12, s[16:19], s44 offen
    s_mov_b32 s44, 3432448
    buffer_load_dword v35, v12, s[16:19], s44 offen
    s_mov_b32 s44, 3440640
    buffer_load_dword v36, v12, s[16:19], s44 offen
    s_mov_b32 s44, 3448832
    buffer_load_dword v37, v12, s[16:19], s44 offen
    s_mov_b32 s44, 3457024
    buffer_load_dword v38, v12, s[16:19], s44 offen
    s_mov_b32 s44, 3465216
    buffer_load_dword v39, v12, s[16:19], s44 offen
    s_mov_b32 s44, 3538944
    buffer_load_dword v40, v12, s[16:19], s44 offen
    s_mov_b32 s44, 3547136
    buffer_load_dword v41, v12, s[16:19], s44 offen
    s_mov_b32 s44, 3555328
    buffer_load_dword v42, v12, s[16:19], s44 offen
    s_mov_b32 s44, 3563520
    buffer_load_dword v43, v12, s[16:19], s44 offen
    s_mov_b32 s44, 3571712
    buffer_load_dword v44, v12, s[16:19], s44 offen
    s_mov_b32 s44, 3579904
    buffer_load_dword v45, v12, s[16:19], s44 offen
    s_mov_b32 s44, 3588096
    buffer_load_dword v46, v12, s[16:19], s44 offen
    s_mov_b32 s44, 3596288
    buffer_load_dword v47, v12, s[16:19], s44 offen
    s_waitcnt vmcnt(62)
    v_perm_b32 v112, v81, v80, v14
    v_perm_b32 v116, v81, v80, v15
    s_waitcnt vmcnt(60)
    v_perm_b32 v113, v83, v82, v14
    v_perm_b32 v117, v83, v82, v15
    s_waitcnt vmcnt(58)
    v_perm_b32 v114, v85, v84, v14
    v_perm_b32 v118, v85, v84, v15
    s_waitcnt vmcnt(56)
    v_perm_b32 v115, v87, v86, v14
    v_perm_b32 v119, v87, v86, v15
    v_accvgpr_write_b32 a160, v112
    v_accvgpr_write_b32 a161, v113
    v_accvgpr_write_b32 a162, v114
    v_accvgpr_write_b32 a163, v115
    v_accvgpr_write_b32 a164, v116
    v_accvgpr_write_b32 a165, v117
    v_accvgpr_write_b32 a166, v118
    v_accvgpr_write_b32 a167, v119
    s_waitcnt vmcnt(54)
    v_perm_b32 v128, v89, v88, v14
    v_perm_b32 v132, v89, v88, v15
    s_waitcnt vmcnt(52)
    v_perm_b32 v129, v91, v90, v14
    v_perm_b32 v133, v91, v90, v15
    s_waitcnt vmcnt(50)
    v_perm_b32 v130, v93, v92, v14
    v_perm_b32 v134, v93, v92, v15
    s_waitcnt vmcnt(48)
    v_perm_b32 v131, v95, v94, v14
    v_perm_b32 v135, v95, v94, v15
    v_accvgpr_write_b32 a168, v128
    v_accvgpr_write_b32 a169, v129
    v_accvgpr_write_b32 a170, v130
    v_accvgpr_write_b32 a171, v131
    v_accvgpr_write_b32 a172, v132
    v_accvgpr_write_b32 a173, v133
    v_accvgpr_write_b32 a174, v134
    v_accvgpr_write_b32 a175, v135
    s_waitcnt vmcnt(46)
    v_perm_b32 v112, v97, v96, v14
    v_perm_b32 v116, v97, v96, v15
    s_waitcnt vmcnt(44)
    v_perm_b32 v113, v99, v98, v14
    v_perm_b32 v117, v99, v98, v15
    s_waitcnt vmcnt(42)
    v_perm_b32 v114, v101, v100, v14
    v_perm_b32 v118, v101, v100, v15
    s_waitcnt vmcnt(40)
    v_perm_b32 v115, v103, v102, v14
    v_perm_b32 v119, v103, v102, v15
    v_accvgpr_write_b32 a176, v112
    v_accvgpr_write_b32 a177, v113
    v_accvgpr_write_b32 a178, v114
    v_accvgpr_write_b32 a179, v115
    v_accvgpr_write_b32 a180, v116
    v_accvgpr_write_b32 a181, v117
    v_accvgpr_write_b32 a182, v118
    v_accvgpr_write_b32 a183, v119
    s_waitcnt vmcnt(38)
    v_perm_b32 v128, v105, v104, v14
    v_perm_b32 v132, v105, v104, v15
    s_waitcnt vmcnt(36)
    v_perm_b32 v129, v107, v106, v14
    v_perm_b32 v133, v107, v106, v15
    s_waitcnt vmcnt(34)
    v_perm_b32 v130, v109, v108, v14
    v_perm_b32 v134, v109, v108, v15
    s_waitcnt vmcnt(32)
    v_perm_b32 v131, v111, v110, v14
    v_perm_b32 v135, v111, v110, v15
    v_accvgpr_write_b32 a184, v128
    v_accvgpr_write_b32 a185, v129
    v_accvgpr_write_b32 a186, v130
    v_accvgpr_write_b32 a187, v131
    v_accvgpr_write_b32 a188, v132
    v_accvgpr_write_b32 a189, v133
    v_accvgpr_write_b32 a190, v134
    v_accvgpr_write_b32 a191, v135
    s_mov_b32 s44, 3670016
    buffer_load_dword v48, v12, s[16:19], s44 offen
    s_mov_b32 s44, 3678208
    buffer_load_dword v49, v12, s[16:19], s44 offen
    s_mov_b32 s44, 3686400
    buffer_load_dword v50, v12, s[16:19], s44 offen
    s_mov_b32 s44, 3694592
    buffer_load_dword v51, v12, s[16:19], s44 offen
    s_mov_b32 s44, 3702784
    buffer_load_dword v52, v12, s[16:19], s44 offen
    s_mov_b32 s44, 3710976
    buffer_load_dword v53, v12, s[16:19], s44 offen
    s_mov_b32 s44, 3719168
    buffer_load_dword v54, v12, s[16:19], s44 offen
    s_mov_b32 s44, 3727360
    buffer_load_dword v55, v12, s[16:19], s44 offen
    s_mov_b32 s44, 3801088
    buffer_load_dword v56, v12, s[16:19], s44 offen
    s_mov_b32 s44, 3809280
    buffer_load_dword v57, v12, s[16:19], s44 offen
    s_mov_b32 s44, 3817472
    buffer_load_dword v58, v12, s[16:19], s44 offen
    s_mov_b32 s44, 3825664
    buffer_load_dword v59, v12, s[16:19], s44 offen
    s_mov_b32 s44, 3833856
    buffer_load_dword v60, v12, s[16:19], s44 offen
    s_mov_b32 s44, 3842048
    buffer_load_dword v61, v12, s[16:19], s44 offen
    s_mov_b32 s44, 3850240
    buffer_load_dword v62, v12, s[16:19], s44 offen
    s_mov_b32 s44, 3858432
    buffer_load_dword v63, v12, s[16:19], s44 offen
    s_mov_b32 s44, 3932160
    buffer_load_dword v64, v12, s[16:19], s44 offen
    s_mov_b32 s44, 3940352
    buffer_load_dword v65, v12, s[16:19], s44 offen
    s_mov_b32 s44, 3948544
    buffer_load_dword v66, v12, s[16:19], s44 offen
    s_mov_b32 s44, 3956736
    buffer_load_dword v67, v12, s[16:19], s44 offen
    s_mov_b32 s44, 3964928
    buffer_load_dword v68, v12, s[16:19], s44 offen
    s_mov_b32 s44, 3973120
    buffer_load_dword v69, v12, s[16:19], s44 offen
    s_mov_b32 s44, 3981312
    buffer_load_dword v70, v12, s[16:19], s44 offen
    s_mov_b32 s44, 3989504
    buffer_load_dword v71, v12, s[16:19], s44 offen
    s_mov_b32 s44, 4063232
    buffer_load_dword v72, v12, s[16:19], s44 offen
    s_mov_b32 s44, 4071424
    buffer_load_dword v73, v12, s[16:19], s44 offen
    s_mov_b32 s44, 4079616
    buffer_load_dword v74, v12, s[16:19], s44 offen
    s_mov_b32 s44, 4087808
    buffer_load_dword v75, v12, s[16:19], s44 offen
    s_mov_b32 s44, 4096000
    buffer_load_dword v76, v12, s[16:19], s44 offen
    s_mov_b32 s44, 4104192
    buffer_load_dword v77, v12, s[16:19], s44 offen
    s_mov_b32 s44, 4112384
    buffer_load_dword v78, v12, s[16:19], s44 offen
    s_mov_b32 s44, 4120576
    buffer_load_dword v79, v12, s[16:19], s44 offen
    s_waitcnt vmcnt(62)
    v_perm_b32 v112, v17, v16, v14
    v_perm_b32 v116, v17, v16, v15
    s_waitcnt vmcnt(60)
    v_perm_b32 v113, v19, v18, v14
    v_perm_b32 v117, v19, v18, v15
    s_waitcnt vmcnt(58)
    v_perm_b32 v114, v21, v20, v14
    v_perm_b32 v118, v21, v20, v15
    s_waitcnt vmcnt(56)
    v_perm_b32 v115, v23, v22, v14
    v_perm_b32 v119, v23, v22, v15
    v_accvgpr_write_b32 a192, v112
    v_accvgpr_write_b32 a193, v113
    v_accvgpr_write_b32 a194, v114
    v_accvgpr_write_b32 a195, v115
    v_accvgpr_write_b32 a196, v116
    v_accvgpr_write_b32 a197, v117
    v_accvgpr_write_b32 a198, v118
    v_accvgpr_write_b32 a199, v119
    s_waitcnt vmcnt(54)
    v_perm_b32 v128, v25, v24, v14
    v_perm_b32 v132, v25, v24, v15
    s_waitcnt vmcnt(52)
    v_perm_b32 v129, v27, v26, v14
    v_perm_b32 v133, v27, v26, v15
    s_waitcnt vmcnt(50)
    v_perm_b32 v130, v29, v28, v14
    v_perm_b32 v134, v29, v28, v15
    s_waitcnt vmcnt(48)
    v_perm_b32 v131, v31, v30, v14
    v_perm_b32 v135, v31, v30, v15
    v_accvgpr_write_b32 a200, v128
    v_accvgpr_write_b32 a201, v129
    v_accvgpr_write_b32 a202, v130
    v_accvgpr_write_b32 a203, v131
    v_accvgpr_write_b32 a204, v132
    v_accvgpr_write_b32 a205, v133
    v_accvgpr_write_b32 a206, v134
    v_accvgpr_write_b32 a207, v135
    s_waitcnt vmcnt(46)
    v_perm_b32 v112, v33, v32, v14
    v_perm_b32 v116, v33, v32, v15
    s_waitcnt vmcnt(44)
    v_perm_b32 v113, v35, v34, v14
    v_perm_b32 v117, v35, v34, v15
    s_waitcnt vmcnt(42)
    v_perm_b32 v114, v37, v36, v14
    v_perm_b32 v118, v37, v36, v15
    s_waitcnt vmcnt(40)
    v_perm_b32 v115, v39, v38, v14
    v_perm_b32 v119, v39, v38, v15
    v_accvgpr_write_b32 a208, v112
    v_accvgpr_write_b32 a209, v113
    v_accvgpr_write_b32 a210, v114
    v_accvgpr_write_b32 a211, v115
    v_accvgpr_write_b32 a212, v116
    v_accvgpr_write_b32 a213, v117
    v_accvgpr_write_b32 a214, v118
    v_accvgpr_write_b32 a215, v119
    s_waitcnt vmcnt(38)
    v_perm_b32 v128, v41, v40, v14
    v_perm_b32 v132, v41, v40, v15
    s_waitcnt vmcnt(36)
    v_perm_b32 v129, v43, v42, v14
    v_perm_b32 v133, v43, v42, v15
    s_waitcnt vmcnt(34)
    v_perm_b32 v130, v45, v44, v14
    v_perm_b32 v134, v45, v44, v15
    s_waitcnt vmcnt(32)
    v_perm_b32 v131, v47, v46, v14
    v_perm_b32 v135, v47, v46, v15
    v_accvgpr_write_b32 a216, v128
    v_accvgpr_write_b32 a217, v129
    v_accvgpr_write_b32 a218, v130
    v_accvgpr_write_b32 a219, v131
    v_accvgpr_write_b32 a220, v132
    v_accvgpr_write_b32 a221, v133
    v_accvgpr_write_b32 a222, v134
    v_accvgpr_write_b32 a223, v135
    s_waitcnt vmcnt(30)
    v_perm_b32 v112, v49, v48, v14
    v_perm_b32 v116, v49, v48, v15
    s_waitcnt vmcnt(28)
    v_perm_b32 v113, v51, v50, v14
    v_perm_b32 v117, v51, v50, v15
    s_waitcnt vmcnt(26)
    v_perm_b32 v114, v53, v52, v14
    v_perm_b32 v118, v53, v52, v15
    s_waitcnt vmcnt(24)
    v_perm_b32 v115, v55, v54, v14
    v_perm_b32 v119, v55, v54, v15
    v_accvgpr_write_b32 a224, v112
    v_accvgpr_write_b32 a225, v113
    v_accvgpr_write_b32 a226, v114
    v_accvgpr_write_b32 a227, v115
    v_accvgpr_write_b32 a228, v116
    v_accvgpr_write_b32 a229, v117
    v_accvgpr_write_b32 a230, v118
    v_accvgpr_write_b32 a231, v119
    s_waitcnt vmcnt(22)
    v_perm_b32 v128, v57, v56, v14
    v_perm_b32 v132, v57, v56, v15
    s_waitcnt vmcnt(20)
    v_perm_b32 v129, v59, v58, v14
    v_perm_b32 v133, v59, v58, v15
    s_waitcnt vmcnt(18)
    v_perm_b32 v130, v61, v60, v14
    v_perm_b32 v134, v61, v60, v15
    s_waitcnt vmcnt(16)
    v_perm_b32 v131, v63, v62, v14
    v_perm_b32 v135, v63, v62, v15
    v_accvgpr_write_b32 a232, v128
    v_accvgpr_write_b32 a233, v129
    v_accvgpr_write_b32 a234, v130
    v_accvgpr_write_b32 a235, v131
    v_accvgpr_write_b32 a236, v132
    v_accvgpr_write_b32 a237, v133
    v_accvgpr_write_b32 a238, v134
    v_accvgpr_write_b32 a239, v135
    s_waitcnt vmcnt(14)
    v_perm_b32 v112, v65, v64, v14
    v_perm_b32 v116, v65, v64, v15
    s_waitcnt vmcnt(12)
    v_perm_b32 v113, v67, v66, v14
    v_perm_b32 v117, v67, v66, v15
    s_waitcnt vmcnt(10)
    v_perm_b32 v114, v69, v68, v14
    v_perm_b32 v118, v69, v68, v15
    s_waitcnt vmcnt(8)
    v_perm_b32 v115, v71, v70, v14
    v_perm_b32 v119, v71, v70, v15
    v_accvgpr_write_b32 a240, v112
    v_accvgpr_write_b32 a241, v113
    v_accvgpr_write_b32 a242, v114
    v_accvgpr_write_b32 a243, v115
    v_accvgpr_write_b32 a244, v116
    v_accvgpr_write_b32 a245, v117
    v_accvgpr_write_b32 a246, v118
    v_accvgpr_write_b32 a247, v119
    s_waitcnt vmcnt(6)
    v_perm_b32 v128, v73, v72, v14
    v_perm_b32 v132, v73, v72, v15
    s_waitcnt vmcnt(4)
    v_perm_b32 v129, v75, v74, v14
    v_perm_b32 v133, v75, v74, v15
    s_waitcnt vmcnt(2)
    v_perm_b32 v130, v77, v76, v14
    v_perm_b32 v134, v77, v76, v15
    s_waitcnt vmcnt(0)
    v_perm_b32 v131, v79, v78, v14
    v_perm_b32 v135, v79, v78, v15
    v_accvgpr_write_b32 a248, v128
    v_accvgpr_write_b32 a249, v129
    v_accvgpr_write_b32 a250, v130
    v_accvgpr_write_b32 a251, v131
    v_accvgpr_write_b32 a252, v132
    v_accvgpr_write_b32 a253, v133
    v_accvgpr_write_b32 a254, v134
    v_accvgpr_write_b32 a255, v135
L_proj_we:
    s_mov_b32 s46, s32
    s_mov_b32 s47, s33
    s_mov_b32 s48, s35
    s_mov_b32 s49, s36
    s_cmp_ge_i32 s63, 0
    s_cbranch_scc1 Lanns_10038
    v_and_b32 v16, 63, v0
    v_lshlrev_b32 v16, 2, v16
Lann_10036:
    buffer_load_dword v17, v16, s[12:15], 0 offen sc1
Lannc_10039:
    s_waitcnt vmcnt(0)
    v_and_b32 v19, 0x0f0f0f0f, v17
    v_subrev_u32 v18, 0x01010101, v19
    v_and_b32 v18, 0x80808080, v18
    v_cmp_ne_u32 vcc, 0, v18
    s_nop 0
    s_cbranch_vccz Lannd_10037
    s_sub_u32 s62, s62, 1
    s_cbranch_scc0 Ltok_10040
    s_movk_i32 s61, 1
    s_branch L_abort
Ltok_10040:
    s_sleep 4
    s_branch Lann_10036
Lannd_10037:
    s_getreg_b32 s32, hwreg(HW_REG_XCC_ID)
    s_and_b32 s32, s32, 15
    s_min_u32 s32, s32, 14
    s_add_u32 s32, s32, 1
    s_mul_i32 s32, s32, 0x11111111
    v_cmp_ne_u32 vcc, s32, v17
    s_not_b32 s33, s63
    s_lshl_b32 s33, s33, 3
    s_lshr_b64 s[34:35], vcc, s33
    s_and_b32 s34, s34, 0xff
    s_cmp_lg_u32 s34, 0
    s_cselect_b32 s63, 1, 0
Lanns_10038:
    s_cmp_eq_u32 s4, 4
    s_cbranch_scc1 L_proj_nr
    v_lshlrev_b32 v19, 4, v0
    v_mov_b32 v20, -1
    v_mov_b32 v21, -1
    v_mov_b32 v22, -1
    v_mov_b32 v23, -1
    s_lshl_b32 s33, s5, 13
    s_add_u32 s32, s33, 117440512
    s_lshl_b32 s33, s6, 24
    s_add_u32 s32, s32, s33
    buffer_store_dwordx4 v[20:23], v19, s[8:11], s32 offen sc1
    s_add_u32 s32, s32, 4096
    buffer_store_dwordx4 v[20:23], v19, s[8:11], s32 offen sc1
    s_add_u32 s32, s32, 258048
    buffer_store_dwordx4 v[20:23], v19, s[8:11], s32 offen sc1
    s_add_u32 s32, s32, 4096
    buffer_store_dwordx4 v[20:23], v19, s[8:11], s32 offen sc1
    s_add_u32 s32, s32, 258048
    buffer_store_dwordx4 v[20:23], v19, s[8:11], s32 offen sc1
    s_add_u32 s32, s32, 4096
    buffer_store_dwordx4 v[20:23], v19, s[8:11], s32 offen sc1
    s_add_u32 s32, s32, 258048
    buffer_store_dwordx4 v[20:23], v19, s[8:11], s32 offen sc1
    s_add_u32 s32, s32, 4096
    buffer_store_dwordx4 v[20:23], v19, s[8:11], s32 offen sc1
    s_add_u32 s32, s32, 258048
    buffer_store_dwordx4 v[20:23], v19, s[8:11], s32 offen sc1
    s_add_u32 s32, s32, 4096
    buffer_store_dwordx4 v[20:23], v19, s[8:11], s32 offen sc1
    s_add_u32 s32, s32, 258048
    buffer_store_dwordx4 v[20:23], v19, s[8:11], s32 offen sc1
    s_add_u32 s32, s32, 4096
    buffer_store_dwordx4 v[20:23], v19, s[8:11], s32 offen sc1
    s_add_u32 s32, s32, 258048
    buffer_store_dwordx4 v[20:23], v19, s[8:11], s32 offen sc1
    s_add_u32 s32, s32, 4096
    buffer_store_dwordx4 v[20:23], v19, s[8:11], s32 offen sc1
    s_add_u32 s32, s32, 258048
    buffer_store_dwordx4 v[20:23], v19, s[8:11], s32 offen sc1
    s_add_u32 s32, s32, 4096
    buffer_store_dwordx4 v[20:23], v19, s[8:11], s32 offen sc1
    s_add_u32 s32, s32, 14938112
    v_and_b32 v24, 7, v0
    v_lshlrev_b32 v24, 13, v24
    v_bfe_u32 v25, v0, 3, 1
    v_lshl_add_u32 v24, v25, 4, v24
    s_lshl_b32 s33, s5, 8
    s_add_u32 s32, s33, 4194304
    s_lshl_b32 s33, s6, 19
    s_add_u32 s32, s32, s33
    s_cmp_eq_u32 s3, 0
    s_cselect_b32 s33, 0x7fff, 0
    s_waitcnt vmcnt(0)
    s_barrier
    s_mov_b32 exec_hi, 0
    s_mov_b32 exec_lo, s33
    buffer_store_dword v20, v24, s[8:11], s32 offen offset:64 sc1
    s_mov_b64 exec, -1
L_proj_nr:
    s_mov_b32 s32, s46
    s_mov_b32 s33, s47
    s_mov_b32 s35, s48
    s_mov_b32 s36, s49
    s_lshl_b32 s44, s6, 24
    s_lshl_b32 s45, s32, 13
    s_add_u32 s44, s44, s45
    s_add_u32 s35, s35, s44
    s_lshl_b32 s44, s6, 19
    s_lshl_b32 s45, s32, 8
    s_add_u32 s44, s44, s45
    s_add_u32 s36, s36, s44
    s_add_u32 s50, s36, 4194304
    s_lshl_b32 s44, s2, 7
    s_lshl_b32 s45, s3, 5
    s_add_u32 s44, s44, s45
    s_add_u32 s36, s44, 5640192
    s_lshl_b32 s44, s6, 17
    s_add_u32 s37, s44, 5242880
    s_lshl_b32 s44, s6, 21
    s_add_u32 s38, s44, 155189248
    s_add_u32 s51, s44, 150994944
    s_mov_b32 s40, 0
    s_mov_b32 s54, 0
    s_mov_b32 s55, -1
    s_lshl_b32 s39, s3, 13
    s_mov_b32 s34, 0
    v_and_b32 v9, 63, v0
    v_lshlrev_b32 v1, 4, v9
    v_add_u32 v2, s39, v1
    v_and_b32 v10, 15, v9
    v_lshlrev_b32 v10, 5, v10
    s_lshl_b32 s44, s3, 9
    v_add_u32 v4, s44, v10
    v_mov_b32 v5, 0
    v_mov_b32 v6, -1
    v_and_b32 v10, 15, v9
    v_lshlrev_b32 v10, 4, v10
    v_lshrrev_b32 v11, 5, v9
    v_lshlrev_b32 v11, 8, v11
    v_add_u32 v10, v10, v11
    v_bfe_u32 v11, v9, 4, 1
    s_add_u32 s44, s33, 10
    v_lshlrev_b32 v11, s44, v11
    v_add_u32 v10, v10, v11
    s_and_b32 s44, s3, 1
    s_lshl_b32 s44, s44, 12
    v_add_u32 v3, s44, v10
    v_and_b32 v20, 63, v0
    s_lshl_b32 s44, s3, 10
    v_add_u32 v8, s44, v1
    s_add_u32 s52, s44, 65536
    v_lshlrev_b32 v21, 3, v20
    v_add_u32 v9, 65536, v21
    s_lshl_b32 s44, s3, 8
    s_add_u32 s44, s44, 73728
    v_lshlrev_b32 v21, 2, v20
    v_add_u32 v10, s44, v21
    v_lshrrev_b32 v21, 5, v20
    v_lshlrev_b32 v21, 4, v21
    v_add_u32 v11, s44, v21
    v_mov_b32 v128, 0x3f803f80
    v_mov_b32 v129, 0x3f803f80
    v_mov_b32 v130, 0x3f803f80
    v_mov_b32 v131, 0x3f803f80
    s_cmp_lg_u32 s33, 0
    s_cbranch_scc1 L_proj_sv
    v_mfma_f32_32x32x16_bf16 v[64:79], a[0:3], v[128:131], 0
    v_mfma_f32_32x32x16_bf16 v[80:95], a[4:7], v[128:131], 0
    v_mfma_f32_32x32x16_bf16 v[64:79], a[8:11], v[128:131], v[64:79]
    v_mfma_f32_32x32x16_bf16 v[80:95], a[12:15], v[128:131], v[80:95]
    v_mfma_f32_32x32x16_bf16 v[64:79], a[16:19], v[128:131], v[64:79]
    v_mfma_f32_32x32x16_bf16 v[80:95], a[20:23], v[128:131], v[80:95]
    v_mfma_f32_32x32x16_bf16 v[64:79], a[24:27], v[128:131], v[64:79]
    v_mfma_f32_32x32x16_bf16 v[80:95], a[28:31], v[128:131], v[80:95]
    v_mfma_f32_32x32x16_bf16 v[64:79], a[32:35], v[128:131], v[64:79]
    v_mfma_f32_32x32x16_bf16 v[80:95], a[36:39], v[128:131], v[80:95]
    v_mfma_f32_32x32x16_bf16 v[64:79], a[40:43], v[128:131], v[64:79]
    v_mfma_f32_32x32x16_bf16 v[80:95], a[44:47], v[128:131], v[80:95]
    v_mfma_f32_32x32x16_bf16 v[64:79], a[48:51], v[128:131], v[64:79]
    v_mfma_f32_32x32x16_bf16 v[80:95], a[52:55], v[128:131], v[80:95]
    v_mfma_f32_32x32x16_bf16 v[64:79], a[56:59], v[128:131], v[64:79]
    v_mfma_f32_32x32x16_bf16 v[80:95], a[60:63], v[128:131], v[80:95]
    v_mfma_f32_32x32x16_bf16 v[64:79], a[64:67], v[128:131], v[64:79]
    v_mfma_f32_32x32x16_bf16 v[80:95], a[68:71], v[128:131], v[80:95]
    v_mfma_f32_32x32x16_bf16 v[64:79], a[72:75], v[128:131], v[64:79]
    v_mfma_f32_32x32x16_bf16 v[80:95], a[76:79], v[128:131], v[80:95]
    v_mfma_f32_32x32x16_bf16 v[64:79], a[80:83], v[128:131], v[64:79]
    v_mfma_f32_32x32x16_bf16 v[80:95], a[84:87], v[128:131], v[80:95]
    v_mfma_f32_32x32x16_bf16 v[64:79], a[88:91], v[128:131], v[64:79]
    v_mfma_f32_32x32x16_bf16 v[80:95], a[92:95], v[128:131], v[80:95]
    v_mfma_f32_32x32x16_bf16 v[64:79], a[96:99], v[128:131], v[64:79]
    v_mfma_f32_32x32x16_bf16 v[80:95], a[100:103], v[128:131], v[80:95]
    v_mfma_f32_32x32x16_bf16 v[64:79], a[104:107], v[128:131], v[64:79]
    v_mfma_f32_32x32x16_bf16 v[80:95], a[108:111], v[128:131], v[80:95]
    v_mfma_f32_32x32x16_bf16 v[64:79], a[112:115], v[128:131], v[64:79]
    v_mfma_f32_32x32x16_bf16 v[80:95], a[116:119], v[128:131], v[80:95]
    v_mfma_f32_32x32x16_bf16 v[64:79], a[120:123], v[128:131], v[64:79]
    v_mfma_f32_32x32x16_bf16 v[80:95], a[124:127], v[128:131], v[80:95]
    v_mfma_f32_32x32x16_bf16 v[64:79], a[128:131], v[128:131], v[64:79]
    v_mfma_f32_32x32x16_bf16 v[80:95], a[132:135], v[128:131], v[80:95]
    v_mfma_f32_32x32x16_bf16 v[64:79], a[136:139], v[128:131], v[64:79]
    v_mfma_f32_32x32x16_bf16 v[80:95], a[140:143], v[128:131], v[80:95]
    v_mfma_f32_32x32x16_bf16 v[64:79], a[144:147], v[128:131], v[64:79]
    v_mfma_f32_32x32x16_bf16 v[80:95], a[148:151], v[128:131], v[80:95]
    v_mfma_f32_32x32x16_bf16 v[64:79], a[152:155], v[128:131], v[64:79]
    v_mfma_f32_32x32x16_bf16 v[80:95], a[156:159], v[128:131], v[80:95]
    v_mfma_f32_32x32x16_bf16 v[64:79], a[160:163], v[128:131], v[64:79]
    v_mfma_f32_32x32x16_bf16 v[80:95], a[164:167], v[128:131], v[80:95]
    v_mfma_f32_32x32x16_bf16 v[64:79], a[168:171], v[128:131], v[64:79]
    v_mfma_f32_32x32x16_bf16 v[80:95], a[172:175], v[128:131], v[80:95]
    v_mfma_f32_32x32x16_bf16 v[64:79], a[176:179], v[128:131], v[64:79]
    v_mfma_f32_32x32x16_bf16 v[80:95], a[180:183], v[128:131], v[80:95]
    v_mfma_f32_32x32x16_bf16 v[64:79], a[184:187], v[128:131], v[64:79]
    v_mfma_f32_32x32x16_bf16 v[80:95], a[188:191], v[128:131], v[80:95]
    v_mfma_f32_32x32x16_bf16 v[64:79], a[192:195], v[128:131], v[64:79]
    v_mfma_f32_32x32x16_bf16 v[80:95], a[196:199], v[128:131], v[80:95]
    v_mfma_f32_32x32x16_bf16 v[64:79], a[200:203], v[128:131], v[64:79]
    v_mfma_f32_32x32x16_bf16 v[80:95], a[204:207], v[128:131], v[80:95]
    v_mfma_f32_32x32x16_bf16 v[64:79], a[208:211], v[128:131], v[64:79]
    v_mfma_f32_32x32x16_bf16 v[80:95], a[212:215], v[128:131], v[80:95]
    v_mfma_f32_32x32x16_bf16 v[64:79], a[216:219], v[128:131], v[64:79]
    v_mfma_f32_32x32x16_bf16 v[80:95], a[220:223], v[128:131], v[80:95]
    v_mfma_f32_32x32x16_bf16 v[64:79], a[224:227], v[128:131], v[64:79]
    v_mfma_f32_32x32x16_bf16 v[80:95], a[228:231], v[128:131], v[80:95]
    v_mfma_f32_32x32x16_bf16 v[64:79], a[232:235], v[128:131], v[64:79]
    v_mfma_f32_32x32x16_bf16 v[80:95], a[236:239], v[128:131], v[80:95]
    v_mfma_f32_32x32x16_bf16 v[64:79], a[240:243], v[128:131], v[64:79]
    v_mfma_f32_32x32x16_bf16 v[80:95], a[244:247], v[128:131], v[80:95]
    v_mfma_f32_32x32x16_bf16 v[64:79], a[248:251], v[128:131], v[64:79]
    v_mfma_f32_32x32x16_bf16 v[80:95], a[252:255], v[128:131], v[80:95]
    s_branch L_proj_in_k
L_proj_sv:
    v_mfma_f32_32x32x16_bf16 v[64:79], v[128:131], a[0:3], 0
    v_mfma_f32_32x32x16_bf16 v[80:95], v[128:131], a[4:7], 0
    v_mfma_f32_32x32x16_bf16 v[64:79], v[128:131], a[8:11], v[64:79]
    v_mfma_f32_32x32x16_bf16 v[80:95], v[128:131], a[12:15], v[80:95]
    v_mfma_f32_32x32x16_bf16 v[64:79], v[128:131], a[16:19], v[64:79]
    v_mfma_f32_32x32x16_bf16 v[80:95], v[128:131], a[20:23], v[80:95]
    v_mfma_f32_32x32x16_bf16 v[64:79], v[128:131], a[24:27], v[64:79]
    v_mfma_f32_32x32x16_bf16 v[80:95], v[128:131], a[28:31], v[80:95]
    v_mfma_f32_32x32x16_bf16 v[64:79], v[128:131], a[32:35], v[64:79]
    v_mfma_f32_32x32x16_bf16 v[80:95], v[128:131], a[36:39], v[80:95]
    v_mfma_f32_32x32x16_bf16 v[64:79], v[128:131], a[40:43], v[64:79]
    v_mfma_f32_32x32x16_bf16 v[80:95], v[128:131], a[44:47], v[80:95]
    v_mfma_f32_32x32x16_bf16 v[64:79], v[128:131], a[48:51], v[64:79]
    v_mfma_f32_32x32x16_bf16 v[80:95], v[128:131], a[52:55], v[80:95]
    v_mfma_f32_32x32x16_bf16 v[64:79], v[128:131], a[56:59], v[64:79]
    v_mfma_f32_32x32x16_bf16 v[80:95], v[128:131], a[60:63], v[80:95]
    v_mfma_f32_32x32x16_bf16 v[64:79], v[128:131], a[64:67], v[64:79]
    v_mfma_f32_32x32x16_bf16 v[80:95], v[128:131], a[68:71], v[80:95]
    v_mfma_f32_32x32x16_bf16 v[64:79], v[128:131], a[72:75], v[64:79]
    v_mfma_f32_32x32x16_bf16 v[80:95], v[128:131], a[76:79], v[80:95]
    v_mfma_f32_32x32x16_bf16 v[64:79], v[128:131], a[80:83], v[64:79]
    v_mfma_f32_32x32x16_bf16 v[80:95], v[128:131], a[84:87], v[80:95]
    v_mfma_f32_32x32x16_bf16 v[64:79], v[128:131], a[88:91], v[64:79]
    v_mfma_f32_32x32x16_bf16 v[80:95], v[128:131], a[92:95], v[80:95]
    v_mfma_f32_32x32x16_bf16 v[64:79], v[128:131], a[96:99], v[64:79]
    v_mfma_f32_32x32x16_bf16 v[80:95], v[128:131], a[100:103], v[80:95]
    v_mfma_f32_32x32x16_bf16 v[64:79], v[128:131], a[104:107], v[64:79]
    v_mfma_f32_32x32x16_bf16 v[80:95], v[128:131], a[108:111], v[80:95]
    v_mfma_f32_32x32x16_bf16 v[64:79], v[128:131], a[112:115], v[64:79]
    v_mfma_f32_32x32x16_bf16 v[80:95], v[128:131], a[116:119], v[80:95]
    v_mfma_f32_32x32x16_bf16 v[64:79], v[128:131], a[120:123], v[64:79]
    v_mfma_f32_32x32x16_bf16 v[80:95], v[128:131], a[124:127], v[80:95]
    v_mfma_f32_32x32x16_bf16 v[64:79], v[128:131], a[128:131], v[64:79]
    v_mfma_f32_32x32x16_bf16 v[80:95], v[128:131], a[132:135], v[80:95]
    v_mfma_f32_32x32x16_bf16 v[64:79], v[128:131], a[136:139], v[64:79]
    v_mfma_f32_32x32x16_bf16 v[80:95], v[128:131], a[140:143], v[80:95]
    v_mfma_f32_32x32x16_bf16 v[64:79], v[128:131], a[144:147], v[64:79]
    v_mfma_f32_32x32x16_bf16 v[80:95], v[128:131], a[148:151], v[80:95]
    v_mfma_f32_32x32x16_bf16 v[64:79], v[128:131], a[152:155], v[64:79]
    v_mfma_f32_32x32x16_bf16 v[80:95], v[128:131], a[156:159], v[80:95]
    v_mfma_f32_32x32x16_bf16 v[64:79], v[128:131], a[160:163], v[64:79]
    v_mfma_f32_32x32x16_bf16 v[80:95], v[128:131], a[164:167], v[80:95]
    v_mfma_f32_32x32x16_bf16 v[64:79], v[128:131], a[168:171], v[64:79]
    v_mfma_f32_32x32x16_bf16 v[80:95], v[128:131], a[172:175], v[80:95]
    v_mfma_f32_32x32x16_bf16 v[64:79], v[128:131], a[176:179], v[64:79]
    v_mfma_f32_32x32x16_bf16 v[80:95], v[128:131], a[180:183], v[80:95]
    v_mfma_f32_32x32x16_bf16 v[64:79], v[128:131], a[184:187], v[64:79]
    v_mfma_f32_32x32x16_bf16 v[80:95], v[128:131], a[188:191], v[80:95]
    v_mfma_f32_32x32x16_bf16 v[64:79], v[128:131], a[192:195], v[64:79]
    v_mfma_f32_32x32x16_bf16 v[80:95], v[128:131], a[196:199], v[80:95]
    v_mfma_f32_32x32x16_bf16 v[64:79], v[128:131], a[200:203], v[64:79]
    v_mfma_f32_32x32x16_bf16 v[80:95], v[128:131], a[204:207], v[80:95]
    v_mfma_f32_32x32x16_bf16 v[64:79], v[128:131], a[208:211], v[64:79]
    v_mfma_f32_32x32x16_bf16 v[80:95], v[128:131], a[212:215], v[80:95]
    v_mfma_f32_32x32x16_bf16 v[64:79], v[128:131], a[216:219], v[64:79]
    v_mfma_f32_32x32x16_bf16 v[80:95], v[128:131], a[220:223], v[80:95]
    v_mfma_f32_32x32x16_bf16 v[64:79], v[128:131], a[224:227], v[64:79]
    v_mfma_f32_32x32x16_bf16 v[80:95], v[128:131], a[228:231], v[80:95]
    v_mfma_f32_32x32x16_bf16 v[64:79], v[128:131], a[232:235], v[64:79]
    v_mfma_f32_32x32x16_bf16 v[80:95], v[128:131], a[236:239], v[80:95]
    v_mfma_f32_32x32x16_bf16 v[64:79], v[128:131], a[240:243], v[64:79]
    v_mfma_f32_32x32x16_bf16 v[80:95], v[128:131], a[244:247], v[80:95]
    v_mfma_f32_32x32x16_bf16 v[64:79], v[128:131], a[248:251], v[64:79]
    v_mfma_f32_32x32x16_bf16 v[80:95], v[128:131], a[252:255], v[80:95]
    s_branch L_proj_in_v
L_proj_e2_k:
    v_cmp_eq_u32 vcc, 0, v7
    s_barrier
    ds_read_b128 v[128:131], v1 offset:0
    ds_read_b128 v[132:135], v1 offset:1024
    ds_read_b128 v[136:139], v1 offset:2048
    ds_read_b128 v[140:143], v1 offset:3072
    ds_read_b128 v[144:147], v1 offset:4096
    ds_read_b128 v[148:151], v1 offset:5120
    ds_read_b128 v[152:155], v1 offset:6144
    ds_read_b128 v[156:159], v1 offset:7168
L_proj_e2_k_b:
    s_cbranch_vccnz Lpa_10041
    s_waitcnt lgkmcnt(7)
    v_mfma_f32_32x32x16_bf16 v[32:47], a[0:3], v[128:131], 0
    ds_read_b128 v[160:163], v1 offset:8192
    s_mov_b32 m0, s39
    s_add_u32 s43, s38, 4096
    buffer_load_dwordx4 v2, s[8:11], s38 offen offset:0 lds
    s_waitcnt lgkmcnt(7)
    v_mfma_f32_32x32x16_bf16 v[32:47], a[8:11], v[132:135], v[32:47]
    ds_read_b128 v[164:167], v1 offset:9216
    buffer_load_dwordx4 v2, s[8:11], s38 offen offset:1024 lds
    v_mfma_f32_32x32x16_bf16 v[48:63], a[4:7], v[128:131], 0
    buffer_load_dwordx4 v2, s[8:11], s38 offen offset:2048 lds
    s_waitcnt lgkmcnt(7)
    v_mfma_f32_32x32x16_bf16 v[32:47], a[16:19], v[136:139], v[32:47]
    ds_read_b128 v[168:171], v1 offset:10240
    ds_read_b64 v[96:97], v9 offset:0
    ds_read_b64 v[98:99], v9 offset:512
    buffer_load_dwordx4 v2, s[8:11], s38 offen offset:3072 lds
    s_waitcnt lgkmcnt(9)
    v_mfma_f32_32x32x16_bf16 v[32:47], a[24:27], v[140:143], v[32:47]
    ds_read_b128 v[172:175], v1 offset:11264
    ds_read_b64 v[100:101], v9 offset:1024
    s_add_u32 m0, s39, 4096
    s_add_u32 s38, s38, 32768
    buffer_load_dwordx4 v2, s[8:11], s43 offen offset:0 lds
    v_mfma_f32_32x32x16_bf16 v[48:63], a[12:15], v[132:135], v[48:63]
    ds_read_b64 v[102:103], v9 offset:1536
    ds_read_b64 v[104:105], v9 offset:2048
    buffer_load_dwordx4 v2, s[8:11], s43 offen offset:1024 lds
    s_waitcnt lgkmcnt(12)
    v_mfma_f32_32x32x16_bf16 v[32:47], a[32:35], v[144:147], v[32:47]
    ds_read_b128 v[176:179], v1 offset:12288
    ds_read_b64 v[106:107], v9 offset:2560
    buffer_load_dwordx4 v2, s[8:11], s43 offen offset:2048 lds
    s_waitcnt lgkmcnt(13)
    v_mfma_f32_32x32x16_bf16 v[32:47], a[40:43], v[148:151], v[32:47]
    ds_read_b128 v[180:183], v1 offset:13312
    ds_read_b64 v[108:109], v9 offset:3072
    ds_read_b64 v[110:111], v9 offset:3584
    buffer_load_dwordx4 v2, s[8:11], s43 offen offset:3072 lds
    v_mfma_f32_32x32x16_bf16 v[48:63], a[20:23], v[136:139], v[48:63]
    v_xor_b32 v9, 0x1000, v9
    s_mov_b32 m0, s52
    s_add_u32 s37, s37, 2048
    buffer_load_dwordx4 v8, s[8:11], s51 offen lds
    s_waitcnt lgkmcnt(15)
    v_mfma_f32_32x32x16_bf16 v[32:47], a[48:51], v[152:155], v[32:47]
    ds_read_b128 v[184:187], v1 offset:14336
    s_waitcnt lgkmcnt(10)
    v_add_f32 v96, v96, v98
    v_add_f32 v97, v97, v99
    s_add_u32 s51, s51, 4096
    s_xor_b32 s39, s39, 32768
    s_xor_b32 s52, s52, 4096
    s_add_u32 s40, s40, 1
    s_cmp_ge_u32 s40, 64
    s_cselect_b32 s37, 5636096, s37
    buffer_load_dword v7, v4, s[8:11], s37 offen sc1
    v_mfma_f32_32x32x16_bf16 v[32:47], a[56:59], v[156:159], v[32:47]
    ds_read_b128 v[188:191], v1 offset:15360
    s_waitcnt lgkmcnt(8)
    v_add_f32 v100, v100, v102
    v_mfma_f32_32x32x16_bf16 v[48:63], a[28:31], v[140:143], v[48:63]
    v_add_f32 v101, v101, v103
    s_waitcnt lgkmcnt(5)
    v_add_f32 v104, v104, v106
    v_mfma_f32_32x32x16_bf16 v[32:47], a[64:67], v[160:163], v[32:47]
    ds_read_b128 v[192:195], v1 offset:16384
    v_add_f32 v105, v105, v107
    v_mfma_f32_32x32x16_bf16 v[32:47], a[72:75], v[164:167], v[32:47]
    ds_read_b128 v[196:199], v1 offset:17408
    s_waitcnt lgkmcnt(4)
    v_add_f32 v108, v108, v110
    v_add_f32 v109, v109, v111
    v_mfma_f32_32x32x16_bf16 v[48:63], a[36:39], v[144:147], v[48:63]
    v_add_f32 v96, v96, v100
    v_mfma_f32_32x32x16_bf16 v[32:47], a[80:83], v[168:171], v[32:47]
    ds_read_b128 v[200:203], v1 offset:18432
    v_add_f32 v97, v97, v101
    v_add_f32 v104, v104, v108
    s_waitcnt vmcnt(10)
    s_mov_b64 exec, 1
    buffer_store_dword v6, v5, s[8:11], s36 offen sc1
    s_mov_b64 exec, -1
    v_mfma_f32_32x32x16_bf16 v[32:47], a[88:91], v[172:175], v[32:47]
    ds_read_b128 v[204:207], v1 offset:19456
    v_add_f32 v105, v105, v109
    v_mfma_f32_32x32x16_bf16 v[48:63], a[44:47], v[148:151], v[48:63]
    v_add_f32 v96, v96, v104
    v_add_f32 v97, v97, v105
    v_mfma_f32_32x32x16_bf16 v[32:47], a[96:99], v[176:179], v[32:47]
    ds_read_b128 v[208:211], v1 offset:20480
    v_mov_b32 v98, v96
    v_mfma_f32_32x32x16_bf16 v[32:47], a[104:107], v[180:183], v[32:47]
    ds_read_b128 v[212:215], v1 offset:21504
    v_mov_b32 v99, v97
    v_permlane32_swap_b32 v96, v98
    v_mfma_f32_32x32x16_bf16 v[48:63], a[52:55], v[152:155], v[48:63]
    v_permlane32_swap_b32 v97, v99
    s_waitcnt lgkmcnt(7)
    v_mfma_f32_32x32x16_bf16 v[32:47], a[112:115], v[184:187], v[32:47]
    ds_read_b128 v[216:219], v1 offset:22528
    v_add_f32 v96, v96, v98
    v_add_f32 v97, v97, v99
    s_waitcnt lgkmcnt(7)
    v_mfma_f32_32x32x16_bf16 v[32:47], a[120:123], v[188:191], v[32:47]
    ds_read_b128 v[220:223], v1 offset:23552
    v_mul_f32 v96, 989855744, v96
    v_mfma_f32_32x32x16_bf16 v[48:63], a[60:63], v[156:159], v[48:63]
    v_mul_f32 v97, 989855744, v97
    v_fma_f32 v97, -v96, v96, v97
    s_waitcnt lgkmcnt(7)
    v_mfma_f32_32x32x16_bf16 v[32:47], a[128:131], v[192:195], v[32:47]
    ds_read_b128 v[224:227], v1 offset:24576
    v_max_f32 v97, 0, v97
    s_waitcnt lgkmcnt(7)
    v_mfma_f32_32x32x16_bf16 v[32:47], a[136:139], v[196:199], v[32:47]
    ds_read_b128 v[228:231], v1 offset:25600
    v_cvt_pk_bf16_f32 v98, v96, v97
    v_lshlrev_b32 v96, 16, v98
    v_mfma_f32_32x32x16_bf16 v[48:63], a[68:71], v[160:163], v[48:63]
    v_and_b32 v97, 0xffff0000, v98
    s_waitcnt lgkmcnt(7)
    v_mfma_f32_32x32x16_bf16 v[32:47], a[144:147], v[200:203], v[32:47]
    ds_read_b128 v[232:235], v1 offset:26624
    v_add_f32 v97, 925353388, v97
    v_cvt_pk_bf16_f32 v98, v97, v97
    s_waitcnt lgkmcnt(7)
    v_mfma_f32_32x32x16_bf16 v[32:47], a[152:155], v[204:207], v[32:47]
    ds_read_b128 v[236:239], v1 offset:27648
    v_lshlrev_b32 v97, 16, v98
    v_mfma_f32_32x32x16_bf16 v[48:63], a[76:79], v[164:167], v[48:63]
    v_sqrt_f32 v97, v97
    s_nop 0
    v_cvt_pk_bf16_f32 v98, v97, v97
    s_waitcnt lgkmcnt(7)
    v_mfma_f32_32x32x16_bf16 v[32:47], a[160:163], v[208:211], v[32:47]
    ds_read_b128 v[240:243], v1 offset:28672
    v_lshlrev_b32 v97, 16, v98
    s_waitcnt lgkmcnt(7)
    v_mfma_f32_32x32x16_bf16 v[32:47], a[168:171], v[212:215], v[32:47]
    ds_read_b128 v[244:247], v1 offset:29696
    v_rcp_f32 v97, v97
    s_nop 0
    v_mov_b32 v100, v97
    v_mfma_f32_32x32x16_bf16 v[48:63], a[84:87], v[168:171], v[48:63]
    v_mul_f32 v102, -v96, v97
    s_waitcnt lgkmcnt(7)
    v_mfma_f32_32x32x16_bf16 v[32:47], a[176:179], v[216:219], v[32:47]
    ds_read_b128 v[248:251], v1 offset:30720
    s_waitcnt lgkmcnt(7)
    v_mfma_f32_32x32x16_bf16 v[32:47], a[184:187], v[220:223], v[32:47]
    ds_read_b128 v[252:255], v1 offset:31744
    v_mfma_f32_32x32x16_bf16 v[48:63], a[92:95], v[172:175], v[48:63]
    s_waitcnt lgkmcnt(7)
    v_mfma_f32_32x32x16_bf16 v[32:47], a[192:195], v[224:227], v[32:47]
    s_waitcnt lgkmcnt(6)
    v_mfma_f32_32x32x16_bf16 v[32:47], a[200:203], v[228:231], v[32:47]
    v_mfma_f32_32x32x16_bf16 v[48:63], a[100:103], v[176:179], v[48:63]
    s_waitcnt lgkmcnt(5)
    v_mfma_f32_32x32x16_bf16 v[32:47], a[208:211], v[232:235], v[32:47]
    s_waitcnt lgkmcnt(4)
    v_mfma_f32_32x32x16_bf16 v[32:47], a[216:219], v[236:239], v[32:47]
    v_mfma_f32_32x32x16_bf16 v[48:63], a[108:111], v[180:183], v[48:63]
    s_waitcnt lgkmcnt(3)
    v_mfma_f32_32x32x16_bf16 v[32:47], a[224:227], v[240:243], v[32:47]
    s_waitcnt lgkmcnt(2)
    v_mfma_f32_32x32x16_bf16 v[32:47], a[232:235], v[244:247], v[32:47]
    v_mfma_f32_32x32x16_bf16 v[48:63], a[116:119], v[184:187], v[48:63]
    s_waitcnt lgkmcnt(1)
    v_mfma_f32_32x32x16_bf16 v[32:47], a[240:243], v[248:251], v[32:47]
    s_waitcnt lgkmcnt(0)
    v_mfma_f32_32x32x16_bf16 v[32:47], a[248:251], v[252:255], v[32:47]
    v_mfma_f32_32x32x16_bf16 v[48:63], a[124:127], v[188:191], v[48:63]
    v_mfma_f32_32x32x16_bf16 v[48:63], a[132:135], v[192:195], v[48:63]
    v_mfma_f32_32x32x16_bf16 v[48:63], a[140:143], v[196:199], v[48:63]
    s_nop 8
    v_mul_f32 v32, v32, v100
    v_mul_f32 v33, v33, v100
    v_mul_f32 v34, v34, v100
    v_mfma_f32_32x32x16_bf16 v[48:63], a[148:151], v[200:203], v[48:63]
    v_mul_f32 v35, v35, v100
    v_mul_f32 v36, v36, v100
    v_mul_f32 v37, v37, v100
    v_mfma_f32_32x32x16_bf16 v[48:63], a[156:159], v[204:207], v[48:63]
    v_mul_f32 v38, v38, v100
    v_mul_f32 v39, v39, v100
    v_fmac_f32 v32, v64, v102
    v_mfma_f32_32x32x16_bf16 v[48:63], a[164:167], v[208:211], v[48:63]
    v_fmac_f32 v33, v65, v102
    v_fmac_f32 v34, v66, v102
    v_fmac_f32 v35, v67, v102
    v_mfma_f32_32x32x16_bf16 v[48:63], a[172:175], v[212:215], v[48:63]
    v_fmac_f32 v36, v68, v102
    v_fmac_f32 v37, v69, v102
    v_fmac_f32 v38, v70, v102
    v_mfma_f32_32x32x16_bf16 v[48:63], a[180:183], v[216:219], v[48:63]
    v_fmac_f32 v39, v71, v102
    v_cvt_pk_bf16_f32 v16, v32, v33
    v_cvt_pk_bf16_f32 v17, v34, v35
    v_mfma_f32_32x32x16_bf16 v[48:63], a[188:191], v[220:223], v[48:63]
    v_cvt_pk_bf16_f32 v18, v36, v37
    v_cvt_pk_bf16_f32 v19, v38, v39
    buffer_store_dwordx4 v[16:19], v3, s[8:11], s35 offen offset:0 sc1
    v_mfma_f32_32x32x16_bf16 v[48:63], a[196:199], v[224:227], v[48:63]
    v_mul_f32 v40, v40, v100
    v_mul_f32 v41, v41, v100
    v_mul_f32 v42, v42, v100
    v_mfma_f32_32x32x16_bf16 v[48:63], a[204:207], v[228:231], v[48:63]
    v_mul_f32 v43, v43, v100
    v_mul_f32 v44, v44, v100
    v_mul_f32 v45, v45, v100
    v_mfma_f32_32x32x16_bf16 v[48:63], a[212:215], v[232:235], v[48:63]
    v_mul_f32 v46, v46, v100
    v_mul_f32 v47, v47, v100
    v_fmac_f32 v40, v72, v102
    v_mfma_f32_32x32x16_bf16 v[48:63], a[220:223], v[236:239], v[48:63]
    v_fmac_f32 v41, v73, v102
    v_fmac_f32 v42, v74, v102
    v_fmac_f32 v43, v75, v102
    v_mfma_f32_32x32x16_bf16 v[48:63], a[228:231], v[240:243], v[48:63]
    v_fmac_f32 v44, v76, v102
    v_fmac_f32 v45, v77, v102
    v_fmac_f32 v46, v78, v102
    v_mfma_f32_32x32x16_bf16 v[48:63], a[236:239], v[244:247], v[48:63]
    v_fmac_f32 v47, v79, v102
    v_cvt_pk_bf16_f32 v20, v40, v41
    v_cvt_pk_bf16_f32 v21, v42, v43
    v_mfma_f32_32x32x16_bf16 v[48:63], a[244:247], v[248:251], v[48:63]
    v_cvt_pk_bf16_f32 v22, v44, v45
    v_cvt_pk_bf16_f32 v23, v46, v47
    buffer_store_dwordx4 v[20:23], v3, s[8:11], s35 offen offset:512 sc1
    v_mfma_f32_32x32x16_bf16 v[48:63], a[252:255], v[252:255], v[48:63]
    v_xor_b32 v1, 0x8000, v1
    s_nop 10
    v_pk_mul_f32 v[48:49], v[48:49], v[100:101] op_sel_hi:[1,0]
    v_pk_mul_f32 v[50:51], v[50:51], v[100:101] op_sel_hi:[1,0]
    v_pk_mul_f32 v[52:53], v[52:53], v[100:101] op_sel_hi:[1,0]
    v_pk_mul_f32 v[54:55], v[54:55], v[100:101] op_sel_hi:[1,0]
    v_pk_fma_f32 v[48:49], v[80:81], v[102:103], v[48:49] op_sel_hi:[1,0,1]
    v_pk_fma_f32 v[50:51], v[82:83], v[102:103], v[50:51] op_sel_hi:[1,0,1]
    v_pk_fma_f32 v[52:53], v[84:85], v[102:103], v[52:53] op_sel_hi:[1,0,1]
    v_pk_fma_f32 v[54:55], v[86:87], v[102:103], v[54:55] op_sel_hi:[1,0,1]
    v_cvt_pk_bf16_f32 v24, v48, v49
    v_cvt_pk_bf16_f32 v25, v50, v51
    v_cvt_pk_bf16_f32 v26, v52, v53
    v_cvt_pk_bf16_f32 v27, v54, v55
    buffer_store_dwordx4 v[24:27], v3, s[8:11], s35 offen offset:2048 sc1
    v_pk_mul_f32 v[56:57], v[56:57], v[100:101] op_sel_hi:[1,0]
    v_pk_mul_f32 v[58:59], v[58:59], v[100:101] op_sel_hi:[1,0]
    v_pk_mul_f32 v[60:61], v[60:61], v[100:101] op_sel_hi:[1,0]
    v_pk_mul_f32 v[62:63], v[62:63], v[100:101] op_sel_hi:[1,0]
    v_pk_fma_f32 v[56:57], v[88:89], v[102:103], v[56:57] op_sel_hi:[1,0,1]
    v_pk_fma_f32 v[58:59], v[90:91], v[102:103], v[58:59] op_sel_hi:[1,0,1]
    v_pk_fma_f32 v[60:61], v[92:93], v[102:103], v[60:61] op_sel_hi:[1,0,1]
    v_pk_fma_f32 v[62:63], v[94:95], v[102:103], v[62:63] op_sel_hi:[1,0,1]
    v_cvt_pk_bf16_f32 v28, v56, v57
    v_cvt_pk_bf16_f32 v29, v58, v59
    v_cvt_pk_bf16_f32 v30, v60, v61
    v_cvt_pk_bf16_f32 v31, v62, v63
    buffer_store_dwordx4 v[28:31], v3, s[8:11], s35 offen offset:2560 sc1
    s_add_u32 s35, s35, 262144
    s_add_u32 s34, s34, 1
    s_mov_b32 s36, s50
    s_add_u32 s50, s50, 8192
    s_mov_b32 s53, 1
    s_waitcnt vmcnt(5)
    s_branch L_proj_e2_k
Lpa_10041:
    s_waitcnt lgkmcnt(7)
    v_mfma_f32_32x32x16_bf16 v[32:47], a[0:3], v[128:131], 0
    ds_read_b128 v[160:163], v1 offset:8192
    buffer_load_dword v12, v4, s[8:11], s37 offen sc1
    s_waitcnt lgkmcnt(7)
    v_mfma_f32_32x32x16_bf16 v[32:47], a[8:11], v[132:135], v[32:47]
    ds_read_b128 v[164:167], v1 offset:9216
    v_mfma_f32_32x32x16_bf16 v[48:63], a[4:7], v[128:131], 0
    s_waitcnt lgkmcnt(7)
    v_mfma_f32_32x32x16_bf16 v[32:47], a[16:19], v[136:139], v[32:47]
    ds_read_b128 v[168:171], v1 offset:10240
    ds_read_b64 v[96:97], v9 offset:0
    ds_read_b64 v[98:99], v9 offset:512
    s_waitcnt lgkmcnt(9)
    v_mfma_f32_32x32x16_bf16 v[32:47], a[24:27], v[140:143], v[32:47]
    ds_read_b128 v[172:175], v1 offset:11264
    ds_read_b64 v[100:101], v9 offset:1024
    v_mfma_f32_32x32x16_bf16 v[48:63], a[12:15], v[132:135], v[48:63]
    ds_read_b64 v[102:103], v9 offset:1536
    ds_read_b64 v[104:105], v9 offset:2048
    s_waitcnt lgkmcnt(12)
    v_mfma_f32_32x32x16_bf16 v[32:47], a[32:35], v[144:147], v[32:47]
    ds_read_b128 v[176:179], v1 offset:12288
    ds_read_b64 v[106:107], v9 offset:2560
    s_waitcnt lgkmcnt(13)
    v_mfma_f32_32x32x16_bf16 v[32:47], a[40:43], v[148:151], v[32:47]
    ds_read_b128 v[180:183], v1 offset:13312
    ds_read_b64 v[108:109], v9 offset:3072
    ds_read_b64 v[110:111], v9 offset:3584
    v_mfma_f32_32x32x16_bf16 v[48:63], a[20:23], v[136:139], v[48:63]
    v_xor_b32 v9, 0x1000, v9
    buffer_load_dword v13, v4, s[8:11], s37 offen sc1
    s_waitcnt lgkmcnt(15)
    v_mfma_f32_32x32x16_bf16 v[32:47], a[48:51], v[152:155], v[32:47]
    ds_read_b128 v[184:187], v1 offset:14336
    s_waitcnt lgkmcnt(10)
    v_add_f32 v96, v96, v98
    v_add_f32 v97, v97, v99
    v_mfma_f32_32x32x16_bf16 v[32:47], a[56:59], v[156:159], v[32:47]
    ds_read_b128 v[188:191], v1 offset:15360
    s_waitcnt lgkmcnt(8)
    v_add_f32 v100, v100, v102
    v_mfma_f32_32x32x16_bf16 v[48:63], a[28:31], v[140:143], v[48:63]
    v_add_f32 v101, v101, v103
    s_waitcnt lgkmcnt(5)
    v_add_f32 v104, v104, v106
    v_mfma_f32_32x32x16_bf16 v[32:47], a[64:67], v[160:163], v[32:47]
    ds_read_b128 v[192:195], v1 offset:16384
    v_add_f32 v105, v105, v107
    v_mfma_f32_32x32x16_bf16 v[32:47], a[72:75], v[164:167], v[32:47]
    ds_read_b128 v[196:199], v1 offset:17408
    s_waitcnt lgkmcnt(4)
    v_add_f32 v108, v108, v110
    v_add_f32 v109, v109, v111
    v_mfma_f32_32x32x16_bf16 v[48:63], a[36:39], v[144:147], v[48:63]
    v_add_f32 v96, v96, v100
    v_mfma_f32_32x32x16_bf16 v[32:47], a[80:83], v[168:171], v[32:47]
    ds_read_b128 v[200:203], v1 offset:18432
    v_add_f32 v97, v97, v101
    v_add_f32 v104, v104, v108
    s_cmp_eq_u32 s53, 0
    s_cbranch_scc1 Lpk_10042
    s_waitcnt vmcnt(2)
    s_mov_b64 exec, 1
    buffer_store_dword v6, v5, s[8:11], s36 offen sc1
    s_mov_b64 exec, -1
Lpk_10042:
    v_mfma_f32_32x32x16_bf16 v[32:47], a[88:91], v[172:175], v[32:47]
    ds_read_b128 v[204:207], v1 offset:19456
    v_add_f32 v105, v105, v109
    buffer_load_dword v14, v4, s[8:11], s37 offen sc1
    v_mfma_f32_32x32x16_bf16 v[48:63], a[44:47], v[148:151], v[48:63]
    v_add_f32 v96, v96, v104
    v_add_f32 v97, v97, v105
    v_mfma_f32_32x32x16_bf16 v[32:47], a[96:99], v[176:179], v[32:47]
    ds_read_b128 v[208:211], v1 offset:20480
    v_mov_b32 v98, v96
    v_mfma_f32_32x32x16_bf16 v[32:47], a[104:107], v[180:183], v[32:47]
    ds_read_b128 v[212:215], v1 offset:21504
    v_mov_b32 v99, v97
    v_permlane32_swap_b32 v96, v98
    v_mfma_f32_32x32x16_bf16 v[48:63], a[52:55], v[152:155], v[48:63]
    v_permlane32_swap_b32 v97, v99
    s_waitcnt lgkmcnt(7)
    v_mfma_f32_32x32x16_bf16 v[32:47], a[112:115], v[184:187], v[32:47]
    ds_read_b128 v[216:219], v1 offset:22528
    v_add_f32 v96, v96, v98
    v_add_f32 v97, v97, v99
    s_waitcnt lgkmcnt(7)
    v_mfma_f32_32x32x16_bf16 v[32:47], a[120:123], v[188:191], v[32:47]
    ds_read_b128 v[220:223], v1 offset:23552
    v_mul_f32 v96, 989855744, v96
    v_mfma_f32_32x32x16_bf16 v[48:63], a[60:63], v[156:159], v[48:63]
    v_mul_f32 v97, 989855744, v97
    v_fma_f32 v97, -v96, v96, v97
    s_waitcnt vmcnt(2)
    v_cmp_eq_u32 vcc, 0, v12
    s_nop 0
    s_cbranch_vccz Lpb_10043
    s_waitcnt lgkmcnt(7)
    v_mfma_f32_32x32x16_bf16 v[32:47], a[128:131], v[192:195], v[32:47]
    ds_read_b128 v[224:227], v1 offset:24576
    v_max_f32 v97, 0, v97
    buffer_load_dword v15, v4, s[8:11], s37 offen sc1
    s_waitcnt lgkmcnt(7)
    v_mfma_f32_32x32x16_bf16 v[32:47], a[136:139], v[196:199], v[32:47]
    ds_read_b128 v[228:231], v1 offset:25600
    v_cvt_pk_bf16_f32 v98, v96, v97
    v_lshlrev_b32 v96, 16, v98
    v_mfma_f32_32x32x16_bf16 v[48:63], a[68:71], v[160:163], v[48:63]
    v_and_b32 v97, 0xffff0000, v98
    s_waitcnt lgkmcnt(7)
    v_mfma_f32_32x32x16_bf16 v[32:47], a[144:147], v[200:203], v[32:47]
    ds_read_b128 v[232:235], v1 offset:26624
    v_add_f32 v97, 925353388, v97
    v_cvt_pk_bf16_f32 v98, v97, v97
    s_waitcnt lgkmcnt(7)
    v_mfma_f32_32x32x16_bf16 v[32:47], a[152:155], v[204:207], v[32:47]
    ds_read_b128 v[236:239], v1 offset:27648
    v_lshlrev_b32 v97, 16, v98
    v_mfma_f32_32x32x16_bf16 v[48:63], a[76:79], v[164:167], v[48:63]
    v_sqrt_f32 v97, v97
    s_nop 0
    v_cvt_pk_bf16_f32 v98, v97, v97
    s_waitcnt lgkmcnt(7)
    v_mfma_f32_32x32x16_bf16 v[32:47], a[160:163], v[208:211], v[32:47]
    ds_read_b128 v[240:243], v1 offset:28672
    v_lshlrev_b32 v97, 16, v98
    s_waitcnt lgkmcnt(7)
    v_mfma_f32_32x32x16_bf16 v[32:47], a[168:171], v[212:215], v[32:47]
    ds_read_b128 v[244:247], v1 offset:29696
    v_rcp_f32 v97, v97
    s_nop 0
    v_mov_b32 v100, v97
    s_waitcnt vmcnt(2)
    v_cmp_eq_u32 vcc, 0, v13
    s_nop 0
    s_cbranch_vccz Lpb_10044
    v_mfma_f32_32x32x16_bf16 v[48:63], a[84:87], v[168:171], v[48:63]
    v_mul_f32 v102, -v96, v97
    buffer_load_dword v12, v4, s[8:11], s37 offen sc1
    s_waitcnt lgkmcnt(7)
    v_mfma_f32_32x32x16_bf16 v[32:47], a[176:179], v[216:219], v[32:47]
    ds_read_b128 v[248:251], v1 offset:30720
    s_waitcnt lgkmcnt(7)
    v_mfma_f32_32x32x16_bf16 v[32:47], a[184:187], v[220:223], v[32:47]
    ds_read_b128 v[252:255], v1 offset:31744
    v_mfma_f32_32x32x16_bf16 v[48:63], a[92:95], v[172:175], v[48:63]
    s_waitcnt lgkmcnt(7)
    v_mfma_f32_32x32x16_bf16 v[32:47], a[192:195], v[224:227], v[32:47]
    s_waitcnt lgkmcnt(6)
    v_mfma_f32_32x32x16_bf16 v[32:47], a[200:203], v[228:231], v[32:47]
    v_mfma_f32_32x32x16_bf16 v[48:63], a[100:103], v[176:179], v[48:63]
    s_waitcnt lgkmcnt(5)
    v_mfma_f32_32x32x16_bf16 v[32:47], a[208:211], v[232:235], v[32:47]
    s_waitcnt vmcnt(2)
    v_cmp_eq_u32 vcc, 0, v14
    s_nop 0
    s_cbranch_vccz Lpb_10045
    s_waitcnt lgkmcnt(4)
    v_mfma_f32_32x32x16_bf16 v[32:47], a[216:219], v[236:239], v[32:47]
    buffer_load_dword v13, v4, s[8:11], s37 offen sc1
    v_mfma_f32_32x32x16_bf16 v[48:63], a[108:111], v[180:183], v[48:63]
    s_waitcnt lgkmcnt(3)
    v_mfma_f32_32x32x16_bf16 v[32:47], a[224:227], v[240:243], v[32:47]
    s_waitcnt lgkmcnt(2)
    v_mfma_f32_32x32x16_bf16 v[32:47], a[232:235], v[244:247], v[32:47]
    v_mfma_f32_32x32x16_bf16 v[48:63], a[116:119], v[184:187], v[48:63]
    s_waitcnt lgkmcnt(1)
    v_mfma_f32_32x32x16_bf16 v[32:47], a[240:243], v[248:251], v[32:47]
    s_waitcnt lgkmcnt(0)
    v_mfma_f32_32x32x16_bf16 v[32:47], a[248:251], v[252:255], v[32:47]
    v_mfma_f32_32x32x16_bf16 v[48:63], a[124:127], v[188:191], v[48:63]
    s_waitcnt vmcnt(2)
    v_cmp_eq_u32 vcc, 0, v15
    s_nop 0
    s_cbranch_vccz Lpb_10046
    v_mfma_f32_32x32x16_bf16 v[48:63], a[132:135], v[192:195], v[48:63]
    buffer_load_dword v14, v4, s[8:11], s37 offen sc1
    v_mfma_f32_32x32x16_bf16 v[48:63], a[140:143], v[196:199], v[48:63]
    s_nop 3
    v_mul_f32 v32, v32, v100
    v_mul_f32 v33, v33, v100
    v_mul_f32 v34, v34, v100
    v_mfma_f32_32x32x16_bf16 v[48:63], a[148:151], v[200:203], v[48:63]
    v_mul_f32 v35, v35, v100
    v_mul_f32 v36, v36, v100
    v_mul_f32 v37, v37, v100
    v_mfma_f32_32x32x16_bf16 v[48:63], a[156:159], v[204:207], v[48:63]
    v_mul_f32 v38, v38, v100
    v_mul_f32 v39, v39, v100
    v_fmac_f32 v32, v64, v102
    v_mfma_f32_32x32x16_bf16 v[48:63], a[164:167], v[208:211], v[48:63]
    v_fmac_f32 v33, v65, v102
    v_fmac_f32 v34, v66, v102
    v_fmac_f32 v35, v67, v102
    v_mfma_f32_32x32x16_bf16 v[48:63], a[172:175], v[212:215], v[48:63]
    v_fmac_f32 v36, v68, v102
    v_fmac_f32 v37, v69, v102
    v_fmac_f32 v38, v70, v102
    v_mfma_f32_32x32x16_bf16 v[48:63], a[180:183], v[216:219], v[48:63]
    v_fmac_f32 v39, v71, v102
    v_cvt_pk_bf16_f32 v16, v32, v33
    v_cvt_pk_bf16_f32 v17, v34, v35
    v_mfma_f32_32x32x16_bf16 v[48:63], a[188:191], v[220:223], v[48:63]
    v_cvt_pk_bf16_f32 v18, v36, v37
    v_cvt_pk_bf16_f32 v19, v38, v39
    buffer_store_dwordx4 v[16:19], v3, s[8:11], s35 offen offset:0 sc1
    s_waitcnt vmcnt(3)
    v_cmp_eq_u32 vcc, 0, v12
    s_nop 0
    s_cbranch_vccz Lpb_10047
    v_mfma_f32_32x32x16_bf16 v[48:63], a[196:199], v[224:227], v[48:63]
    v_mul_f32 v40, v40, v100
    v_mul_f32 v41, v41, v100
    v_mul_f32 v42, v42, v100
    buffer_load_dword v15, v4, s[8:11], s37 offen sc1
    v_mfma_f32_32x32x16_bf16 v[48:63], a[204:207], v[228:231], v[48:63]
    v_mul_f32 v43, v43, v100
    v_mul_f32 v44, v44, v100
    v_mul_f32 v45, v45, v100
    v_mfma_f32_32x32x16_bf16 v[48:63], a[212:215], v[232:235], v[48:63]
    v_mul_f32 v46, v46, v100
    v_mul_f32 v47, v47, v100
    v_fmac_f32 v40, v72, v102
    v_mfma_f32_32x32x16_bf16 v[48:63], a[220:223], v[236:239], v[48:63]
    v_fmac_f32 v41, v73, v102
    v_fmac_f32 v42, v74, v102
    v_fmac_f32 v43, v75, v102
    v_mfma_f32_32x32x16_bf16 v[48:63], a[228:231], v[240:243], v[48:63]
    v_fmac_f32 v44, v76, v102
    v_fmac_f32 v45, v77, v102
    v_fmac_f32 v46, v78, v102
    v_mfma_f32_32x32x16_bf16 v[48:63], a[236:239], v[244:247], v[48:63]
    v_fmac_f32 v47, v79, v102
    v_cvt_pk_bf16_f32 v20, v40, v41
    v_cvt_pk_bf16_f32 v21, v42, v43
    v_mfma_f32_32x32x16_bf16 v[48:63], a[244:247], v[248:251], v[48:63]
    v_cvt_pk_bf16_f32 v22, v44, v45
    v_cvt_pk_bf16_f32 v23, v46, v47
    buffer_store_dwordx4 v[20:23], v3, s[8:11], s35 offen offset:512 sc1
    v_mfma_f32_32x32x16_bf16 v[48:63], a[252:255], v[252:255], v[48:63]
    v_xor_b32 v1, 0x8000, v1
    s_nop 10
    v_pk_mul_f32 v[48:49], v[48:49], v[100:101] op_sel_hi:[1,0]
    v_pk_mul_f32 v[50:51], v[50:51], v[100:101] op_sel_hi:[1,0]
    v_pk_mul_f32 v[52:53], v[52:53], v[100:101] op_sel_hi:[1,0]
    v_pk_mul_f32 v[54:55], v[54:55], v[100:101] op_sel_hi:[1,0]
    v_pk_fma_f32 v[48:49], v[80:81], v[102:103], v[48:49] op_sel_hi:[1,0,1]
    v_pk_fma_f32 v[50:51], v[82:83], v[102:103], v[50:51] op_sel_hi:[1,0,1]
    v_pk_fma_f32 v[52:53], v[84:85], v[102:103], v[52:53] op_sel_hi:[1,0,1]
    v_pk_fma_f32 v[54:55], v[86:87], v[102:103], v[54:55] op_sel_hi:[1,0,1]
    v_cvt_pk_bf16_f32 v24, v48, v49
    v_cvt_pk_bf16_f32 v25, v50, v51
    v_cvt_pk_bf16_f32 v26, v52, v53
    v_cvt_pk_bf16_f32 v27, v54, v55
    buffer_store_dwordx4 v[24:27], v3, s[8:11], s35 offen offset:2048 sc1
    v_pk_mul_f32 v[56:57], v[56:57], v[100:101] op_sel_hi:[1,0]
    v_pk_mul_f32 v[58:59], v[58:59], v[100:101] op_sel_hi:[1,0]
    v_pk_mul_f32 v[60:61], v[60:61], v[100:101] op_sel_hi:[1,0]
    v_pk_mul_f32 v[62:63], v[62:63], v[100:101] op_sel_hi:[1,0]
    v_pk_fma_f32 v[56:57], v[88:89], v[102:103], v[56:57] op_sel_hi:[1,0,1]
    v_pk_fma_f32 v[58:59], v[90:91], v[102:103], v[58:59] op_sel_hi:[1,0,1]
    v_pk_fma_f32 v[60:61], v[92:93], v[102:103], v[60:61] op_sel_hi:[1,0,1]
    v_pk_fma_f32 v[62:63], v[94:95], v[102:103], v[62:63] op_sel_hi:[1,0,1]
    v_cvt_pk_bf16_f32 v28, v56, v57
    v_cvt_pk_bf16_f32 v29, v58, v59
    v_cvt_pk_bf16_f32 v30, v60, v61
    v_cvt_pk_bf16_f32 v31, v62, v63
    buffer_store_dwordx4 v[28:31], v3, s[8:11], s35 offen offset:2560 sc1
    s_add_u32 s35, s35, 262144
    s_add_u32 s34, s34, 1
    s_mov_b32 s36, s50
    s_add_u32 s50, s50, 8192
    s_mov_b32 s53, 0
    s_waitcnt vmcnt(6)
    v_cmp_eq_u32 vcc, 0, v13
    s_nop 0
    s_cbranch_vccz Lpe_10048
    buffer_load_dword v13, v4, s[8:11], s37 offen sc1
    s_waitcnt vmcnt(6)
    v_cmp_eq_u32 vcc, 0, v14
    s_nop 0
    s_cbranch_vccz Lpe_10048
    buffer_load_dword v14, v4, s[8:11], s37 offen sc1
    s_waitcnt vmcnt(5)
    v_cmp_eq_u32 vcc, 0, v15
    s_nop 0
    s_cbranch_vccz Lpe_10048
    buffer_load_dword v15, v4, s[8:11], s37 offen sc1
    s_waitcnt vmcnt(3)
    s_mov_b64 exec, 1
    buffer_store_dword v6, v5, s[8:11], s36 offen sc1
    s_mov_b64 exec, -1
    s_cmp_ge_u32 s34, 64
    s_cbranch_scc1 L_proj_end
Lpp_10050:
    s_waitcnt vmcnt(2)
    v_cmp_eq_u32 vcc, 0, v13
    s_nop 0
    s_cbranch_vccz Lpl_10049
    buffer_load_dword v13, v4, s[8:11], s37 offen sc1
    s_waitcnt vmcnt(2)
    v_cmp_eq_u32 vcc, 0, v14
    s_nop 0
    s_cbranch_vccz Lpl_10049
    buffer_load_dword v14, v4, s[8:11], s37 offen sc1
    s_waitcnt vmcnt(2)
    v_cmp_eq_u32 vcc, 0, v15
    s_nop 0
    s_cbranch_vccz Lpl_10049
    buffer_load_dword v15, v4, s[8:11], s37 offen sc1
    s_sub_u32 s62, s62, 1
    s_cbranch_scc0 Ltok_15041
    s_movk_i32 s61, 10
    s_branch L_abort
Ltok_15041:
    s_branch Lpp_10050
L_proj_in_k:
    s_mov_b32 s53, 0
    buffer_load_dword v13, v4, s[8:11], s37 offen sc1
    buffer_load_dword v14, v4, s[8:11], s37 offen sc1
    buffer_load_dword v15, v4, s[8:11], s37 offen sc1
    s_branch Lpp_10050
Lpl_10049:
    s_mov_b32 m0, s39
    s_add_u32 s43, s38, 4096
    buffer_load_dwordx4 v2, s[8:11], s38 offen offset:0 lds
    buffer_load_dwordx4 v2, s[8:11], s38 offen offset:1024 lds
    buffer_load_dwordx4 v2, s[8:11], s38 offen offset:2048 lds
    buffer_load_dwordx4 v2, s[8:11], s38 offen offset:3072 lds
    s_add_u32 m0, s39, 4096
    s_add_u32 s38, s38, 32768
    buffer_load_dwordx4 v2, s[8:11], s43 offen offset:0 lds
    buffer_load_dwordx4 v2, s[8:11], s43 offen offset:1024 lds
    buffer_load_dwordx4 v2, s[8:11], s43 offen offset:2048 lds
    buffer_load_dwordx4 v2, s[8:11], s43 offen offset:3072 lds
    s_mov_b32 m0, s52
    s_add_u32 s37, s37, 2048
    buffer_load_dwordx4 v8, s[8:11], s51 offen lds
    s_add_u32 s51, s51, 4096
    s_xor_b32 s39, s39, 32768
    s_xor_b32 s52, s52, 4096
    s_add_u32 s40, s40, 1
    s_cmp_ge_u32 s40, 64
    s_cselect_b32 s37, 5636096, s37
    buffer_load_dword v7, v4, s[8:11], s37 offen sc1
    s_waitcnt vmcnt(0)
    s_branch L_proj_e2_k
Lpe_10048:
    s_mov_b32 m0, s39
    s_add_u32 s43, s38, 4096
    buffer_load_dwordx4 v2, s[8:11], s38 offen offset:0 lds
    buffer_load_dwordx4 v2, s[8:11], s38 offen offset:1024 lds
    buffer_load_dwordx4 v2, s[8:11], s38 offen offset:2048 lds
    buffer_load_dwordx4 v2, s[8:11], s38 offen offset:3072 lds
    s_add_u32 m0, s39, 4096
    s_add_u32 s38, s38, 32768
    buffer_load_dwordx4 v2, s[8:11], s43 offen offset:0 lds
    buffer_load_dwordx4 v2, s[8:11], s43 offen offset:1024 lds
    buffer_load_dwordx4 v2, s[8:11], s43 offen offset:2048 lds
    buffer_load_dwordx4 v2, s[8:11], s43 offen offset:3072 lds
    s_mov_b32 m0, s52
    s_add_u32 s37, s37, 2048
    buffer_load_dwordx4 v8, s[8:11], s51 offen lds
    s_add_u32 s51, s51, 4096
    s_xor_b32 s39, s39, 32768
    s_xor_b32 s52, s52, 4096
    s_add_u32 s40, s40, 1
    s_cmp_ge_u32 s40, 64
    s_cselect_b32 s37, 5636096, s37
    buffer_load_dword v7, v4, s[8:11], s37 offen sc1
    s_waitcnt vmcnt(10)
    s_mov_b64 exec, 1
    buffer_store_dword v6, v5, s[8:11], s36 offen sc1
    s_mov_b64 exec, -1
    s_waitcnt vmcnt(1)
    s_branch L_proj_e2_k
Lpb_10043:
    s_waitcnt lgkmcnt(7)
    v_mfma_f32_32x32x16_bf16 v[32:47], a[128:131], v[192:195], v[32:47]
    ds_read_b128 v[224:227], v1 offset:24576
    v_max_f32 v97, 0, v97
    s_mov_b32 m0, s39
    s_add_u32 s43, s38, 4096
    buffer_load_dwordx4 v2, s[8:11], s38 offen offset:0 lds
    buffer_load_dwordx4 v2, s[8:11], s38 offen offset:1024 lds
    s_waitcnt lgkmcnt(7)
    v_mfma_f32_32x32x16_bf16 v[32:47], a[136:139], v[196:199], v[32:47]
    ds_read_b128 v[228:231], v1 offset:25600
    v_cvt_pk_bf16_f32 v98, v96, v97
    v_lshlrev_b32 v96, 16, v98
    buffer_load_dwordx4 v2, s[8:11], s38 offen offset:2048 lds
    buffer_load_dwordx4 v2, s[8:11], s38 offen offset:3072 lds
    v_mfma_f32_32x32x16_bf16 v[48:63], a[68:71], v[160:163], v[48:63]
    v_and_b32 v97, 0xffff0000, v98
    s_add_u32 m0, s39, 4096
    s_add_u32 s38, s38, 32768
    buffer_load_dwordx4 v2, s[8:11], s43 offen offset:0 lds
    buffer_load_dwordx4 v2, s[8:11], s43 offen offset:1024 lds
    s_waitcnt lgkmcnt(7)
    v_mfma_f32_32x32x16_bf16 v[32:47], a[144:147], v[200:203], v[32:47]
    ds_read_b128 v[232:235], v1 offset:26624
    v_add_f32 v97, 925353388, v97
    v_cvt_pk_bf16_f32 v98, v97, v97
    buffer_load_dwordx4 v2, s[8:11], s43 offen offset:2048 lds
    buffer_load_dwordx4 v2, s[8:11], s43 offen offset:3072 lds
    s_waitcnt lgkmcnt(7)
    v_mfma_f32_32x32x16_bf16 v[32:47], a[152:155], v[204:207], v[32:47]
    ds_read_b128 v[236:239], v1 offset:27648
    v_lshlrev_b32 v97, 16, v98
    s_mov_b32 m0, s52
    s_add_u32 s37, s37, 2048
    buffer_load_dwordx4 v8, s[8:11], s51 offen lds
    s_add_u32 s51, s51, 4096
    s_xor_b32 s39, s39, 32768
    s_xor_b32 s52, s52, 4096
    s_add_u32 s40, s40, 1
    s_cmp_ge_u32 s40, 64
    s_cselect_b32 s37, 5636096, s37
    buffer_load_dword v7, v4, s[8:11], s37 offen sc1
    v_mfma_f32_32x32x16_bf16 v[48:63], a[76:79], v[164:167], v[48:63]
    v_sqrt_f32 v97, v97
    s_nop 0
    v_cvt_pk_bf16_f32 v98, v97, v97
    s_waitcnt lgkmcnt(7)
    v_mfma_f32_32x32x16_bf16 v[32:47], a[160:163], v[208:211], v[32:47]
    ds_read_b128 v[240:243], v1 offset:28672
    v_lshlrev_b32 v97, 16, v98
    s_waitcnt lgkmcnt(7)
    v_mfma_f32_32x32x16_bf16 v[32:47], a[168:171], v[212:215], v[32:47]
    ds_read_b128 v[244:247], v1 offset:29696
    v_rcp_f32 v97, v97
    s_nop 0
    v_mov_b32 v100, v97
    v_mfma_f32_32x32x16_bf16 v[48:63], a[84:87], v[168:171], v[48:63]
    v_mul_f32 v102, -v96, v97
    s_waitcnt lgkmcnt(7)
    v_mfma_f32_32x32x16_bf16 v[32:47], a[176:179], v[216:219], v[32:47]
    ds_read_b128 v[248:251], v1 offset:30720
    s_waitcnt lgkmcnt(7)
    v_mfma_f32_32x32x16_bf16 v[32:47], a[184:187], v[220:223], v[32:47]
    ds_read_b128 v[252:255], v1 offset:31744
    v_mfma_f32_32x32x16_bf16 v[48:63], a[92:95], v[172:175], v[48:63]
    s_waitcnt lgkmcnt(7)
    v_mfma_f32_32x32x16_bf16 v[32:47], a[192:195], v[224:227], v[32:47]
    s_waitcnt lgkmcnt(6)
    v_mfma_f32_32x32x16_bf16 v[32:47], a[200:203], v[228:231], v[32:47]
    v_mfma_f32_32x32x16_bf16 v[48:63], a[100:103], v[176:179], v[48:63]
    s_waitcnt lgkmcnt(5)
    v_mfma_f32_32x32x16_bf16 v[32:47], a[208:211], v[232:235], v[32:47]
    s_waitcnt lgkmcnt(4)
    v_mfma_f32_32x32x16_bf16 v[32:47], a[216:219], v[236:239], v[32:47]
    v_mfma_f32_32x32x16_bf16 v[48:63], a[108:111], v[180:183], v[48:63]
    s_waitcnt lgkmcnt(3)
    v_mfma_f32_32x32x16_bf16 v[32:47], a[224:227], v[240:243], v[32:47]
    s_waitcnt lgkmcnt(2)
    v_mfma_f32_32x32x16_bf16 v[32:47], a[232:235], v[244:247], v[32:47]
    v_mfma_f32_32x32x16_bf16 v[48:63], a[116:119], v[184:187], v[48:63]
    s_waitcnt lgkmcnt(1)
    v_mfma_f32_32x32x16_bf16 v[32:47], a[240:243], v[248:251], v[32:47]
    s_waitcnt lgkmcnt(0)
    v_mfma_f32_32x32x16_bf16 v[32:47], a[248:251], v[252:255], v[32:47]
    v_mfma_f32_32x32x16_bf16 v[48:63], a[124:127], v[188:191], v[48:63]
    v_mfma_f32_32x32x16_bf16 v[48:63], a[132:135], v[192:195], v[48:63]
    v_mfma_f32_32x32x16_bf16 v[48:63], a[140:143], v[196:199], v[48:63]
    s_nop 8
    v_mul_f32 v32, v32, v100
    v_mul_f32 v33, v33, v100
    v_mul_f32 v34, v34, v100
    v_mfma_f32_32x32x16_bf16 v[48:63], a[148:151], v[200:203], v[48:63]
    v_mul_f32 v35, v35, v100
    v_mul_f32 v36, v36, v100
    v_mul_f32 v37, v37, v100
    v_mfma_f32_32x32x16_bf16 v[48:63], a[156:159], v[204:207], v[48:63]
    v_mul_f32 v38, v38, v100
    v_mul_f32 v39, v39, v100
    v_fmac_f32 v32, v64, v102
    v_mfma_f32_32x32x16_bf16 v[48:63], a[164:167], v[208:211], v[48:63]
    v_fmac_f32 v33, v65, v102
    v_fmac_f32 v34, v66, v102
    v_fmac_f32 v35, v67, v102
    v_mfma_f32_32x32x16_bf16 v[48:63], a[172:175], v[212:215], v[48:63]
    v_fmac_f32 v36, v68, v102
    v_fmac_f32 v37, v69, v102
    v_fmac_f32 v38, v70, v102
    v_mfma_f32_32x32x16_bf16 v[48:63], a[180:183], v[216:219], v[48:63]
    v_fmac_f32 v39, v71, v102
    v_cvt_pk_bf16_f32 v16, v32, v33
    v_cvt_pk_bf16_f32 v17, v34, v35
    v_mfma_f32_32x32x16_bf16 v[48:63], a[188:191], v[220:223], v[48:63]
    v_cvt_pk_bf16_f32 v18, v36, v37
    v_cvt_pk_bf16_f32 v19, v38, v39
    buffer_store_dwordx4 v[16:19], v3, s[8:11], s35 offen offset:0 sc1
    v_mfma_f32_32x32x16_bf16 v[48:63], a[196:199], v[224:227], v[48:63]
    v_mul_f32 v40, v40, v100
    v_mul_f32 v41, v41, v100
    v_mul_f32 v42, v42, v100
    v_mfma_f32_32x32x16_bf16 v[48:63], a[204:207], v[228:231], v[48:63]
    v_mul_f32 v43, v43, v100
    v_mul_f32 v44, v44, v100
    v_mul_f32 v45, v45, v100
    v_mfma_f32_32x32x16_bf16 v[48:63], a[212:215], v[232:235], v[48:63]
    v_mul_f32 v46, v46, v100
    v_mul_f32 v47, v47, v100
    v_fmac_f32 v40, v72, v102
    v_mfma_f32_32x32x16_bf16 v[48:63], a[220:223], v[236:239], v[48:63]
    v_fmac_f32 v41, v73, v102
    v_fmac_f32 v42, v74, v102
    v_fmac_f32 v43, v75, v102
    v_mfma_f32_32x32x16_bf16 v[48:63], a[228:231], v[240:243], v[48:63]
    v_fmac_f32 v44, v76, v102
    v_fmac_f32 v45, v77, v102
    v_fmac_f32 v46, v78, v102
    v_mfma_f32_32x32x16_bf16 v[48:63], a[236:239], v[244:247], v[48:63]
    v_fmac_f32 v47, v79, v102
    v_cvt_pk_bf16_f32 v20, v40, v41
    v_cvt_pk_bf16_f32 v21, v42, v43
    v_mfma_f32_32x32x16_bf16 v[48:63], a[244:247], v[248:251], v[48:63]
    v_cvt_pk_bf16_f32 v22, v44, v45
    v_cvt_pk_bf16_f32 v23, v46, v47
    buffer_store_dwordx4 v[20:23], v3, s[8:11], s35 offen offset:512 sc1
    v_mfma_f32_32x32x16_bf16 v[48:63], a[252:255], v[252:255], v[48:63]
    v_xor_b32 v1, 0x8000, v1
    s_nop 10
    v_pk_mul_f32 v[48:49], v[48:49], v[100:101] op_sel_hi:[1,0]
    v_pk_mul_f32 v[50:51], v[50:51], v[100:101] op_sel_hi:[1,0]
    v_pk_mul_f32 v[52:53], v[52:53], v[100:101] op_sel_hi:[1,0]
    v_pk_mul_f32 v[54:55], v[54:55], v[100:101] op_sel_hi:[1,0]
    v_pk_fma_f32 v[48:49], v[80:81], v[102:103], v[48:49] op_sel_hi:[1,0,1]
    v_pk_fma_f32 v[50:51], v[82:83], v[102:103], v[50:51] op_sel_hi:[1,0,1]
    v_pk_fma_f32 v[52:53], v[84:85], v[102:103], v[52:53] op_sel_hi:[1,0,1]
    v_pk_fma_f32 v[54:55], v[86:87], v[102:103], v[54:55] op_sel_hi:[1,0,1]
    v_cvt_pk_bf16_f32 v24, v48, v49
    v_cvt_pk_bf16_f32 v25, v50, v51
    v_cvt_pk_bf16_f32 v26, v52, v53
    v_cvt_pk_bf16_f32 v27, v54, v55
    buffer_store_dwordx4 v[24:27], v3, s[8:11], s35 offen offset:2048 sc1
    v_pk_mul_f32 v[56:57], v[56:57], v[100:101] op_sel_hi:[1,0]
    v_pk_mul_f32 v[58:59], v[58:59], v[100:101] op_sel_hi:[1,0]
    v_pk_mul_f32 v[60:61], v[60:61], v[100:101] op_sel_hi:[1,0]
    v_pk_mul_f32 v[62:63], v[62:63], v[100:101] op_sel_hi:[1,0]
    v_pk_fma_f32 v[56:57], v[88:89], v[102:103], v[56:57] op_sel_hi:[1,0,1]
    v_pk_fma_f32 v[58:59], v[90:91], v[102:103], v[58:59] op_sel_hi:[1,0,1]
    v_pk_fma_f32 v[60:61], v[92:93], v[102:103], v[60:61] op_sel_hi:[1,0,1]
    v_pk_fma_f32 v[62:63], v[94:95], v[102:103], v[62:63] op_sel_hi:[1,0,1]
    v_cvt_pk_bf16_f32 v28, v56, v57
    v_cvt_pk_bf16_f32 v29, v58, v59
    v_cvt_pk_bf16_f32 v30, v60, v61
    v_cvt_pk_bf16_f32 v31, v62, v63
    buffer_store_dwordx4 v[28:31], v3, s[8:11], s35 offen offset:2560 sc1
    s_add_u32 s35, s35, 262144
    s_add_u32 s34, s34, 1
    s_mov_b32 s36, s50
    s_add_u32 s50, s50, 8192
    s_mov_b32 s53, 1
    s_waitcnt vmcnt(4)
    s_branch L_proj_e2_k
Lpb_10044:
    v_mfma_f32_32x32x16_bf16 v[48:63], a[84:87], v[168:171], v[48:63]
    v_mul_f32 v102, -v96, v97
    s_mov_b32 m0, s39
    s_add_u32 s43, s38, 4096
    buffer_load_dwordx4 v2, s[8:11], s38 offen offset:0 lds
    buffer_load_dwordx4 v2, s[8:11], s38 offen offset:1024 lds
    s_waitcnt lgkmcnt(7)
    v_mfma_f32_32x32x16_bf16 v[32:47], a[176:179], v[216:219], v[32:47]
    ds_read_b128 v[248:251], v1 offset:30720
    buffer_load_dwordx4 v2, s[8:11], s38 offen offset:2048 lds
    buffer_load_dwordx4 v2, s[8:11], s38 offen offset:3072 lds
    s_waitcnt lgkmcnt(7)
    v_mfma_f32_32x32x16_bf16 v[32:47], a[184:187], v[220:223], v[32:47]
    ds_read_b128 v[252:255], v1 offset:31744
    s_add_u32 m0, s39, 4096
    s_add_u32 s38, s38, 32768
    buffer_load_dwordx4 v2, s[8:11], s43 offen offset:0 lds
    buffer_load_dwordx4 v2, s[8:11], s43 offen offset:1024 lds
    v_mfma_f32_32x32x16_bf16 v[48:63], a[92:95], v[172:175], v[48:63]
    buffer_load_dwordx4 v2, s[8:11], s43 offen offset:2048 lds
    buffer_load_dwordx4 v2, s[8:11], s43 offen offset:3072 lds
    s_waitcnt lgkmcnt(7)
    v_mfma_f32_32x32x16_bf16 v[32:47], a[192:195], v[224:227], v[32:47]
    s_mov_b32 m0, s52
    s_add_u32 s37, s37, 2048
    buffer_load_dwordx4 v8, s[8:11], s51 offen lds
    s_add_u32 s51, s51, 4096
    s_xor_b32 s39, s39, 32768
    s_xor_b32 s52, s52, 4096
    s_add_u32 s40, s40, 1
    s_cmp_ge_u32 s40, 64
    s_cselect_b32 s37, 5636096, s37
    buffer_load_dword v7, v4, s[8:11], s37 offen sc1
    s_waitcnt lgkmcnt(6)
    v_mfma_f32_32x32x16_bf16 v[32:47], a[200:203], v[228:231], v[32:47]
    v_mfma_f32_32x32x16_bf16 v[48:63], a[100:103], v[176:179], v[48:63]
    s_waitcnt lgkmcnt(5)
    v_mfma_f32_32x32x16_bf16 v[32:47], a[208:211], v[232:235], v[32:47]
    s_waitcnt lgkmcnt(4)
    v_mfma_f32_32x32x16_bf16 v[32:47], a[216:219], v[236:239], v[32:47]
    v_mfma_f32_32x32x16_bf16 v[48:63], a[108:111], v[180:183], v[48:63]
    s_waitcnt lgkmcnt(3)
    v_mfma_f32_32x32x16_bf16 v[32:47], a[224:227], v[240:243], v[32:47]
    s_waitcnt lgkmcnt(2)
    v_mfma_f32_32x32x16_bf16 v[32:47], a[232:235], v[244:247], v[32:47]
    v_mfma_f32_32x32x16_bf16 v[48:63], a[116:119], v[184:187], v[48:63]
    s_waitcnt lgkmcnt(1)
    v_mfma_f32_32x32x16_bf16 v[32:47], a[240:243], v[248:251], v[32:47]
    s_waitcnt lgkmcnt(0)
    v_mfma_f32_32x32x16_bf16 v[32:47], a[248:251], v[252:255], v[32:47]
    v_mfma_f32_32x32x16_bf16 v[48:63], a[124:127], v[188:191], v[48:63]
    v_mfma_f32_32x32x16_bf16 v[48:63], a[132:135], v[192:195], v[48:63]
    v_mfma_f32_32x32x16_bf16 v[48:63], a[140:143], v[196:199], v[48:63]
    s_nop 8
    v_mul_f32 v32, v32, v100
    v_mul_f32 v33, v33, v100
    v_mul_f32 v34, v34, v100
    v_mfma_f32_32x32x16_bf16 v[48:63], a[148:151], v[200:203], v[48:63]
    v_mul_f32 v35, v35, v100
    v_mul_f32 v36, v36, v100
    v_mul_f32 v37, v37, v100
    v_mfma_f32_32x32x16_bf16 v[48:63], a[156:159], v[204:207], v[48:63]
    v_mul_f32 v38, v38, v100
    v_mul_f32 v39, v39, v100
    v_fmac_f32 v32, v64, v102
    v_mfma_f32_32x32x16_bf16 v[48:63], a[164:167], v[208:211], v[48:63]
    v_fmac_f32 v33, v65, v102
    v_fmac_f32 v34, v66, v102
    v_fmac_f32 v35, v67, v102
    v_mfma_f32_32x32x16_bf16 v[48:63], a[172:175], v[212:215], v[48:63]
    v_fmac_f32 v36, v68, v102
    v_fmac_f32 v37, v69, v102
    v_fmac_f32 v38, v70, v102
    v_mfma_f32_32x32x16_bf16 v[48:63], a[180:183], v[216:219], v[48:63]
    v_fmac_f32 v39, v71, v102
    v_cvt_pk_bf16_f32 v16, v32, v33
    v_cvt_pk_bf16_f32 v17, v34, v35
    v_mfma_f32_32x32x16_bf16 v[48:63], a[188:191], v[220:223], v[48:63]
    v_cvt_pk_bf16_f32 v18, v36, v37
    v_cvt_pk_bf16_f32 v19, v38, v39
    buffer_store_dwordx4 v[16:19], v3, s[8:11], s35 offen offset:0 sc1
    v_mfma_f32_32x32x16_bf16 v[48:63], a[196:199], v[224:227], v[48:63]
    v_mul_f32 v40, v40, v100
    v_mul_f32 v41, v41, v100
    v_mul_f32 v42, v42, v100
    v_mfma_f32_32x32x16_bf16 v[48:63], a[204:207], v[228:231], v[48:63]
    v_mul_f32 v43, v43, v100
    v_mul_f32 v44, v44, v100
    v_mul_f32 v45, v45, v100
    v_mfma_f32_32x32x16_bf16 v[48:63], a[212:215], v[232:235], v[48:63]
    v_mul_f32 v46, v46, v100
    v_mul_f32 v47, v47, v100
    v_fmac_f32 v40, v72, v102
    v_mfma_f32_32x32x16_bf16 v[48:63], a[220:223], v[236:239], v[48:63]
    v_fmac_f32 v41, v73, v102
    v_fmac_f32 v42, v74, v102
    v_fmac_f32 v43, v75, v102
    v_mfma_f32_32x32x16_bf16 v[48:63], a[228:231], v[240:243], v[48:63]
    v_fmac_f32 v44, v76, v102
    v_fmac_f32 v45, v77, v102
    v_fmac_f32 v46, v78, v102
    v_mfma_f32_32x32x16_bf16 v[48:63], a[236:239], v[244:247], v[48:63]
    v_fmac_f32 v47, v79, v102
    v_cvt_pk_bf16_f32 v20, v40, v41
    v_cvt_pk_bf16_f32 v21, v42, v43
    v_mfma_f32_32x32x16_bf16 v[48:63], a[244:247], v[248:251], v[48:63]
    v_cvt_pk_bf16_f32 v22, v44, v45
    v_cvt_pk_bf16_f32 v23, v46, v47
    buffer_store_dwordx4 v[20:23], v3, s[8:11], s35 offen offset:512 sc1
    v_mfma_f32_32x32x16_bf16 v[48:63], a[252:255], v[252:255], v[48:63]
    v_xor_b32 v1, 0x8000, v1
    s_nop 10
    v_pk_mul_f32 v[48:49], v[48:49], v[100:101] op_sel_hi:[1,0]
    v_pk_mul_f32 v[50:51], v[50:51], v[100:101] op_sel_hi:[1,0]
    v_pk_mul_f32 v[52:53], v[52:53], v[100:101] op_sel_hi:[1,0]
    v_pk_mul_f32 v[54:55], v[54:55], v[100:101] op_sel_hi:[1,0]
    v_pk_fma_f32 v[48:49], v[80:81], v[102:103], v[48:49] op_sel_hi:[1,0,1]
    v_pk_fma_f32 v[50:51], v[82:83], v[102:103], v[50:51] op_sel_hi:[1,0,1]
    v_pk_fma_f32 v[52:53], v[84:85], v[102:103], v[52:53] op_sel_hi:[1,0,1]
    v_pk_fma_f32 v[54:55], v[86:87], v[102:103], v[54:55] op_sel_hi:[1,0,1]
    v_cvt_pk_bf16_f32 v24, v48, v49
    v_cvt_pk_bf16_f32 v25, v50, v51
    v_cvt_pk_bf16_f32 v26, v52, v53
    v_cvt_pk_bf16_f32 v27, v54, v55
    buffer_store_dwordx4 v[24:27], v3, s[8:11], s35 offen offset:2048 sc1
    v_pk_mul_f32 v[56:57], v[56:57], v[100:101] op_sel_hi:[1,0]
    v_pk_mul_f32 v[58:59], v[58:59], v[100:101] op_sel_hi:[1,0]
    v_pk_mul_f32 v[60:61], v[60:61], v[100:101] op_sel_hi:[1,0]
    v_pk_mul_f32 v[62:63], v[62:63], v[100:101] op_sel_hi:[1,0]
    v_pk_fma_f32 v[56:57], v[88:89], v[102:103], v[56:57] op_sel_hi:[1,0,1]
    v_pk_fma_f32 v[58:59], v[90:91], v[102:103], v[58:59] op_sel_hi:[1,0,1]
    v_pk_fma_f32 v[60:61], v[92:93], v[102:103], v[60:61] op_sel_hi:[1,0,1]
    v_pk_fma_f32 v[62:63], v[94:95], v[102:103], v[62:63] op_sel_hi:[1,0,1]
    v_cvt_pk_bf16_f32 v28, v56, v57
    v_cvt_pk_bf16_f32 v29, v58, v59
    v_cvt_pk_bf16_f32 v30, v60, v61
    v_cvt_pk_bf16_f32 v31, v62, v63
    buffer_store_dwordx4 v[28:31], v3, s[8:11], s35 offen offset:2560 sc1
    s_add_u32 s35, s35, 262144
    s_add_u32 s34, s34, 1
    s_mov_b32 s36, s50
    s_add_u32 s50, s50, 8192
    s_mov_b32 s53, 1
    s_waitcnt vmcnt(4)
    s_branch L_proj_e2_k
Lpb_10045:
    s_waitcnt lgkmcnt(4)
    v_mfma_f32_32x32x16_bf16 v[32:47], a[216:219], v[236:239], v[32:47]
    s_mov_b32 m0, s39
    s_add_u32 s43, s38, 4096
    buffer_load_dwordx4 v2, s[8:11], s38 offen offset:0 lds
    buffer_load_dwordx4 v2, s[8:11], s38 offen offset:1024 lds
    v_mfma_f32_32x32x16_bf16 v[48:63], a[108:111], v[180:183], v[48:63]
    buffer_load_dwordx4 v2, s[8:11], s38 offen offset:2048 lds
    buffer_load_dwordx4 v2, s[8:11], s38 offen offset:3072 lds
    s_waitcnt lgkmcnt(3)
    v_mfma_f32_32x32x16_bf16 v[32:47], a[224:227], v[240:243], v[32:47]
    s_add_u32 m0, s39, 4096
    s_add_u32 s38, s38, 32768
    buffer_load_dwordx4 v2, s[8:11], s43 offen offset:0 lds
    buffer_load_dwordx4 v2, s[8:11], s43 offen offset:1024 lds
    s_waitcnt lgkmcnt(2)
    v_mfma_f32_32x32x16_bf16 v[32:47], a[232:235], v[244:247], v[32:47]
    buffer_load_dwordx4 v2, s[8:11], s43 offen offset:2048 lds
    buffer_load_dwordx4 v2, s[8:11], s43 offen offset:3072 lds
    v_mfma_f32_32x32x16_bf16 v[48:63], a[116:119], v[184:187], v[48:63]
    s_mov_b32 m0, s52
    s_add_u32 s37, s37, 2048
    buffer_load_dwordx4 v8, s[8:11], s51 offen lds
    s_add_u32 s51, s51, 4096
    s_xor_b32 s39, s39, 32768
    s_xor_b32 s52, s52, 4096
    s_add_u32 s40, s40, 1
    s_cmp_ge_u32 s40, 64
    s_cselect_b32 s37, 5636096, s37
    buffer_load_dword v7, v4, s[8:11], s37 offen sc1
    s_waitcnt lgkmcnt(1)
    v_mfma_f32_32x32x16_bf16 v[32:47], a[240:243], v[248:251], v[32:47]
    s_waitcnt lgkmcnt(0)
    v_mfma_f32_32x32x16_bf16 v[32:47], a[248:251], v[252:255], v[32:47]
    v_mfma_f32_32x32x16_bf16 v[48:63], a[124:127], v[188:191], v[48:63]
    v_mfma_f32_32x32x16_bf16 v[48:63], a[132:135], v[192:195], v[48:63]
    v_mfma_f32_32x32x16_bf16 v[48:63], a[140:143], v[196:199], v[48:63]
    s_nop 8
    v_mul_f32 v32, v32, v100
    v_mul_f32 v33, v33, v100
    v_mul_f32 v34, v34, v100
    v_mfma_f32_32x32x16_bf16 v[48:63], a[148:151], v[200:203], v[48:63]
    v_mul_f32 v35, v35, v100
    v_mul_f32 v36, v36, v100
    v_mul_f32 v37, v37, v100
    v_mfma_f32_32x32x16_bf16 v[48:63], a[156:159], v[204:207], v[48:63]
    v_mul_f32 v38, v38, v100
    v_mul_f32 v39, v39, v100
    v_fmac_f32 v32, v64, v102
    v_mfma_f32_32x32x16_bf16 v[48:63], a[164:167], v[208:211], v[48:63]
    v_fmac_f32 v33, v65, v102
    v_fmac_f32 v34, v66, v102
    v_fmac_f32 v35, v67, v102
    v_mfma_f32_32x32x16_bf16 v[48:63], a[172:175], v[212:215], v[48:63]
    v_fmac_f32 v36, v68, v102
    v_fmac_f32 v37, v69, v102
    v_fmac_f32 v38, v70, v102
    v_mfma_f32_32x32x16_bf16 v[48:63], a[180:183], v[216:219], v[48:63]
    v_fmac_f32 v39, v71, v102
    v_cvt_pk_bf16_f32 v16, v32, v33
    v_cvt_pk_bf16_f32 v17, v34, v35
    v_mfma_f32_32x32x16_bf16 v[48:63], a[188:191], v[220:223], v[48:63]
    v_cvt_pk_bf16_f32 v18, v36, v37
    v_cvt_pk_bf16_f32 v19, v38, v39
    buffer_store_dwordx4 v[16:19], v3, s[8:11], s35 offen offset:0 sc1
    v_mfma_f32_32x32x16_bf16 v[48:63], a[196:199], v[224:227], v[48:63]
    v_mul_f32 v40, v40, v100
    v_mul_f32 v41, v41, v100
    v_mul_f32 v42, v42, v100
    v_mfma_f32_32x32x16_bf16 v[48:63], a[204:207], v[228:231], v[48:63]
    v_mul_f32 v43, v43, v100
    v_mul_f32 v44, v44, v100
    v_mul_f32 v45, v45, v100
    v_mfma_f32_32x32x16_bf16 v[48:63], a[212:215], v[232:235], v[48:63]
    v_mul_f32 v46, v46, v100
    v_mul_f32 v47, v47, v100
    v_fmac_f32 v40, v72, v102
    v_mfma_f32_32x32x16_bf16 v[48:63], a[220:223], v[236:239], v[48:63]
    v_fmac_f32 v41, v73, v102
    v_fmac_f32 v42, v74, v102
    v_fmac_f32 v43, v75, v102
    v_mfma_f32_32x32x16_bf16 v[48:63], a[228:231], v[240:243], v[48:63]
    v_fmac_f32 v44, v76, v102
    v_fmac_f32 v45, v77, v102
    v_fmac_f32 v46, v78, v102
    v_mfma_f32_32x32x16_bf16 v[48:63], a[236:239], v[244:247], v[48:63]
    v_fmac_f32 v47, v79, v102
    v_cvt_pk_bf16_f32 v20, v40, v41
    v_cvt_pk_bf16_f32 v21, v42, v43
    v_mfma_f32_32x32x16_bf16 v[48:63], a[244:247], v[248:251], v[48:63]
    v_cvt_pk_bf16_f32 v22, v44, v45
    v_cvt_pk_bf16_f32 v23, v46, v47
    buffer_store_dwordx4 v[20:23], v3, s[8:11], s35 offen offset:512 sc1
    v_mfma_f32_32x32x16_bf16 v[48:63], a[252:255], v[252:255], v[48:63]
    v_xor_b32 v1, 0x8000, v1
    s_nop 10
    v_pk_mul_f32 v[48:49], v[48:49], v[100:101] op_sel_hi:[1,0]
    v_pk_mul_f32 v[50:51], v[50:51], v[100:101] op_sel_hi:[1,0]
    v_pk_mul_f32 v[52:53], v[52:53], v[100:101] op_sel_hi:[1,0]
    v_pk_mul_f32 v[54:55], v[54:55], v[100:101] op_sel_hi:[1,0]
    v_pk_fma_f32 v[48:49], v[80:81], v[102:103], v[48:49] op_sel_hi:[1,0,1]
    v_pk_fma_f32 v[50:51], v[82:83], v[102:103], v[50:51] op_sel_hi:[1,0,1]
    v_pk_fma_f32 v[52:53], v[84:85], v[102:103], v[52:53] op_sel_hi:[1,0,1]
    v_pk_fma_f32 v[54:55], v[86:87], v[102:103], v[54:55] op_sel_hi:[1,0,1]
    v_cvt_pk_bf16_f32 v24, v48, v49
    v_cvt_pk_bf16_f32 v25, v50, v51
    v_cvt_pk_bf16_f32 v26, v52, v53
    v_cvt_pk_bf16_f32 v27, v54, v55
    buffer_store_dwordx4 v[24:27], v3, s[8:11], s35 offen offset:2048 sc1
    v_pk_mul_f32 v[56:57], v[56:57], v[100:101] op_sel_hi:[1,0]
    v_pk_mul_f32 v[58:59], v[58:59], v[100:101] op_sel_hi:[1,0]
    v_pk_mul_f32 v[60:61], v[60:61], v[100:101] op_sel_hi:[1,0]
    v_pk_mul_f32 v[62:63], v[62:63], v[100:101] op_sel_hi:[1,0]
    v_pk_fma_f32 v[56:57], v[88:89], v[102:103], v[56:57] op_sel_hi:[1,0,1]
    v_pk_fma_f32 v[58:59], v[90:91], v[102:103], v[58:59] op_sel_hi:[1,0,1]
    v_pk_fma_f32 v[60:61], v[92:93], v[102:103], v[60:61] op_sel_hi:[1,0,1]
    v_pk_fma_f32 v[62:63], v[94:95], v[102:103], v[62:63] op_sel_hi:[1,0,1]
    v_cvt_pk_bf16_f32 v28, v56, v57
    v_cvt_pk_bf16_f32 v29, v58, v59
    v_cvt_pk_bf16_f32 v30, v60, v61
    v_cvt_pk_bf16_f32 v31, v62, v63
    buffer_store_dwordx4 v[28:31], v3, s[8:11], s35 offen offset:2560 sc1
    s_add_u32 s35, s35, 262144
    s_add_u32 s34, s34, 1
    s_mov_b32 s36, s50
    s_add_u32 s50, s50, 8192
    s_mov_b32 s53, 1
    s_waitcnt vmcnt(4)
    s_branch L_proj_e2_k
Lpb_10046:
    v_mfma_f32_32x32x16_bf16 v[48:63], a[132:135], v[192:195], v[48:63]
    s_mov_b32 m0, s39
    s_add_u32 s43, s38, 4096
    buffer_load_dwordx4 v2, s[8:11], s38 offen offset:0 lds
    buffer_load_dwordx4 v2, s[8:11], s38 offen offset:1024 lds
    v_mfma_f32_32x32x16_bf16 v[48:63], a[140:143], v[196:199], v[48:63]
    s_nop 0
    v_mul_f32 v32, v32, v100
    v_mul_f32 v33, v33, v100
    v_mul_f32 v34, v34, v100
    buffer_load_dwordx4 v2, s[8:11], s38 offen offset:2048 lds
    buffer_load_dwordx4 v2, s[8:11], s38 offen offset:3072 lds
    v_mfma_f32_32x32x16_bf16 v[48:63], a[148:151], v[200:203], v[48:63]
    v_mul_f32 v35, v35, v100
    v_mul_f32 v36, v36, v100
    v_mul_f32 v37, v37, v100
    s_add_u32 m0, s39, 4096
    s_add_u32 s38, s38, 32768
    buffer_load_dwordx4 v2, s[8:11], s43 offen offset:0 lds
    buffer_load_dwordx4 v2, s[8:11], s43 offen offset:1024 lds
    v_mfma_f32_32x32x16_bf16 v[48:63], a[156:159], v[204:207], v[48:63]
    v_mul_f32 v38, v38, v100
    v_mul_f32 v39, v39, v100
    v_fmac_f32 v32, v64, v102
    buffer_load_dwordx4 v2, s[8:11], s43 offen offset:2048 lds
    buffer_load_dwordx4 v2, s[8:11], s43 offen offset:3072 lds
    v_mfma_f32_32x32x16_bf16 v[48:63], a[164:167], v[208:211], v[48:63]
    v_fmac_f32 v33, v65, v102
    v_fmac_f32 v34, v66, v102
    v_fmac_f32 v35, v67, v102
    s_mov_b32 m0, s52
    s_add_u32 s37, s37, 2048
    buffer_load_dwordx4 v8, s[8:11], s51 offen lds
    s_add_u32 s51, s51, 4096
    s_xor_b32 s39, s39, 32768
    s_xor_b32 s52, s52, 4096
    s_add_u32 s40, s40, 1
    s_cmp_ge_u32 s40, 64
    s_cselect_b32 s37, 5636096, s37
    buffer_load_dword v7, v4, s[8:11], s37 offen sc1
    v_mfma_f32_32x32x16_bf16 v[48:63], a[172:175], v[212:215], v[48:63]
    v_fmac_f32 v36, v68, v102
    v_fmac_f32 v37, v69, v102
    v_fmac_f32 v38, v70, v102
    v_mfma_f32_32x32x16_bf16 v[48:63], a[180:183], v[216:219], v[48:63]
    v_fmac_f32 v39, v71, v102
    v_cvt_pk_bf16_f32 v16, v32, v33
    v_cvt_pk_bf16_f32 v17, v34, v35
    v_mfma_f32_32x32x16_bf16 v[48:63], a[188:191], v[220:223], v[48:63]
    v_cvt_pk_bf16_f32 v18, v36, v37
    v_cvt_pk_bf16_f32 v19, v38, v39
    buffer_store_dwordx4 v[16:19], v3, s[8:11], s35 offen offset:0 sc1
    v_mfma_f32_32x32x16_bf16 v[48:63], a[196:199], v[224:227], v[48:63]
    v_mul_f32 v40, v40, v100
    v_mul_f32 v41, v41, v100
    v_mul_f32 v42, v42, v100
    v_mfma_f32_32x32x16_bf16 v[48:63], a[204:207], v[228:231], v[48:63]
    v_mul_f32 v43, v43, v100
    v_mul_f32 v44, v44, v100
    v_mul_f32 v45, v45, v100
    v_mfma_f32_32x32x16_bf16 v[48:63], a[212:215], v[232:235], v[48:63]
    v_mul_f32 v46, v46, v100
    v_mul_f32 v47, v47, v100
    v_fmac_f32 v40, v72, v102
    v_mfma_f32_32x32x16_bf16 v[48:63], a[220:223], v[236:239], v[48:63]
    v_fmac_f32 v41, v73, v102
    v_fmac_f32 v42, v74, v102
    v_fmac_f32 v43, v75, v102
    v_mfma_f32_32x32x16_bf16 v[48:63], a[228:231], v[240:243], v[48:63]
    v_fmac_f32 v44, v76, v102
    v_fmac_f32 v45, v77, v102
    v_fmac_f32 v46, v78, v102
    v_mfma_f32_32x32x16_bf16 v[48:63], a[236:239], v[244:247], v[48:63]
    v_fmac_f32 v47, v79, v102
    v_cvt_pk_bf16_f32 v20, v40, v41
    v_cvt_pk_bf16_f32 v21, v42, v43
    v_mfma_f32_32x32x16_bf16 v[48:63], a[244:247], v[248:251], v[48:63]
    v_cvt_pk_bf16_f32 v22, v44, v45
    v_cvt_pk_bf16_f32 v23, v46, v47
    buffer_store_dwordx4 v[20:23], v3, s[8:11], s35 offen offset:512 sc1
    v_mfma_f32_32x32x16_bf16 v[48:63], a[252:255], v[252:255], v[48:63]
    v_xor_b32 v1, 0x8000, v1
    s_nop 10
    v_pk_mul_f32 v[48:49], v[48:49], v[100:101] op_sel_hi:[1,0]
    v_pk_mul_f32 v[50:51], v[50:51], v[100:101] op_sel_hi:[1,0]
    v_pk_mul_f32 v[52:53], v[52:53], v[100:101] op_sel_hi:[1,0]
    v_pk_mul_f32 v[54:55], v[54:55], v[100:101] op_sel_hi:[1,0]
    v_pk_fma_f32 v[48:49], v[80:81], v[102:103], v[48:49] op_sel_hi:[1,0,1]
    v_pk_fma_f32 v[50:51], v[82:83], v[102:103], v[50:51] op_sel_hi:[1,0,1]
    v_pk_fma_f32 v[52:53], v[84:85], v[102:103], v[52:53] op_sel_hi:[1,0,1]
    v_pk_fma_f32 v[54:55], v[86:87], v[102:103], v[54:55] op_sel_hi:[1,0,1]
    v_cvt_pk_bf16_f32 v24, v48, v49
    v_cvt_pk_bf16_f32 v25, v50, v51
    v_cvt_pk_bf16_f32 v26, v52, v53
    v_cvt_pk_bf16_f32 v27, v54, v55
    buffer_store_dwordx4 v[24:27], v3, s[8:11], s35 offen offset:2048 sc1
    v_pk_mul_f32 v[56:57], v[56:57], v[100:101] op_sel_hi:[1,0]
    v_pk_mul_f32 v[58:59], v[58:59], v[100:101] op_sel_hi:[1,0]
    v_pk_mul_f32 v[60:61], v[60:61], v[100:101] op_sel_hi:[1,0]
    v_pk_mul_f32 v[62:63], v[62:63], v[100:101] op_sel_hi:[1,0]
    v_pk_fma_f32 v[56:57], v[88:89], v[102:103], v[56:57] op_sel_hi:[1,0,1]
    v_pk_fma_f32 v[58:59], v[90:91], v[102:103], v[58:59] op_sel_hi:[1,0,1]
    v_pk_fma_f32 v[60:61], v[92:93], v[102:103], v[60:61] op_sel_hi:[1,0,1]
    v_pk_fma_f32 v[62:63], v[94:95], v[102:103], v[62:63] op_sel_hi:[1,0,1]
    v_cvt_pk_bf16_f32 v28, v56, v57
    v_cvt_pk_bf16_f32 v29, v58, v59
    v_cvt_pk_bf16_f32 v30, v60, v61
    v_cvt_pk_bf16_f32 v31, v62, v63
    buffer_store_dwordx4 v[28:31], v3, s[8:11], s35 offen offset:2560 sc1
    s_add_u32 s35, s35, 262144
    s_add_u32 s34, s34, 1
    s_mov_b32 s36, s50
    s_add_u32 s50, s50, 8192
    s_mov_b32 s53, 1
    s_waitcnt vmcnt(4)
    s_branch L_proj_e2_k
Lpb_10047:
    v_mfma_f32_32x32x16_bf16 v[48:63], a[196:199], v[224:227], v[48:63]
    v_mul_f32 v40, v40, v100
    v_mul_f32 v41, v41, v100
    v_mul_f32 v42, v42, v100
    s_mov_b32 m0, s39
    s_add_u32 s43, s38, 4096
    buffer_load_dwordx4 v2, s[8:11], s38 offen offset:0 lds
    buffer_load_dwordx4 v2, s[8:11], s38 offen offset:1024 lds
    v_mfma_f32_32x32x16_bf16 v[48:63], a[204:207], v[228:231], v[48:63]
    v_mul_f32 v43, v43, v100
    v_mul_f32 v44, v44, v100
    v_mul_f32 v45, v45, v100
    buffer_load_dwordx4 v2, s[8:11], s38 offen offset:2048 lds
    buffer_load_dwordx4 v2, s[8:11], s38 offen offset:3072 lds
    v_mfma_f32_32x32x16_bf16 v[48:63], a[212:215], v[232:235], v[48:63]
    v_mul_f32 v46, v46, v100
    v_mul_f32 v47, v47, v100
    v_fmac_f32 v40, v72, v102
    s_add_u32 m0, s39, 4096
    s_add_u32 s38, s38, 32768
    buffer_load_dwordx4 v2, s[8:11], s43 offen offset:0 lds
    buffer_load_dwordx4 v2, s[8:11], s43 offen offset:1024 lds
    v_mfma_f32_32x32x16_bf16 v[48:63], a[220:223], v[236:239], v[48:63]
    v_fmac_f32 v41, v73, v102
    v_fmac_f32 v42, v74, v102
    v_fmac_f32 v43, v75, v102
    buffer_load_dwordx4 v2, s[8:11], s43 offen offset:2048 lds
    buffer_load_dwordx4 v2, s[8:11], s43 offen offset:3072 lds
    v_mfma_f32_32x32x16_bf16 v[48:63], a[228:231], v[240:243], v[48:63]
    v_fmac_f32 v44, v76, v102
    v_fmac_f32 v45, v77, v102
    v_fmac_f32 v46, v78, v102
    s_mov_b32 m0, s52
    s_add_u32 s37, s37, 2048
    buffer_load_dwordx4 v8, s[8:11], s51 offen lds
    s_add_u32 s51, s51, 4096
    s_xor_b32 s39, s39, 32768
    s_xor_b32 s52, s52, 4096
    s_add_u32 s40, s40, 1
    s_cmp_ge_u32 s40, 64
    s_cselect_b32 s37, 5636096, s37
    buffer_load_dword v7, v4, s[8:11], s37 offen sc1
    v_mfma_f32_32x32x16_bf16 v[48:63], a[236:239], v[244:247], v[48:63]
    v_fmac_f32 v47, v79, v102
    v_cvt_pk_bf16_f32 v20, v40, v41
    v_cvt_pk_bf16_f32 v21, v42, v43
    v_mfma_f32_32x32x16_bf16 v[48:63], a[244:247], v[248:251], v[48:63]
    v_cvt_pk_bf16_f32 v22, v44, v45
    v_cvt_pk_bf16_f32 v23, v46, v47
    buffer_store_dwordx4 v[20:23], v3, s[8:11], s35 offen offset:512 sc1
    v_mfma_f32_32x32x16_bf16 v[48:63], a[252:255], v[252:255], v[48:63]
    v_xor_b32 v1, 0x8000, v1
    s_nop 10
    v_pk_mul_f32 v[48:49], v[48:49], v[100:101] op_sel_hi:[1,0]
    v_pk_mul_f32 v[50:51], v[50:51], v[100:101] op_sel_hi:[1,0]
    v_pk_mul_f32 v[52:53], v[52:53], v[100:101] op_sel_hi:[1,0]
    v_pk_mul_f32 v[54:55], v[54:55], v[100:101] op_sel_hi:[1,0]
    v_pk_fma_f32 v[48:49], v[80:81], v[102:103], v[48:49] op_sel_hi:[1,0,1]
    v_pk_fma_f32 v[50:51], v[82:83], v[102:103], v[50:51] op_sel_hi:[1,0,1]
    v_pk_fma_f32 v[52:53], v[84:85], v[102:103], v[52:53] op_sel_hi:[1,0,1]
    v_pk_fma_f32 v[54:55], v[86:87], v[102:103], v[54:55] op_sel_hi:[1,0,1]
    v_cvt_pk_bf16_f32 v24, v48, v49
    v_cvt_pk_bf16_f32 v25, v50, v51
    v_cvt_pk_bf16_f32 v26, v52, v53
    v_cvt_pk_bf16_f32 v27, v54, v55
    buffer_store_dwordx4 v[24:27], v3, s[8:11], s35 offen offset:2048 sc1
    v_pk_mul_f32 v[56:57], v[56:57], v[100:101] op_sel_hi:[1,0]
    v_pk_mul_f32 v[58:59], v[58:59], v[100:101] op_sel_hi:[1,0]
    v_pk_mul_f32 v[60:61], v[60:61], v[100:101] op_sel_hi:[1,0]
    v_pk_mul_f32 v[62:63], v[62:63], v[100:101] op_sel_hi:[1,0]
    v_pk_fma_f32 v[56:57], v[88:89], v[102:103], v[56:57] op_sel_hi:[1,0,1]
    v_pk_fma_f32 v[58:59], v[90:91], v[102:103], v[58:59] op_sel_hi:[1,0,1]
    v_pk_fma_f32 v[60:61], v[92:93], v[102:103], v[60:61] op_sel_hi:[1,0,1]
    v_pk_fma_f32 v[62:63], v[94:95], v[102:103], v[62:63] op_sel_hi:[1,0,1]
    v_cvt_pk_bf16_f32 v28, v56, v57
    v_cvt_pk_bf16_f32 v29, v58, v59
    v_cvt_pk_bf16_f32 v30, v60, v61
    v_cvt_pk_bf16_f32 v31, v62, v63
    buffer_store_dwordx4 v[28:31], v3, s[8:11], s35 offen offset:2560 sc1
    s_add_u32 s35, s35, 262144
    s_add_u32 s34, s34, 1
    s_mov_b32 s36, s50
    s_add_u32 s50, s50, 8192
    s_mov_b32 s53, 1
    s_waitcnt vmcnt(3)
    s_branch L_proj_e2_k
L_proj_e2_v:
    v_cmp_eq_u32 vcc, 0, v7
    s_barrier
    ds_read_b128 v[128:131], v1 offset:0
    ds_read_b128 v[132:135], v1 offset:1024
    ds_read_b128 v[136:139], v1 offset:2048
    ds_read_b128 v[140:143], v1 offset:3072
    ds_read_b128 v[144:147], v1 offset:4096
    ds_read_b128 v[148:151], v1 offset:5120
    ds_read_b128 v[152:155], v1 offset:6144
    ds_read_b128 v[156:159], v1 offset:7168
L_proj_e2_v_b:
    s_cbranch_vccnz Lpa_18041
    s_waitcnt lgkmcnt(7)
    v_mfma_f32_32x32x16_bf16 v[32:47], v[128:131], a[0:3], 0
    ds_read_b128 v[160:163], v1 offset:8192
    s_mov_b32 m0, s39
    s_add_u32 s43, s38, 4096
    buffer_load_dwordx4 v2, s[8:11], s38 offen offset:0 lds
    s_waitcnt lgkmcnt(7)
    v_mfma_f32_32x32x16_bf16 v[32:47], v[132:135], a[8:11], v[32:47]
    ds_read_b128 v[164:167], v1 offset:9216
    buffer_load_dwordx4 v2, s[8:11], s38 offen offset:1024 lds
    v_mfma_f32_32x32x16_bf16 v[48:63], v[128:131], a[4:7], 0
    buffer_load_dwordx4 v2, s[8:11], s38 offen offset:2048 lds
    s_waitcnt lgkmcnt(7)
    v_mfma_f32_32x32x16_bf16 v[32:47], v[136:139], a[16:19], v[32:47]
    ds_read_b128 v[168:171], v1 offset:10240
    ds_read_b64 v[96:97], v9 offset:0
    ds_read_b64 v[98:99], v9 offset:512
    buffer_load_dwordx4 v2, s[8:11], s38 offen offset:3072 lds
    s_waitcnt lgkmcnt(9)
    v_mfma_f32_32x32x16_bf16 v[32:47], v[140:143], a[24:27], v[32:47]
    ds_read_b128 v[172:175], v1 offset:11264
    ds_read_b64 v[100:101], v9 offset:1024
    s_add_u32 m0, s39, 4096
    s_add_u32 s38, s38, 32768
    buffer_load_dwordx4 v2, s[8:11], s43 offen offset:0 lds
    v_mfma_f32_32x32x16_bf16 v[48:63], v[132:135], a[12:15], v[48:63]
    ds_read_b64 v[102:103], v9 offset:1536
    ds_read_b64 v[104:105], v9 offset:2048
    buffer_load_dwordx4 v2, s[8:11], s43 offen offset:1024 lds
    s_waitcnt lgkmcnt(12)
    v_mfma_f32_32x32x16_bf16 v[32:47], v[144:147], a[32:35], v[32:47]
    ds_read_b128 v[176:179], v1 offset:12288
    ds_read_b64 v[106:107], v9 offset:2560
    buffer_load_dwordx4 v2, s[8:11], s43 offen offset:2048 lds
    s_waitcnt lgkmcnt(13)
    v_mfma_f32_32x32x16_bf16 v[32:47], v[148:151], a[40:43], v[32:47]
    ds_read_b128 v[180:183], v1 offset:13312
    ds_read_b64 v[108:109], v9 offset:3072
    ds_read_b64 v[110:111], v9 offset:3584
    buffer_load_dwordx4 v2, s[8:11], s43 offen offset:3072 lds
    v_mfma_f32_32x32x16_bf16 v[48:63], v[136:139], a[20:23], v[48:63]
    v_xor_b32 v9, 0x1000, v9
    s_mov_b32 m0, s52
    s_add_u32 s37, s37, 2048
    buffer_load_dwordx4 v8, s[8:11], s51 offen lds
    s_waitcnt lgkmcnt(15)
    v_mfma_f32_32x32x16_bf16 v[32:47], v[152:155], a[48:51], v[32:47]
    ds_read_b128 v[184:187], v1 offset:14336
    s_waitcnt lgkmcnt(10)
    v_add_f32 v96, v96, v98
    v_add_f32 v97, v97, v99
    s_add_u32 s51, s51, 4096
    s_xor_b32 s39, s39, 32768
    s_xor_b32 s52, s52, 4096
    s_add_u32 s40, s40, 1
    s_cmp_ge_u32 s40, 64
    s_cselect_b32 s37, 5636096, s37
    buffer_load_dword v7, v4, s[8:11], s37 offen sc1
    v_mfma_f32_32x32x16_bf16 v[32:47], v[156:159], a[56:59], v[32:47]
    ds_read_b128 v[188:191], v1 offset:15360
    s_waitcnt lgkmcnt(8)
    v_add_f32 v100, v100, v102
    v_mfma_f32_32x32x16_bf16 v[48:63], v[140:143], a[28:31], v[48:63]
    v_add_f32 v101, v101, v103
    s_waitcnt lgkmcnt(5)
    v_add_f32 v104, v104, v106
    v_mfma_f32_32x32x16_bf16 v[32:47], v[160:163], a[64:67], v[32:47]
    ds_read_b128 v[192:195], v1 offset:16384
    v_add_f32 v105, v105, v107
    v_mfma_f32_32x32x16_bf16 v[32:47], v[164:167], a[72:75], v[32:47]
    ds_read_b128 v[196:199], v1 offset:17408
    s_waitcnt lgkmcnt(4)
    v_add_f32 v108, v108, v110
    v_add_f32 v109, v109, v111
    v_mfma_f32_32x32x16_bf16 v[48:63], v[144:147], a[36:39], v[48:63]
    v_add_f32 v96, v96, v100
    v_mfma_f32_32x32x16_bf16 v[32:47], v[168:171], a[80:83], v[32:47]
    ds_read_b128 v[200:203], v1 offset:18432
    v_add_f32 v97, v97, v101
    v_add_f32 v104, v104, v108
    s_waitcnt vmcnt(10)
    s_mov_b64 exec, 1
    buffer_store_dword v6, v5, s[8:11], s36 offen sc1
    s_mov_b64 exec, -1
    v_mfma_f32_32x32x16_bf16 v[32:47], v[172:175], a[88:91], v[32:47]
    ds_read_b128 v[204:207], v1 offset:19456
    v_add_f32 v105, v105, v109
    v_mfma_f32_32x32x16_bf16 v[48:63], v[148:151], a[44:47], v[48:63]
    v_add_f32 v96, v96, v104
    v_add_f32 v97, v97, v105
    v_mfma_f32_32x32x16_bf16 v[32:47], v[176:179], a[96:99], v[32:47]
    ds_read_b128 v[208:211], v1 offset:20480
    v_mov_b32 v98, v96
    v_mfma_f32_32x32x16_bf16 v[32:47], v[180:183], a[104:107], v[32:47]
    ds_read_b128 v[212:215], v1 offset:21504
    v_mov_b32 v99, v97
    v_permlane32_swap_b32 v96, v98
    v_mfma_f32_32x32x16_bf16 v[48:63], v[152:155], a[52:55], v[48:63]
    v_permlane32_swap_b32 v97, v99
    s_waitcnt lgkmcnt(7)
    v_mfma_f32_32x32x16_bf16 v[32:47], v[184:187], a[112:115], v[32:47]
    ds_read_b128 v[216:219], v1 offset:22528
    v_add_f32 v96, v96, v98
    v_add_f32 v97, v97, v99
    s_waitcnt lgkmcnt(7)
    v_mfma_f32_32x32x16_bf16 v[32:47], v[188:191], a[120:123], v[32:47]
    ds_read_b128 v[220:223], v1 offset:23552
    v_mul_f32 v96, 989855744, v96
    v_mfma_f32_32x32x16_bf16 v[48:63], v[156:159], a[60:63], v[48:63]
    v_mul_f32 v97, 989855744, v97
    v_fma_f32 v97, -v96, v96, v97
    s_waitcnt lgkmcnt(7)
    v_mfma_f32_32x32x16_bf16 v[32:47], v[192:195], a[128:131], v[32:47]
    ds_read_b128 v[224:227], v1 offset:24576
    v_max_f32 v97, 0, v97
    s_waitcnt lgkmcnt(7)
    v_mfma_f32_32x32x16_bf16 v[32:47], v[196:199], a[136:139], v[32:47]
    ds_read_b128 v[228:231], v1 offset:25600
    v_cvt_pk_bf16_f32 v98, v96, v97
    v_lshlrev_b32 v96, 16, v98
    v_mfma_f32_32x32x16_bf16 v[48:63], v[160:163], a[68:71], v[48:63]
    v_and_b32 v97, 0xffff0000, v98
    s_waitcnt lgkmcnt(7)
    v_mfma_f32_32x32x16_bf16 v[32:47], v[200:203], a[144:147], v[32:47]
    ds_read_b128 v[232:235], v1 offset:26624
    v_add_f32 v97, 925353388, v97
    v_cvt_pk_bf16_f32 v98, v97, v97
    s_waitcnt lgkmcnt(7)
    v_mfma_f32_32x32x16_bf16 v[32:47], v[204:207], a[152:155], v[32:47]
    ds_read_b128 v[236:239], v1 offset:27648
    v_lshlrev_b32 v97, 16, v98
    v_mfma_f32_32x32x16_bf16 v[48:63], v[164:167], a[76:79], v[48:63]
    v_sqrt_f32 v97, v97
    s_nop 0
    v_cvt_pk_bf16_f32 v98, v97, v97
    s_waitcnt lgkmcnt(7)
    v_mfma_f32_32x32x16_bf16 v[32:47], v[208:211], a[160:163], v[32:47]
    ds_read_b128 v[240:243], v1 offset:28672
    v_lshlrev_b32 v97, 16, v98
    s_waitcnt lgkmcnt(7)
    v_mfma_f32_32x32x16_bf16 v[32:47], v[212:215], a[168:171], v[32:47]
    ds_read_b128 v[244:247], v1 offset:29696
    v_rcp_f32 v97, v97
    s_nop 0
    v_mov_b32 v100, v97
    v_mfma_f32_32x32x16_bf16 v[48:63], v[168:171], a[84:87], v[48:63]
    v_mul_f32 v102, -v96, v97
    s_waitcnt lgkmcnt(7)
    v_mfma_f32_32x32x16_bf16 v[32:47], v[216:219], a[176:179], v[32:47]
    ds_read_b128 v[248:251], v1 offset:30720
    v_cndmask_b32 v98, v100, v102, s[54:55]
    ds_write_b32 v10, v98
    s_waitcnt lgkmcnt(8)
    v_mfma_f32_32x32x16_bf16 v[32:47], v[220:223], a[184:187], v[32:47]
    ds_read_b128 v[252:255], v1 offset:31744
    ds_read_b128 v[96:99], v11 offset:0
    v_mfma_f32_32x32x16_bf16 v[48:63], v[172:175], a[92:95], v[48:63]
    ds_read_b128 v[112:115], v11 offset:128
    ds_read_b128 v[100:103], v11 offset:32
    s_waitcnt lgkmcnt(11)
    v_mfma_f32_32x32x16_bf16 v[32:47], v[224:227], a[192:195], v[32:47]
    ds_read_b128 v[116:119], v11 offset:160
    s_waitcnt lgkmcnt(11)
    v_mfma_f32_32x32x16_bf16 v[32:47], v[228:231], a[200:203], v[32:47]
    ds_read_b128 v[104:107], v11 offset:64
    ds_read_b128 v[120:123], v11 offset:192
    v_mfma_f32_32x32x16_bf16 v[48:63], v[176:179], a[100:103], v[48:63]
    ds_read_b128 v[108:111], v11 offset:96
    s_waitcnt lgkmcnt(13)
    v_mfma_f32_32x32x16_bf16 v[32:47], v[232:235], a[208:211], v[32:47]
    ds_read_b128 v[124:127], v11 offset:224
    s_waitcnt lgkmcnt(13)
    v_mfma_f32_32x32x16_bf16 v[32:47], v[236:239], a[216:219], v[32:47]
    v_mfma_f32_32x32x16_bf16 v[48:63], v[180:183], a[108:111], v[48:63]
    s_waitcnt lgkmcnt(12)
    v_mfma_f32_32x32x16_bf16 v[32:47], v[240:243], a[224:227], v[32:47]
    s_waitcnt lgkmcnt(11)
    v_mfma_f32_32x32x16_bf16 v[32:47], v[244:247], a[232:235], v[32:47]
    v_mfma_f32_32x32x16_bf16 v[48:63], v[184:187], a[116:119], v[48:63]
    s_waitcnt lgkmcnt(10)
    v_mfma_f32_32x32x16_bf16 v[32:47], v[248:251], a[240:243], v[32:47]
    s_waitcnt lgkmcnt(8)
    v_mfma_f32_32x32x16_bf16 v[32:47], v[252:255], a[248:251], v[32:47]
    v_mfma_f32_32x32x16_bf16 v[48:63], v[188:191], a[124:127], v[48:63]
    v_mfma_f32_32x32x16_bf16 v[48:63], v[192:195], a[132:135], v[48:63]
    v_mfma_f32_32x32x16_bf16 v[48:63], v[196:199], a[140:143], v[48:63]
    s_waitcnt lgkmcnt(7)
    s_nop 7
    v_mul_f32 v32, v32, v96
    v_mul_f32 v33, v33, v97
    v_mul_f32 v34, v34, v98
    v_mfma_f32_32x32x16_bf16 v[48:63], v[200:203], a[148:151], v[48:63]
    v_mul_f32 v35, v35, v99
    s_waitcnt lgkmcnt(3)
    v_mul_f32 v40, v40, v104
    v_mul_f32 v41, v41, v105
    v_mfma_f32_32x32x16_bf16 v[48:63], v[204:207], a[156:159], v[48:63]
    v_mul_f32 v42, v42, v106
    v_mul_f32 v43, v43, v107
    v_fmac_f32 v32, v112, v64
    v_mfma_f32_32x32x16_bf16 v[48:63], v[208:211], a[164:167], v[48:63]
    v_fmac_f32 v33, v113, v64
    v_fmac_f32 v34, v114, v64
    v_fmac_f32 v35, v115, v64
    v_mfma_f32_32x32x16_bf16 v[48:63], v[212:215], a[172:175], v[48:63]
    s_waitcnt lgkmcnt(2)
    v_fmac_f32 v40, v120, v64
    v_fmac_f32 v41, v121, v64
    v_fmac_f32 v42, v122, v64
    v_mfma_f32_32x32x16_bf16 v[48:63], v[216:219], a[180:183], v[48:63]
    v_fmac_f32 v43, v123, v64
    v_cvt_pk_bf16_f32 v16, v32, v33
    v_cvt_pk_bf16_f32 v17, v34, v35
    v_mfma_f32_32x32x16_bf16 v[48:63], v[220:223], a[188:191], v[48:63]
    v_cvt_pk_bf16_f32 v18, v40, v41
    v_cvt_pk_bf16_f32 v19, v42, v43
    buffer_store_dwordx4 v[16:19], v3, s[8:11], s35 offen offset:0 sc1
    v_mfma_f32_32x32x16_bf16 v[48:63], v[224:227], a[196:199], v[48:63]
    v_mul_f32 v36, v36, v100
    v_mul_f32 v37, v37, v101
    v_mul_f32 v38, v38, v102
    v_mfma_f32_32x32x16_bf16 v[48:63], v[228:231], a[204:207], v[48:63]
    v_mul_f32 v39, v39, v103
    s_waitcnt lgkmcnt(1)
    v_mul_f32 v44, v44, v108
    v_mul_f32 v45, v45, v109
    v_mfma_f32_32x32x16_bf16 v[48:63], v[232:235], a[212:215], v[48:63]
    v_mul_f32 v46, v46, v110
    v_mul_f32 v47, v47, v111
    v_fmac_f32 v36, v116, v64
    v_mfma_f32_32x32x16_bf16 v[48:63], v[236:239], a[220:223], v[48:63]
    v_fmac_f32 v37, v117, v64
    v_fmac_f32 v38, v118, v64
    v_fmac_f32 v39, v119, v64
    v_mfma_f32_32x32x16_bf16 v[48:63], v[240:243], a[228:231], v[48:63]
    s_waitcnt lgkmcnt(0)
    v_fmac_f32 v44, v124, v64
    v_fmac_f32 v45, v125, v64
    v_fmac_f32 v46, v126, v64
    v_mfma_f32_32x32x16_bf16 v[48:63], v[244:247], a[236:239], v[48:63]
    v_fmac_f32 v47, v127, v64
    v_cvt_pk_bf16_f32 v20, v36, v37
    v_cvt_pk_bf16_f32 v21, v38, v39
    v_mfma_f32_32x32x16_bf16 v[48:63], v[248:251], a[244:247], v[48:63]
    v_cvt_pk_bf16_f32 v22, v44, v45
    v_cvt_pk_bf16_f32 v23, v46, v47
    buffer_store_dwordx4 v[20:23], v3, s[8:11], s35 offen offset:512 sc1
    v_mfma_f32_32x32x16_bf16 v[48:63], v[252:255], a[252:255], v[48:63]
    v_xor_b32 v1, 0x8000, v1
    s_nop 10
    v_pk_mul_f32 v[48:49], v[48:49], v[96:97]
    v_pk_mul_f32 v[50:51], v[50:51], v[98:99]
    v_pk_mul_f32 v[56:57], v[56:57], v[104:105]
    v_pk_mul_f32 v[58:59], v[58:59], v[106:107]
    v_pk_fma_f32 v[48:49], v[112:113], v[80:81], v[48:49]
    v_pk_fma_f32 v[50:51], v[114:115], v[80:81], v[50:51]
    v_pk_fma_f32 v[56:57], v[120:121], v[80:81], v[56:57]
    v_pk_fma_f32 v[58:59], v[122:123], v[80:81], v[58:59]
    v_cvt_pk_bf16_f32 v24, v48, v49
    v_cvt_pk_bf16_f32 v25, v50, v51
    v_cvt_pk_bf16_f32 v26, v56, v57
    v_cvt_pk_bf16_f32 v27, v58, v59
    buffer_store_dwordx4 v[24:27], v3, s[8:11], s35 offen offset:1024 sc1
    v_pk_mul_f32 v[52:53], v[52:53], v[100:101]
    v_pk_mul_f32 v[54:55], v[54:55], v[102:103]
    v_pk_mul_f32 v[60:61], v[60:61], v[108:109]
    v_pk_mul_f32 v[62:63], v[62:63], v[110:111]
    v_pk_fma_f32 v[52:53], v[116:117], v[80:81], v[52:53]
    v_pk_fma_f32 v[54:55], v[118:119], v[80:81], v[54:55]
    v_pk_fma_f32 v[60:61], v[124:125], v[80:81], v[60:61]
    v_pk_fma_f32 v[62:63], v[126:127], v[80:81], v[62:63]
    v_cvt_pk_bf16_f32 v28, v52, v53
    v_cvt_pk_bf16_f32 v29, v54, v55
    v_cvt_pk_bf16_f32 v30, v60, v61
    v_cvt_pk_bf16_f32 v31, v62, v63
    buffer_store_dwordx4 v[28:31], v3, s[8:11], s35 offen offset:1536 sc1
    s_add_u32 s35, s35, 262144
    s_add_u32 s34, s34, 1
    s_mov_b32 s36, s50
    s_add_u32 s50, s50, 8192
    s_mov_b32 s53, 1
    s_waitcnt vmcnt(5)
    s_branch L_proj_e2_v
Lpa_18041:
    s_waitcnt lgkmcnt(7)
    v_mfma_f32_32x32x16_bf16 v[32:47], v[128:131], a[0:3], 0
    ds_read_b128 v[160:163], v1 offset:8192
    buffer_load_dword v12, v4, s[8:11], s37 offen sc1
    s_waitcnt lgkmcnt(7)
    v_mfma_f32_32x32x16_bf16 v[32:47], v[132:135], a[8:11], v[32:47]
    ds_read_b128 v[164:167], v1 offset:9216
    v_mfma_f32_32x32x16_bf16 v[48:63], v[128:131], a[4:7], 0
    s_waitcnt lgkmcnt(7)
    v_mfma_f32_32x32x16_bf16 v[32:47], v[136:139], a[16:19], v[32:47]
    ds_read_b128 v[168:171], v1 offset:10240
    ds_read_b64 v[96:97], v9 offset:0
    ds_read_b64 v[98:99], v9 offset:512
    s_waitcnt lgkmcnt(9)
    v_mfma_f32_32x32x16_bf16 v[32:47], v[140:143], a[24:27], v[32:47]
    ds_read_b128 v[172:175], v1 offset:11264
    ds_read_b64 v[100:101], v9 offset:1024
    v_mfma_f32_32x32x16_bf16 v[48:63], v[132:135], a[12:15], v[48:63]
    ds_read_b64 v[102:103], v9 offset:1536
    ds_read_b64 v[104:105], v9 offset:2048
    s_waitcnt lgkmcnt(12)
    v_mfma_f32_32x32x16_bf16 v[32:47], v[144:147], a[32:35], v[32:47]
    ds_read_b128 v[176:179], v1 offset:12288
    ds_read_b64 v[106:107], v9 offset:2560
    s_waitcnt lgkmcnt(13)
    v_mfma_f32_32x32x16_bf16 v[32:47], v[148:151], a[40:43], v[32:47]
    ds_read_b128 v[180:183], v1 offset:13312
    ds_read_b64 v[108:109], v9 offset:3072
    ds_read_b64 v[110:111], v9 offset:3584
    v_mfma_f32_32x32x16_bf16 v[48:63], v[136:139], a[20:23], v[48:63]
    v_xor_b32 v9, 0x1000, v9
    buffer_load_dword v13, v4, s[8:11], s37 offen sc1
    s_waitcnt lgkmcnt(15)
    v_mfma_f32_32x32x16_bf16 v[32:47], v[152:155], a[48:51], v[32:47]
    ds_read_b128 v[184:187], v1 offset:14336
    s_waitcnt lgkmcnt(10)
    v_add_f32 v96, v96, v98
    v_add_f32 v97, v97, v99
    v_mfma_f32_32x32x16_bf16 v[32:47], v[156:159], a[56:59], v[32:47]
    ds_read_b128 v[188:191], v1 offset:15360
    s_waitcnt lgkmcnt(8)
    v_add_f32 v100, v100, v102
    v_mfma_f32_32x32x16_bf16 v[48:63], v[140:143], a[28:31], v[48:63]
    v_add_f32 v101, v101, v103
    s_waitcnt lgkmcnt(5)
    v_add_f32 v104, v104, v106
    v_mfma_f32_32x32x16_bf16 v[32:47], v[160:163], a[64:67], v[32:47]
    ds_read_b128 v[192:195], v1 offset:16384
    v_add_f32 v105, v105, v107
    v_mfma_f32_32x32x16_bf16 v[32:47], v[164:167], a[72:75], v[32:47]
    ds_read_b128 v[196:199], v1 offset:17408
    s_waitcnt lgkmcnt(4)
    v_add_f32 v108, v108, v110
    v_add_f32 v109, v109, v111
    v_mfma_f32_32x32x16_bf16 v[48:63], v[144:147], a[36:39], v[48:63]
    v_add_f32 v96, v96, v100
    v_mfma_f32_32x32x16_bf16 v[32:47], v[168:171], a[80:83], v[32:47]
    ds_read_b128 v[200:203], v1 offset:18432
    v_add_f32 v97, v97, v101
    v_add_f32 v104, v104, v108
    s_cmp_eq_u32 s53, 0
    s_cbranch_scc1 Lpk_18042
    s_waitcnt vmcnt(2)
    s_mov_b64 exec, 1
    buffer_store_dword v6, v5, s[8:11], s36 offen sc1
    s_mov_b64 exec, -1
Lpk_18042:
    v_mfma_f32_32x32x16_bf16 v[32:47], v[172:175], a[88:91], v[32:47]
    ds_read_b128 v[204:207], v1 offset:19456
    v_add_f32 v105, v105, v109
    buffer_load_dword v14, v4, s[8:11], s37 offen sc1
    v_mfma_f32_32x32x16_bf16 v[48:63], v[148:151], a[44:47], v[48:63]
    v_add_f32 v96, v96, v104
    v_add_f32 v97, v97, v105
    v_mfma_f32_32x32x16_bf16 v[32:47], v[176:179], a[96:99], v[32:47]
    ds_read_b128 v[208:211], v1 offset:20480
    v_mov_b32 v98, v96
    v_mfma_f32_32x32x16_bf16 v[32:47], v[180:183], a[104:107], v[32:47]
    ds_read_b128 v[212:215], v1 offset:21504
    v_mov_b32 v99, v97
    v_permlane32_swap_b32 v96, v98
    v_mfma_f32_32x32x16_bf16 v[48:63], v[152:155], a[52:55], v[48:63]
    v_permlane32_swap_b32 v97, v99
    s_waitcnt lgkmcnt(7)
    v_mfma_f32_32x32x16_bf16 v[32:47], v[184:187], a[112:115], v[32:47]
    ds_read_b128 v[216:219], v1 offset:22528
    v_add_f32 v96, v96, v98
    v_add_f32 v97, v97, v99
    s_waitcnt lgkmcnt(7)
    v_mfma_f32_32x32x16_bf16 v[32:47], v[188:191], a[120:123], v[32:47]
    ds_read_b128 v[220:223], v1 offset:23552
    v_mul_f32 v96, 989855744, v96
    v_mfma_f32_32x32x16_bf16 v[48:63], v[156:159], a[60:63], v[48:63]
    v_mul_f32 v97, 989855744, v97
    v_fma_f32 v97, -v96, v96, v97
    s_waitcnt vmcnt(2)
    v_cmp_eq_u32 vcc, 0, v12
    s_nop 0
    s_cbranch_vccz Lpb_18043
    s_waitcnt lgkmcnt(7)
    v_mfma_f32_32x32x16_bf16 v[32:47], v[192:195], a[128:131], v[32:47]
    ds_read_b128 v[224:227], v1 offset:24576
    v_max_f32 v97, 0, v97
    buffer_load_dword v15, v4, s[8:11], s37 offen sc1
    s_waitcnt lgkmcnt(7)
    v_mfma_f32_32x32x16_bf16 v[32:47], v[196:199], a[136:139], v[32:47]
    ds_read_b128 v[228:231], v1 offset:25600
    v_cvt_pk_bf16_f32 v98, v96, v97
    v_lshlrev_b32 v96, 16, v98
    v_mfma_f32_32x32x16_bf16 v[48:63], v[160:163], a[68:71], v[48:63]
    v_and_b32 v97, 0xffff0000, v98
    s_waitcnt lgkmcnt(7)
    v_mfma_f32_32x32x16_bf16 v[32:47], v[200:203], a[144:147], v[32:47]
    ds_read_b128 v[232:235], v1 offset:26624
    v_add_f32 v97, 925353388, v97
    v_cvt_pk_bf16_f32 v98, v97, v97
    s_waitcnt lgkmcnt(7)
    v_mfma_f32_32x32x16_bf16 v[32:47], v[204:207], a[152:155], v[32:47]
    ds_read_b128 v[236:239], v1 offset:27648
    v_lshlrev_b32 v97, 16, v98
    v_mfma_f32_32x32x16_bf16 v[48:63], v[164:167], a[76:79], v[48:63]
    v_sqrt_f32 v97, v97
    s_nop 0
    v_cvt_pk_bf16_f32 v98, v97, v97
    s_waitcnt lgkmcnt(7)
    v_mfma_f32_32x32x16_bf16 v[32:47], v[208:211], a[160:163], v[32:47]
    ds_read_b128 v[240:243], v1 offset:28672
    v_lshlrev_b32 v97, 16, v98
    s_waitcnt lgkmcnt(7)
    v_mfma_f32_32x32x16_bf16 v[32:47], v[212:215], a[168:171], v[32:47]
    ds_read_b128 v[244:247], v1 offset:29696
    v_rcp_f32 v97, v97
    s_nop 0
    v_mov_b32 v100, v97
    s_waitcnt vmcnt(2)
    v_cmp_eq_u32 vcc, 0, v13
    s_nop 0
    s_cbranch_vccz Lpb_18044
    v_mfma_f32_32x32x16_bf16 v[48:63], v[168:171], a[84:87], v[48:63]
    v_mul_f32 v102, -v96, v97
    buffer_load_dword v12, v4, s[8:11], s37 offen sc1
    s_waitcnt lgkmcnt(7)
    v_mfma_f32_32x32x16_bf16 v[32:47], v[216:219], a[176:179], v[32:47]
    ds_read_b128 v[248:251], v1 offset:30720
    v_cndmask_b32 v98, v100, v102, s[54:55]
    ds_write_b32 v10, v98
    s_waitcnt lgkmcnt(8)
    v_mfma_f32_32x32x16_bf16 v[32:47], v[220:223], a[184:187], v[32:47]
    ds_read_b128 v[252:255], v1 offset:31744
    ds_read_b128 v[96:99], v11 offset:0
    v_mfma_f32_32x32x16_bf16 v[48:63], v[172:175], a[92:95], v[48:63]
    ds_read_b128 v[112:115], v11 offset:128
    ds_read_b128 v[100:103], v11 offset:32
    s_waitcnt lgkmcnt(11)
    v_mfma_f32_32x32x16_bf16 v[32:47], v[224:227], a[192:195], v[32:47]
    ds_read_b128 v[116:119], v11 offset:160
    s_waitcnt lgkmcnt(11)
    v_mfma_f32_32x32x16_bf16 v[32:47], v[228:231], a[200:203], v[32:47]
    ds_read_b128 v[104:107], v11 offset:64
    ds_read_b128 v[120:123], v11 offset:192
    v_mfma_f32_32x32x16_bf16 v[48:63], v[176:179], a[100:103], v[48:63]
    ds_read_b128 v[108:111], v11 offset:96
    s_waitcnt lgkmcnt(13)
    v_mfma_f32_32x32x16_bf16 v[32:47], v[232:235], a[208:211], v[32:47]
    ds_read_b128 v[124:127], v11 offset:224
    s_waitcnt vmcnt(2)
    v_cmp_eq_u32 vcc, 0, v14
    s_nop 0
    s_cbranch_vccz Lpb_18045
    s_waitcnt lgkmcnt(13)
    v_mfma_f32_32x32x16_bf16 v[32:47], v[236:239], a[216:219], v[32:47]
    buffer_load_dword v13, v4, s[8:11], s37 offen sc1
    v_mfma_f32_32x32x16_bf16 v[48:63], v[180:183], a[108:111], v[48:63]
    s_waitcnt lgkmcnt(12)
    v_mfma_f32_32x32x16_bf16 v[32:47], v[240:243], a[224:227], v[32:47]
    s_waitcnt lgkmcnt(11)
    v_mfma_f32_32x32x16_bf16 v[32:47], v[244:247], a[232:235], v[32:47]
    v_mfma_f32_32x32x16_bf16 v[48:63], v[184:187], a[116:119], v[48:63]
    s_waitcnt lgkmcnt(10)
    v_mfma_f32_32x32x16_bf16 v[32:47], v[248:251], a[240:243], v[32:47]
    s_waitcnt lgkmcnt(8)
    v_mfma_f32_32x32x16_bf16 v[32:47], v[252:255], a[248:251], v[32:47]
    v_mfma_f32_32x32x16_bf16 v[48:63], v[188:191], a[124:127], v[48:63]
    s_waitcnt vmcnt(2)
    v_cmp_eq_u32 vcc, 0, v15
    s_nop 0
    s_cbranch_vccz Lpb_18046
    v_mfma_f32_32x32x16_bf16 v[48:63], v[192:195], a[132:135], v[48:63]
    buffer_load_dword v14, v4, s[8:11], s37 offen sc1
    v_mfma_f32_32x32x16_bf16 v[48:63], v[196:199], a[140:143], v[48:63]
    s_waitcnt lgkmcnt(7)
    s_nop 2
    v_mul_f32 v32, v32, v96
    v_mul_f32 v33, v33, v97
    v_mul_f32 v34, v34, v98
    v_mfma_f32_32x32x16_bf16 v[48:63], v[200:203], a[148:151], v[48:63]
    v_mul_f32 v35, v35, v99
    s_waitcnt lgkmcnt(3)
    v_mul_f32 v40, v40, v104
    v_mul_f32 v41, v41, v105
    v_mfma_f32_32x32x16_bf16 v[48:63], v[204:207], a[156:159], v[48:63]
    v_mul_f32 v42, v42, v106
    v_mul_f32 v43, v43, v107
    v_fmac_f32 v32, v112, v64
    v_mfma_f32_32x32x16_bf16 v[48:63], v[208:211], a[164:167], v[48:63]
    v_fmac_f32 v33, v113, v64
    v_fmac_f32 v34, v114, v64
    v_fmac_f32 v35, v115, v64
    v_mfma_f32_32x32x16_bf16 v[48:63], v[212:215], a[172:175], v[48:63]
    s_waitcnt lgkmcnt(2)
    v_fmac_f32 v40, v120, v64
    v_fmac_f32 v41, v121, v64
    v_fmac_f32 v42, v122, v64
    v_mfma_f32_32x32x16_bf16 v[48:63], v[216:219], a[180:183], v[48:63]
    v_fmac_f32 v43, v123, v64
    v_cvt_pk_bf16_f32 v16, v32, v33
    v_cvt_pk_bf16_f32 v17, v34, v35
    v_mfma_f32_32x32x16_bf16 v[48:63], v[220:223], a[188:191], v[48:63]
    v_cvt_pk_bf16_f32 v18, v40, v41
    v_cvt_pk_bf16_f32 v19, v42, v43
    buffer_store_dwordx4 v[16:19], v3, s[8:11], s35 offen offset:0 sc1
    s_waitcnt vmcnt(3)
    v_cmp_eq_u32 vcc, 0, v12
    s_nop 0
    s_cbranch_vccz Lpb_18047
    v_mfma_f32_32x32x16_bf16 v[48:63], v[224:227], a[196:199], v[48:63]
    v_mul_f32 v36, v36, v100
    v_mul_f32 v37, v37, v101
    v_mul_f32 v38, v38, v102
    buffer_load_dword v15, v4, s[8:11], s37 offen sc1
    v_mfma_f32_32x32x16_bf16 v[48:63], v[228:231], a[204:207], v[48:63]
    v_mul_f32 v39, v39, v103
    s_waitcnt lgkmcnt(1)
    v_mul_f32 v44, v44, v108
    v_mul_f32 v45, v45, v109
    v_mfma_f32_32x32x16_bf16 v[48:63], v[232:235], a[212:215], v[48:63]
    v_mul_f32 v46, v46, v110
    v_mul_f32 v47, v47, v111
    v_fmac_f32 v36, v116, v64
    v_mfma_f32_32x32x16_bf16 v[48:63], v[236:239], a[220:223], v[48:63]
    v_fmac_f32 v37, v117, v64
    v_fmac_f32 v38, v118, v64
    v_fmac_f32 v39, v119, v64
    v_mfma_f32_32x32x16_bf16 v[48:63], v[240:243], a[228:231], v[48:63]
    s_waitcnt lgkmcnt(0)
    v_fmac_f32 v44, v124, v64
    v_fmac_f32 v45, v125, v64
    v_fmac_f32 v46, v126, v64
    v_mfma_f32_32x32x16_bf16 v[48:63], v[244:247], a[236:239], v[48:63]
    v_fmac_f32 v47, v127, v64
    v_cvt_pk_bf16_f32 v20, v36, v37
    v_cvt_pk_bf16_f32 v21, v38, v39
    v_mfma_f32_32x32x16_bf16 v[48:63], v[248:251], a[244:247], v[48:63]
    v_cvt_pk_bf16_f32 v22, v44, v45
    v_cvt_pk_bf16_f32 v23, v46, v47
    buffer_store_dwordx4 v[20:23], v3, s[8:11], s35 offen offset:512 sc1
    v_mfma_f32_32x32x16_bf16 v[48:63], v[252:255], a[252:255], v[48:63]
    v_xor_b32 v1, 0x8000, v1
    s_nop 10
    v_pk_mul_f32 v[48:49], v[48:49], v[96:97]
    v_pk_mul_f32 v[50:51], v[50:51], v[98:99]
    v_pk_mul_f32 v[56:57], v[56:57], v[104:105]
    v_pk_mul_f32 v[58:59], v[58:59], v[106:107]
    v_pk_fma_f32 v[48:49], v[112:113], v[80:81], v[48:49]
    v_pk_fma_f32 v[50:51], v[114:115], v[80:81], v[50:51]
    v_pk_fma_f32 v[56:57], v[120:121], v[80:81], v[56:57]
    v_pk_fma_f32 v[58:59], v[122:123], v[80:81], v[58:59]
    v_cvt_pk_bf16_f32 v24, v48, v49
    v_cvt_pk_bf16_f32 v25, v50, v51
    v_cvt_pk_bf16_f32 v26, v56, v57
    v_cvt_pk_bf16_f32 v27, v58, v59
    buffer_store_dwordx4 v[24:27], v3, s[8:11], s35 offen offset:1024 sc1
    v_pk_mul_f32 v[52:53], v[52:53], v[100:101]
    v_pk_mul_f32 v[54:55], v[54:55], v[102:103]
    v_pk_mul_f32 v[60:61], v[60:61], v[108:109]
    v_pk_mul_f32 v[62:63], v[62:63], v[110:111]
    v_pk_fma_f32 v[52:53], v[116:117], v[80:81], v[52:53]
    v_pk_fma_f32 v[54:55], v[118:119], v[80:81], v[54:55]
    v_pk_fma_f32 v[60:61], v[124:125], v[80:81], v[60:61]
    v_pk_fma_f32 v[62:63], v[126:127], v[80:81], v[62:63]
    v_cvt_pk_bf16_f32 v28, v52, v53
    v_cvt_pk_bf16_f32 v29, v54, v55
    v_cvt_pk_bf16_f32 v30, v60, v61
    v_cvt_pk_bf16_f32 v31, v62, v63
    buffer_store_dwordx4 v[28:31], v3, s[8:11], s35 offen offset:1536 sc1
    s_add_u32 s35, s35, 262144
    s_add_u32 s34, s34, 1
    s_mov_b32 s36, s50
    s_add_u32 s50, s50, 8192
    s_mov_b32 s53, 0
    s_waitcnt vmcnt(6)
    v_cmp_eq_u32 vcc, 0, v13
    s_nop 0
    s_cbranch_vccz Lpe_18048
    buffer_load_dword v13, v4, s[8:11], s37 offen sc1
    s_waitcnt vmcnt(6)
    v_cmp_eq_u32 vcc, 0, v14
    s_nop 0
    s_cbranch_vccz Lpe_18048
    buffer_load_dword v14, v4, s[8:11], s37 offen sc1
    s_waitcnt vmcnt(5)
    v_cmp_eq_u32 vcc, 0, v15
    s_nop 0
    s_cbranch_vccz Lpe_18048
    buffer_load_dword v15, v4, s[8:11], s37 offen sc1
    s_waitcnt vmcnt(3)
    s_mov_b64 exec, 1
    buffer_store_dword v6, v5, s[8:11], s36 offen sc1
    s_mov_b64 exec, -1
    s_cmp_ge_u32 s34, 64
    s_cbranch_scc1 L_proj_end
Lpp_18050:
    s_waitcnt vmcnt(2)
    v_cmp_eq_u32 vcc, 0, v13
    s_nop 0
    s_cbranch_vccz Lpl_18049
    buffer_load_dword v13, v4, s[8:11], s37 offen sc1
    s_waitcnt vmcnt(2)
    v_cmp_eq_u32 vcc, 0, v14
    s_nop 0
    s_cbranch_vccz Lpl_18049
    buffer_load_dword v14, v4, s[8:11], s37 offen sc1
    s_waitcnt vmcnt(2)
    v_cmp_eq_u32 vcc, 0, v15
    s_nop 0
    s_cbranch_vccz Lpl_18049
    buffer_load_dword v15, v4, s[8:11], s37 offen sc1
    s_sub_u32 s62, s62, 1
    s_cbranch_scc0 Ltok_23041
    s_movk_i32 s61, 10
    s_branch L_abort
Ltok_23041:
    s_branch Lpp_18050
L_proj_in_v:
    s_mov_b32 s53, 0
    buffer_load_dword v13, v4, s[8:11], s37 offen sc1
    buffer_load_dword v14, v4, s[8:11], s37 offen sc1
    buffer_load_dword v15, v4, s[8:11], s37 offen sc1
    s_branch Lpp_18050
Lpl_18049:
    s_mov_b32 m0, s39
    s_add_u32 s43, s38, 4096
    buffer_load_dwordx4 v2, s[8:11], s38 offen offset:0 lds
    buffer_load_dwordx4 v2, s[8:11], s38 offen offset:1024 lds
    buffer_load_dwordx4 v2, s[8:11], s38 offen offset:2048 lds
    buffer_load_dwordx4 v2, s[8:11], s38 offen offset:3072 lds
    s_add_u32 m0, s39, 4096
    s_add_u32 s38, s38, 32768
    buffer_load_dwordx4 v2, s[8:11], s43 offen offset:0 lds
    buffer_load_dwordx4 v2, s[8:11], s43 offen offset:1024 lds
    buffer_load_dwordx4 v2, s[8:11], s43 offen offset:2048 lds
    buffer_load_dwordx4 v2, s[8:11], s43 offen offset:3072 lds
    s_mov_b32 m0, s52
    s_add_u32 s37, s37, 2048
    buffer_load_dwordx4 v8, s[8:11], s51 offen lds
    s_add_u32 s51, s51, 4096
    s_xor_b32 s39, s39, 32768
    s_xor_b32 s52, s52, 4096
    s_add_u32 s40, s40, 1
    s_cmp_ge_u32 s40, 64
    s_cselect_b32 s37, 5636096, s37
    buffer_load_dword v7, v4, s[8:11], s37 offen sc1
    s_waitcnt vmcnt(0)
    s_branch L_proj_e2_v
Lpe_18048:
    s_mov_b32 m0, s39
    s_add_u32 s43, s38, 4096
    buffer_load_dwordx4 v2, s[8:11], s38 offen offset:0 lds
    buffer_load_dwordx4 v2, s[8:11], s38 offen offset:1024 lds
    buffer_load_dwordx4 v2, s[8:11], s38 offen offset:2048 lds
    buffer_load_dwordx4 v2, s[8:11], s38 offen offset:3072 lds
    s_add_u32 m0, s39, 4096
    s_add_u32 s38, s38, 32768
    buffer_load_dwordx4 v2, s[8:11], s43 offen offset:0 lds
    buffer_load_dwordx4 v2, s[8:11], s43 offen offset:1024 lds
    buffer_load_dwordx4 v2, s[8:11], s43 offen offset:2048 lds
    buffer_load_dwordx4 v2, s[8:11], s43 offen offset:3072 lds
    s_mov_b32 m0, s52
    s_add_u32 s37, s37, 2048
    buffer_load_dwordx4 v8, s[8:11], s51 offen lds
    s_add_u32 s51, s51, 4096
    s_xor_b32 s39, s39, 32768
    s_xor_b32 s52, s52, 4096
    s_add_u32 s40, s40, 1
    s_cmp_ge_u32 s40, 64
    s_cselect_b32 s37, 5636096, s37
    buffer_load_dword v7, v4, s[8:11], s37 offen sc1
    s_waitcnt vmcnt(10)
    s_mov_b64 exec, 1
    buffer_store_dword v6, v5, s[8:11], s36 offen sc1
    s_mov_b64 exec, -1
    s_waitcnt vmcnt(1)
    s_branch L_proj_e2_v
Lpb_18043:
    s_waitcnt lgkmcnt(7)
    v_mfma_f32_32x32x16_bf16 v[32:47], v[192:195], a[128:131], v[32:47]
    ds_read_b128 v[224:227], v1 offset:24576
    v_max_f32 v97, 0, v97
    s_mov_b32 m0, s39
    s_add_u32 s43, s38, 4096
    buffer_load_dwordx4 v2, s[8:11], s38 offen offset:0 lds
    buffer_load_dwordx4 v2, s[8:11], s38 offen offset:1024 lds
    s_waitcnt lgkmcnt(7)
    v_mfma_f32_32x32x16_bf16 v[32:47], v[196:199], a[136:139], v[32:47]
    ds_read_b128 v[228:231], v1 offset:25600
    v_cvt_pk_bf16_f32 v98, v96, v97
    v_lshlrev_b32 v96, 16, v98
    buffer_load_dwordx4 v2, s[8:11], s38 offen offset:2048 lds
    buffer_load_dwordx4 v2, s[8:11], s38 offen offset:3072 lds
    v_mfma_f32_32x32x16_bf16 v[48:63], v[160:163], a[68:71], v[48:63]
    v_and_b32 v97, 0xffff0000, v98
    s_add_u32 m0, s39, 4096
    s_add_u32 s38, s38, 32768
    buffer_load_dwordx4 v2, s[8:11], s43 offen offset:0 lds
    buffer_load_dwordx4 v2, s[8:11], s43 offen offset:1024 lds
    s_waitcnt lgkmcnt(7)
    v_mfma_f32_32x32x16_bf16 v[32:47], v[200:203], a[144:147], v[32:47]
    ds_read_b128 v[232:235], v1 offset:26624
    v_add_f32 v97, 925353388, v97
    v_cvt_pk_bf16_f32 v98, v97, v97
    buffer_load_dwordx4 v2, s[8:11], s43 offen offset:2048 lds
    buffer_load_dwordx4 v2, s[8:11], s43 offen offset:3072 lds
    s_waitcnt lgkmcnt(7)
    v_mfma_f32_32x32x16_bf16 v[32:47], v[204:207], a[152:155], v[32:47]
    ds_read_b128 v[236:239], v1 offset:27648
    v_lshlrev_b32 v97, 16, v98
    s_mov_b32 m0, s52
    s_add_u32 s37, s37, 2048
    buffer_load_dwordx4 v8, s[8:11], s51 offen lds
    s_add_u32 s51, s51, 4096
    s_xor_b32 s39, s39, 32768
    s_xor_b32 s52, s52, 4096
    s_add_u32 s40, s40, 1
    s_cmp_ge_u32 s40, 64
    s_cselect_b32 s37, 5636096, s37
    buffer_load_dword v7, v4, s[8:11], s37 offen sc1
    v_mfma_f32_32x32x16_bf16 v[48:63], v[164:167], a[76:79], v[48:63]
    v_sqrt_f32 v97, v97
    s_nop 0
    v_cvt_pk_bf16_f32 v98, v97, v97
    s_waitcnt lgkmcnt(7)
    v_mfma_f32_32x32x16_bf16 v[32:47], v[208:211], a[160:163], v[32:47]
    ds_read_b128 v[240:243], v1 offset:28672
    v_lshlrev_b32 v97, 16, v98
    s_waitcnt lgkmcnt(7)
    v_mfma_f32_32x32x16_bf16 v[32:47], v[212:215], a[168:171], v[32:47]
    ds_read_b128 v[244:247], v1 offset:29696
    v_rcp_f32 v97, v97
    s_nop 0
    v_mov_b32 v100, v97
    v_mfma_f32_32x32x16_bf16 v[48:63], v[168:171], a[84:87], v[48:63]
    v_mul_f32 v102, -v96, v97
    s_waitcnt lgkmcnt(7)
    v_mfma_f32_32x32x16_bf16 v[32:47], v[216:219], a[176:179], v[32:47]
    ds_read_b128 v[248:251], v1 offset:30720
    v_cndmask_b32 v98, v100, v102, s[54:55]
    ds_write_b32 v10, v98
    s_waitcnt lgkmcnt(8)
    v_mfma_f32_32x32x16_bf16 v[32:47], v[220:223], a[184:187], v[32:47]
    ds_read_b128 v[252:255], v1 offset:31744
    ds_read_b128 v[96:99], v11 offset:0
    v_mfma_f32_32x32x16_bf16 v[48:63], v[172:175], a[92:95], v[48:63]
    ds_read_b128 v[112:115], v11 offset:128
    ds_read_b128 v[100:103], v11 offset:32
    s_waitcnt lgkmcnt(11)
    v_mfma_f32_32x32x16_bf16 v[32:47], v[224:227], a[192:195], v[32:47]
    ds_read_b128 v[116:119], v11 offset:160
    s_waitcnt lgkmcnt(11)
    v_mfma_f32_32x32x16_bf16 v[32:47], v[228:231], a[200:203], v[32:47]
    ds_read_b128 v[104:107], v11 offset:64
    ds_read_b128 v[120:123], v11 offset:192
    v_mfma_f32_32x32x16_bf16 v[48:63], v[176:179], a[100:103], v[48:63]
    ds_read_b128 v[108:111], v11 offset:96
    s_waitcnt lgkmcnt(13)
    v_mfma_f32_32x32x16_bf16 v[32:47], v[232:235], a[208:211], v[32:47]
    ds_read_b128 v[124:127], v11 offset:224
    s_waitcnt lgkmcnt(13)
    v_mfma_f32_32x32x16_bf16 v[32:47], v[236:239], a[216:219], v[32:47]
    v_mfma_f32_32x32x16_bf16 v[48:63], v[180:183], a[108:111], v[48:63]
    s_waitcnt lgkmcnt(12)
    v_mfma_f32_32x32x16_bf16 v[32:47], v[240:243], a[224:227], v[32:47]
    s_waitcnt lgkmcnt(11)
    v_mfma_f32_32x32x16_bf16 v[32:47], v[244:247], a[232:235], v[32:47]
    v_mfma_f32_32x32x16_bf16 v[48:63], v[184:187], a[116:119], v[48:63]
    s_waitcnt lgkmcnt(10)
    v_mfma_f32_32x32x16_bf16 v[32:47], v[248:251], a[240:243], v[32:47]
    s_waitcnt lgkmcnt(8)
    v_mfma_f32_32x32x16_bf16 v[32:47], v[252:255], a[248:251], v[32:47]
    v_mfma_f32_32x32x16_bf16 v[48:63], v[188:191], a[124:127], v[48:63]
    v_mfma_f32_32x32x16_bf16 v[48:63], v[192:195], a[132:135], v[48:63]
    v_mfma_f32_32x32x16_bf16 v[48:63], v[196:199], a[140:143], v[48:63]
    s_waitcnt lgkmcnt(7)
    s_nop 7
    v_mul_f32 v32, v32, v96
    v_mul_f32 v33, v33, v97
    v_mul_f32 v34, v34, v98
    v_mfma_f32_32x32x16_bf16 v[48:63], v[200:203], a[148:151], v[48:63]
    v_mul_f32 v35, v35, v99
    s_waitcnt lgkmcnt(3)
    v_mul_f32 v40, v40, v104
    v_mul_f32 v41, v41, v105
    v_mfma_f32_32x32x16_bf16 v[48:63], v[204:207], a[156:159], v[48:63]
    v_mul_f32 v42, v42, v106
    v_mul_f32 v43, v43, v107
    v_fmac_f32 v32, v112, v64
    v_mfma_f32_32x32x16_bf16 v[48:63], v[208:211], a[164:167], v[48:63]
    v_fmac_f32 v33, v113, v64
    v_fmac_f32 v34, v114, v64
    v_fmac_f32 v35, v115, v64
    v_mfma_f32_32x32x16_bf16 v[48:63], v[212:215], a[172:175], v[48:63]
    s_waitcnt lgkmcnt(2)
    v_fmac_f32 v40, v120, v64
    v_fmac_f32 v41, v121, v64
    v_fmac_f32 v42, v122, v64
    v_mfma_f32_32x32x16_bf16 v[48:63], v[216:219], a[180:183], v[48:63]
    v_fmac_f32 v43, v123, v64
    v_cvt_pk_bf16_f32 v16, v32, v33
    v_cvt_pk_bf16_f32 v17, v34, v35
    v_mfma_f32_32x32x16_bf16 v[48:63], v[220:223], a[188:191], v[48:63]
    v_cvt_pk_bf16_f32 v18, v40, v41
    v_cvt_pk_bf16_f32 v19, v42, v43
    buffer_store_dwordx4 v[16:19], v3, s[8:11], s35 offen offset:0 sc1
    v_mfma_f32_32x32x16_bf16 v[48:63], v[224:227], a[196:199], v[48:63]
    v_mul_f32 v36, v36, v100
    v_mul_f32 v37, v37, v101
    v_mul_f32 v38, v38, v102
    v_mfma_f32_32x32x16_bf16 v[48:63], v[228:231], a[204:207], v[48:63]
    v_mul_f32 v39, v39, v103
    s_waitcnt lgkmcnt(1)
    v_mul_f32 v44, v44, v108
    v_mul_f32 v45, v45, v109
    v_mfma_f32_32x32x16_bf16 v[48:63], v[232:235], a[212:215], v[48:63]
    v_mul_f32 v46, v46, v110
    v_mul_f32 v47, v47, v111
    v_fmac_f32 v36, v116, v64
    v_mfma_f32_32x32x16_bf16 v[48:63], v[236:239], a[220:223], v[48:63]
    v_fmac_f32 v37, v117, v64
    v_fmac_f32 v38, v118, v64
    v_fmac_f32 v39, v119, v64
    v_mfma_f32_32x32x16_bf16 v[48:63], v[240:243], a[228:231], v[48:63]
    s_waitcnt lgkmcnt(0)
    v_fmac_f32 v44, v124, v64
    v_fmac_f32 v45, v125, v64
    v_fmac_f32 v46, v126, v64
    v_mfma_f32_32x32x16_bf16 v[48:63], v[244:247], a[236:239], v[48:63]
    v_fmac_f32 v47, v127, v64
    v_cvt_pk_bf16_f32 v20, v36, v37
    v_cvt_pk_bf16_f32 v21, v38, v39
    v_mfma_f32_32x32x16_bf16 v[48:63], v[248:251], a[244:247], v[48:63]
    v_cvt_pk_bf16_f32 v22, v44, v45
    v_cvt_pk_bf16_f32 v23, v46, v47
    buffer_store_dwordx4 v[20:23], v3, s[8:11], s35 offen offset:512 sc1
    v_mfma_f32_32x32x16_bf16 v[48:63], v[252:255], a[252:255], v[48:63]
    v_xor_b32 v1, 0x8000, v1
    s_nop 10
    v_pk_mul_f32 v[48:49], v[48:49], v[96:97]
    v_pk_mul_f32 v[50:51], v[50:51], v[98:99]
    v_pk_mul_f32 v[56:57], v[56:57], v[104:105]
    v_pk_mul_f32 v[58:59], v[58:59], v[106:107]
    v_pk_fma_f32 v[48:49], v[112:113], v[80:81], v[48:49]
    v_pk_fma_f32 v[50:51], v[114:115], v[80:81], v[50:51]
    v_pk_fma_f32 v[56:57], v[120:121], v[80:81], v[56:57]
    v_pk_fma_f32 v[58:59], v[122:123], v[80:81], v[58:59]
    v_cvt_pk_bf16_f32 v24, v48, v49
    v_cvt_pk_bf16_f32 v25, v50, v51
    v_cvt_pk_bf16_f32 v26, v56, v57
    v_cvt_pk_bf16_f32 v27, v58, v59
    buffer_store_dwordx4 v[24:27], v3, s[8:11], s35 offen offset:1024 sc1
    v_pk_mul_f32 v[52:53], v[52:53], v[100:101]
    v_pk_mul_f32 v[54:55], v[54:55], v[102:103]
    v_pk_mul_f32 v[60:61], v[60:61], v[108:109]
    v_pk_mul_f32 v[62:63], v[62:63], v[110:111]
    v_pk_fma_f32 v[52:53], v[116:117], v[80:81], v[52:53]
    v_pk_fma_f32 v[54:55], v[118:119], v[80:81], v[54:55]
    v_pk_fma_f32 v[60:61], v[124:125], v[80:81], v[60:61]
    v_pk_fma_f32 v[62:63], v[126:127], v[80:81], v[62:63]
    v_cvt_pk_bf16_f32 v28, v52, v53
    v_cvt_pk_bf16_f32 v29, v54, v55
    v_cvt_pk_bf16_f32 v30, v60, v61
    v_cvt_pk_bf16_f32 v31, v62, v63
    buffer_store_dwordx4 v[28:31], v3, s[8:11], s35 offen offset:1536 sc1
    s_add_u32 s35, s35, 262144
    s_add_u32 s34, s34, 1
    s_mov_b32 s36, s50
    s_add_u32 s50, s50, 8192
    s_mov_b32 s53, 1
    s_waitcnt vmcnt(4)
    s_branch L_proj_e2_v
Lpb_18044:
    v_mfma_f32_32x32x16_bf16 v[48:63], v[168:171], a[84:87], v[48:63]
    v_mul_f32 v102, -v96, v97
    s_mov_b32 m0, s39
    s_add_u32 s43, s38, 4096
    buffer_load_dwordx4 v2, s[8:11], s38 offen offset:0 lds
    buffer_load_dwordx4 v2, s[8:11], s38 offen offset:1024 lds
    s_waitcnt lgkmcnt(7)
    v_mfma_f32_32x32x16_bf16 v[32:47], v[216:219], a[176:179], v[32:47]
    ds_read_b128 v[248:251], v1 offset:30720
    v_cndmask_b32 v98, v100, v102, s[54:55]
    ds_write_b32 v10, v98
    buffer_load_dwordx4 v2, s[8:11], s38 offen offset:2048 lds
    buffer_load_dwordx4 v2, s[8:11], s38 offen offset:3072 lds
    s_waitcnt lgkmcnt(8)
    v_mfma_f32_32x32x16_bf16 v[32:47], v[220:223], a[184:187], v[32:47]
    ds_read_b128 v[252:255], v1 offset:31744
    ds_read_b128 v[96:99], v11 offset:0
    s_add_u32 m0, s39, 4096
    s_add_u32 s38, s38, 32768
    buffer_load_dwordx4 v2, s[8:11], s43 offen offset:0 lds
    buffer_load_dwordx4 v2, s[8:11], s43 offen offset:1024 lds
    v_mfma_f32_32x32x16_bf16 v[48:63], v[172:175], a[92:95], v[48:63]
    ds_read_b128 v[112:115], v11 offset:128
    ds_read_b128 v[100:103], v11 offset:32
    buffer_load_dwordx4 v2, s[8:11], s43 offen offset:2048 lds
    buffer_load_dwordx4 v2, s[8:11], s43 offen offset:3072 lds
    s_waitcnt lgkmcnt(11)
    v_mfma_f32_32x32x16_bf16 v[32:47], v[224:227], a[192:195], v[32:47]
    ds_read_b128 v[116:119], v11 offset:160
    s_mov_b32 m0, s52
    s_add_u32 s37, s37, 2048
    buffer_load_dwordx4 v8, s[8:11], s51 offen lds
    s_add_u32 s51, s51, 4096
    s_xor_b32 s39, s39, 32768
    s_xor_b32 s52, s52, 4096
    s_add_u32 s40, s40, 1
    s_cmp_ge_u32 s40, 64
    s_cselect_b32 s37, 5636096, s37
    buffer_load_dword v7, v4, s[8:11], s37 offen sc1
    s_waitcnt lgkmcnt(11)
    v_mfma_f32_32x32x16_bf16 v[32:47], v[228:231], a[200:203], v[32:47]
    ds_read_b128 v[104:107], v11 offset:64
    ds_read_b128 v[120:123], v11 offset:192
    v_mfma_f32_32x32x16_bf16 v[48:63], v[176:179], a[100:103], v[48:63]
    ds_read_b128 v[108:111], v11 offset:96
    s_waitcnt lgkmcnt(13)
    v_mfma_f32_32x32x16_bf16 v[32:47], v[232:235], a[208:211], v[32:47]
    ds_read_b128 v[124:127], v11 offset:224
    s_waitcnt lgkmcnt(13)
    v_mfma_f32_32x32x16_bf16 v[32:47], v[236:239], a[216:219], v[32:47]
    v_mfma_f32_32x32x16_bf16 v[48:63], v[180:183], a[108:111], v[48:63]
    s_waitcnt lgkmcnt(12)
    v_mfma_f32_32x32x16_bf16 v[32:47], v[240:243], a[224:227], v[32:47]
    s_waitcnt lgkmcnt(11)
    v_mfma_f32_32x32x16_bf16 v[32:47], v[244:247], a[232:235], v[32:47]
    v_mfma_f32_32x32x16_bf16 v[48:63], v[184:187], a[116:119], v[48:63]
    s_waitcnt lgkmcnt(10)
    v_mfma_f32_32x32x16_bf16 v[32:47], v[248:251], a[240:243], v[32:47]
    s_waitcnt lgkmcnt(8)
    v_mfma_f32_32x32x16_bf16 v[32:47], v[252:255], a[248:251], v[32:47]
    v_mfma_f32_32x32x16_bf16 v[48:63], v[188:191], a[124:127], v[48:63]
    v_mfma_f32_32x32x16_bf16 v[48:63], v[192:195], a[132:135], v[48:63]
    v_mfma_f32_32x32x16_bf16 v[48:63], v[196:199], a[140:143], v[48:63]
    s_waitcnt lgkmcnt(7)
    s_nop 7
    v_mul_f32 v32, v32, v96
    v_mul_f32 v33, v33, v97
    v_mul_f32 v34, v34, v98
    v_mfma_f32_32x32x16_bf16 v[48:63], v[200:203], a[148:151], v[48:63]
    v_mul_f32 v35, v35, v99
    s_waitcnt lgkmcnt(3)
    v_mul_f32 v40, v40, v104
    v_mul_f32 v41, v41, v105
    v_mfma_f32_32x32x16_bf16 v[48:63], v[204:207], a[156:159], v[48:63]
    v_mul_f32 v42, v42, v106
    v_mul_f32 v43, v43, v107
    v_fmac_f32 v32, v112, v64
    v_mfma_f32_32x32x16_bf16 v[48:63], v[208:211], a[164:167], v[48:63]
    v_fmac_f32 v33, v113, v64
    v_fmac_f32 v34, v114, v64
    v_fmac_f32 v35, v115, v64
    v_mfma_f32_32x32x16_bf16 v[48:63], v[212:215], a[172:175], v[48:63]
    s_waitcnt lgkmcnt(2)
    v_fmac_f32 v40, v120, v64
    v_fmac_f32 v41, v121, v64
    v_fmac_f32 v42, v122, v64
    v_mfma_f32_32x32x16_bf16 v[48:63], v[216:219], a[180:183], v[48:63]
    v_fmac_f32 v43, v123, v64
    v_cvt_pk_bf16_f32 v16, v32, v33
    v_cvt_pk_bf16_f32 v17, v34, v35
    v_mfma_f32_32x32x16_bf16 v[48:63], v[220:223], a[188:191], v[48:63]
    v_cvt_pk_bf16_f32 v18, v40, v41
    v_cvt_pk_bf16_f32 v19, v42, v43
    buffer_store_dwordx4 v[16:19], v3, s[8:11], s35 offen offset:0 sc1
    v_mfma_f32_32x32x16_bf16 v[48:63], v[224:227], a[196:199], v[48:63]
    v_mul_f32 v36, v36, v100
    v_mul_f32 v37, v37, v101
    v_mul_f32 v38, v38, v102
    v_mfma_f32_32x32x16_bf16 v[48:63], v[228:231], a[204:207], v[48:63]
    v_mul_f32 v39, v39, v103
    s_waitcnt lgkmcnt(1)
    v_mul_f32 v44, v44, v108
    v_mul_f32 v45, v45, v109
    v_mfma_f32_32x32x16_bf16 v[48:63], v[232:235], a[212:215], v[48:63]
    v_mul_f32 v46, v46, v110
    v_mul_f32 v47, v47, v111
    v_fmac_f32 v36, v116, v64
    v_mfma_f32_32x32x16_bf16 v[48:63], v[236:239], a[220:223], v[48:63]
    v_fmac_f32 v37, v117, v64
    v_fmac_f32 v38, v118, v64
    v_fmac_f32 v39, v119, v64
    v_mfma_f32_32x32x16_bf16 v[48:63], v[240:243], a[228:231], v[48:63]
    s_waitcnt lgkmcnt(0)
    v_fmac_f32 v44, v124, v64
    v_fmac_f32 v45, v125, v64
    v_fmac_f32 v46, v126, v64
    v_mfma_f32_32x32x16_bf16 v[48:63], v[244:247], a[236:239], v[48:63]
    v_fmac_f32 v47, v127, v64
    v_cvt_pk_bf16_f32 v20, v36, v37
    v_cvt_pk_bf16_f32 v21, v38, v39
    v_mfma_f32_32x32x16_bf16 v[48:63], v[248:251], a[244:247], v[48:63]
    v_cvt_pk_bf16_f32 v22, v44, v45
    v_cvt_pk_bf16_f32 v23, v46, v47
    buffer_store_dwordx4 v[20:23], v3, s[8:11], s35 offen offset:512 sc1
    v_mfma_f32_32x32x16_bf16 v[48:63], v[252:255], a[252:255], v[48:63]
    v_xor_b32 v1, 0x8000, v1
    s_nop 10
    v_pk_mul_f32 v[48:49], v[48:49], v[96:97]
    v_pk_mul_f32 v[50:51], v[50:51], v[98:99]
    v_pk_mul_f32 v[56:57], v[56:57], v[104:105]
    v_pk_mul_f32 v[58:59], v[58:59], v[106:107]
    v_pk_fma_f32 v[48:49], v[112:113], v[80:81], v[48:49]
    v_pk_fma_f32 v[50:51], v[114:115], v[80:81], v[50:51]
    v_pk_fma_f32 v[56:57], v[120:121], v[80:81], v[56:57]
    v_pk_fma_f32 v[58:59], v[122:123], v[80:81], v[58:59]
    v_cvt_pk_bf16_f32 v24, v48, v49
    v_cvt_pk_bf16_f32 v25, v50, v51
    v_cvt_pk_bf16_f32 v26, v56, v57
    v_cvt_pk_bf16_f32 v27, v58, v59
    buffer_store_dwordx4 v[24:27], v3, s[8:11], s35 offen offset:1024 sc1
    v_pk_mul_f32 v[52:53], v[52:53], v[100:101]
    v_pk_mul_f32 v[54:55], v[54:55], v[102:103]
    v_pk_mul_f32 v[60:61], v[60:61], v[108:109]
    v_pk_mul_f32 v[62:63], v[62:63], v[110:111]
    v_pk_fma_f32 v[52:53], v[116:117], v[80:81], v[52:53]
    v_pk_fma_f32 v[54:55], v[118:119], v[80:81], v[54:55]
    v_pk_fma_f32 v[60:61], v[124:125], v[80:81], v[60:61]
    v_pk_fma_f32 v[62:63], v[126:127], v[80:81], v[62:63]
    v_cvt_pk_bf16_f32 v28, v52, v53
    v_cvt_pk_bf16_f32 v29, v54, v55
    v_cvt_pk_bf16_f32 v30, v60, v61
    v_cvt_pk_bf16_f32 v31, v62, v63
    buffer_store_dwordx4 v[28:31], v3, s[8:11], s35 offen offset:1536 sc1
    s_add_u32 s35, s35, 262144
    s_add_u32 s34, s34, 1
    s_mov_b32 s36, s50
    s_add_u32 s50, s50, 8192
    s_mov_b32 s53, 1
    s_waitcnt vmcnt(4)
    s_branch L_proj_e2_v
Lpb_18045:
    s_waitcnt lgkmcnt(13)
    v_mfma_f32_32x32x16_bf16 v[32:47], v[236:239], a[216:219], v[32:47]
    s_mov_b32 m0, s39
    s_add_u32 s43, s38, 4096
    buffer_load_dwordx4 v2, s[8:11], s38 offen offset:0 lds
    buffer_load_dwordx4 v2, s[8:11], s38 offen offset:1024 lds
    v_mfma_f32_32x32x16_bf16 v[48:63], v[180:183], a[108:111], v[48:63]
    buffer_load_dwordx4 v2, s[8:11], s38 offen offset:2048 lds
    buffer_load_dwordx4 v2, s[8:11], s38 offen offset:3072 lds
    s_waitcnt lgkmcnt(12)
    v_mfma_f32_32x32x16_bf16 v[32:47], v[240:243], a[224:227], v[32:47]
    s_add_u32 m0, s39, 4096
    s_add_u32 s38, s38, 32768
    buffer_load_dwordx4 v2, s[8:11], s43 offen offset:0 lds
    buffer_load_dwordx4 v2, s[8:11], s43 offen offset:1024 lds
    s_waitcnt lgkmcnt(11)
    v_mfma_f32_32x32x16_bf16 v[32:47], v[244:247], a[232:235], v[32:47]
    buffer_load_dwordx4 v2, s[8:11], s43 offen offset:2048 lds
    buffer_load_dwordx4 v2, s[8:11], s43 offen offset:3072 lds
    v_mfma_f32_32x32x16_bf16 v[48:63], v[184:187], a[116:119], v[48:63]
    s_mov_b32 m0, s52
    s_add_u32 s37, s37, 2048
    buffer_load_dwordx4 v8, s[8:11], s51 offen lds
    s_add_u32 s51, s51, 4096
    s_xor_b32 s39, s39, 32768
    s_xor_b32 s52, s52, 4096
    s_add_u32 s40, s40, 1
    s_cmp_ge_u32 s40, 64
    s_cselect_b32 s37, 5636096, s37
    buffer_load_dword v7, v4, s[8:11], s37 offen sc1
    s_waitcnt lgkmcnt(10)
    v_mfma_f32_32x32x16_bf16 v[32:47], v[248:251], a[240:243], v[32:47]
    s_waitcnt lgkmcnt(8)
    v_mfma_f32_32x32x16_bf16 v[32:47], v[252:255], a[248:251], v[32:47]
    v_mfma_f32_32x32x16_bf16 v[48:63], v[188:191], a[124:127], v[48:63]
    v_mfma_f32_32x32x16_bf16 v[48:63], v[192:195], a[132:135], v[48:63]
    v_mfma_f32_32x32x16_bf16 v[48:63], v[196:199], a[140:143], v[48:63]
    s_waitcnt lgkmcnt(7)
    s_nop 7
    v_mul_f32 v32, v32, v96
    v_mul_f32 v33, v33, v97
    v_mul_f32 v34, v34, v98
    v_mfma_f32_32x32x16_bf16 v[48:63], v[200:203], a[148:151], v[48:63]
    v_mul_f32 v35, v35, v99
    s_waitcnt lgkmcnt(3)
    v_mul_f32 v40, v40, v104
    v_mul_f32 v41, v41, v105
    v_mfma_f32_32x32x16_bf16 v[48:63], v[204:207], a[156:159], v[48:63]
    v_mul_f32 v42, v42, v106
    v_mul_f32 v43, v43, v107
    v_fmac_f32 v32, v112, v64
    v_mfma_f32_32x32x16_bf16 v[48:63], v[208:211], a[164:167], v[48:63]
    v_fmac_f32 v33, v113, v64
    v_fmac_f32 v34, v114, v64
    v_fmac_f32 v35, v115, v64
    v_mfma_f32_32x32x16_bf16 v[48:63], v[212:215], a[172:175], v[48:63]
    s_waitcnt lgkmcnt(2)
    v_fmac_f32 v40, v120, v64
    v_fmac_f32 v41, v121, v64
    v_fmac_f32 v42, v122, v64
    v_mfma_f32_32x32x16_bf16 v[48:63], v[216:219], a[180:183], v[48:63]
    v_fmac_f32 v43, v123, v64
    v_cvt_pk_bf16_f32 v16, v32, v33
    v_cvt_pk_bf16_f32 v17, v34, v35
    v_mfma_f32_32x32x16_bf16 v[48:63], v[220:223], a[188:191], v[48:63]
    v_cvt_pk_bf16_f32 v18, v40, v41
    v_cvt_pk_bf16_f32 v19, v42, v43
    buffer_store_dwordx4 v[16:19], v3, s[8:11], s35 offen offset:0 sc1
    v_mfma_f32_32x32x16_bf16 v[48:63], v[224:227], a[196:199], v[48:63]
    v_mul_f32 v36, v36, v100
    v_mul_f32 v37, v37, v101
    v_mul_f32 v38, v38, v102
    v_mfma_f32_32x32x16_bf16 v[48:63], v[228:231], a[204:207], v[48:63]
    v_mul_f32 v39, v39, v103
    s_waitcnt lgkmcnt(1)
    v_mul_f32 v44, v44, v108
    v_mul_f32 v45, v45, v109
    v_mfma_f32_32x32x16_bf16 v[48:63], v[232:235], a[212:215], v[48:63]
    v_mul_f32 v46, v46, v110
    v_mul_f32 v47, v47, v111
    v_fmac_f32 v36, v116, v64
    v_mfma_f32_32x32x16_bf16 v[48:63], v[236:239], a[220:223], v[48:63]
    v_fmac_f32 v37, v117, v64
    v_fmac_f32 v38, v118, v64
    v_fmac_f32 v39, v119, v64
    v_mfma_f32_32x32x16_bf16 v[48:63], v[240:243], a[228:231], v[48:63]
    s_waitcnt lgkmcnt(0)
    v_fmac_f32 v44, v124, v64
    v_fmac_f32 v45, v125, v64
    v_fmac_f32 v46, v126, v64
    v_mfma_f32_32x32x16_bf16 v[48:63], v[244:247], a[236:239], v[48:63]
    v_fmac_f32 v47, v127, v64
    v_cvt_pk_bf16_f32 v20, v36, v37
    v_cvt_pk_bf16_f32 v21, v38, v39
    v_mfma_f32_32x32x16_bf16 v[48:63], v[248:251], a[244:247], v[48:63]
    v_cvt_pk_bf16_f32 v22, v44, v45
    v_cvt_pk_bf16_f32 v23, v46, v47
    buffer_store_dwordx4 v[20:23], v3, s[8:11], s35 offen offset:512 sc1
    v_mfma_f32_32x32x16_bf16 v[48:63], v[252:255], a[252:255], v[48:63]
    v_xor_b32 v1, 0x8000, v1
    s_nop 10
    v_pk_mul_f32 v[48:49], v[48:49], v[96:97]
    v_pk_mul_f32 v[50:51], v[50:51], v[98:99]
    v_pk_mul_f32 v[56:57], v[56:57], v[104:105]
    v_pk_mul_f32 v[58:59], v[58:59], v[106:107]
    v_pk_fma_f32 v[48:49], v[112:113], v[80:81], v[48:49]
    v_pk_fma_f32 v[50:51], v[114:115], v[80:81], v[50:51]
    v_pk_fma_f32 v[56:57], v[120:121], v[80:81], v[56:57]
    v_pk_fma_f32 v[58:59], v[122:123], v[80:81], v[58:59]
    v_cvt_pk_bf16_f32 v24, v48, v49
    v_cvt_pk_bf16_f32 v25, v50, v51
    v_cvt_pk_bf16_f32 v26, v56, v57
    v_cvt_pk_bf16_f32 v27, v58, v59
    buffer_store_dwordx4 v[24:27], v3, s[8:11], s35 offen offset:1024 sc1
    v_pk_mul_f32 v[52:53], v[52:53], v[100:101]
    v_pk_mul_f32 v[54:55], v[54:55], v[102:103]
    v_pk_mul_f32 v[60:61], v[60:61], v[108:109]
    v_pk_mul_f32 v[62:63], v[62:63], v[110:111]
    v_pk_fma_f32 v[52:53], v[116:117], v[80:81], v[52:53]
    v_pk_fma_f32 v[54:55], v[118:119], v[80:81], v[54:55]
    v_pk_fma_f32 v[60:61], v[124:125], v[80:81], v[60:61]
    v_pk_fma_f32 v[62:63], v[126:127], v[80:81], v[62:63]
    v_cvt_pk_bf16_f32 v28, v52, v53
    v_cvt_pk_bf16_f32 v29, v54, v55
    v_cvt_pk_bf16_f32 v30, v60, v61
    v_cvt_pk_bf16_f32 v31, v62, v63
    buffer_store_dwordx4 v[28:31], v3, s[8:11], s35 offen offset:1536 sc1
    s_add_u32 s35, s35, 262144
    s_add_u32 s34, s34, 1
    s_mov_b32 s36, s50
    s_add_u32 s50, s50, 8192
    s_mov_b32 s53, 1
    s_waitcnt vmcnt(4)
    s_branch L_proj_e2_v
Lpb_18046:
    v_mfma_f32_32x32x16_bf16 v[48:63], v[192:195], a[132:135], v[48:63]
    s_mov_b32 m0, s39
    s_add_u32 s43, s38, 4096
    buffer_load_dwordx4 v2, s[8:11], s38 offen offset:0 lds
    buffer_load_dwordx4 v2, s[8:11], s38 offen offset:1024 lds
    v_mfma_f32_32x32x16_bf16 v[48:63], v[196:199], a[140:143], v[48:63]
    s_waitcnt lgkmcnt(7)
    v_mul_f32 v32, v32, v96
    v_mul_f32 v33, v33, v97
    v_mul_f32 v34, v34, v98
    buffer_load_dwordx4 v2, s[8:11], s38 offen offset:2048 lds
    buffer_load_dwordx4 v2, s[8:11], s38 offen offset:3072 lds
    v_mfma_f32_32x32x16_bf16 v[48:63], v[200:203], a[148:151], v[48:63]
    v_mul_f32 v35, v35, v99
    s_waitcnt lgkmcnt(3)
    v_mul_f32 v40, v40, v104
    v_mul_f32 v41, v41, v105
    s_add_u32 m0, s39, 4096
    s_add_u32 s38, s38, 32768
    buffer_load_dwordx4 v2, s[8:11], s43 offen offset:0 lds
    buffer_load_dwordx4 v2, s[8:11], s43 offen offset:1024 lds
    v_mfma_f32_32x32x16_bf16 v[48:63], v[204:207], a[156:159], v[48:63]
    v_mul_f32 v42, v42, v106
    v_mul_f32 v43, v43, v107
    v_fmac_f32 v32, v112, v64
    buffer_load_dwordx4 v2, s[8:11], s43 offen offset:2048 lds
    buffer_load_dwordx4 v2, s[8:11], s43 offen offset:3072 lds
    v_mfma_f32_32x32x16_bf16 v[48:63], v[208:211], a[164:167], v[48:63]
    v_fmac_f32 v33, v113, v64
    v_fmac_f32 v34, v114, v64
    v_fmac_f32 v35, v115, v64
    s_mov_b32 m0, s52
    s_add_u32 s37, s37, 2048
    buffer_load_dwordx4 v8, s[8:11], s51 offen lds
    s_add_u32 s51, s51, 4096
    s_xor_b32 s39, s39, 32768
    s_xor_b32 s52, s52, 4096
    s_add_u32 s40, s40, 1
    s_cmp_ge_u32 s40, 64
    s_cselect_b32 s37, 5636096, s37
    buffer_load_dword v7, v4, s[8:11], s37 offen sc1
    v_mfma_f32_32x32x16_bf16 v[48:63], v[212:215], a[172:175], v[48:63]
    s_waitcnt lgkmcnt(2)
    v_fmac_f32 v40, v120, v64
    v_fmac_f32 v41, v121, v64
    v_fmac_f32 v42, v122, v64
    v_mfma_f32_32x32x16_bf16 v[48:63], v[216:219], a[180:183], v[48:63]
    v_fmac_f32 v43, v123, v64
    v_cvt_pk_bf16_f32 v16, v32, v33
    v_cvt_pk_bf16_f32 v17, v34, v35
    v_mfma_f32_32x32x16_bf16 v[48:63], v[220:223], a[188:191], v[48:63]
    v_cvt_pk_bf16_f32 v18, v40, v41
    v_cvt_pk_bf16_f32 v19, v42, v43
    buffer_store_dwordx4 v[16:19], v3, s[8:11], s35 offen offset:0 sc1
    v_mfma_f32_32x32x16_bf16 v[48:63], v[224:227], a[196:199], v[48:63]
    v_mul_f32 v36, v36, v100
    v_mul_f32 v37, v37, v101
    v_mul_f32 v38, v38, v102
    v_mfma_f32_32x32x16_bf16 v[48:63], v[228:231], a[204:207], v[48:63]
    v_mul_f32 v39, v39, v103
    s_waitcnt lgkmcnt(1)
    v_mul_f32 v44, v44, v108
    v_mul_f32 v45, v45, v109
    v_mfma_f32_32x32x16_bf16 v[48:63], v[232:235], a[212:215], v[48:63]
    v_mul_f32 v46, v46, v110
    v_mul_f32 v47, v47, v111
    v_fmac_f32 v36, v116, v64
    v_mfma_f32_32x32x16_bf16 v[48:63], v[236:239], a[220:223], v[48:63]
    v_fmac_f32 v37, v117, v64
    v_fmac_f32 v38, v118, v64
    v_fmac_f32 v39, v119, v64
    v_mfma_f32_32x32x16_bf16 v[48:63], v[240:243], a[228:231], v[48:63]
    s_waitcnt lgkmcnt(0)
    v_fmac_f32 v44, v124, v64
    v_fmac_f32 v45, v125, v64
    v_fmac_f32 v46, v126, v64
    v_mfma_f32_32x32x16_bf16 v[48:63], v[244:247], a[236:239], v[48:63]
    v_fmac_f32 v47, v127, v64
    v_cvt_pk_bf16_f32 v20, v36, v37
    v_cvt_pk_bf16_f32 v21, v38, v39
    v_mfma_f32_32x32x16_bf16 v[48:63], v[248:251], a[244:247], v[48:63]
    v_cvt_pk_bf16_f32 v22, v44, v45
    v_cvt_pk_bf16_f32 v23, v46, v47
    buffer_store_dwordx4 v[20:23], v3, s[8:11], s35 offen offset:512 sc1
    v_mfma_f32_32x32x16_bf16 v[48:63], v[252:255], a[252:255], v[48:63]
    v_xor_b32 v1, 0x8000, v1
    s_nop 10
    v_pk_mul_f32 v[48:49], v[48:49], v[96:97]
    v_pk_mul_f32 v[50:51], v[50:51], v[98:99]
    v_pk_mul_f32 v[56:57], v[56:57], v[104:105]
    v_pk_mul_f32 v[58:59], v[58:59], v[106:107]
    v_pk_fma_f32 v[48:49], v[112:113], v[80:81], v[48:49]
    v_pk_fma_f32 v[50:51], v[114:115], v[80:81], v[50:51]
    v_pk_fma_f32 v[56:57], v[120:121], v[80:81], v[56:57]
    v_pk_fma_f32 v[58:59], v[122:123], v[80:81], v[58:59]
    v_cvt_pk_bf16_f32 v24, v48, v49
    v_cvt_pk_bf16_f32 v25, v50, v51
    v_cvt_pk_bf16_f32 v26, v56, v57
    v_cvt_pk_bf16_f32 v27, v58, v59
    buffer_store_dwordx4 v[24:27], v3, s[8:11], s35 offen offset:1024 sc1
    v_pk_mul_f32 v[52:53], v[52:53], v[100:101]
    v_pk_mul_f32 v[54:55], v[54:55], v[102:103]
    v_pk_mul_f32 v[60:61], v[60:61], v[108:109]
    v_pk_mul_f32 v[62:63], v[62:63], v[110:111]
    v_pk_fma_f32 v[52:53], v[116:117], v[80:81], v[52:53]
    v_pk_fma_f32 v[54:55], v[118:119], v[80:81], v[54:55]
    v_pk_fma_f32 v[60:61], v[124:125], v[80:81], v[60:61]
    v_pk_fma_f32 v[62:63], v[126:127], v[80:81], v[62:63]
    v_cvt_pk_bf16_f32 v28, v52, v53
    v_cvt_pk_bf16_f32 v29, v54, v55
    v_cvt_pk_bf16_f32 v30, v60, v61
    v_cvt_pk_bf16_f32 v31, v62, v63
    buffer_store_dwordx4 v[28:31], v3, s[8:11], s35 offen offset:1536 sc1
    s_add_u32 s35, s35, 262144
    s_add_u32 s34, s34, 1
    s_mov_b32 s36, s50
    s_add_u32 s50, s50, 8192
    s_mov_b32 s53, 1
    s_waitcnt vmcnt(4)
    s_branch L_proj_e2_v
Lpb_18047:
    v_mfma_f32_32x32x16_bf16 v[48:63], v[224:227], a[196:199], v[48:63]
    v_mul_f32 v36, v36, v100
    v_mul_f32 v37, v37, v101
    v_mul_f32 v38, v38, v102
    s_mov_b32 m0, s39
    s_add_u32 s43, s38, 4096
    buffer_load_dwordx4 v2, s[8:11], s38 offen offset:0 lds
    buffer_load_dwordx4 v2, s[8:11], s38 offen offset:1024 lds
    v_mfma_f32_32x32x16_bf16 v[48:63], v[228:231], a[204:207], v[48:63]
    v_mul_f32 v39, v39, v103
    s_waitcnt lgkmcnt(1)
    v_mul_f32 v44, v44, v108
    v_mul_f32 v45, v45, v109
    buffer_load_dwordx4 v2, s[8:11], s38 offen offset:2048 lds
    buffer_load_dwordx4 v2, s[8:11], s38 offen offset:3072 lds
    v_mfma_f32_32x32x16_bf16 v[48:63], v[232:235], a[212:215], v[48:63]
    v_mul_f32 v46, v46, v110
    v_mul_f32 v47, v47, v111
    v_fmac_f32 v36, v116, v64
    s_add_u32 m0, s39, 4096
    s_add_u32 s38, s38, 32768
    buffer_load_dwordx4 v2, s[8:11], s43 offen offset:0 lds
    buffer_load_dwordx4 v2, s[8:11], s43 offen offset:1024 lds
    v_mfma_f32_32x32x16_bf16 v[48:63], v[236:239], a[220:223], v[48:63]
    v_fmac_f32 v37, v117, v64
    v_fmac_f32 v38, v118, v64
    v_fmac_f32 v39, v119, v64
    buffer_load_dwordx4 v2, s[8:11], s43 offen offset:2048 lds
    buffer_load_dwordx4 v2, s[8:11], s43 offen offset:3072 lds
    v_mfma_f32_32x32x16_bf16 v[48:63], v[240:243], a[228:231], v[48:63]
    s_waitcnt lgkmcnt(0)
    v_fmac_f32 v44, v124, v64
    v_fmac_f32 v45, v125, v64
    v_fmac_f32 v46, v126, v64
    s_mov_b32 m0, s52
    s_add_u32 s37, s37, 2048
    buffer_load_dwordx4 v8, s[8:11], s51 offen lds
    s_add_u32 s51, s51, 4096
    s_xor_b32 s39, s39, 32768
    s_xor_b32 s52, s52, 4096
    s_add_u32 s40, s40, 1
    s_cmp_ge_u32 s40, 64
    s_cselect_b32 s37, 5636096, s37
    buffer_load_dword v7, v4, s[8:11], s37 offen sc1
    v_mfma_f32_32x32x16_bf16 v[48:63], v[244:247], a[236:239], v[48:63]
    v_fmac_f32 v47, v127, v64
    v_cvt_pk_bf16_f32 v20, v36, v37
    v_cvt_pk_bf16_f32 v21, v38, v39
    v_mfma_f32_32x32x16_bf16 v[48:63], v[248:251], a[244:247], v[48:63]
    v_cvt_pk_bf16_f32 v22, v44, v45
    v_cvt_pk_bf16_f32 v23, v46, v47
    buffer_store_dwordx4 v[20:23], v3, s[8:11], s35 offen offset:512 sc1
    v_mfma_f32_32x32x16_bf16 v[48:63], v[252:255], a[252:255], v[48:63]
    v_xor_b32 v1, 0x8000, v1
    s_nop 10
    v_pk_mul_f32 v[48:49], v[48:49], v[96:97]
    v_pk_mul_f32 v[50:51], v[50:51], v[98:99]
    v_pk_mul_f32 v[56:57], v[56:57], v[104:105]
    v_pk_mul_f32 v[58:59], v[58:59], v[106:107]
    v_pk_fma_f32 v[48:49], v[112:113], v[80:81], v[48:49]
    v_pk_fma_f32 v[50:51], v[114:115], v[80:81], v[50:51]
    v_pk_fma_f32 v[56:57], v[120:121], v[80:81], v[56:57]
    v_pk_fma_f32 v[58:59], v[122:123], v[80:81], v[58:59]
    v_cvt_pk_bf16_f32 v24, v48, v49
    v_cvt_pk_bf16_f32 v25, v50, v51
    v_cvt_pk_bf16_f32 v26, v56, v57
    v_cvt_pk_bf16_f32 v27, v58, v59
    buffer_store_dwordx4 v[24:27], v3, s[8:11], s35 offen offset:1024 sc1
    v_pk_mul_f32 v[52:53], v[52:53], v[100:101]
    v_pk_mul_f32 v[54:55], v[54:55], v[102:103]
    v_pk_mul_f32 v[60:61], v[60:61], v[108:109]
    v_pk_mul_f32 v[62:63], v[62:63], v[110:111]
    v_pk_fma_f32 v[52:53], v[116:117], v[80:81], v[52:53]
    v_pk_fma_f32 v[54:55], v[118:119], v[80:81], v[54:55]
    v_pk_fma_f32 v[60:61], v[124:125], v[80:81], v[60:61]
    v_pk_fma_f32 v[62:63], v[126:127], v[80:81], v[62:63]
    v_cvt_pk_bf16_f32 v28, v52, v53
    v_cvt_pk_bf16_f32 v29, v54, v55
    v_cvt_pk_bf16_f32 v30, v60, v61
    v_cvt_pk_bf16_f32 v31, v62, v63
    buffer_store_dwordx4 v[28:31], v3, s[8:11], s35 offen offset:1536 sc1
    s_add_u32 s35, s35, 262144
    s_add_u32 s34, s34, 1
    s_mov_b32 s36, s50
    s_add_u32 s50, s50, 8192
    s_mov_b32 s53, 1
    s_waitcnt vmcnt(3)
    s_branch L_proj_e2_v
L_proj_end:
    s_branch L_end
L_o:
    s_sub_u32 s6, s4, 5
    s_cmp_ge_i32 s63, 0
    s_cbranch_scc1 Lanns_26043
    v_and_b32 v16, 63, v0
    v_lshlrev_b32 v16, 2, v16
Lann_26041:
    buffer_load_dword v17, v16, s[12:15], 0 offen sc1
Lannc_26044:
    s_waitcnt vmcnt(0)
    v_and_b32 v19, 0x0f0f0f0f, v17
    v_subrev_u32 v18, 0x01010101, v19
    v_and_b32 v18, 0x80808080, v18
    v_cmp_ne_u32 vcc, 0, v18
    s_nop 0
    s_cbranch_vccz Lannd_26042
    s_sub_u32 s62, s62, 1
    s_cbranch_scc0 Ltok_26045
    s_movk_i32 s61, 1
    s_branch L_abort
Ltok_26045:
    s_sleep 4
    s_branch Lann_26041
Lannd_26042:
    s_getreg_b32 s32, hwreg(HW_REG_XCC_ID)
    s_and_b32 s32, s32, 15
    s_min_u32 s32, s32, 14
    s_add_u32 s32, s32, 1
    s_mul_i32 s32, s32, 0x11111111
    v_cmp_ne_u32 vcc, s32, v17
    s_not_b32 s33, s63
    s_lshl_b32 s33, s33, 3
    s_lshr_b64 s[34:35], vcc, s33
    s_and_b32 s34, s34, 0xff
    s_cmp_lg_u32 s34, 0
    s_cselect_b32 s63, 1, 0
Lanns_26043:
    v_and_b32 v20, 63, v0
    s_lshl_b32 s32, s6, 7
    s_lshl_b32 s33, s5, 2
    s_add_u32 s32, s32, s33
    s_add_u32 s32, s32, s3
    v_lshlrev_b32 v221, 4, v20
    v_mov_b32 v224, 0
    v_mov_b32 v225, 0
    v_mov_b32 v226, 0
    v_mov_b32 v227, 0
    s_lshl_b32 s33, s32, 14
    s_add_u32 s33, s33, 171966464
    s_cmp_lg_u32 s63, 0
    s_cbranch_scc1 Lopi_26046_s
    buffer_store_dwordx4 v[224:227], v221, s[8:11], s33 offen offset:0
    buffer_store_dwordx4 v[224:227], v221, s[8:11], s33 offen offset:1024
    buffer_store_dwordx4 v[224:227], v221, s[8:11], s33 offen offset:2048
    buffer_store_dwordx4 v[224:227], v221, s[8:11], s33 offen offset:3072
    s_add_u32 s33, s33, 4096
    buffer_store_dwordx4 v[224:227], v221, s[8:11], s33 offen offset:0
    buffer_store_dwordx4 v[224:227], v221, s[8:11], s33 offen offset:1024
    buffer_store_dwordx4 v[224:227], v221, s[8:11], s33 offen offset:2048
    buffer_store_dwordx4 v[224:227], v221, s[8:11], s33 offen offset:3072
    s_add_u32 s33, s33, 4096
    buffer_store_dwordx4 v[224:227], v221, s[8:11], s33 offen offset:0
    buffer_store_dwordx4 v[224:227], v221, s[8:11], s33 offen offset:1024
    buffer_store_dwordx4 v[224:227], v221, s[8:11], s33 offen offset:2048
    buffer_store_dwordx4 v[224:227], v221, s[8:11], s33 offen offset:3072
    s_add_u32 s33, s33, 4096
    buffer_store_dwordx4 v[224:227], v221, s[8:11], s33 offen offset:0
    buffer_store_dwordx4 v[224:227], v221, s[8:11], s33 offen offset:1024
    buffer_store_dwordx4 v[224:227], v221, s[8:11], s33 offen offset:2048
    buffer_store_dwordx4 v[224:227], v221, s[8:11], s33 offen offset:3072
    s_branch Lopi_26046_e
Lopi_26046_s:
    buffer_store_dwordx4 v[224:227], v221, s[8:11], s33 offen offset:0 sc1
    buffer_store_dwordx4 v[224:227], v221, s[8:11], s33 offen offset:1024 sc1
    buffer_store_dwordx4 v[224:227], v221, s[8:11], s33 offen offset:2048 sc1
    buffer_store_dwordx4 v[224:227], v221, s[8:11], s33 offen offset:3072 sc1
    s_add_u32 s33, s33, 4096
    buffer_store_dwordx4 v[224:227], v221, s[8:11], s33 offen offset:0 sc1
    buffer_store_dwordx4 v[224:227], v221, s[8:11], s33 offen offset:1024 sc1
    buffer_store_dwordx4 v[224:227], v221, s[8:11], s33 offen offset:2048 sc1
    buffer_store_dwordx4 v[224:227], v221, s[8:11], s33 offen offset:3072 sc1
    s_add_u32 s33, s33, 4096
    buffer_store_dwordx4 v[224:227], v221, s[8:11], s33 offen offset:0 sc1
    buffer_store_dwordx4 v[224:227], v221, s[8:11], s33 offen offset:1024 sc1
    buffer_store_dwordx4 v[224:227], v221, s[8:11], s33 offen offset:2048 sc1
    buffer_store_dwordx4 v[224:227], v221, s[8:11], s33 offen offset:3072 sc1
    s_add_u32 s33, s33, 4096
    buffer_store_dwordx4 v[224:227], v221, s[8:11], s33 offen offset:0 sc1
    buffer_store_dwordx4 v[224:227], v221, s[8:11], s33 offen offset:1024 sc1
    buffer_store_dwordx4 v[224:227], v221, s[8:11], s33 offen offset:2048 sc1
    buffer_store_dwordx4 v[224:227], v221, s[8:11], s33 offen offset:3072 sc1
Lopi_26046_e:
    v_and_b32 v20, 63, v0
    s_lshl_b32 s32, s6, 7
    s_lshl_b32 s33, s5, 2
    s_add_u32 s32, s32, s33
    s_add_u32 s32, s32, s3
    s_lshl_b32 s32, s32, 5
    s_add_u32 s32, s32, 5677056
    s_lshl_b32 s33, s6, 12
    s_add_u32 s33, s33, 5677056
    v_lshlrev_b32 v21, 5, v20
    v_mov_b32 v22, -1
    s_waitcnt vmcnt(0)
    s_mov_b64 exec, 1
    buffer_store_dword v22, off, s[8:11], s32 sc1
    s_mov_b64 exec, -1
    s_mov_b32 s16, s88
    s_and_b32 s17, s89, 0xffff
    s_mov_b32 s18, 4194304
    s_mov_b32 s19, 0x20000
    v_and_b32 v9, 63, v0
    v_and_b32 v10, 15, v9
    v_lshrrev_b32 v11, 4, v9
    s_mov_b32 s59, 0x05040100
    s_mov_b32 s60, 0x07060302
    v_lshlrev_b32 v13, 13, v11
    v_lshlrev_b32 v14, 4, v10
    v_add_u32 v13, v13, v14
    s_and_b32 s32, s5, 15
    s_lshl_b32 s32, s32, 18
    s_lshl_b32 s33, s3, 8
    s_add_u32 s32, s32, s33
    v_add_u32 v13, s32, v13
    s_mov_b32 s32, 0
    buffer_load_dwordx4 v[16:19], v13, s[16:19], s32 offen
    s_mov_b32 s32, 1024
    buffer_load_dwordx4 v[20:23], v13, s[16:19], s32 offen
    s_mov_b32 s32, 2048
    buffer_load_dwordx4 v[24:27], v13, s[16:19], s32 offen
    s_mov_b32 s32, 3072
    buffer_load_dwordx4 v[28:31], v13, s[16:19], s32 offen
    s_mov_b32 s32, 4096
    buffer_load_dwordx4 v[32:35], v13, s[16:19], s32 offen
    s_mov_b32 s32, 5120
    buffer_load_dwordx4 v[36:39], v13, s[16:19], s32 offen
    s_mov_b32 s32, 6144
    buffer_load_dwordx4 v[40:43], v13, s[16:19], s32 offen
    s_mov_b32 s32, 7168
    buffer_load_dwordx4 v[44:47], v13, s[16:19], s32 offen
    s_mov_b32 s32, 32768
    buffer_load_dwordx4 v[48:51], v13, s[16:19], s32 offen
    s_mov_b32 s32, 33792
    buffer_load_dwordx4 v[52:55], v13, s[16:19], s32 offen
    s_mov_b32 s32, 34816
    buffer_load_dwordx4 v[56:59], v13, s[16:19], s32 offen
    s_mov_b32 s32, 35840
    buffer_load_dwordx4 v[60:63], v13, s[16:19], s32 offen
    s_mov_b32 s32, 36864
    buffer_load_dwordx4 v[64:67], v13, s[16:19], s32 offen
    s_mov_b32 s32, 37888
    buffer_load_dwordx4 v[68:71], v13, s[16:19], s32 offen
    s_mov_b32 s32, 38912
    buffer_load_dwordx4 v[72:75], v13, s[16:19], s32 offen
    s_mov_b32 s32, 39936
    buffer_load_dwordx4 v[76:79], v13, s[16:19], s32 offen
    s_mov_b32 s32, 65536
    buffer_load_dwordx4 v[80:83], v13, s[16:19], s32 offen
    s_mov_b32 s32, 66560
    buffer_load_dwordx4 v[84:87], v13, s[16:19], s32 offen
    s_mov_b32 s32, 67584
    buffer_load_dwordx4 v[88:91], v13, s[16:19], s32 offen
    s_mov_b32 s32, 68608
    buffer_load_dwordx4 v[92:95], v13, s[16:19], s32 offen
    s_mov_b32 s32, 69632
    buffer_load_dwordx4 v[96:99], v13, s[16:19], s32 offen
    s_mov_b32 s32, 70656
    buffer_load_dwordx4 v[100:103], v13, s[16:19], s32 offen
    s_mov_b32 s32, 71680
    buffer_load_dwordx4 v[104:107], v13, s[16:19], s32 offen
    s_mov_b32 s32, 72704
    buffer_load_dwordx4 v[108:111], v13, s[16:19], s32 offen
    s_mov_b32 s32, 98304
    buffer_load_dwordx4 v[112:115], v13, s[16:19], s32 offen
    s_mov_b32 s32, 99328
    buffer_load_dwordx4 v[116:119], v13, s[16:19], s32 offen
    s_mov_b32 s32, 100352
    buffer_load_dwordx4 v[120:123], v13, s[16:19], s32 offen
    s_mov_b32 s32, 101376
    buffer_load_dwordx4 v[124:127], v13, s[16:19], s32 offen
    s_mov_b32 s32, 102400
    buffer_load_dwordx4 v[128:131], v13, s[16:19], s32 offen
    s_mov_b32 s32, 103424
    buffer_load_dwordx4 v[132:135], v13, s[16:19], s32 offen
    s_mov_b32 s32, 104448
    buffer_load_dwordx4 v[136:139], v13, s[16:19], s32 offen
    s_mov_b32 s32, 105472
    buffer_load_dwordx4 v[140:143], v13, s[16:19], s32 offen
    s_mov_b32 s32, 131072
    buffer_load_dwordx4 v[144:147], v13, s[16:19], s32 offen
    s_mov_b32 s32, 132096
    buffer_load_dwordx4 v[148:151], v13, s[16:19], s32 offen
    s_mov_b32 s32, 133120
    buffer_load_dwordx4 v[152:155], v13, s[16:19], s32 offen
    s_mov_b32 s32, 134144
    buffer_load_dwordx4 v[156:159], v13, s[16:19], s32 offen
    s_mov_b32 s32, 135168
    buffer_load_dwordx4 v[160:163], v13, s[16:19], s32 offen
    s_mov_b32 s32, 136192
    buffer_load_dwordx4 v[164:167], v13, s[16:19], s32 offen
    s_mov_b32 s32, 137216
    buffer_load_dwordx4 v[168:171], v13, s[16:19], s32 offen
    s_mov_b32 s32, 138240
    buffer_load_dwordx4 v[172:175], v13, s[16:19], s32 offen
    s_mov_b32 s32, 163840
    buffer_load_dwordx4 v[176:179], v13, s[16:19], s32 offen
    s_mov_b32 s32, 164864
    buffer_load_dwordx4 v[180:183], v13, s[16:19], s32 offen
    s_mov_b32 s32, 165888
    buffer_load_dwordx4 v[184:187], v13, s[16:19], s32 offen
    s_mov_b32 s32, 166912
    buffer_load_dwordx4 v[188:191], v13, s[16:19], s32 offen
    s_mov_b32 s32, 167936
    buffer_load_dwordx4 v[192:195], v13, s[16:19], s32 offen
    s_mov_b32 s32, 168960
    buffer_load_dwordx4 v[196:199], v13, s[16:19], s32 offen
    s_mov_b32 s32, 169984
    buffer_load_dwordx4 v[200:203], v13, s[16:19], s32 offen
    s_mov_b32 s32, 171008
    buffer_load_dwordx4 v[204:207], v13, s[16:19], s32 offen
    s_waitcnt vmcnt(46)
    v_perm_b32 v240, v20, v16, s59
    v_accvgpr_write_b32 a0, v240
    s_waitcnt vmcnt(44)
    v_perm_b32 v241, v28, v24, s59
    v_accvgpr_write_b32 a1, v241
    s_waitcnt vmcnt(42)
    v_perm_b32 v242, v36, v32, s59
    v_accvgpr_write_b32 a2, v242
    s_waitcnt vmcnt(40)
    v_perm_b32 v243, v44, v40, s59
    v_accvgpr_write_b32 a3, v243
    v_perm_b32 v244, v20, v16, s60
    v_accvgpr_write_b32 a32, v244
    v_perm_b32 v245, v28, v24, s60
    v_accvgpr_write_b32 a33, v245
    v_perm_b32 v246, v36, v32, s60
    v_accvgpr_write_b32 a34, v246
    v_perm_b32 v247, v44, v40, s60
    v_accvgpr_write_b32 a35, v247
    v_perm_b32 v240, v21, v17, s59
    v_accvgpr_write_b32 a64, v240
    v_perm_b32 v241, v29, v25, s59
    v_accvgpr_write_b32 a65, v241
    v_perm_b32 v242, v37, v33, s59
    v_accvgpr_write_b32 a66, v242
    v_perm_b32 v243, v45, v41, s59
    v_accvgpr_write_b32 a67, v243
    v_perm_b32 v244, v21, v17, s60
    v_accvgpr_write_b32 a96, v244
    v_perm_b32 v245, v29, v25, s60
    v_accvgpr_write_b32 a97, v245
    v_perm_b32 v246, v37, v33, s60
    v_accvgpr_write_b32 a98, v246
    v_perm_b32 v247, v45, v41, s60
    v_accvgpr_write_b32 a99, v247
    v_perm_b32 v240, v22, v18, s59
    v_accvgpr_write_b32 a128, v240
    v_perm_b32 v241, v30, v26, s59
    v_accvgpr_write_b32 a129, v241
    v_perm_b32 v242, v38, v34, s59
    v_accvgpr_write_b32 a130, v242
    v_perm_b32 v243, v46, v42, s59
    v_accvgpr_write_b32 a131, v243
    v_perm_b32 v244, v22, v18, s60
    v_accvgpr_write_b32 a160, v244
    v_perm_b32 v245, v30, v26, s60
    v_accvgpr_write_b32 a161, v245
    v_perm_b32 v246, v38, v34, s60
    v_accvgpr_write_b32 a162, v246
    v_perm_b32 v247, v46, v42, s60
    v_accvgpr_write_b32 a163, v247
    v_perm_b32 v240, v23, v19, s59
    v_accvgpr_write_b32 a192, v240
    v_perm_b32 v241, v31, v27, s59
    v_accvgpr_write_b32 a193, v241
    v_perm_b32 v242, v39, v35, s59
    v_accvgpr_write_b32 a194, v242
    v_perm_b32 v243, v47, v43, s59
    v_accvgpr_write_b32 a195, v243
    v_perm_b32 v244, v23, v19, s60
    v_accvgpr_write_b32 a224, v244
    v_perm_b32 v245, v31, v27, s60
    v_accvgpr_write_b32 a225, v245
    v_perm_b32 v246, v39, v35, s60
    v_accvgpr_write_b32 a226, v246
    v_perm_b32 v247, v47, v43, s60
    v_accvgpr_write_b32 a227, v247
    s_mov_b32 s32, 196608
    buffer_load_dwordx4 v[16:19], v13, s[16:19], s32 offen
    s_mov_b32 s32, 197632
    buffer_load_dwordx4 v[20:23], v13, s[16:19], s32 offen
    s_mov_b32 s32, 198656
    buffer_load_dwordx4 v[24:27], v13, s[16:19], s32 offen
    s_mov_b32 s32, 199680
    buffer_load_dwordx4 v[28:31], v13, s[16:19], s32 offen
    s_mov_b32 s32, 200704
    buffer_load_dwordx4 v[32:35], v13, s[16:19], s32 offen
    s_mov_b32 s32, 201728
    buffer_load_dwordx4 v[36:39], v13, s[16:19], s32 offen
    s_mov_b32 s32, 202752
    buffer_load_dwordx4 v[40:43], v13, s[16:19], s32 offen
    s_mov_b32 s32, 203776
    buffer_load_dwordx4 v[44:47], v13, s[16:19], s32 offen
    s_waitcnt vmcnt(46)
    v_perm_b32 v240, v52, v48, s59
    v_accvgpr_write_b32 a4, v240
    s_waitcnt vmcnt(44)
    v_perm_b32 v241, v60, v56, s59
    v_accvgpr_write_b32 a5, v241
    s_waitcnt vmcnt(42)
    v_perm_b32 v242, v68, v64, s59
    v_accvgpr_write_b32 a6, v242
    s_waitcnt vmcnt(40)
    v_perm_b32 v243, v76, v72, s59
    v_accvgpr_write_b32 a7, v243
    v_perm_b32 v244, v52, v48, s60
    v_accvgpr_write_b32 a36, v244
    v_perm_b32 v245, v60, v56, s60
    v_accvgpr_write_b32 a37, v245
    v_perm_b32 v246, v68, v64, s60
    v_accvgpr_write_b32 a38, v246
    v_perm_b32 v247, v76, v72, s60
    v_accvgpr_write_b32 a39, v247
    v_perm_b32 v240, v53, v49, s59
    v_accvgpr_write_b32 a68, v240
    v_perm_b32 v241, v61, v57, s59
    v_accvgpr_write_b32 a69, v241
    v_perm_b32 v242, v69, v65, s59
    v_accvgpr_write_b32 a70, v242
    v_perm_b32 v243, v77, v73, s59
    v_accvgpr_write_b32 a71, v243
    v_perm_b32 v244, v53, v49, s60
    v_accvgpr_write_b32 a100, v244
    v_perm_b32 v245, v61, v57, s60
    v_accvgpr_write_b32 a101, v245
    v_perm_b32 v246, v69, v65, s60
    v_accvgpr_write_b32 a102, v246
    v_perm_b32 v247, v77, v73, s60
    v_accvgpr_write_b32 a103, v247
    v_perm_b32 v240, v54, v50, s59
    v_accvgpr_write_b32 a132, v240
    v_perm_b32 v241, v62, v58, s59
    v_accvgpr_write_b32 a133, v241
    v_perm_b32 v242, v70, v66, s59
    v_accvgpr_write_b32 a134, v242
    v_perm_b32 v243, v78, v74, s59
    v_accvgpr_write_b32 a135, v243
    v_perm_b32 v244, v54, v50, s60
    v_accvgpr_write_b32 a164, v244
    v_perm_b32 v245, v62, v58, s60
    v_accvgpr_write_b32 a165, v245
    v_perm_b32 v246, v70, v66, s60
    v_accvgpr_write_b32 a166, v246
    v_perm_b32 v247, v78, v74, s60
    v_accvgpr_write_b32 a167, v247
    v_perm_b32 v240, v55, v51, s59
    v_accvgpr_write_b32 a196, v240
    v_perm_b32 v241, v63, v59, s59
    v_accvgpr_write_b32 a197, v241
    v_perm_b32 v242, v71, v67, s59
    v_accvgpr_write_b32 a198, v242
    v_perm_b32 v243, v79, v75, s59
    v_accvgpr_write_b32 a199, v243
    v_perm_b32 v244, v55, v51, s60
    v_accvgpr_write_b32 a228, v244
    v_perm_b32 v245, v63, v59, s60
    v_accvgpr_write_b32 a229, v245
    v_perm_b32 v246, v71, v67, s60
    v_accvgpr_write_b32 a230, v246
    v_perm_b32 v247, v79, v75, s60
    v_accvgpr_write_b32 a231, v247
    s_mov_b32 s32, 229376
    buffer_load_dwordx4 v[48:51], v13, s[16:19], s32 offen
    s_mov_b32 s32, 230400
    buffer_load_dwordx4 v[52:55], v13, s[16:19], s32 offen
    s_mov_b32 s32, 231424
    buffer_load_dwordx4 v[56:59], v13, s[16:19], s32 offen
    s_mov_b32 s32, 232448
    buffer_load_dwordx4 v[60:63], v13, s[16:19], s32 offen
    s_mov_b32 s32, 233472
    buffer_load_dwordx4 v[64:67], v13, s[16:19], s32 offen
    s_mov_b32 s32, 234496
    buffer_load_dwordx4 v[68:71], v13, s[16:19], s32 offen
    s_mov_b32 s32, 235520
    buffer_load_dwordx4 v[72:75], v13, s[16:19], s32 offen
    s_mov_b32 s32, 236544
    buffer_load_dwordx4 v[76:79], v13, s[16:19], s32 offen
    s_waitcnt vmcnt(46)
    v_perm_b32 v240, v84, v80, s59
    v_accvgpr_write_b32 a8, v240
    s_waitcnt vmcnt(44)
    v_perm_b32 v241, v92, v88, s59
    v_accvgpr_write_b32 a9, v241
    s_waitcnt vmcnt(42)
    v_perm_b32 v242, v100, v96, s59
    v_accvgpr_write_b32 a10, v242
    s_waitcnt vmcnt(40)
    v_perm_b32 v243, v108, v104, s59
    v_accvgpr_write_b32 a11, v243
    v_perm_b32 v244, v84, v80, s60
    v_accvgpr_write_b32 a40, v244
    v_perm_b32 v245, v92, v88, s60
    v_accvgpr_write_b32 a41, v245
    v_perm_b32 v246, v100, v96, s60
    v_accvgpr_write_b32 a42, v246
    v_perm_b32 v247, v108, v104, s60
    v_accvgpr_write_b32 a43, v247
    v_perm_b32 v240, v85, v81, s59
    v_accvgpr_write_b32 a72, v240
    v_perm_b32 v241, v93, v89, s59
    v_accvgpr_write_b32 a73, v241
    v_perm_b32 v242, v101, v97, s59
    v_accvgpr_write_b32 a74, v242
    v_perm_b32 v243, v109, v105, s59
    v_accvgpr_write_b32 a75, v243
    v_perm_b32 v244, v85, v81, s60
    v_accvgpr_write_b32 a104, v244
    v_perm_b32 v245, v93, v89, s60
    v_accvgpr_write_b32 a105, v245
    v_perm_b32 v246, v101, v97, s60
    v_accvgpr_write_b32 a106, v246
    v_perm_b32 v247, v109, v105, s60
    v_accvgpr_write_b32 a107, v247
    v_perm_b32 v240, v86, v82, s59
    v_accvgpr_write_b32 a136, v240
    v_perm_b32 v241, v94, v90, s59
    v_accvgpr_write_b32 a137, v241
    v_perm_b32 v242, v102, v98, s59
    v_accvgpr_write_b32 a138, v242
    v_perm_b32 v243, v110, v106, s59
    v_accvgpr_write_b32 a139, v243
    v_perm_b32 v244, v86, v82, s60
    v_accvgpr_write_b32 a168, v244
    v_perm_b32 v245, v94, v90, s60
    v_accvgpr_write_b32 a169, v245
    v_perm_b32 v246, v102, v98, s60
    v_accvgpr_write_b32 a170, v246
    v_perm_b32 v247, v110, v106, s60
    v_accvgpr_write_b32 a171, v247
    v_perm_b32 v240, v87, v83, s59
    v_accvgpr_write_b32 a200, v240
    v_perm_b32 v241, v95, v91, s59
    v_accvgpr_write_b32 a201, v241
    v_perm_b32 v242, v103, v99, s59
    v_accvgpr_write_b32 a202, v242
    v_perm_b32 v243, v111, v107, s59
    v_accvgpr_write_b32 a203, v243
    v_perm_b32 v244, v87, v83, s60
    v_accvgpr_write_b32 a232, v244
    v_perm_b32 v245, v95, v91, s60
    v_accvgpr_write_b32 a233, v245
    v_perm_b32 v246, v103, v99, s60
    v_accvgpr_write_b32 a234, v246
    v_perm_b32 v247, v111, v107, s60
    v_accvgpr_write_b32 a235, v247
    s_waitcnt vmcnt(38)
    v_perm_b32 v240, v116, v112, s59
    v_accvgpr_write_b32 a12, v240
    s_waitcnt vmcnt(36)
    v_perm_b32 v241, v124, v120, s59
    v_accvgpr_write_b32 a13, v241
    s_waitcnt vmcnt(34)
    v_perm_b32 v242, v132, v128, s59
    v_accvgpr_write_b32 a14, v242
    s_waitcnt vmcnt(32)
    v_perm_b32 v243, v140, v136, s59
    v_accvgpr_write_b32 a15, v243
    v_perm_b32 v244, v116, v112, s60
    v_accvgpr_write_b32 a44, v244
    v_perm_b32 v245, v124, v120, s60
    v_accvgpr_write_b32 a45, v245
    v_perm_b32 v246, v132, v128, s60
    v_accvgpr_write_b32 a46, v246
    v_perm_b32 v247, v140, v136, s60
    v_accvgpr_write_b32 a47, v247
    v_perm_b32 v240, v117, v113, s59
    v_accvgpr_write_b32 a76, v240
    v_perm_b32 v241, v125, v121, s59
    v_accvgpr_write_b32 a77, v241
    v_perm_b32 v242, v133, v129, s59
    v_accvgpr_write_b32 a78, v242
    v_perm_b32 v243, v141, v137, s59
    v_accvgpr_write_b32 a79, v243
    v_perm_b32 v244, v117, v113, s60
    v_accvgpr_write_b32 a108, v244
    v_perm_b32 v245, v125, v121, s60
    v_accvgpr_write_b32 a109, v245
    v_perm_b32 v246, v133, v129, s60
    v_accvgpr_write_b32 a110, v246
    v_perm_b32 v247, v141, v137, s60
    v_accvgpr_write_b32 a111, v247
    v_perm_b32 v240, v118, v114, s59
    v_accvgpr_write_b32 a140, v240
    v_perm_b32 v241, v126, v122, s59
    v_accvgpr_write_b32 a141, v241
    v_perm_b32 v242, v134, v130, s59
    v_accvgpr_write_b32 a142, v242
    v_perm_b32 v243, v142, v138, s59
    v_accvgpr_write_b32 a143, v243
    v_perm_b32 v244, v118, v114, s60
    v_accvgpr_write_b32 a172, v244
    v_perm_b32 v245, v126, v122, s60
    v_accvgpr_write_b32 a173, v245
    v_perm_b32 v246, v134, v130, s60
    v_accvgpr_write_b32 a174, v246
    v_perm_b32 v247, v142, v138, s60
    v_accvgpr_write_b32 a175, v247
    v_perm_b32 v240, v119, v115, s59
    v_accvgpr_write_b32 a204, v240
    v_perm_b32 v241, v127, v123, s59
    v_accvgpr_write_b32 a205, v241
    v_perm_b32 v242, v135, v131, s59
    v_accvgpr_write_b32 a206, v242
    v_perm_b32 v243, v143, v139, s59
    v_accvgpr_write_b32 a207, v243
    v_perm_b32 v244, v119, v115, s60
    v_accvgpr_write_b32 a236, v244
    v_perm_b32 v245, v127, v123, s60
    v_accvgpr_write_b32 a237, v245
    v_perm_b32 v246, v135, v131, s60
    v_accvgpr_write_b32 a238, v246
    v_perm_b32 v247, v143, v139, s60
    v_accvgpr_write_b32 a239, v247
    s_waitcnt vmcnt(30)
    v_perm_b32 v240, v148, v144, s59
    v_accvgpr_write_b32 a16, v240
    s_waitcnt vmcnt(28)
    v_perm_b32 v241, v156, v152, s59
    v_accvgpr_write_b32 a17, v241
    s_waitcnt vmcnt(26)
    v_perm_b32 v242, v164, v160, s59
    v_accvgpr_write_b32 a18, v242
    s_waitcnt vmcnt(24)
    v_perm_b32 v243, v172, v168, s59
    v_accvgpr_write_b32 a19, v243
    v_perm_b32 v244, v148, v144, s60
    v_accvgpr_write_b32 a48, v244
    v_perm_b32 v245, v156, v152, s60
    v_accvgpr_write_b32 a49, v245
    v_perm_b32 v246, v164, v160, s60
    v_accvgpr_write_b32 a50, v246
    v_perm_b32 v247, v172, v168, s60
    v_accvgpr_write_b32 a51, v247
    v_perm_b32 v240, v149, v145, s59
    v_accvgpr_write_b32 a80, v240
    v_perm_b32 v241, v157, v153, s59
    v_accvgpr_write_b32 a81, v241
    v_perm_b32 v242, v165, v161, s59
    v_accvgpr_write_b32 a82, v242
    v_perm_b32 v243, v173, v169, s59
    v_accvgpr_write_b32 a83, v243
    v_perm_b32 v244, v149, v145, s60
    v_accvgpr_write_b32 a112, v244
    v_perm_b32 v245, v157, v153, s60
    v_accvgpr_write_b32 a113, v245
    v_perm_b32 v246, v165, v161, s60
    v_accvgpr_write_b32 a114, v246
    v_perm_b32 v247, v173, v169, s60
    v_accvgpr_write_b32 a115, v247
    v_perm_b32 v240, v150, v146, s59
    v_accvgpr_write_b32 a144, v240
    v_perm_b32 v241, v158, v154, s59
    v_accvgpr_write_b32 a145, v241
    v_perm_b32 v242, v166, v162, s59
    v_accvgpr_write_b32 a146, v242
    v_perm_b32 v243, v174, v170, s59
    v_accvgpr_write_b32 a147, v243
    v_perm_b32 v244, v150, v146, s60
    v_accvgpr_write_b32 a176, v244
    v_perm_b32 v245, v158, v154, s60
    v_accvgpr_write_b32 a177, v245
    v_perm_b32 v246, v166, v162, s60
    v_accvgpr_write_b32 a178, v246
    v_perm_b32 v247, v174, v170, s60
    v_accvgpr_write_b32 a179, v247
    v_perm_b32 v240, v151, v147, s59
    v_accvgpr_write_b32 a208, v240
    v_perm_b32 v241, v159, v155, s59
    v_accvgpr_write_b32 a209, v241
    v_perm_b32 v242, v167, v163, s59
    v_accvgpr_write_b32 a210, v242
    v_perm_b32 v243, v175, v171, s59
    v_accvgpr_write_b32 a211, v243
    v_perm_b32 v244, v151, v147, s60
    v_accvgpr_write_b32 a240, v244
    v_perm_b32 v245, v159, v155, s60
    v_accvgpr_write_b32 a241, v245
    v_perm_b32 v246, v167, v163, s60
    v_accvgpr_write_b32 a242, v246
    v_perm_b32 v247, v175, v171, s60
    v_accvgpr_write_b32 a243, v247
    s_waitcnt vmcnt(22)
    v_perm_b32 v240, v180, v176, s59
    v_accvgpr_write_b32 a20, v240
    s_waitcnt vmcnt(20)
    v_perm_b32 v241, v188, v184, s59
    v_accvgpr_write_b32 a21, v241
    s_waitcnt vmcnt(18)
    v_perm_b32 v242, v196, v192, s59
    v_accvgpr_write_b32 a22, v242
    s_waitcnt vmcnt(16)
    v_perm_b32 v243, v204, v200, s59
    v_accvgpr_write_b32 a23, v243
    v_perm_b32 v244, v180, v176, s60
    v_accvgpr_write_b32 a52, v244
    v_perm_b32 v245, v188, v184, s60
    v_accvgpr_write_b32 a53, v245
    v_perm_b32 v246, v196, v192, s60
    v_accvgpr_write_b32 a54, v246
    v_perm_b32 v247, v204, v200, s60
    v_accvgpr_write_b32 a55, v247
    v_perm_b32 v240, v181, v177, s59
    v_accvgpr_write_b32 a84, v240
    v_perm_b32 v241, v189, v185, s59
    v_accvgpr_write_b32 a85, v241
    v_perm_b32 v242, v197, v193, s59
    v_accvgpr_write_b32 a86, v242
    v_perm_b32 v243, v205, v201, s59
    v_accvgpr_write_b32 a87, v243
    v_perm_b32 v244, v181, v177, s60
    v_accvgpr_write_b32 a116, v244
    v_perm_b32 v245, v189, v185, s60
    v_accvgpr_write_b32 a117, v245
    v_perm_b32 v246, v197, v193, s60
    v_accvgpr_write_b32 a118, v246
    v_perm_b32 v247, v205, v201, s60
    v_accvgpr_write_b32 a119, v247
    v_perm_b32 v240, v182, v178, s59
    v_accvgpr_write_b32 a148, v240
    v_perm_b32 v241, v190, v186, s59
    v_accvgpr_write_b32 a149, v241
    v_perm_b32 v242, v198, v194, s59
    v_accvgpr_write_b32 a150, v242
    v_perm_b32 v243, v206, v202, s59
    v_accvgpr_write_b32 a151, v243
    v_perm_b32 v244, v182, v178, s60
    v_accvgpr_write_b32 a180, v244
    v_perm_b32 v245, v190, v186, s60
    v_accvgpr_write_b32 a181, v245
    v_perm_b32 v246, v198, v194, s60
    v_accvgpr_write_b32 a182, v246
    v_perm_b32 v247, v206, v202, s60
    v_accvgpr_write_b32 a183, v247
    v_perm_b32 v240, v183, v179, s59
    v_accvgpr_write_b32 a212, v240
    v_perm_b32 v241, v191, v187, s59
    v_accvgpr_write_b32 a213, v241
    v_perm_b32 v242, v199, v195, s59
    v_accvgpr_write_b32 a214, v242
    v_perm_b32 v243, v207, v203, s59
    v_accvgpr_write_b32 a215, v243
    v_perm_b32 v244, v183, v179, s60
    v_accvgpr_write_b32 a244, v244
    v_perm_b32 v245, v191, v187, s60
    v_accvgpr_write_b32 a245, v245
    v_perm_b32 v246, v199, v195, s60
    v_accvgpr_write_b32 a246, v246
    v_perm_b32 v247, v207, v203, s60
    v_accvgpr_write_b32 a247, v247
    s_waitcnt vmcnt(14)
    v_perm_b32 v240, v20, v16, s59
    v_accvgpr_write_b32 a24, v240
    s_waitcnt vmcnt(12)
    v_perm_b32 v241, v28, v24, s59
    v_accvgpr_write_b32 a25, v241
    s_waitcnt vmcnt(10)
    v_perm_b32 v242, v36, v32, s59
    v_accvgpr_write_b32 a26, v242
    s_waitcnt vmcnt(8)
    v_perm_b32 v243, v44, v40, s59
    v_accvgpr_write_b32 a27, v243
    v_perm_b32 v244, v20, v16, s60
    v_accvgpr_write_b32 a56, v244
    v_perm_b32 v245, v28, v24, s60
    v_accvgpr_write_b32 a57, v245
    v_perm_b32 v246, v36, v32, s60
    v_accvgpr_write_b32 a58, v246
    v_perm_b32 v247, v44, v40, s60
    v_accvgpr_write_b32 a59, v247
    v_perm_b32 v240, v21, v17, s59
    v_accvgpr_write_b32 a88, v240
    v_perm_b32 v241, v29, v25, s59
    v_accvgpr_write_b32 a89, v241
    v_perm_b32 v242, v37, v33, s59
    v_accvgpr_write_b32 a90, v242
    v_perm_b32 v243, v45, v41, s59
    v_accvgpr_write_b32 a91, v243
    v_perm_b32 v244, v21, v17, s60
    v_accvgpr_write_b32 a120, v244
    v_perm_b32 v245, v29, v25, s60
    v_accvgpr_write_b32 a121, v245
    v_perm_b32 v246, v37, v33, s60
    v_accvgpr_write_b32 a122, v246
    v_perm_b32 v247, v45, v41, s60
    v_accvgpr_write_b32 a123, v247
    v_perm_b32 v240, v22, v18, s59
    v_accvgpr_write_b32 a152, v240
    v_perm_b32 v241, v30, v26, s59
    v_accvgpr_write_b32 a153, v241
    v_perm_b32 v242, v38, v34, s59
    v_accvgpr_write_b32 a154, v242
    v_perm_b32 v243, v46, v42, s59
    v_accvgpr_write_b32 a155, v243
    v_perm_b32 v244, v22, v18, s60
    v_accvgpr_write_b32 a184, v244
    v_perm_b32 v245, v30, v26, s60
    v_accvgpr_write_b32 a185, v245
    v_perm_b32 v246, v38, v34, s60
    v_accvgpr_write_b32 a186, v246
    v_perm_b32 v247, v46, v42, s60
    v_accvgpr_write_b32 a187, v247
    v_perm_b32 v240, v23, v19, s59
    v_accvgpr_write_b32 a216, v240
    v_perm_b32 v241, v31, v27, s59
    v_accvgpr_write_b32 a217, v241
    v_perm_b32 v242, v39, v35, s59
    v_accvgpr_write_b32 a218, v242
    v_perm_b32 v243, v47, v43, s59
    v_accvgpr_write_b32 a219, v243
    v_perm_b32 v244, v23, v19, s60
    v_accvgpr_write_b32 a248, v244
    v_perm_b32 v245, v31, v27, s60
    v_accvgpr_write_b32 a249, v245
    v_perm_b32 v246, v39, v35, s60
    v_accvgpr_write_b32 a250, v246
    v_perm_b32 v247, v47, v43, s60
    v_accvgpr_write_b32 a251, v247
    s_waitcnt vmcnt(6)
    v_perm_b32 v240, v52, v48, s59
    v_accvgpr_write_b32 a28, v240
    s_waitcnt vmcnt(4)
    v_perm_b32 v241, v60, v56, s59
    v_accvgpr_write_b32 a29, v241
    s_waitcnt vmcnt(2)
    v_perm_b32 v242, v68, v64, s59
    v_accvgpr_write_b32 a30, v242
    s_waitcnt vmcnt(0)
    v_perm_b32 v243, v76, v72, s59
    v_accvgpr_write_b32 a31, v243
    v_perm_b32 v244, v52, v48, s60
    v_accvgpr_write_b32 a60, v244
    v_perm_b32 v245, v60, v56, s60
    v_accvgpr_write_b32 a61, v245
    v_perm_b32 v246, v68, v64, s60
    v_accvgpr_write_b32 a62, v246
    v_perm_b32 v247, v76, v72, s60
    v_accvgpr_write_b32 a63, v247
    v_perm_b32 v240, v53, v49, s59
    v_accvgpr_write_b32 a92, v240
    v_perm_b32 v241, v61, v57, s59
    v_accvgpr_write_b32 a93, v241
    v_perm_b32 v242, v69, v65, s59
    v_accvgpr_write_b32 a94, v242
    v_perm_b32 v243, v77, v73, s59
    v_accvgpr_write_b32 a95, v243
    v_perm_b32 v244, v53, v49, s60
    v_accvgpr_write_b32 a124, v244
    v_perm_b32 v245, v61, v57, s60
    v_accvgpr_write_b32 a125, v245
    v_perm_b32 v246, v69, v65, s60
    v_accvgpr_write_b32 a126, v246
    v_perm_b32 v247, v77, v73, s60
    v_accvgpr_write_b32 a127, v247
    v_perm_b32 v240, v54, v50, s59
    v_accvgpr_write_b32 a156, v240
    v_perm_b32 v241, v62, v58, s59
    v_accvgpr_write_b32 a157, v241
    v_perm_b32 v242, v70, v66, s59
    v_accvgpr_write_b32 a158, v242
    v_perm_b32 v243, v78, v74, s59
    v_accvgpr_write_b32 a159, v243
    v_perm_b32 v244, v54, v50, s60
    v_accvgpr_write_b32 a188, v244
    v_perm_b32 v245, v62, v58, s60
    v_accvgpr_write_b32 a189, v245
    v_perm_b32 v246, v70, v66, s60
    v_accvgpr_write_b32 a190, v246
    v_perm_b32 v247, v78, v74, s60
    v_accvgpr_write_b32 a191, v247
    v_perm_b32 v240, v55, v51, s59
    v_accvgpr_write_b32 a220, v240
    v_perm_b32 v241, v63, v59, s59
    v_accvgpr_write_b32 a221, v241
    v_perm_b32 v242, v71, v67, s59
    v_accvgpr_write_b32 a222, v242
    v_perm_b32 v243, v79, v75, s59
    v_accvgpr_write_b32 a223, v243
    v_perm_b32 v244, v55, v51, s60
    v_accvgpr_write_b32 a252, v244
    v_perm_b32 v245, v63, v59, s60
    v_accvgpr_write_b32 a253, v245
    v_perm_b32 v246, v71, v67, s60
    v_accvgpr_write_b32 a254, v246
    v_perm_b32 v247, v79, v75, s60
    v_accvgpr_write_b32 a255, v247
    v_and_b32 v20, 63, v0
    s_lshl_b32 s32, s6, 7
    s_lshl_b32 s33, s5, 2
    s_add_u32 s32, s32, s33
    s_add_u32 s32, s32, s3
    s_lshl_b32 s32, s32, 5
    s_add_u32 s32, s32, 5677056
    s_lshl_b32 s33, s6, 12
    s_add_u32 s33, s33, 5677056
    v_lshlrev_b32 v21, 5, v20
    v_mov_b32 v22, -1
Lopi_26048:
    buffer_load_dword v22, v21, s[8:11], s33 offen sc1
    buffer_load_dword v23, v21, s[8:11], s33 offen offset:2048 sc1
    s_sub_u32 s62, s62, 1
    s_cbranch_scc0 Ltok_26049
    s_movk_i32 s61, 24
    s_branch L_abort
Ltok_26049:
    s_waitcnt vmcnt(0)
    v_and_b32 v22, v22, v23
    v_cmp_eq_u32 vcc, 0, v22
    s_nop 0
    s_cbranch_vccnz Lopi_26048
    s_mov_b32 s20, s92
    s_and_b32 s21, s93, 0xffff
    s_mov_b32 s22, 2097152
    s_mov_b32 s23, 0x20000
    s_mov_b32 s24, s96
    s_and_b32 s25, s97, 0xffff
    s_mov_b32 s26, 268435456
    s_mov_b32 s27, 0x20000
    s_mov_b32 s16, s96
    s_and_b32 s17, s97, 0xffff
    s_mov_b32 s18, 268435456
    s_mov_b32 s19, 0x20000
    v_and_b32 v20, 63, v0
    v_and_b32 v21, 15, v20
    v_lshrrev_b32 v22, 4, v20
    v_lshlrev_b32 v27, 4, v20
    v_add_u32 v1, 0, v27
    s_lshr_b32 s43, s5, 4
    s_and_b32 s61, s5, 15
    v_mov_b32 v3, 0
    v_mov_b32 v4, 0xff800000
    v_lshlrev_b32 v23, 16, v22
    v_lshlrev_b32 v24, 4, v21
    v_add_u32 v23, v23, v24
    s_lshl_b32 s59, s61, 10
    s_lshl_b32 s60, s3, 8
    s_add_u32 s59, s59, s60
    v_add_u32 v2, s59, v23
    s_mov_b32 s54, 1035273459
    s_mov_b32 s55, 1040356334
    s_lshl_b32 s59, s6, 24
    s_lshl_b32 s60, s43, 18
    s_add_u32 s59, s59, s60
    s_add_u32 s33, s59, 83886080
    s_add_u32 s34, s59, 16777216
    s_add_u32 s35, s59, 50331648
    s_add_u32 s36, s59, 117440512
    s_lshl_b32 s59, s6, 19
    s_lshl_b32 s60, s43, 13
    s_add_u32 s59, s59, s60
    s_add_u32 s37, s59, 4194304
    s_lshl_b32 s59, s6, 21
    s_lshl_b32 s60, s43, 19
    s_add_u32 s60, s59, s60
    s_add_u32 s38, s60, 171966464
    s_lshl_b32 s40, s43, 15
    s_add_u32 s39, s59, s40
    s_add_u32 s39, s39, 155189248
    s_mov_b32 s42, 0
    s_mov_b32 s32, 0
    s_mov_b32 s58, 1
    s_cmp_ge_u32 s3, 2
    s_cbranch_scc1 L_o_setup_b
    s_lshl_b32 s59, s61, 14
    s_lshl_b32 s60, s3, 13
    s_add_u32 s59, s59, s60
    v_add_u32 v5, s59, v27
    v_add_u32 v6, 4096, v5
    s_add_u32 s56, s60, 32768
    v_and_b32 v23, 3, v21
    v_lshlrev_b32 v23, 8, v23
    v_lshl_add_u32 v23, v22, 6, v23
    v_lshrrev_b32 v24, 2, v21
    v_lshl_add_u32 v23, v24, 3, v23
    v_add_u32 v9, s56, v23
    s_add_u32 s60, s60, 49152
    v_add_u32 v14, s60, v27
    v_and_b32 v23, 1, v22
    v_lshlrev_b32 v23, 14, v23
    v_lshl_add_u32 v23, v21, 4, v23
    s_lshr_b32 s59, s59, 5
    v_add_u32 v7, s59, v23
    s_lshl_b32 s60, s3, 12
    v_add_u32 v8, s60, v1
    v_lshlrev_b32 v23, 2, v22
    v_add_u32 v24, 0, v23
    v_cmp_gt_u32 s[46:47], v24, v21
    v_add_u32 v24, 1, v23
    v_cmp_gt_u32 s[48:49], v24, v21
    v_add_u32 v24, 2, v23
    v_cmp_gt_u32 s[50:51], v24, v21
    v_add_u32 v24, 3, v23
    v_cmp_gt_u32 s[52:53], v24, v21
    v_and_b32 v23, 3, v20
    v_lshlrev_b32 v23, 11, v23
    s_lshl_b32 s60, s59, 5
    s_add_u32 s60, s60, 1008
    v_add_u32 v15, s60, v23
    v_mul_i32_i24 v23, -8176, v20
    s_add_u32 s60, s59, 49216
    v_add_u32 v0, s60, v23
    s_mov_b32 s29, 0
    s_mov_b32 s28, 799
    v_add_u32 v3, s56, v27
    v_mov_b32 v11, 1
    s_mov_b32 s20, s96
    s_and_b32 s21, s97, 0xffff
    s_mov_b32 s22, 268435456
    s_mov_b32 s23, 0x20000
    s_branch L_o_setup_e
L_o_setup_b:
    v_and_b32 v23, 1, v21
    v_lshlrev_b32 v23, 4, v23
    v_mov_b32 v24, 0x3f80
    v_lshlrev_b32 v24, v23, v24
    v_and_b32 v23, 1, v22
    v_lshlrev_b32 v23, 2, v23
    v_lshrrev_b32 v28, 1, v21
    v_xor_b32 v23, v23, v28
    v_cmp_eq_u32 vcc, 0, v23
    s_nop 1
    v_cndmask_b32 v12, 0, v24, vcc
    v_cmp_eq_u32 vcc, 1, v23
    s_nop 1
    v_cndmask_b32 v13, 0, v24, vcc
    v_cmp_eq_u32 vcc, 2, v23
    s_nop 1
    v_cndmask_b32 v14, 0, v24, vcc
    v_cmp_eq_u32 vcc, 3, v23
    s_nop 1
    v_cndmask_b32 v15, 0, v24, vcc
    s_and_b32 s57, s3, 1
    s_lshl_b32 s57, s57, 4
    s_add_u32 s57, s57, s61
    v_lshrrev_b32 v25, 5, v20
    v_and_b32 v26, 31, v20
    v_lshlrev_b32 v23, 10, v25
    v_lshl_add_u32 v23, v26, 4, v23
    s_lshl_b32 s59, s57, 14
    v_add_u32 v5, s59, v23
    v_lshlrev_b32 v23, 8, v22
    v_lshl_add_u32 v23, v21, 10, v23
    v_add_u32 v7, s59, v23
    v_and_b32 v28, 1, v22
    v_lshlrev_b32 v23, 5, v28
    v_lshl_add_u32 v23, v25, 4, v23
    v_add_u32 v23, v23, v21
    s_lshl_b32 s59, s57, 10
    v_lshlrev_b32 v24, 4, v23
    v_add_u32 v6, s59, v24
    s_lshl_b32 s59, s57, 4
    v_lshlrev_b32 v24, 9, v23
    v_add_u32 v8, s59, v24
    s_lshl_b32 s59, s57, 5
    s_lshl_b32 s60, s43, 10
    s_add_u32 s59, s59, s60
    s_add_u32 s41, s59, 5570560
L_o_setup_e:
    s_cmp_ge_u32 s3, 2
    s_cbranch_scc1 L_o_b
    s_cmp_lg_u32 s63, 0
    s_cbranch_scc1 L_oa_slow
    s_branch L_oa_fast
L_o_b:
    s_cmp_lg_u32 s63, 0
    s_cbranch_scc1 L_ob_slow
    s_branch L_ob_fast
L_oa_fast:
    s_cmp_eq_u32 s42, 0
    s_cbranch_scc1 Loaw_26050
Loag_26051:
    buffer_load_dword v10, v7, s[8:11], s37 offen sc1
    s_waitcnt vmcnt(16)
    ds_read_b128 v[16:19], v14 offset:0
    ds_read_b128 v[20:23], v14 offset:1024
    ds_read_b128 v[24:27], v14 offset:2048
    ds_read_b128 v[28:31], v14 offset:3072
    ds_read_b128 v[32:35], v14 offset:4096
    ds_read_b128 v[36:39], v14 offset:5120
    ds_read_b128 v[40:43], v14 offset:6144
    ds_read_b128 v[44:47], v14 offset:7168
    s_waitcnt lgkmcnt(7)
    v_mfma_f32_16x16x32_bf16 v[144:147], v[48:51], v[16:19], 0
    s_waitcnt lgkmcnt(6)
    v_mfma_f32_16x16x32_bf16 v[148:151], v[48:51], v[20:23], 0
    s_waitcnt vmcnt(15)
    v_mfma_f32_16x16x32_bf16 v[152:155], v[52:55], v[20:23], 0
    s_waitcnt vmcnt(14) lgkmcnt(5)
    v_mfma_f32_16x16x32_bf16 v[144:147], v[56:59], v[24:27], v[144:147]
    s_waitcnt lgkmcnt(4)
    v_mfma_f32_16x16x32_bf16 v[148:151], v[56:59], v[28:31], v[148:151]
    s_waitcnt vmcnt(13)
    v_mfma_f32_16x16x32_bf16 v[152:155], v[60:63], v[28:31], v[152:155]
    s_waitcnt vmcnt(12) lgkmcnt(3)
    v_mfma_f32_16x16x32_bf16 v[144:147], v[64:67], v[32:35], v[144:147]
    s_waitcnt lgkmcnt(2)
    v_mfma_f32_16x16x32_bf16 v[148:151], v[64:67], v[36:39], v[148:151]
    s_waitcnt vmcnt(11)
    v_mfma_f32_16x16x32_bf16 v[152:155], v[68:71], v[36:39], v[152:155]
    s_waitcnt vmcnt(10) lgkmcnt(1)
    v_mfma_f32_16x16x32_bf16 v[144:147], v[72:75], v[40:43], v[144:147]
    s_waitcnt lgkmcnt(0)
    v_mfma_f32_16x16x32_bf16 v[148:151], v[72:75], v[44:47], v[148:151]
    s_waitcnt vmcnt(9)
    v_mfma_f32_16x16x32_bf16 v[152:155], v[76:79], v[44:47], v[152:155]
    s_waitcnt vmcnt(5)
    v_bitop3_b32 v232, v11, s29, 1 bitop3:0x28
    v_cmp_ne_u32 vcc, 0, v232
    s_nop 0
    s_cmp_eq_u64 vcc, 0
    s_cselect_b32 s18, 0, 268435456
    s_cselect_b32 s22, 268435456, 0
    s_mov_b32 m0, s56
    s_nop 0
    buffer_load_dwordx4 v5, s[20:23], s36 offen sc1 lds
    buffer_load_dwordx4 v5, s[20:23], s36 offen offset:2048 sc1 lds
    s_add_u32 m0, s56, 4096
    s_nop 0
    buffer_load_dwordx4 v6, s[20:23], s36 offen sc1 lds
    buffer_load_dwordx4 v6, s[20:23], s36 offen offset:2048 sc1 lds
    buffer_load_dwordx4 v[128:131], v5, s[20:23], s36 offen offset:1024 sc1
    buffer_load_dwordx4 v[132:135], v5, s[20:23], s36 offen offset:3072 sc1
    buffer_load_dwordx4 v[136:139], v6, s[20:23], s36 offen offset:1024 sc1
    buffer_load_dwordx4 v[140:143], v6, s[20:23], s36 offen offset:3072 sc1
    v_cndmask_b32 v144, v144, v4, s[46:47]
    v_cndmask_b32 v152, v152, v4, s[46:47]
    v_cndmask_b32 v145, v145, v4, s[48:49]
    v_cndmask_b32 v153, v153, v4, s[48:49]
    v_cndmask_b32 v146, v146, v4, s[50:51]
    v_cndmask_b32 v154, v154, v4, s[50:51]
    v_cndmask_b32 v147, v147, v4, s[52:53]
    v_cndmask_b32 v155, v155, v4, s[52:53]
    v_max3_f32 v164, v144, v145, v146
    v_max3_f32 v165, v148, v149, v150
    v_max_f32 v164, v164, v147
    v_max3_f32 v165, v165, v151, v152
    v_max3_f32 v165, v165, v153, v154
    v_max_f32 v165, v165, v155
    v_mov_b32 v232, v164
    v_mov_b32 v233, v165
    s_nop 0
    v_permlane16_swap_b32 v164, v232
    v_permlane16_swap_b32 v165, v233
    v_max_f32 v164, v164, v232
    v_max_f32 v165, v165, v233
    v_mov_b32 v232, v164
    v_mov_b32 v233, v165
    s_nop 0
    v_permlane32_swap_b32 v164, v232
    v_permlane32_swap_b32 v165, v233
    v_max_f32 v164, v164, v232
    v_max_f32 v165, v165, v233
    v_mul_f32 v232, s55, v164
    v_mul_f32 v233, s55, v165
    v_fma_f32 v144, v144, s55, -v232
    v_fma_f32 v145, v145, s55, -v232
    v_fma_f32 v146, v146, s55, -v232
    v_fma_f32 v147, v147, s55, -v232
    v_fma_f32 v148, v148, s55, -v233
    v_fma_f32 v149, v149, s55, -v233
    v_fma_f32 v150, v150, s55, -v233
    v_fma_f32 v151, v151, s55, -v233
    v_fma_f32 v152, v152, s55, -v233
    v_fma_f32 v153, v153, s55, -v233
    v_fma_f32 v154, v154, s55, -v233
    v_fma_f32 v155, v155, s55, -v233
    v_exp_f32 v144, v144
    v_exp_f32 v145, v145
    v_exp_f32 v146, v146
    v_exp_f32 v147, v147
    v_exp_f32 v148, v148
    v_exp_f32 v149, v149
    v_exp_f32 v150, v150
    v_exp_f32 v151, v151
    v_exp_f32 v152, v152
    v_exp_f32 v153, v153
    v_exp_f32 v154, v154
    v_exp_f32 v155, v155
    buffer_load_dword v11, v15, s[16:19], s36 offen sc1
    v_cvt_pk_bf16_f32 v248, v144, v145
    v_cvt_pk_bf16_f32 v249, v146, v147
    v_cvt_pk_bf16_f32 v250, v148, v149
    v_cvt_pk_bf16_f32 v251, v150, v151
    v_cvt_pk_bf16_f32 v252, v152, v153
    v_cvt_pk_bf16_f32 v253, v154, v155
    v_mfma_f32_16x16x16_bf16 v[168:171], v[80:81], v[248:249], 0
    v_add_f32 v166, v144, v145
    v_mfma_f32_16x16x32_bf16 v[200:203], v[80:83], v[250:253], 0
    v_add_f32 v167, v148, v149
    v_mfma_f32_16x16x16_bf16 v[172:175], v[84:85], v[248:249], 0
    v_add_f32 v166, v166, v146
    v_mfma_f32_16x16x32_bf16 v[204:207], v[84:87], v[250:253], 0
    v_add_f32 v167, v167, v150
    v_mfma_f32_16x16x16_bf16 v[176:179], v[88:89], v[248:249], 0
    v_add_f32 v166, v166, v147
    v_mfma_f32_16x16x32_bf16 v[208:211], v[88:91], v[250:253], 0
    v_add_f32 v167, v167, v151
    buffer_load_dword v12, v15, s[16:19], s36 offen sc1
    v_mfma_f32_16x16x16_bf16 v[180:183], v[92:93], v[248:249], 0
    v_add_f32 v167, v167, v152
    v_mfma_f32_16x16x32_bf16 v[212:215], v[92:95], v[250:253], 0
    v_add_f32 v167, v167, v153
    s_waitcnt vmcnt(14)
    v_mfma_f32_16x16x16_bf16 v[184:187], v[96:97], v[248:249], 0
    v_add_f32 v167, v167, v154
    v_mfma_f32_16x16x32_bf16 v[216:219], v[96:99], v[250:253], 0
    v_add_f32 v167, v167, v155
    s_waitcnt vmcnt(13)
    v_mfma_f32_16x16x16_bf16 v[188:191], v[100:101], v[248:249], 0
    v_mfma_f32_16x16x32_bf16 v[220:223], v[100:103], v[250:253], 0
    s_waitcnt vmcnt(12)
    v_mfma_f32_16x16x16_bf16 v[192:195], v[104:105], v[248:249], 0
    v_mfma_f32_16x16x32_bf16 v[224:227], v[104:107], v[250:253], 0
    s_waitcnt vmcnt(11)
    v_mfma_f32_16x16x16_bf16 v[196:199], v[108:109], v[248:249], 0
    v_mfma_f32_16x16x32_bf16 v[228:231], v[108:111], v[250:253], 0
    buffer_load_dword v13, v15, s[16:19], s36 offen sc1
    s_cmp_eq_u32 s18, 0
    s_cbranch_scc1 Loaoe_26059
Loam_26054:
    s_waitcnt vmcnt(2)
    v_bitop3_b32 v232, v11, s29, 1 bitop3:0x28
    v_cmp_ne_u32 vcc, 0, v232
    s_nop 0
    s_cbranch_vccz Loamk_26055
    buffer_load_dword v11, v15, s[16:19], s36 offen sc1
    s_waitcnt vmcnt(2)
    v_bitop3_b32 v232, v12, s29, 1 bitop3:0x28
    v_cmp_ne_u32 vcc, 0, v232
    s_nop 0
    s_cbranch_vccz Loamk_26055
    buffer_load_dword v12, v15, s[16:19], s36 offen sc1
    s_waitcnt vmcnt(2)
    v_bitop3_b32 v232, v13, s29, 1 bitop3:0x28
    v_cmp_ne_u32 vcc, 0, v232
    s_nop 0
    s_cbranch_vccz Loamk_26055
    buffer_load_dword v13, v15, s[16:19], s36 offen sc1
    buffer_load_dword v10, v7, s[8:11], s37 offen sc1
    s_sub_u32 s62, s62, 1
    s_cbranch_scc0 Ltok_26061
    s_movk_i32 s61, 21
    s_branch L_abort
Ltok_26061:
    s_branch Loam_26054
Loamk_26055:
    s_mov_b32 m0, s56
    s_nop 0
    buffer_load_dwordx4 v5, s[8:11], s36 offen sc1 lds
    buffer_load_dwordx4 v5, s[8:11], s36 offen offset:2048 sc1 lds
    s_add_u32 m0, s56, 4096
    s_nop 0
    buffer_load_dwordx4 v6, s[8:11], s36 offen sc1 lds
    buffer_load_dwordx4 v6, s[8:11], s36 offen offset:2048 sc1 lds
    s_waitcnt vmcnt(4)
    v_cmp_ne_u32 s[44:45], 0, v10
    s_add_u32 s37, s37, 16384
    s_lshr_b32 s61, s44, 16
    s_and_b32 s61, s61, 783
    s_cmp_ge_u32 s32, 31
    s_cselect_b32 s61, 0, s61
    s_cmp_lg_u32 s61, 783
    s_cbranch_scc1 Loan_26056
    s_mov_b32 s42, 1
Loaj_26057:
    s_cmp_lg_u32 s42, 0
    s_cselect_b32 s26, 268435456, 0
    s_cselect_b32 s31, 524288, 0
Loar_26058:
    s_waitcnt vmcnt(3)
    ds_read_b64_tr_b16 v[112:113], v9 offset:0
    ds_read_b64_tr_b16 v[114:115], v9 offset:32
    s_waitcnt vmcnt(2)
    ds_read_b64_tr_b16 v[116:117], v9 offset:2048
    ds_read_b64_tr_b16 v[118:119], v9 offset:2080
    s_waitcnt vmcnt(1)
    ds_read_b64_tr_b16 v[120:121], v9 offset:4096
    ds_read_b64_tr_b16 v[122:123], v9 offset:4128
    s_waitcnt vmcnt(0)
    buffer_load_dwordx4 v[128:131], v5, s[8:11], s36 offen offset:1024 sc1
    buffer_load_dwordx4 v[132:135], v5, s[8:11], s36 offen offset:3072 sc1
    buffer_load_dwordx4 v[136:139], v6, s[8:11], s36 offen offset:1024 sc1
    buffer_load_dwordx4 v[140:143], v6, s[8:11], s36 offen offset:3072 sc1
    ds_read_b64_tr_b16 v[124:125], v9 offset:6144
    ds_read_b64_tr_b16 v[126:127], v9 offset:6176
Loajn_26060:
    ds_read_b32 v144, v3 offset:0
    ds_read_b32 v145, v3 offset:2048
    ds_read_b32 v146, v3 offset:4096
    ds_read_b32 v147, v3 offset:6144
    s_waitcnt lgkmcnt(10)
    v_mfma_f32_16x16x32_bf16 v[156:159], v[112:115], v[16:19], 0
    v_mfma_f32_16x16x32_bf16 v[160:163], v[112:115], v[20:23], 0
    s_waitcnt lgkmcnt(8)
    v_mfma_f32_16x16x32_bf16 v[156:159], v[116:119], v[24:27], v[156:159]
    v_mfma_f32_16x16x32_bf16 v[160:163], v[116:119], v[28:31], v[160:163]
    s_waitcnt lgkmcnt(6)
    v_mfma_f32_16x16x32_bf16 v[156:159], v[120:123], v[32:35], v[156:159]
    v_mfma_f32_16x16x32_bf16 v[160:163], v[120:123], v[36:39], v[160:163]
    s_waitcnt lgkmcnt(4)
    v_mfma_f32_16x16x32_bf16 v[156:159], v[124:127], v[40:43], v[156:159]
    v_mfma_f32_16x16x32_bf16 v[160:163], v[124:127], v[44:47], v[160:163]
    s_nop 6
    v_permlane32_swap_b32 v156, v158
    v_permlane32_swap_b32 v160, v162
    v_permlane32_swap_b32 v157, v159
    s_add_u32 m0, s56, 16384
    s_nop 0
    buffer_load_dwordx4 v5, s[24:27], s33 offen offset:0 lds
    v_permlane32_swap_b32 v161, v163
    v_add_f32 v156, v156, v158
    v_add_f32 v160, v160, v162
    v_add_f32 v157, v157, v159
    v_add_f32 v161, v161, v163
    v_max3_f32 v234, v156, v157, v164
    v_max3_f32 v242, v160, v161, v165
    v_mov_b32 v235, v234
    v_mov_b32 v243, v242
    s_nop 0
    v_permlane16_swap_b32 v234, v235
    v_permlane16_swap_b32 v242, v243
    buffer_load_dwordx4 v5, s[24:27], s33 offen offset:1024 lds
    v_max_f32 v234, v234, v235
    v_max_f32 v242, v242, v243
    v_mov_b32 v235, v234
    v_mov_b32 v243, v242
    s_nop 0
    v_permlane32_swap_b32 v234, v235
    v_permlane32_swap_b32 v242, v243
    v_max_f32 v234, v234, v235
    v_max_f32 v242, v242, v243
    v_mul_f32 v234, s55, v234
    v_mul_f32 v242, s55, v242
    v_fma_f32 v232, v164, s55, -v234
    buffer_load_dwordx4 v5, s[24:27], s33 offen offset:2048 lds
    v_fma_f32 v240, v165, s55, -v242
    v_fma_f32 v156, v156, s55, -v234
    v_fma_f32 v160, v160, s55, -v242
    v_fma_f32 v157, v157, s55, -v234
    v_fma_f32 v161, v161, s55, -v242
    v_exp_f32 v232, v232
    v_exp_f32 v240, v240
    v_exp_f32 v156, v156
    v_exp_f32 v160, v160
    v_exp_f32 v157, v157
    v_exp_f32 v161, v161
    buffer_load_dwordx4 v5, s[24:27], s33 offen offset:3072 lds
    v_fma_f32 v234, v232, v166, v156
    v_fma_f32 v242, v240, v167, v160
    v_add_f32 v234, v234, v157
    v_add_f32 v242, v242, v161
    v_mov_b32 v235, v234
    v_mov_b32 v243, v242
    s_nop 0
    v_permlane16_swap_b32 v234, v235
    v_permlane16_swap_b32 v242, v243
    v_add_f32 v234, v234, v235
    v_add_f32 v242, v242, v243
    v_mov_b32 v235, v234
    s_add_u32 m0, s56, 20480
    s_nop 0
    buffer_load_dwordx4 v6, s[24:27], s33 offen offset:0 lds
    v_mov_b32 v243, v242
    v_permlane32_swap_b32 v234, v235
    s_nop 0
    v_permlane32_swap_b32 v242, v243
    v_add_f32 v234, v234, v235
    v_add_f32 v242, v242, v243
    v_rcp_f32 v234, v234
    v_rcp_f32 v242, v242
    v_mul_f32 v232, v232, v234
    v_mul_f32 v240, v240, v242
    v_mul_f32 v156, v156, v234
    v_mul_f32 v160, v160, v242
    buffer_load_dwordx4 v6, s[24:27], s33 offen offset:1024 lds
    v_mul_f32 v157, v157, v234
    v_mul_f32 v161, v161, v242
    v_cvt_pk_bf16_f32 v238, v156, v157
    v_cvt_pk_bf16_f32 v246, v160, v161
    v_mov_b32 v239, v238
    v_mov_b32 v247, v246
    s_nop 0
    v_permlane32_swap_b32 v238, v239
    v_permlane32_swap_b32 v246, v247
    s_waitcnt lgkmcnt(2)
    v_bitop3_b32 v144, v144, v145, s29 bitop3:0x7e
    s_waitcnt lgkmcnt(0)
    v_bitop3_b32 v146, v146, v147, s29 bitop3:0x7e
    v_bitop3_b32 v144, v144, v146, 1 bitop3:0xa8
    buffer_load_dwordx4 v6, s[24:27], s33 offen offset:2048 lds
    v_cmp_ne_u32 vcc, 0, v144
    s_nop 0
    s_cbranch_vccnz Loakr_26064
    v_pk_mul_f32 v[168:169], v[168:169], v[232:233] op_sel_hi:[1,0]
    v_pk_mul_f32 v[170:171], v[170:171], v[232:233] op_sel_hi:[1,0]
    v_pk_mul_f32 v[172:173], v[172:173], v[232:233] op_sel_hi:[1,0]
    v_pk_mul_f32 v[174:175], v[174:175], v[232:233] op_sel_hi:[1,0]
    v_pk_mul_f32 v[176:177], v[176:177], v[232:233] op_sel_hi:[1,0]
    v_pk_mul_f32 v[178:179], v[178:179], v[232:233] op_sel_hi:[1,0]
    v_pk_mul_f32 v[180:181], v[180:181], v[232:233] op_sel_hi:[1,0]
    v_pk_mul_f32 v[182:183], v[182:183], v[232:233] op_sel_hi:[1,0]
    v_pk_mul_f32 v[184:185], v[184:185], v[232:233] op_sel_hi:[1,0]
    buffer_load_dwordx4 v6, s[24:27], s33 offen offset:3072 lds
    v_pk_mul_f32 v[186:187], v[186:187], v[232:233] op_sel_hi:[1,0]
    v_pk_mul_f32 v[188:189], v[188:189], v[232:233] op_sel_hi:[1,0]
    v_pk_mul_f32 v[190:191], v[190:191], v[232:233] op_sel_hi:[1,0]
    v_pk_mul_f32 v[192:193], v[192:193], v[232:233] op_sel_hi:[1,0]
    v_pk_mul_f32 v[194:195], v[194:195], v[232:233] op_sel_hi:[1,0]
    v_pk_mul_f32 v[196:197], v[196:197], v[232:233] op_sel_hi:[1,0]
    v_pk_mul_f32 v[198:199], v[198:199], v[232:233] op_sel_hi:[1,0]
    v_pk_mul_f32 v[200:201], v[200:201], v[240:241] op_sel_hi:[1,0]
    v_pk_mul_f32 v[202:203], v[202:203], v[240:241] op_sel_hi:[1,0]
    v_pk_mul_f32 v[204:205], v[204:205], v[240:241] op_sel_hi:[1,0]
    v_pk_mul_f32 v[206:207], v[206:207], v[240:241] op_sel_hi:[1,0]
    buffer_load_dwordx4 v[48:51], v5, s[24:27], s34 offen offset:0
    v_pk_mul_f32 v[208:209], v[208:209], v[240:241] op_sel_hi:[1,0]
    v_pk_mul_f32 v[210:211], v[210:211], v[240:241] op_sel_hi:[1,0]
    v_pk_mul_f32 v[212:213], v[212:213], v[240:241] op_sel_hi:[1,0]
    v_pk_mul_f32 v[214:215], v[214:215], v[240:241] op_sel_hi:[1,0]
    v_pk_mul_f32 v[216:217], v[216:217], v[240:241] op_sel_hi:[1,0]
    v_pk_mul_f32 v[218:219], v[218:219], v[240:241] op_sel_hi:[1,0]
    v_pk_mul_f32 v[220:221], v[220:221], v[240:241] op_sel_hi:[1,0]
    v_pk_mul_f32 v[222:223], v[222:223], v[240:241] op_sel_hi:[1,0]
    v_pk_mul_f32 v[224:225], v[224:225], v[240:241] op_sel_hi:[1,0]
    v_pk_mul_f32 v[226:227], v[226:227], v[240:241] op_sel_hi:[1,0]
    v_pk_mul_f32 v[228:229], v[228:229], v[240:241] op_sel_hi:[1,0]
    buffer_load_dwordx4 v[52:55], v5, s[24:27], s34 offen offset:1024
    v_pk_mul_f32 v[230:231], v[230:231], v[240:241] op_sel_hi:[1,0]
Loav_26062:
    s_waitcnt vmcnt(12)
    v_bitop3_b32 v144, v128, v132, s29 bitop3:0x7e
    s_waitcnt vmcnt(10)
    v_bitop3_b32 v146, v136, v140, s29 bitop3:0x7e
    v_bitop3_b32 v144, v144, v146, 1 bitop3:0xa8
    v_cmp_ne_u32 vcc, 0, v144
    s_nop 0
    s_cbranch_vccnz Loavr_26063
    s_cmp_le_u32 s32, 27
    s_cselect_b64 exec, 3, 0
    buffer_store_dword v4, v0, s[8:11], s37 offen sc1
    s_mov_b64 exec, -1
    buffer_load_dwordx4 v[56:59], v5, s[24:27], s34 offen offset:2048
    s_add_u32 s36, s36, 524288
    s_bitset0_b32 s36, 21
    s_add_u32 s61, s32, 1
    s_bfe_u32 s29, s61, 0x10002
    v_mfma_f32_16x16x16_bf16 v[168:171], v[128:129], v[238:239], v[168:171]
    v_mfma_f32_16x16x16_bf16 v[172:175], v[130:131], v[238:239], v[172:175]
    v_mfma_f32_16x16x16_bf16 v[176:179], v[132:133], v[238:239], v[176:179]
    v_mfma_f32_16x16x16_bf16 v[180:183], v[134:135], v[238:239], v[180:183]
    s_nop 5
    v_cvt_pk_bf16_f32 v112, v168, v172
    v_cvt_pk_bf16_f32 v113, v169, v173
    v_cvt_pk_bf16_f32 v114, v170, v174
    buffer_load_dwordx4 v[60:63], v5, s[24:27], s34 offen offset:3072
    v_mfma_f32_16x16x16_bf16 v[184:187], v[136:137], v[238:239], v[184:187]
    v_cvt_pk_bf16_f32 v115, v171, v175
    ds_write_b128 v8, v[112:115] offset:0
    v_mfma_f32_16x16x16_bf16 v[188:191], v[138:139], v[238:239], v[188:191]
    v_cvt_pk_bf16_f32 v116, v176, v180
    v_cvt_pk_bf16_f32 v117, v177, v181
    v_cvt_pk_bf16_f32 v118, v178, v182
    v_mfma_f32_16x16x16_bf16 v[192:195], v[140:141], v[238:239], v[192:195]
    v_cvt_pk_bf16_f32 v119, v179, v183
    ds_write_b128 v8, v[116:119] offset:1024
    v_mfma_f32_16x16x16_bf16 v[196:199], v[142:143], v[238:239], v[196:199]
    s_nop 0
    v_cvt_pk_bf16_f32 v120, v184, v188
    v_cvt_pk_bf16_f32 v121, v185, v189
    v_cvt_pk_bf16_f32 v122, v186, v190
    v_mfma_f32_16x16x16_bf16 v[200:203], v[128:129], v[246:247], v[200:203]
    v_cvt_pk_bf16_f32 v123, v187, v191
    ds_write_b128 v8, v[120:123] offset:2048
    v_mfma_f32_16x16x16_bf16 v[204:207], v[130:131], v[246:247], v[204:207]
    v_cvt_pk_bf16_f32 v124, v192, v196
    v_cvt_pk_bf16_f32 v125, v193, v197
    v_cvt_pk_bf16_f32 v126, v194, v198
    v_mfma_f32_16x16x16_bf16 v[208:211], v[132:133], v[246:247], v[208:211]
    v_cvt_pk_bf16_f32 v127, v195, v199
    ds_write_b128 v8, v[124:127] offset:3072
    v_mfma_f32_16x16x16_bf16 v[212:215], v[134:135], v[246:247], v[212:215]
    s_nop 0
    v_cvt_pk_bf16_f32 v112, v200, v204
    v_cvt_pk_bf16_f32 v113, v201, v205
    v_cvt_pk_bf16_f32 v114, v202, v206
    v_mfma_f32_16x16x16_bf16 v[216:219], v[136:137], v[246:247], v[216:219]
    v_cvt_pk_bf16_f32 v115, v203, v207
    ds_write_b128 v8, v[112:115] offset:8192
    v_mfma_f32_16x16x16_bf16 v[220:223], v[138:139], v[246:247], v[220:223]
    v_cvt_pk_bf16_f32 v116, v208, v212
    v_cvt_pk_bf16_f32 v117, v209, v213
    v_cvt_pk_bf16_f32 v118, v210, v214
    v_mfma_f32_16x16x16_bf16 v[224:227], v[140:141], v[246:247], v[224:227]
    v_cvt_pk_bf16_f32 v119, v211, v215
    ds_write_b128 v8, v[116:119] offset:9216
    v_mfma_f32_16x16x16_bf16 v[228:231], v[142:143], v[246:247], v[228:231]
    s_nop 0
    v_cvt_pk_bf16_f32 v120, v216, v220
    v_cvt_pk_bf16_f32 v121, v217, v221
    v_cvt_pk_bf16_f32 v122, v218, v222
    v_cvt_pk_bf16_f32 v123, v219, v223
    ds_write_b128 v8, v[120:123] offset:10240
    s_nop 1
    v_cvt_pk_bf16_f32 v124, v224, v228
    v_cvt_pk_bf16_f32 v125, v225, v229
    v_cvt_pk_bf16_f32 v126, v226, v230
    v_cvt_pk_bf16_f32 v127, v227, v231
    ds_write_b128 v8, v[124:127] offset:11264
    v_xor_b32 v8, 0x4000, v8
    s_waitcnt lgkmcnt(0)
    s_barrier
    ds_read_b128 v[232:235], v1 offset:0
    ds_read_b128 v[236:239], v1 offset:1024
    ds_read_b128 v[240:243], v1 offset:2048
    ds_read_b128 v[244:247], v1 offset:3072
    ds_read_b128 v[248:251], v1 offset:4096
    ds_read_b128 v[252:255], v1 offset:5120
    s_waitcnt lgkmcnt(5)
    v_mfma_f32_16x16x32_bf16 v[168:171], v[232:235], a[0:3], 0
    buffer_load_dwordx4 v[64:67], v6, s[24:27], s34 offen offset:0
    v_mfma_f32_16x16x32_bf16 v[172:175], v[232:235], a[32:35], 0
    v_mfma_f32_16x16x32_bf16 v[176:179], v[232:235], a[64:67], 0
    v_mfma_f32_16x16x32_bf16 v[180:183], v[232:235], a[96:99], 0
    v_mfma_f32_16x16x32_bf16 v[184:187], v[232:235], a[128:131], 0
    v_mfma_f32_16x16x32_bf16 v[188:191], v[232:235], a[160:163], 0
    buffer_load_dwordx4 v[68:71], v6, s[24:27], s34 offen offset:1024
    v_mfma_f32_16x16x32_bf16 v[192:195], v[232:235], a[192:195], 0
    v_mfma_f32_16x16x32_bf16 v[196:199], v[232:235], a[224:227], 0
    ds_read_b128 v[232:235], v1 offset:6144
    s_waitcnt lgkmcnt(5)
    v_mfma_f32_16x16x32_bf16 v[168:171], v[236:239], a[4:7], v[168:171]
    v_mfma_f32_16x16x32_bf16 v[172:175], v[236:239], a[36:39], v[172:175]
    v_mfma_f32_16x16x32_bf16 v[176:179], v[236:239], a[68:71], v[176:179]
    buffer_load_dwordx4 v[72:75], v6, s[24:27], s34 offen offset:2048
    v_mfma_f32_16x16x32_bf16 v[180:183], v[236:239], a[100:103], v[180:183]
    v_mfma_f32_16x16x32_bf16 v[184:187], v[236:239], a[132:135], v[184:187]
    v_mfma_f32_16x16x32_bf16 v[188:191], v[236:239], a[164:167], v[188:191]
    v_mfma_f32_16x16x32_bf16 v[192:195], v[236:239], a[196:199], v[192:195]
    v_mfma_f32_16x16x32_bf16 v[196:199], v[236:239], a[228:231], v[196:199]
    buffer_load_dwordx4 v[76:79], v6, s[24:27], s34 offen offset:3072
    ds_read_b128 v[236:239], v1 offset:7168
    s_waitcnt lgkmcnt(5)
    v_mfma_f32_16x16x32_bf16 v[168:171], v[240:243], a[8:11], v[168:171]
    v_mfma_f32_16x16x32_bf16 v[172:175], v[240:243], a[40:43], v[172:175]
    v_mfma_f32_16x16x32_bf16 v[176:179], v[240:243], a[72:75], v[176:179]
    v_mfma_f32_16x16x32_bf16 v[180:183], v[240:243], a[104:107], v[180:183]
    v_mfma_f32_16x16x32_bf16 v[184:187], v[240:243], a[136:139], v[184:187]
    buffer_load_dwordx4 v[80:83], v5, s[24:27], s35 offen offset:0
    v_mfma_f32_16x16x32_bf16 v[188:191], v[240:243], a[168:171], v[188:191]
    v_mfma_f32_16x16x32_bf16 v[192:195], v[240:243], a[200:203], v[192:195]
    v_mfma_f32_16x16x32_bf16 v[196:199], v[240:243], a[232:235], v[196:199]
    ds_read_b128 v[240:243], v1 offset:8192
    s_waitcnt lgkmcnt(5)
    v_mfma_f32_16x16x32_bf16 v[168:171], v[244:247], a[12:15], v[168:171]
    v_mfma_f32_16x16x32_bf16 v[172:175], v[244:247], a[44:47], v[172:175]
    buffer_load_dwordx4 v[84:87], v5, s[24:27], s35 offen offset:1024
    v_mfma_f32_16x16x32_bf16 v[176:179], v[244:247], a[76:79], v[176:179]
    v_mfma_f32_16x16x32_bf16 v[180:183], v[244:247], a[108:111], v[180:183]
    v_mfma_f32_16x16x32_bf16 v[184:187], v[244:247], a[140:143], v[184:187]
    v_mfma_f32_16x16x32_bf16 v[188:191], v[244:247], a[172:175], v[188:191]
    v_mfma_f32_16x16x32_bf16 v[192:195], v[244:247], a[204:207], v[192:195]
    buffer_load_dwordx4 v[88:91], v5, s[24:27], s35 offen offset:2048
    v_mfma_f32_16x16x32_bf16 v[196:199], v[244:247], a[236:239], v[196:199]
    ds_read_b128 v[244:247], v1 offset:9216
    s_waitcnt lgkmcnt(5)
    v_mfma_f32_16x16x32_bf16 v[168:171], v[248:251], a[16:19], v[168:171]
    v_mfma_f32_16x16x32_bf16 v[172:175], v[248:251], a[48:51], v[172:175]
    v_mfma_f32_16x16x32_bf16 v[176:179], v[248:251], a[80:83], v[176:179]
    v_mfma_f32_16x16x32_bf16 v[180:183], v[248:251], a[112:115], v[180:183]
    buffer_load_dwordx4 v[92:95], v5, s[24:27], s35 offen offset:3072
    v_mfma_f32_16x16x32_bf16 v[184:187], v[248:251], a[144:147], v[184:187]
    v_mfma_f32_16x16x32_bf16 v[188:191], v[248:251], a[176:179], v[188:191]
    v_mfma_f32_16x16x32_bf16 v[192:195], v[248:251], a[208:211], v[192:195]
    v_mfma_f32_16x16x32_bf16 v[196:199], v[248:251], a[240:243], v[196:199]
    ds_read_b128 v[248:251], v1 offset:10240
    s_waitcnt lgkmcnt(5)
    v_mfma_f32_16x16x32_bf16 v[168:171], v[252:255], a[20:23], v[168:171]
    buffer_load_dwordx4 v[96:99], v6, s[24:27], s35 offen offset:0
    v_mfma_f32_16x16x32_bf16 v[172:175], v[252:255], a[52:55], v[172:175]
    v_mfma_f32_16x16x32_bf16 v[176:179], v[252:255], a[84:87], v[176:179]
    v_mfma_f32_16x16x32_bf16 v[180:183], v[252:255], a[116:119], v[180:183]
    v_mfma_f32_16x16x32_bf16 v[184:187], v[252:255], a[148:151], v[184:187]
    v_mfma_f32_16x16x32_bf16 v[188:191], v[252:255], a[180:183], v[188:191]
    buffer_load_dwordx4 v[100:103], v6, s[24:27], s35 offen offset:1024
    v_mfma_f32_16x16x32_bf16 v[192:195], v[252:255], a[212:215], v[192:195]
    v_mfma_f32_16x16x32_bf16 v[196:199], v[252:255], a[244:247], v[196:199]
    ds_read_b128 v[252:255], v1 offset:11264
    s_waitcnt lgkmcnt(5)
    v_mfma_f32_16x16x32_bf16 v[168:171], v[232:235], a[24:27], v[168:171]
    v_mfma_f32_16x16x32_bf16 v[172:175], v[232:235], a[56:59], v[172:175]
    v_mfma_f32_16x16x32_bf16 v[176:179], v[232:235], a[88:91], v[176:179]
    buffer_load_dwordx4 v[104:107], v6, s[24:27], s35 offen offset:2048
    v_mfma_f32_16x16x32_bf16 v[180:183], v[232:235], a[120:123], v[180:183]
    v_mfma_f32_16x16x32_bf16 v[184:187], v[232:235], a[152:155], v[184:187]
    v_mfma_f32_16x16x32_bf16 v[188:191], v[232:235], a[184:187], v[188:191]
    v_mfma_f32_16x16x32_bf16 v[192:195], v[232:235], a[216:219], v[192:195]
    v_mfma_f32_16x16x32_bf16 v[196:199], v[232:235], a[248:251], v[196:199]
    buffer_load_dwordx4 v[108:111], v6, s[24:27], s35 offen offset:3072
    ds_read_b128 v[232:235], v1 offset:12288
    s_waitcnt lgkmcnt(5)
    v_mfma_f32_16x16x32_bf16 v[168:171], v[236:239], a[28:31], v[168:171]
    v_mfma_f32_16x16x32_bf16 v[172:175], v[236:239], a[60:63], v[172:175]
    v_mfma_f32_16x16x32_bf16 v[176:179], v[236:239], a[92:95], v[176:179]
    v_mfma_f32_16x16x32_bf16 v[180:183], v[236:239], a[124:127], v[180:183]
    v_mfma_f32_16x16x32_bf16 v[184:187], v[236:239], a[156:159], v[184:187]
    s_add_u32 s33, s33, s31
    s_add_u32 s34, s34, s31
    s_add_u32 s35, s35, s31
    v_mfma_f32_16x16x32_bf16 v[188:191], v[236:239], a[188:191], v[188:191]
    v_mfma_f32_16x16x32_bf16 v[192:195], v[236:239], a[220:223], v[192:195]
    v_mfma_f32_16x16x32_bf16 v[196:199], v[236:239], a[252:255], v[196:199]
    ds_read_b128 v[236:239], v1 offset:13312
    s_waitcnt lgkmcnt(5)
    v_mfma_f32_16x16x32_bf16 v[200:203], v[240:243], a[0:3], 0
    v_mfma_f32_16x16x32_bf16 v[204:207], v[240:243], a[32:35], 0
    v_mfma_f32_16x16x32_bf16 v[208:211], v[240:243], a[64:67], 0
    v_cvt_pk_bf16_f32 v112, v168, v172
    v_mfma_f32_16x16x32_bf16 v[212:215], v[240:243], a[96:99], 0
    v_cvt_pk_bf16_f32 v113, v176, v180
    v_mfma_f32_16x16x32_bf16 v[216:219], v[240:243], a[128:131], 0
    v_and_or_b32 v112, v112, -2, s58
    v_mfma_f32_16x16x32_bf16 v[220:223], v[240:243], a[160:163], 0
    v_cvt_pk_bf16_f32 v114, v184, v188
    v_mfma_f32_16x16x32_bf16 v[224:227], v[240:243], a[192:195], 0
    v_cvt_pk_bf16_f32 v115, v192, v196
    s_add_u32 s57, s38, 0
    v_mfma_f32_16x16x32_bf16 v[228:231], v[240:243], a[224:227], 0
    buffer_store_dwordx4 v[112:115], v2, s[8:11], s57 offen
    ds_read_b128 v[240:243], v1 offset:14336
    s_waitcnt lgkmcnt(5)
    v_mfma_f32_16x16x32_bf16 v[200:203], v[244:247], a[4:7], v[200:203]
    v_cvt_pk_bf16_f32 v116, v169, v173
    v_mfma_f32_16x16x32_bf16 v[204:207], v[244:247], a[36:39], v[204:207]
    v_cvt_pk_bf16_f32 v117, v177, v181
    v_mfma_f32_16x16x32_bf16 v[208:211], v[244:247], a[68:71], v[208:211]
    v_and_or_b32 v116, v116, -2, s58
    v_mfma_f32_16x16x32_bf16 v[212:215], v[244:247], a[100:103], v[212:215]
    v_cvt_pk_bf16_f32 v118, v185, v189
    v_mfma_f32_16x16x32_bf16 v[216:219], v[244:247], a[132:135], v[216:219]
    v_cvt_pk_bf16_f32 v119, v193, v197
    s_add_u32 s57, s38, 16384
    v_mfma_f32_16x16x32_bf16 v[220:223], v[244:247], a[164:167], v[220:223]
    buffer_store_dwordx4 v[116:119], v2, s[8:11], s57 offen
    v_mfma_f32_16x16x32_bf16 v[224:227], v[244:247], a[196:199], v[224:227]
    v_cvt_pk_bf16_f32 v120, v170, v174
    v_mfma_f32_16x16x32_bf16 v[228:231], v[244:247], a[228:231], v[228:231]
    v_cvt_pk_bf16_f32 v121, v178, v182
    ds_read_b128 v[244:247], v1 offset:15360
    s_waitcnt lgkmcnt(5)
    v_mfma_f32_16x16x32_bf16 v[200:203], v[248:251], a[8:11], v[200:203]
    v_and_or_b32 v120, v120, -2, s58
    v_mfma_f32_16x16x32_bf16 v[204:207], v[248:251], a[40:43], v[204:207]
    v_cvt_pk_bf16_f32 v122, v186, v190
    v_mfma_f32_16x16x32_bf16 v[208:211], v[248:251], a[72:75], v[208:211]
    v_cvt_pk_bf16_f32 v123, v194, v198
    s_add_u32 s57, s38, 32768
    v_mfma_f32_16x16x32_bf16 v[212:215], v[248:251], a[104:107], v[212:215]
    buffer_store_dwordx4 v[120:123], v2, s[8:11], s57 offen
    v_mfma_f32_16x16x32_bf16 v[216:219], v[248:251], a[136:139], v[216:219]
    v_cvt_pk_bf16_f32 v124, v171, v175
    v_mfma_f32_16x16x32_bf16 v[220:223], v[248:251], a[168:171], v[220:223]
    v_cvt_pk_bf16_f32 v125, v179, v183
    v_mfma_f32_16x16x32_bf16 v[224:227], v[248:251], a[200:203], v[224:227]
    v_and_or_b32 v124, v124, -2, s58
    v_mfma_f32_16x16x32_bf16 v[228:231], v[248:251], a[232:235], v[228:231]
    v_cvt_pk_bf16_f32 v126, v187, v191
    s_waitcnt lgkmcnt(4)
    v_mfma_f32_16x16x32_bf16 v[200:203], v[252:255], a[12:15], v[200:203]
    v_cvt_pk_bf16_f32 v127, v195, v199
    s_add_u32 s57, s38, 49152
    v_mfma_f32_16x16x32_bf16 v[204:207], v[252:255], a[44:47], v[204:207]
    buffer_store_dwordx4 v[124:127], v2, s[8:11], s57 offen
    v_mfma_f32_16x16x32_bf16 v[208:211], v[252:255], a[76:79], v[208:211]
    v_mfma_f32_16x16x32_bf16 v[212:215], v[252:255], a[108:111], v[212:215]
    v_mfma_f32_16x16x32_bf16 v[216:219], v[252:255], a[140:143], v[216:219]
    v_mfma_f32_16x16x32_bf16 v[220:223], v[252:255], a[172:175], v[220:223]
    v_mfma_f32_16x16x32_bf16 v[224:227], v[252:255], a[204:207], v[224:227]
    v_mfma_f32_16x16x32_bf16 v[228:231], v[252:255], a[236:239], v[228:231]
    s_waitcnt lgkmcnt(3)
    v_mfma_f32_16x16x32_bf16 v[200:203], v[232:235], a[16:19], v[200:203]
    v_mfma_f32_16x16x32_bf16 v[204:207], v[232:235], a[48:51], v[204:207]
    v_mfma_f32_16x16x32_bf16 v[208:211], v[232:235], a[80:83], v[208:211]
    v_mfma_f32_16x16x32_bf16 v[212:215], v[232:235], a[112:115], v[212:215]
    v_mfma_f32_16x16x32_bf16 v[216:219], v[232:235], a[144:147], v[216:219]
    v_mfma_f32_16x16x32_bf16 v[220:223], v[232:235], a[176:179], v[220:223]
    v_mfma_f32_16x16x32_bf16 v[224:227], v[232:235], a[208:211], v[224:227]
    v_mfma_f32_16x16x32_bf16 v[228:231], v[232:235], a[240:243], v[228:231]
    s_waitcnt lgkmcnt(2)
    v_mfma_f32_16x16x32_bf16 v[200:203], v[236:239], a[20:23], v[200:203]
    v_mfma_f32_16x16x32_bf16 v[204:207], v[236:239], a[52:55], v[204:207]
    v_mfma_f32_16x16x32_bf16 v[208:211], v[236:239], a[84:87], v[208:211]
    v_mfma_f32_16x16x32_bf16 v[212:215], v[236:239], a[116:119], v[212:215]
    v_mfma_f32_16x16x32_bf16 v[216:219], v[236:239], a[148:151], v[216:219]
    v_mfma_f32_16x16x32_bf16 v[220:223], v[236:239], a[180:183], v[220:223]
    v_mfma_f32_16x16x32_bf16 v[224:227], v[236:239], a[212:215], v[224:227]
    v_mfma_f32_16x16x32_bf16 v[228:231], v[236:239], a[244:247], v[228:231]
    s_waitcnt lgkmcnt(1)
    v_mfma_f32_16x16x32_bf16 v[200:203], v[240:243], a[24:27], v[200:203]
    v_mfma_f32_16x16x32_bf16 v[204:207], v[240:243], a[56:59], v[204:207]
    buffer_load_dword v11, v15, s[8:11], s36 offen sc1
    v_mfma_f32_16x16x32_bf16 v[208:211], v[240:243], a[88:91], v[208:211]
    v_mfma_f32_16x16x32_bf16 v[212:215], v[240:243], a[120:123], v[212:215]
    v_mfma_f32_16x16x32_bf16 v[216:219], v[240:243], a[152:155], v[216:219]
    v_mfma_f32_16x16x32_bf16 v[220:223], v[240:243], a[184:187], v[220:223]
    v_mfma_f32_16x16x32_bf16 v[224:227], v[240:243], a[216:219], v[224:227]
    v_mfma_f32_16x16x32_bf16 v[228:231], v[240:243], a[248:251], v[228:231]
    s_waitcnt lgkmcnt(0)
    v_mfma_f32_16x16x32_bf16 v[200:203], v[244:247], a[28:31], v[200:203]
    v_mfma_f32_16x16x32_bf16 v[204:207], v[244:247], a[60:63], v[204:207]
    v_mfma_f32_16x16x32_bf16 v[208:211], v[244:247], a[92:95], v[208:211]
    v_mfma_f32_16x16x32_bf16 v[212:215], v[244:247], a[124:127], v[212:215]
    v_mfma_f32_16x16x32_bf16 v[216:219], v[244:247], a[156:159], v[216:219]
    v_mfma_f32_16x16x32_bf16 v[220:223], v[244:247], a[188:191], v[220:223]
    v_mfma_f32_16x16x32_bf16 v[224:227], v[244:247], a[220:223], v[224:227]
    v_mfma_f32_16x16x32_bf16 v[228:231], v[244:247], a[252:255], v[228:231]
    v_xor_b32 v1, 0x4000, v1
    s_nop 0
    v_cvt_pk_bf16_f32 v128, v200, v204
    s_nop 0
    v_cvt_pk_bf16_f32 v129, v208, v212
    v_and_or_b32 v128, v128, -2, s58
    v_cvt_pk_bf16_f32 v130, v216, v220
    s_nop 0
    v_cvt_pk_bf16_f32 v131, v224, v228
    s_add_u32 s57, s38, 262144
    buffer_store_dwordx4 v[128:131], v2, s[8:11], s57 offen
    v_cvt_pk_bf16_f32 v132, v201, v205
    v_cvt_pk_bf16_f32 v133, v209, v213
    v_and_or_b32 v132, v132, -2, s58
    v_cvt_pk_bf16_f32 v134, v217, v221
    v_cvt_pk_bf16_f32 v135, v225, v229
    s_add_u32 s57, s38, 278528
    buffer_store_dwordx4 v[132:135], v2, s[8:11], s57 offen
    v_cvt_pk_bf16_f32 v136, v202, v206
    v_cvt_pk_bf16_f32 v137, v210, v214
    v_and_or_b32 v136, v136, -2, s58
    v_cvt_pk_bf16_f32 v138, v218, v222
    v_cvt_pk_bf16_f32 v139, v226, v230
    s_add_u32 s57, s38, 294912
    buffer_store_dwordx4 v[136:139], v2, s[8:11], s57 offen
    v_cvt_pk_bf16_f32 v140, v203, v207
    v_cvt_pk_bf16_f32 v141, v211, v215
    v_and_or_b32 v140, v140, -2, s58
    v_cvt_pk_bf16_f32 v142, v219, v223
    v_cvt_pk_bf16_f32 v143, v227, v231
    s_add_u32 s57, s38, 311296
    buffer_store_dwordx4 v[140:143], v2, s[8:11], s57 offen
    s_xor_b32 s38, s38, 1048576
    s_add_u32 s32, s32, 1
    s_bfe_u32 s58, s32, 0x10001
    s_xor_b32 s58, s58, 1
    s_cmp_lt_u32 s32, 32
    s_cbranch_scc1 L_oa_fast
    s_branch L_o_end
Loaw_26050:
    buffer_load_dword v10, v7, s[8:11], s37 offen sc1
    s_sub_u32 s62, s62, 1
    s_cbranch_scc0 Ltok_31050
    s_movk_i32 s61, 20
    s_branch L_abort
Ltok_31050:
    s_waitcnt vmcnt(0)
    v_cmp_ne_u32 vcc, 0, v10
    s_nop 0
    s_and_b32 s61, vcc_lo, s28
    s_cmp_lg_u32 s61, s28
    s_cbranch_scc1 Loaw_26050
    s_mov_b32 s28, 783
    s_add_u32 m0, s56, 16384
    s_nop 0
    buffer_load_dwordx4 v5, s[8:11], s33 offen offset:0 lds
    buffer_load_dwordx4 v5, s[8:11], s33 offen offset:1024 lds
    buffer_load_dwordx4 v5, s[8:11], s33 offen offset:2048 lds
    buffer_load_dwordx4 v5, s[8:11], s33 offen offset:3072 lds
    s_add_u32 m0, s56, 20480
    s_nop 0
    buffer_load_dwordx4 v6, s[8:11], s33 offen offset:0 lds
    buffer_load_dwordx4 v6, s[8:11], s33 offen offset:1024 lds
    buffer_load_dwordx4 v6, s[8:11], s33 offen offset:2048 lds
    buffer_load_dwordx4 v6, s[8:11], s33 offen offset:3072 lds
    buffer_load_dwordx4 v[48:51], v5, s[8:11], s34 offen offset:0
    buffer_load_dwordx4 v[52:55], v5, s[8:11], s34 offen offset:1024
    buffer_load_dwordx4 v[56:59], v5, s[8:11], s34 offen offset:2048
    buffer_load_dwordx4 v[60:63], v5, s[8:11], s34 offen offset:3072
    buffer_load_dwordx4 v[64:67], v6, s[8:11], s34 offen offset:0
    buffer_load_dwordx4 v[68:71], v6, s[8:11], s34 offen offset:1024
    buffer_load_dwordx4 v[72:75], v6, s[8:11], s34 offen offset:2048
    buffer_load_dwordx4 v[76:79], v6, s[8:11], s34 offen offset:3072
    buffer_load_dwordx4 v[80:83], v5, s[8:11], s35 offen offset:0
    buffer_load_dwordx4 v[84:87], v5, s[8:11], s35 offen offset:1024
    buffer_load_dwordx4 v[88:91], v5, s[8:11], s35 offen offset:2048
    buffer_load_dwordx4 v[92:95], v5, s[8:11], s35 offen offset:3072
    buffer_load_dwordx4 v[96:99], v6, s[8:11], s35 offen offset:0
    buffer_load_dwordx4 v[100:103], v6, s[8:11], s35 offen offset:1024
    buffer_load_dwordx4 v[104:107], v6, s[8:11], s35 offen offset:2048
    buffer_load_dwordx4 v[108:111], v6, s[8:11], s35 offen offset:3072
    s_add_u32 s33, s33, 524288
    s_add_u32 s34, s34, 524288
    s_add_u32 s35, s35, 524288
    s_branch Loag_26051
Loaoe_26059:
    s_waitcnt vmcnt(11)
    v_cmp_ne_u32 s[44:45], 0, v10
    s_add_u32 s37, s37, 16384
    s_lshr_b32 s61, s44, 16
    s_and_b32 s61, s61, 783
    s_cmp_ge_u32 s32, 31
    s_cselect_b32 s61, 0, s61
    s_cmp_eq_u32 s61, 783
    s_cselect_b32 s42, 1, 0
    s_cselect_b32 s26, 268435456, 0
    s_cselect_b32 s31, 524288, 0
    s_waitcnt vmcnt(3)
    ds_read_b64_tr_b16 v[112:113], v9 offset:0
    ds_read_b64_tr_b16 v[114:115], v9 offset:32
    ds_read_b64_tr_b16 v[116:117], v9 offset:2048
    ds_read_b64_tr_b16 v[118:119], v9 offset:2080
    ds_read_b64_tr_b16 v[120:121], v9 offset:4096
    ds_read_b64_tr_b16 v[122:123], v9 offset:4128
    ds_read_b64_tr_b16 v[124:125], v9 offset:6144
    ds_read_b64_tr_b16 v[126:127], v9 offset:6176
    s_branch Loajn_26060
Loan_26056:
    buffer_load_dword v10, v7, s[8:11], s37 offen sc1
    s_waitcnt vmcnt(0)
    v_cmp_ne_u32 vcc, 0, v10
    s_nop 0
    s_and_b32 s61, vcc_lo, 783
    s_cmp_ge_u32 s32, 31
    s_cselect_b32 s61, 0, s61
    s_cmp_eq_u32 s61, 783
    s_cselect_b32 s42, 1, 0
    s_branch Loaj_26057
Loakr_26064:
    s_mov_b32 m0, s56
    s_nop 0
    buffer_load_dwordx4 v5, s[8:11], s36 offen sc1 lds
    buffer_load_dwordx4 v5, s[8:11], s36 offen offset:2048 sc1 lds
    s_add_u32 m0, s56, 4096
    s_nop 0
    buffer_load_dwordx4 v6, s[8:11], s36 offen sc1 lds
    buffer_load_dwordx4 v6, s[8:11], s36 offen offset:2048 sc1 lds
    s_sub_u32 s62, s62, 1
    s_cbranch_scc0 Ltok_31051
    s_movk_i32 s61, 25
    s_branch L_abort
Ltok_31051:
    s_branch Loar_26058
Loavr_26063:
    buffer_load_dwordx4 v[128:131], v5, s[8:11], s36 offen offset:1024 sc1
    buffer_load_dwordx4 v[132:135], v5, s[8:11], s36 offen offset:3072 sc1
    buffer_load_dwordx4 v[136:139], v6, s[8:11], s36 offen offset:1024 sc1
    buffer_load_dwordx4 v[140:143], v6, s[8:11], s36 offen offset:3072 sc1
    s_sub_u32 s62, s62, 1
    s_cbranch_scc0 Ltok_31052
    s_movk_i32 s61, 26
    s_branch L_abort
Ltok_31052:
    s_waitcnt vmcnt(0)
    s_branch Loav_26062
L_oa_slow:
    s_cmp_eq_u32 s42, 0
    s_cbranch_scc1 Loaw_31053
Loag_31054:
    buffer_load_dword v10, v7, s[8:11], s37 offen sc1
    s_waitcnt vmcnt(16)
    ds_read_b128 v[16:19], v14 offset:0
    ds_read_b128 v[20:23], v14 offset:1024
    ds_read_b128 v[24:27], v14 offset:2048
    ds_read_b128 v[28:31], v14 offset:3072
    ds_read_b128 v[32:35], v14 offset:4096
    ds_read_b128 v[36:39], v14 offset:5120
    ds_read_b128 v[40:43], v14 offset:6144
    ds_read_b128 v[44:47], v14 offset:7168
    s_waitcnt lgkmcnt(7)
    v_mfma_f32_16x16x32_bf16 v[144:147], v[48:51], v[16:19], 0
    s_waitcnt lgkmcnt(6)
    v_mfma_f32_16x16x32_bf16 v[148:151], v[48:51], v[20:23], 0
    s_waitcnt vmcnt(15)
    v_mfma_f32_16x16x32_bf16 v[152:155], v[52:55], v[20:23], 0
    s_waitcnt vmcnt(14) lgkmcnt(5)
    v_mfma_f32_16x16x32_bf16 v[144:147], v[56:59], v[24:27], v[144:147]
    s_waitcnt lgkmcnt(4)
    v_mfma_f32_16x16x32_bf16 v[148:151], v[56:59], v[28:31], v[148:151]
    s_waitcnt vmcnt(13)
    v_mfma_f32_16x16x32_bf16 v[152:155], v[60:63], v[28:31], v[152:155]
    s_waitcnt vmcnt(12) lgkmcnt(3)
    v_mfma_f32_16x16x32_bf16 v[144:147], v[64:67], v[32:35], v[144:147]
    s_waitcnt lgkmcnt(2)
    v_mfma_f32_16x16x32_bf16 v[148:151], v[64:67], v[36:39], v[148:151]
    s_waitcnt vmcnt(11)
    v_mfma_f32_16x16x32_bf16 v[152:155], v[68:71], v[36:39], v[152:155]
    s_waitcnt vmcnt(10) lgkmcnt(1)
    v_mfma_f32_16x16x32_bf16 v[144:147], v[72:75], v[40:43], v[144:147]
    s_waitcnt lgkmcnt(0)
    v_mfma_f32_16x16x32_bf16 v[148:151], v[72:75], v[44:47], v[148:151]
    s_waitcnt vmcnt(9)
    v_mfma_f32_16x16x32_bf16 v[152:155], v[76:79], v[44:47], v[152:155]
    s_waitcnt vmcnt(5)
    v_bitop3_b32 v232, v11, s29, 1 bitop3:0x28
    v_cmp_ne_u32 vcc, 0, v232
    s_nop 0
    s_cmp_eq_u64 vcc, 0
    s_cselect_b32 s18, 0, 268435456
    s_cselect_b32 s22, 268435456, 0
    s_mov_b32 m0, s56
    s_nop 0
    buffer_load_dwordx4 v5, s[20:23], s36 offen sc1 lds
    buffer_load_dwordx4 v5, s[20:23], s36 offen offset:2048 sc1 lds
    s_add_u32 m0, s56, 4096
    s_nop 0
    buffer_load_dwordx4 v6, s[20:23], s36 offen sc1 lds
    buffer_load_dwordx4 v6, s[20:23], s36 offen offset:2048 sc1 lds
    buffer_load_dwordx4 v[128:131], v5, s[20:23], s36 offen offset:1024 sc1
    buffer_load_dwordx4 v[132:135], v5, s[20:23], s36 offen offset:3072 sc1
    buffer_load_dwordx4 v[136:139], v6, s[20:23], s36 offen offset:1024 sc1
    buffer_load_dwordx4 v[140:143], v6, s[20:23], s36 offen offset:3072 sc1
    v_cndmask_b32 v144, v144, v4, s[46:47]
    v_cndmask_b32 v152, v152, v4, s[46:47]
    v_cndmask_b32 v145, v145, v4, s[48:49]
    v_cndmask_b32 v153, v153, v4, s[48:49]
    v_cndmask_b32 v146, v146, v4, s[50:51]
    v_cndmask_b32 v154, v154, v4, s[50:51]
    v_cndmask_b32 v147, v147, v4, s[52:53]
    v_cndmask_b32 v155, v155, v4, s[52:53]
    v_max3_f32 v164, v144, v145, v146
    v_max3_f32 v165, v148, v149, v150
    v_max_f32 v164, v164, v147
    v_max3_f32 v165, v165, v151, v152
    v_max3_f32 v165, v165, v153, v154
    v_max_f32 v165, v165, v155
    v_mov_b32 v232, v164
    v_mov_b32 v233, v165
    s_nop 0
    v_permlane16_swap_b32 v164, v232
    v_permlane16_swap_b32 v165, v233
    v_max_f32 v164, v164, v232
    v_max_f32 v165, v165, v233
    v_mov_b32 v232, v164
    v_mov_b32 v233, v165
    s_nop 0
    v_permlane32_swap_b32 v164, v232
    v_permlane32_swap_b32 v165, v233
    v_max_f32 v164, v164, v232
    v_max_f32 v165, v165, v233
    v_mul_f32 v232, s55, v164
    v_mul_f32 v233, s55, v165
    v_fma_f32 v144, v144, s55, -v232
    v_fma_f32 v145, v145, s55, -v232
    v_fma_f32 v146, v146, s55, -v232
    v_fma_f32 v147, v147, s55, -v232
    v_fma_f32 v148, v148, s55, -v233
    v_fma_f32 v149, v149, s55, -v233
    v_fma_f32 v150, v150, s55, -v233
    v_fma_f32 v151, v151, s55, -v233
    v_fma_f32 v152, v152, s55, -v233
    v_fma_f32 v153, v153, s55, -v233
    v_fma_f32 v154, v154, s55, -v233
    v_fma_f32 v155, v155, s55, -v233
    v_exp_f32 v144, v144
    v_exp_f32 v145, v145
    v_exp_f32 v146, v146
    v_exp_f32 v147, v147
    v_exp_f32 v148, v148
    v_exp_f32 v149, v149
    v_exp_f32 v150, v150
    v_exp_f32 v151, v151
    v_exp_f32 v152, v152
    v_exp_f32 v153, v153
    v_exp_f32 v154, v154
    v_exp_f32 v155, v155
    buffer_load_dword v11, v15, s[16:19], s36 offen sc1
    v_cvt_pk_bf16_f32 v248, v144, v145
    v_cvt_pk_bf16_f32 v249, v146, v147
    v_cvt_pk_bf16_f32 v250, v148, v149
    v_cvt_pk_bf16_f32 v251, v150, v151
    v_cvt_pk_bf16_f32 v252, v152, v153
    v_cvt_pk_bf16_f32 v253, v154, v155
    v_mfma_f32_16x16x16_bf16 v[168:171], v[80:81], v[248:249], 0
    v_add_f32 v166, v144, v145
    v_mfma_f32_16x16x32_bf16 v[200:203], v[80:83], v[250:253], 0
    v_add_f32 v167, v148, v149
    v_mfma_f32_16x16x16_bf16 v[172:175], v[84:85], v[248:249], 0
    v_add_f32 v166, v166, v146
    v_mfma_f32_16x16x32_bf16 v[204:207], v[84:87], v[250:253], 0
    v_add_f32 v167, v167, v150
    v_mfma_f32_16x16x16_bf16 v[176:179], v[88:89], v[248:249], 0
    v_add_f32 v166, v166, v147
    v_mfma_f32_16x16x32_bf16 v[208:211], v[88:91], v[250:253], 0
    v_add_f32 v167, v167, v151
    buffer_load_dword v12, v15, s[16:19], s36 offen sc1
    v_mfma_f32_16x16x16_bf16 v[180:183], v[92:93], v[248:249], 0
    v_add_f32 v167, v167, v152
    v_mfma_f32_16x16x32_bf16 v[212:215], v[92:95], v[250:253], 0
    v_add_f32 v167, v167, v153
    s_waitcnt vmcnt(14)
    v_mfma_f32_16x16x16_bf16 v[184:187], v[96:97], v[248:249], 0
    v_add_f32 v167, v167, v154
    v_mfma_f32_16x16x32_bf16 v[216:219], v[96:99], v[250:253], 0
    v_add_f32 v167, v167, v155
    s_waitcnt vmcnt(13)
    v_mfma_f32_16x16x16_bf16 v[188:191], v[100:101], v[248:249], 0
    v_mfma_f32_16x16x32_bf16 v[220:223], v[100:103], v[250:253], 0
    s_waitcnt vmcnt(12)
    v_mfma_f32_16x16x16_bf16 v[192:195], v[104:105], v[248:249], 0
    v_mfma_f32_16x16x32_bf16 v[224:227], v[104:107], v[250:253], 0
    s_waitcnt vmcnt(11)
    v_mfma_f32_16x16x16_bf16 v[196:199], v[108:109], v[248:249], 0
    v_mfma_f32_16x16x32_bf16 v[228:231], v[108:111], v[250:253], 0
    buffer_load_dword v13, v15, s[16:19], s36 offen sc1
    s_cmp_eq_u32 s18, 0
    s_cbranch_scc1 Loaoe_31062
Loam_31057:
    s_waitcnt vmcnt(2)
    v_bitop3_b32 v232, v11, s29, 1 bitop3:0x28
    v_cmp_ne_u32 vcc, 0, v232
    s_nop 0
    s_cbranch_vccz Loamk_31058
    buffer_load_dword v11, v15, s[16:19], s36 offen sc1
    s_waitcnt vmcnt(2)
    v_bitop3_b32 v232, v12, s29, 1 bitop3:0x28
    v_cmp_ne_u32 vcc, 0, v232
    s_nop 0
    s_cbranch_vccz Loamk_31058
    buffer_load_dword v12, v15, s[16:19], s36 offen sc1
    s_waitcnt vmcnt(2)
    v_bitop3_b32 v232, v13, s29, 1 bitop3:0x28
    v_cmp_ne_u32 vcc, 0, v232
    s_nop 0
    s_cbranch_vccz Loamk_31058
    buffer_load_dword v13, v15, s[16:19], s36 offen sc1
    buffer_load_dword v10, v7, s[8:11], s37 offen sc1
    s_sub_u32 s62, s62, 1
    s_cbranch_scc0 Ltok_31064
    s_movk_i32 s61, 21
    s_branch L_abort
Ltok_31064:
    s_branch Loam_31057
Loamk_31058:
    s_mov_b32 m0, s56
    s_nop 0
    buffer_load_dwordx4 v5, s[8:11], s36 offen sc1 lds
    buffer_load_dwordx4 v5, s[8:11], s36 offen offset:2048 sc1 lds
    s_add_u32 m0, s56, 4096
    s_nop 0
    buffer_load_dwordx4 v6, s[8:11], s36 offen sc1 lds
    buffer_load_dwordx4 v6, s[8:11], s36 offen offset:2048 sc1 lds
    s_waitcnt vmcnt(4)
    v_cmp_ne_u32 s[44:45], 0, v10
    s_add_u32 s37, s37, 16384
    s_lshr_b32 s61, s44, 16
    s_and_b32 s61, s61, 783
    s_cmp_ge_u32 s32, 31
    s_cselect_b32 s61, 0, s61
    s_cmp_lg_u32 s61, 783
    s_cbranch_scc1 Loan_31059
    s_mov_b32 s42, 1
Loaj_31060:
    s_cmp_lg_u32 s42, 0
    s_cselect_b32 s26, 268435456, 0
    s_cselect_b32 s31, 524288, 0
Loar_31061:
    s_waitcnt vmcnt(3)
    ds_read_b64_tr_b16 v[112:113], v9 offset:0
    ds_read_b64_tr_b16 v[114:115], v9 offset:32
    s_waitcnt vmcnt(2)
    ds_read_b64_tr_b16 v[116:117], v9 offset:2048
    ds_read_b64_tr_b16 v[118:119], v9 offset:2080
    s_waitcnt vmcnt(1)
    ds_read_b64_tr_b16 v[120:121], v9 offset:4096
    ds_read_b64_tr_b16 v[122:123], v9 offset:4128
    s_waitcnt vmcnt(0)
    buffer_load_dwordx4 v[128:131], v5, s[8:11], s36 offen offset:1024 sc1
    buffer_load_dwordx4 v[132:135], v5, s[8:11], s36 offen offset:3072 sc1
    buffer_load_dwordx4 v[136:139], v6, s[8:11], s36 offen offset:1024 sc1
    buffer_load_dwordx4 v[140:143], v6, s[8:11], s36 offen offset:3072 sc1
    ds_read_b64_tr_b16 v[124:125], v9 offset:6144
    ds_read_b64_tr_b16 v[126:127], v9 offset:6176
Loajn_31063:
    ds_read_b32 v144, v3 offset:0
    ds_read_b32 v145, v3 offset:2048
    ds_read_b32 v146, v3 offset:4096
    ds_read_b32 v147, v3 offset:6144
    s_waitcnt lgkmcnt(10)
    v_mfma_f32_16x16x32_bf16 v[156:159], v[112:115], v[16:19], 0
    v_mfma_f32_16x16x32_bf16 v[160:163], v[112:115], v[20:23], 0
    s_waitcnt lgkmcnt(8)
    v_mfma_f32_16x16x32_bf16 v[156:159], v[116:119], v[24:27], v[156:159]
    v_mfma_f32_16x16x32_bf16 v[160:163], v[116:119], v[28:31], v[160:163]
    s_waitcnt lgkmcnt(6)
    v_mfma_f32_16x16x32_bf16 v[156:159], v[120:123], v[32:35], v[156:159]
    v_mfma_f32_16x16x32_bf16 v[160:163], v[120:123], v[36:39], v[160:163]
    s_waitcnt lgkmcnt(4)
    v_mfma_f32_16x16x32_bf16 v[156:159], v[124:127], v[40:43], v[156:159]
    v_mfma_f32_16x16x32_bf16 v[160:163], v[124:127], v[44:47], v[160:163]
    s_nop 6
    v_permlane32_swap_b32 v156, v158
    v_permlane32_swap_b32 v160, v162
    v_permlane32_swap_b32 v157, v159
    s_add_u32 m0, s56, 16384
    s_nop 0
    buffer_load_dwordx4 v5, s[24:27], s33 offen offset:0 lds
    v_permlane32_swap_b32 v161, v163
    v_add_f32 v156, v156, v158
    v_add_f32 v160, v160, v162
    v_add_f32 v157, v157, v159
    v_add_f32 v161, v161, v163
    v_max3_f32 v234, v156, v157, v164
    v_max3_f32 v242, v160, v161, v165
    v_mov_b32 v235, v234
    v_mov_b32 v243, v242
    s_nop 0
    v_permlane16_swap_b32 v234, v235
    v_permlane16_swap_b32 v242, v243
    buffer_load_dwordx4 v5, s[24:27], s33 offen offset:1024 lds
    v_max_f32 v234, v234, v235
    v_max_f32 v242, v242, v243
    v_mov_b32 v235, v234
    v_mov_b32 v243, v242
    s_nop 0
    v_permlane32_swap_b32 v234, v235
    v_permlane32_swap_b32 v242, v243
    v_max_f32 v234, v234, v235
    v_max_f32 v242, v242, v243
    v_mul_f32 v234, s55, v234
    v_mul_f32 v242, s55, v242
    v_fma_f32 v232, v164, s55, -v234
    buffer_load_dwordx4 v5, s[24:27], s33 offen offset:2048 lds
    v_fma_f32 v240, v165, s55, -v242
    v_fma_f32 v156, v156, s55, -v234
    v_fma_f32 v160, v160, s55, -v242
    v_fma_f32 v157, v157, s55, -v234
    v_fma_f32 v161, v161, s55, -v242
    v_exp_f32 v232, v232
    v_exp_f32 v240, v240
    v_exp_f32 v156, v156
    v_exp_f32 v160, v160
    v_exp_f32 v157, v157
    v_exp_f32 v161, v161
    buffer_load_dwordx4 v5, s[24:27], s33 offen offset:3072 lds
    v_fma_f32 v234, v232, v166, v156
    v_fma_f32 v242, v240, v167, v160
    v_add_f32 v234, v234, v157
    v_add_f32 v242, v242, v161
    v_mov_b32 v235, v234
    v_mov_b32 v243, v242
    s_nop 0
    v_permlane16_swap_b32 v234, v235
    v_permlane16_swap_b32 v242, v243
    v_add_f32 v234, v234, v235
    v_add_f32 v242, v242, v243
    v_mov_b32 v235, v234
    s_add_u32 m0, s56, 20480
    s_nop 0
    buffer_load_dwordx4 v6, s[24:27], s33 offen offset:0 lds
    v_mov_b32 v243, v242
    v_permlane32_swap_b32 v234, v235
    s_nop 0
    v_permlane32_swap_b32 v242, v243
    v_add_f32 v234, v234, v235
    v_add_f32 v242, v242, v243
    v_rcp_f32 v234, v234
    v_rcp_f32 v242, v242
    v_mul_f32 v232, v232, v234
    v_mul_f32 v240, v240, v242
    v_mul_f32 v156, v156, v234
    v_mul_f32 v160, v160, v242
    buffer_load_dwordx4 v6, s[24:27], s33 offen offset:1024 lds
    v_mul_f32 v157, v157, v234
    v_mul_f32 v161, v161, v242
    v_cvt_pk_bf16_f32 v238, v156, v157
    v_cvt_pk_bf16_f32 v246, v160, v161
    v_mov_b32 v239, v238
    v_mov_b32 v247, v246
    s_nop 0
    v_permlane32_swap_b32 v238, v239
    v_permlane32_swap_b32 v246, v247
    s_waitcnt lgkmcnt(2)
    v_bitop3_b32 v144, v144, v145, s29 bitop3:0x7e
    s_waitcnt lgkmcnt(0)
    v_bitop3_b32 v146, v146, v147, s29 bitop3:0x7e
    v_bitop3_b32 v144, v144, v146, 1 bitop3:0xa8
    buffer_load_dwordx4 v6, s[24:27], s33 offen offset:2048 lds
    v_cmp_ne_u32 vcc, 0, v144
    s_nop 0
    s_cbranch_vccnz Loakr_31067
    v_pk_mul_f32 v[168:169], v[168:169], v[232:233] op_sel_hi:[1,0]
    v_pk_mul_f32 v[170:171], v[170:171], v[232:233] op_sel_hi:[1,0]
    v_pk_mul_f32 v[172:173], v[172:173], v[232:233] op_sel_hi:[1,0]
    v_pk_mul_f32 v[174:175], v[174:175], v[232:233] op_sel_hi:[1,0]
    v_pk_mul_f32 v[176:177], v[176:177], v[232:233] op_sel_hi:[1,0]
    v_pk_mul_f32 v[178:179], v[178:179], v[232:233] op_sel_hi:[1,0]
    v_pk_mul_f32 v[180:181], v[180:181], v[232:233] op_sel_hi:[1,0]
    v_pk_mul_f32 v[182:183], v[182:183], v[232:233] op_sel_hi:[1,0]
    v_pk_mul_f32 v[184:185], v[184:185], v[232:233] op_sel_hi:[1,0]
    buffer_load_dwordx4 v6, s[24:27], s33 offen offset:3072 lds
    v_pk_mul_f32 v[186:187], v[186:187], v[232:233] op_sel_hi:[1,0]
    v_pk_mul_f32 v[188:189], v[188:189], v[232:233] op_sel_hi:[1,0]
    v_pk_mul_f32 v[190:191], v[190:191], v[232:233] op_sel_hi:[1,0]
    v_pk_mul_f32 v[192:193], v[192:193], v[232:233] op_sel_hi:[1,0]
    v_pk_mul_f32 v[194:195], v[194:195], v[232:233] op_sel_hi:[1,0]
    v_pk_mul_f32 v[196:197], v[196:197], v[232:233] op_sel_hi:[1,0]
    v_pk_mul_f32 v[198:199], v[198:199], v[232:233] op_sel_hi:[1,0]
    v_pk_mul_f32 v[200:201], v[200:201], v[240:241] op_sel_hi:[1,0]
    v_pk_mul_f32 v[202:203], v[202:203], v[240:241] op_sel_hi:[1,0]
    v_pk_mul_f32 v[204:205], v[204:205], v[240:241] op_sel_hi:[1,0]
    v_pk_mul_f32 v[206:207], v[206:207], v[240:241] op_sel_hi:[1,0]
    buffer_load_dwordx4 v[48:51], v5, s[24:27], s34 offen offset:0
    v_pk_mul_f32 v[208:209], v[208:209], v[240:241] op_sel_hi:[1,0]
    v_pk_mul_f32 v[210:211], v[210:211], v[240:241] op_sel_hi:[1,0]
    v_pk_mul_f32 v[212:213], v[212:213], v[240:241] op_sel_hi:[1,0]
    v_pk_mul_f32 v[214:215], v[214:215], v[240:241] op_sel_hi:[1,0]
    v_pk_mul_f32 v[216:217], v[216:217], v[240:241] op_sel_hi:[1,0]
    v_pk_mul_f32 v[218:219], v[218:219], v[240:241] op_sel_hi:[1,0]
    v_pk_mul_f32 v[220:221], v[220:221], v[240:241] op_sel_hi:[1,0]
    v_pk_mul_f32 v[222:223], v[222:223], v[240:241] op_sel_hi:[1,0]
    v_pk_mul_f32 v[224:225], v[224:225], v[240:241] op_sel_hi:[1,0]
    v_pk_mul_f32 v[226:227], v[226:227], v[240:241] op_sel_hi:[1,0]
    v_pk_mul_f32 v[228:229], v[228:229], v[240:241] op_sel_hi:[1,0]
    buffer_load_dwordx4 v[52:55], v5, s[24:27], s34 offen offset:1024
    v_pk_mul_f32 v[230:231], v[230:231], v[240:241] op_sel_hi:[1,0]
Loav_31065:
    s_waitcnt vmcnt(12)
    v_bitop3_b32 v144, v128, v132, s29 bitop3:0x7e
    s_waitcnt vmcnt(10)
    v_bitop3_b32 v146, v136, v140, s29 bitop3:0x7e
    v_bitop3_b32 v144, v144, v146, 1 bitop3:0xa8
    v_cmp_ne_u32 vcc, 0, v144
    s_nop 0
    s_cbranch_vccnz Loavr_31066
    s_cmp_le_u32 s32, 27
    s_cselect_b64 exec, 3, 0
    buffer_store_dword v4, v0, s[8:11], s37 offen sc1
    s_mov_b64 exec, -1
    buffer_load_dwordx4 v[56:59], v5, s[24:27], s34 offen offset:2048
    s_add_u32 s36, s36, 524288
    s_bitset0_b32 s36, 21
    s_add_u32 s61, s32, 1
    s_bfe_u32 s29, s61, 0x10002
    v_mfma_f32_16x16x16_bf16 v[168:171], v[128:129], v[238:239], v[168:171]
    v_mfma_f32_16x16x16_bf16 v[172:175], v[130:131], v[238:239], v[172:175]
    v_mfma_f32_16x16x16_bf16 v[176:179], v[132:133], v[238:239], v[176:179]
    v_mfma_f32_16x16x16_bf16 v[180:183], v[134:135], v[238:239], v[180:183]
    s_nop 5
    v_cvt_pk_bf16_f32 v112, v168, v172
    v_cvt_pk_bf16_f32 v113, v169, v173
    v_cvt_pk_bf16_f32 v114, v170, v174
    buffer_load_dwordx4 v[60:63], v5, s[24:27], s34 offen offset:3072
    v_mfma_f32_16x16x16_bf16 v[184:187], v[136:137], v[238:239], v[184:187]
    v_cvt_pk_bf16_f32 v115, v171, v175
    ds_write_b128 v8, v[112:115] offset:0
    v_mfma_f32_16x16x16_bf16 v[188:191], v[138:139], v[238:239], v[188:191]
    v_cvt_pk_bf16_f32 v116, v176, v180
    v_cvt_pk_bf16_f32 v117, v177, v181
    v_cvt_pk_bf16_f32 v118, v178, v182
    v_mfma_f32_16x16x16_bf16 v[192:195], v[140:141], v[238:239], v[192:195]
    v_cvt_pk_bf16_f32 v119, v179, v183
    ds_write_b128 v8, v[116:119] offset:1024
    v_mfma_f32_16x16x16_bf16 v[196:199], v[142:143], v[238:239], v[196:199]
    s_nop 0
    v_cvt_pk_bf16_f32 v120, v184, v188
    v_cvt_pk_bf16_f32 v121, v185, v189
    v_cvt_pk_bf16_f32 v122, v186, v190
    v_mfma_f32_16x16x16_bf16 v[200:203], v[128:129], v[246:247], v[200:203]
    v_cvt_pk_bf16_f32 v123, v187, v191
    ds_write_b128 v8, v[120:123] offset:2048
    v_mfma_f32_16x16x16_bf16 v[204:207], v[130:131], v[246:247], v[204:207]
    v_cvt_pk_bf16_f32 v124, v192, v196
    v_cvt_pk_bf16_f32 v125, v193, v197
    v_cvt_pk_bf16_f32 v126, v194, v198
    v_mfma_f32_16x16x16_bf16 v[208:211], v[132:133], v[246:247], v[208:211]
    v_cvt_pk_bf16_f32 v127, v195, v199
    ds_write_b128 v8, v[124:127] offset:3072
    v_mfma_f32_16x16x16_bf16 v[212:215], v[134:135], v[246:247], v[212:215]
    s_nop 0
    v_cvt_pk_bf16_f32 v112, v200, v204
    v_cvt_pk_bf16_f32 v113, v201, v205
    v_cvt_pk_bf16_f32 v114, v202, v206
    v_mfma_f32_16x16x16_bf16 v[216:219], v[136:137], v[246:247], v[216:219]
    v_cvt_pk_bf16_f32 v115, v203, v207
    ds_write_b128 v8, v[112:115] offset:8192
    v_mfma_f32_16x16x16_bf16 v[220:223], v[138:139], v[246:247], v[220:223]
    v_cvt_pk_bf16_f32 v116, v208, v212
    v_cvt_pk_bf16_f32 v117, v209, v213
    v_cvt_pk_bf16_f32 v118, v210, v214
    v_mfma_f32_16x16x16_bf16 v[224:227], v[140:141], v[246:247], v[224:227]
    v_cvt_pk_bf16_f32 v119, v211, v215
    ds_write_b128 v8, v[116:119] offset:9216
    v_mfma_f32_16x16x16_bf16 v[228:231], v[142:143], v[246:247], v[228:231]
    s_nop 0
    v_cvt_pk_bf16_f32 v120, v216, v220
    v_cvt_pk_bf16_f32 v121, v217, v221
    v_cvt_pk_bf16_f32 v122, v218, v222
    v_cvt_pk_bf16_f32 v123, v219, v223
    ds_write_b128 v8, v[120:123] offset:10240
    s_nop 1
    v_cvt_pk_bf16_f32 v124, v224, v228
    v_cvt_pk_bf16_f32 v125, v225, v229
    v_cvt_pk_bf16_f32 v126, v226, v230
    v_cvt_pk_bf16_f32 v127, v227, v231
    ds_write_b128 v8, v[124:127] offset:11264
    v_xor_b32 v8, 0x4000, v8
    s_waitcnt lgkmcnt(0)
    s_barrier
    ds_read_b128 v[232:235], v1 offset:0
    ds_read_b128 v[236:239], v1 offset:1024
    ds_read_b128 v[240:243], v1 offset:2048
    ds_read_b128 v[244:247], v1 offset:3072
    ds_read_b128 v[248:251], v1 offset:4096
    ds_read_b128 v[252:255], v1 offset:5120
    s_waitcnt lgkmcnt(5)
    v_mfma_f32_16x16x32_bf16 v[168:171], v[232:235], a[0:3], 0
    buffer_load_dwordx4 v[64:67], v6, s[24:27], s34 offen offset:0
    v_mfma_f32_16x16x32_bf16 v[172:175], v[232:235], a[32:35], 0
    v_mfma_f32_16x16x32_bf16 v[176:179], v[232:235], a[64:67], 0
    v_mfma_f32_16x16x32_bf16 v[180:183], v[232:235], a[96:99], 0
    v_mfma_f32_16x16x32_bf16 v[184:187], v[232:235], a[128:131], 0
    v_mfma_f32_16x16x32_bf16 v[188:191], v[232:235], a[160:163], 0
    buffer_load_dwordx4 v[68:71], v6, s[24:27], s34 offen offset:1024
    v_mfma_f32_16x16x32_bf16 v[192:195], v[232:235], a[192:195], 0
    v_mfma_f32_16x16x32_bf16 v[196:199], v[232:235], a[224:227], 0
    ds_read_b128 v[232:235], v1 offset:6144
    s_waitcnt lgkmcnt(5)
    v_mfma_f32_16x16x32_bf16 v[168:171], v[236:239], a[4:7], v[168:171]
    v_mfma_f32_16x16x32_bf16 v[172:175], v[236:239], a[36:39], v[172:175]
    v_mfma_f32_16x16x32_bf16 v[176:179], v[236:239], a[68:71], v[176:179]
    buffer_load_dwordx4 v[72:75], v6, s[24:27], s34 offen offset:2048
    v_mfma_f32_16x16x32_bf16 v[180:183], v[236:239], a[100:103], v[180:183]
    v_mfma_f32_16x16x32_bf16 v[184:187], v[236:239], a[132:135], v[184:187]
    v_mfma_f32_16x16x32_bf16 v[188:191], v[236:239], a[164:167], v[188:191]
    v_mfma_f32_16x16x32_bf16 v[192:195], v[236:239], a[196:199], v[192:195]
    v_mfma_f32_16x16x32_bf16 v[196:199], v[236:239], a[228:231], v[196:199]
    buffer_load_dwordx4 v[76:79], v6, s[24:27], s34 offen offset:3072
    ds_read_b128 v[236:239], v1 offset:7168
    s_waitcnt lgkmcnt(5)
    v_mfma_f32_16x16x32_bf16 v[168:171], v[240:243], a[8:11], v[168:171]
    v_mfma_f32_16x16x32_bf16 v[172:175], v[240:243], a[40:43], v[172:175]
    v_mfma_f32_16x16x32_bf16 v[176:179], v[240:243], a[72:75], v[176:179]
    v_mfma_f32_16x16x32_bf16 v[180:183], v[240:243], a[104:107], v[180:183]
    v_mfma_f32_16x16x32_bf16 v[184:187], v[240:243], a[136:139], v[184:187]
    buffer_load_dwordx4 v[80:83], v5, s[24:27], s35 offen offset:0
    v_mfma_f32_16x16x32_bf16 v[188:191], v[240:243], a[168:171], v[188:191]
    v_mfma_f32_16x16x32_bf16 v[192:195], v[240:243], a[200:203], v[192:195]
    v_mfma_f32_16x16x32_bf16 v[196:199], v[240:243], a[232:235], v[196:199]
    ds_read_b128 v[240:243], v1 offset:8192
    s_waitcnt lgkmcnt(5)
    v_mfma_f32_16x16x32_bf16 v[168:171], v[244:247], a[12:15], v[168:171]
    v_mfma_f32_16x16x32_bf16 v[172:175], v[244:247], a[44:47], v[172:175]
    buffer_load_dwordx4 v[84:87], v5, s[24:27], s35 offen offset:1024
    v_mfma_f32_16x16x32_bf16 v[176:179], v[244:247], a[76:79], v[176:179]
    v_mfma_f32_16x16x32_bf16 v[180:183], v[244:247], a[108:111], v[180:183]
    v_mfma_f32_16x16x32_bf16 v[184:187], v[244:247], a[140:143], v[184:187]
    v_mfma_f32_16x16x32_bf16 v[188:191], v[244:247], a[172:175], v[188:191]
    v_mfma_f32_16x16x32_bf16 v[192:195], v[244:247], a[204:207], v[192:195]
    buffer_load_dwordx4 v[88:91], v5, s[24:27], s35 offen offset:2048
    v_mfma_f32_16x16x32_bf16 v[196:199], v[244:247], a[236:239], v[196:199]
    ds_read_b128 v[244:247], v1 offset:9216
    s_waitcnt lgkmcnt(5)
    v_mfma_f32_16x16x32_bf16 v[168:171], v[248:251], a[16:19], v[168:171]
    v_mfma_f32_16x16x32_bf16 v[172:175], v[248:251], a[48:51], v[172:175]
    v_mfma_f32_16x16x32_bf16 v[176:179], v[248:251], a[80:83], v[176:179]
    v_mfma_f32_16x16x32_bf16 v[180:183], v[248:251], a[112:115], v[180:183]
    buffer_load_dwordx4 v[92:95], v5, s[24:27], s35 offen offset:3072
    v_mfma_f32_16x16x32_bf16 v[184:187], v[248:251], a[144:147], v[184:187]
    v_mfma_f32_16x16x32_bf16 v[188:191], v[248:251], a[176:179], v[188:191]
    v_mfma_f32_16x16x32_bf16 v[192:195], v[248:251], a[208:211], v[192:195]
    v_mfma_f32_16x16x32_bf16 v[196:199], v[248:251], a[240:243], v[196:199]
    ds_read_b128 v[248:251], v1 offset:10240
    s_waitcnt lgkmcnt(5)
    v_mfma_f32_16x16x32_bf16 v[168:171], v[252:255], a[20:23], v[168:171]
    buffer_load_dwordx4 v[96:99], v6, s[24:27], s35 offen offset:0
    v_mfma_f32_16x16x32_bf16 v[172:175], v[252:255], a[52:55], v[172:175]
    v_mfma_f32_16x16x32_bf16 v[176:179], v[252:255], a[84:87], v[176:179]
    v_mfma_f32_16x16x32_bf16 v[180:183], v[252:255], a[116:119], v[180:183]
    v_mfma_f32_16x16x32_bf16 v[184:187], v[252:255], a[148:151], v[184:187]
    v_mfma_f32_16x16x32_bf16 v[188:191], v[252:255], a[180:183], v[188:191]
    buffer_load_dwordx4 v[100:103], v6, s[24:27], s35 offen offset:1024
    v_mfma_f32_16x16x32_bf16 v[192:195], v[252:255], a[212:215], v[192:195]
    v_mfma_f32_16x16x32_bf16 v[196:199], v[252:255], a[244:247], v[196:199]
    ds_read_b128 v[252:255], v1 offset:11264
    s_waitcnt lgkmcnt(5)
    v_mfma_f32_16x16x32_bf16 v[168:171], v[232:235], a[24:27], v[168:171]
    v_mfma_f32_16x16x32_bf16 v[172:175], v[232:235], a[56:59], v[172:175]
    v_mfma_f32_16x16x32_bf16 v[176:179], v[232:235], a[88:91], v[176:179]
    buffer_load_dwordx4 v[104:107], v6, s[24:27], s35 offen offset:2048
    v_mfma_f32_16x16x32_bf16 v[180:183], v[232:235], a[120:123], v[180:183]
    v_mfma_f32_16x16x32_bf16 v[184:187], v[232:235], a[152:155], v[184:187]
    v_mfma_f32_16x16x32_bf16 v[188:191], v[232:235], a[184:187], v[188:191]
    v_mfma_f32_16x16x32_bf16 v[192:195], v[232:235], a[216:219], v[192:195]
    v_mfma_f32_16x16x32_bf16 v[196:199], v[232:235], a[248:251], v[196:199]
    buffer_load_dwordx4 v[108:111], v6, s[24:27], s35 offen offset:3072
    ds_read_b128 v[232:235], v1 offset:12288
    s_waitcnt lgkmcnt(5)
    v_mfma_f32_16x16x32_bf16 v[168:171], v[236:239], a[28:31], v[168:171]
    v_mfma_f32_16x16x32_bf16 v[172:175], v[236:239], a[60:63], v[172:175]
    v_mfma_f32_16x16x32_bf16 v[176:179], v[236:239], a[92:95], v[176:179]
    v_mfma_f32_16x16x32_bf16 v[180:183], v[236:239], a[124:127], v[180:183]
    v_mfma_f32_16x16x32_bf16 v[184:187], v[236:239], a[156:159], v[184:187]
    s_add_u32 s33, s33, s31
    s_add_u32 s34, s34, s31
    s_add_u32 s35, s35, s31
    v_mfma_f32_16x16x32_bf16 v[188:191], v[236:239], a[188:191], v[188:191]
    v_mfma_f32_16x16x32_bf16 v[192:195], v[236:239], a[220:223], v[192:195]
    v_mfma_f32_16x16x32_bf16 v[196:199], v[236:239], a[252:255], v[196:199]
    ds_read_b128 v[236:239], v1 offset:13312
    s_waitcnt lgkmcnt(5)
    v_mfma_f32_16x16x32_bf16 v[200:203], v[240:243], a[0:3], 0
    v_mfma_f32_16x16x32_bf16 v[204:207], v[240:243], a[32:35], 0
    v_mfma_f32_16x16x32_bf16 v[208:211], v[240:243], a[64:67], 0
    v_cvt_pk_bf16_f32 v112, v168, v172
    v_mfma_f32_16x16x32_bf16 v[212:215], v[240:243], a[96:99], 0
    v_cvt_pk_bf16_f32 v113, v176, v180
    v_mfma_f32_16x16x32_bf16 v[216:219], v[240:243], a[128:131], 0
    v_and_or_b32 v112, v112, -2, s58
    v_mfma_f32_16x16x32_bf16 v[220:223], v[240:243], a[160:163], 0
    v_cvt_pk_bf16_f32 v114, v184, v188
    v_mfma_f32_16x16x32_bf16 v[224:227], v[240:243], a[192:195], 0
    v_cvt_pk_bf16_f32 v115, v192, v196
    s_add_u32 s57, s38, 0
    v_mfma_f32_16x16x32_bf16 v[228:231], v[240:243], a[224:227], 0
    buffer_store_dwordx4 v[112:115], v2, s[8:11], s57 offen sc1
    ds_read_b128 v[240:243], v1 offset:14336
    s_waitcnt lgkmcnt(5)
    v_mfma_f32_16x16x32_bf16 v[200:203], v[244:247], a[4:7], v[200:203]
    v_cvt_pk_bf16_f32 v116, v169, v173
    v_mfma_f32_16x16x32_bf16 v[204:207], v[244:247], a[36:39], v[204:207]
    v_cvt_pk_bf16_f32 v117, v177, v181
    v_mfma_f32_16x16x32_bf16 v[208:211], v[244:247], a[68:71], v[208:211]
    v_and_or_b32 v116, v116, -2, s58
    v_mfma_f32_16x16x32_bf16 v[212:215], v[244:247], a[100:103], v[212:215]
    v_cvt_pk_bf16_f32 v118, v185, v189
    v_mfma_f32_16x16x32_bf16 v[216:219], v[244:247], a[132:135], v[216:219]
    v_cvt_pk_bf16_f32 v119, v193, v197
    s_add_u32 s57, s38, 16384
    v_mfma_f32_16x16x32_bf16 v[220:223], v[244:247], a[164:167], v[220:223]
    buffer_store_dwordx4 v[116:119], v2, s[8:11], s57 offen sc1
    v_mfma_f32_16x16x32_bf16 v[224:227], v[244:247], a[196:199], v[224:227]
    v_cvt_pk_bf16_f32 v120, v170, v174
    v_mfma_f32_16x16x32_bf16 v[228:231], v[244:247], a[228:231], v[228:231]
    v_cvt_pk_bf16_f32 v121, v178, v182
    ds_read_b128 v[244:247], v1 offset:15360
    s_waitcnt lgkmcnt(5)
    v_mfma_f32_16x16x32_bf16 v[200:203], v[248:251], a[8:11], v[200:203]
    v_and_or_b32 v120, v120, -2, s58
    v_mfma_f32_16x16x32_bf16 v[204:207], v[248:251], a[40:43], v[204:207]
    v_cvt_pk_bf16_f32 v122, v186, v190
    v_mfma_f32_16x16x32_bf16 v[208:211], v[248:251], a[72:75], v[208:211]
    v_cvt_pk_bf16_f32 v123, v194, v198
    s_add_u32 s57, s38, 32768
    v_mfma_f32_16x16x32_bf16 v[212:215], v[248:251], a[104:107], v[212:215]
    buffer_store_dwordx4 v[120:123], v2, s[8:11], s57 offen sc1
    v_mfma_f32_16x16x32_bf16 v[216:219], v[248:251], a[136:139], v[216:219]
    v_cvt_pk_bf16_f32 v124, v171, v175
    v_mfma_f32_16x16x32_bf16 v[220:223], v[248:251], a[168:171], v[220:223]
    v_cvt_pk_bf16_f32 v125, v179, v183
    v_mfma_f32_16x16x32_bf16 v[224:227], v[248:251], a[200:203], v[224:227]
    v_and_or_b32 v124, v124, -2, s58
    v_mfma_f32_16x16x32_bf16 v[228:231], v[248:251], a[232:235], v[228:231]
    v_cvt_pk_bf16_f32 v126, v187, v191
    s_waitcnt lgkmcnt(4)
    v_mfma_f32_16x16x32_bf16 v[200:203], v[252:255], a[12:15], v[200:203]
    v_cvt_pk_bf16_f32 v127, v195, v199
    s_add_u32 s57, s38, 49152
    v_mfma_f32_16x16x32_bf16 v[204:207], v[252:255], a[44:47], v[204:207]
    buffer_store_dwordx4 v[124:127], v2, s[8:11], s57 offen sc1
    v_mfma_f32_16x16x32_bf16 v[208:211], v[252:255], a[76:79], v[208:211]
    v_mfma_f32_16x16x32_bf16 v[212:215], v[252:255], a[108:111], v[212:215]
    v_mfma_f32_16x16x32_bf16 v[216:219], v[252:255], a[140:143], v[216:219]
    v_mfma_f32_16x16x32_bf16 v[220:223], v[252:255], a[172:175], v[220:223]
    v_mfma_f32_16x16x32_bf16 v[224:227], v[252:255], a[204:207], v[224:227]
    v_mfma_f32_16x16x32_bf16 v[228:231], v[252:255], a[236:239], v[228:231]
    s_waitcnt lgkmcnt(3)
    v_mfma_f32_16x16x32_bf16 v[200:203], v[232:235], a[16:19], v[200:203]
    v_mfma_f32_16x16x32_bf16 v[204:207], v[232:235], a[48:51], v[204:207]
    v_mfma_f32_16x16x32_bf16 v[208:211], v[232:235], a[80:83], v[208:211]
    v_mfma_f32_16x16x32_bf16 v[212:215], v[232:235], a[112:115], v[212:215]
    v_mfma_f32_16x16x32_bf16 v[216:219], v[232:235], a[144:147], v[216:219]
    v_mfma_f32_16x16x32_bf16 v[220:223], v[232:235], a[176:179], v[220:223]
    v_mfma_f32_16x16x32_bf16 v[224:227], v[232:235], a[208:211], v[224:227]
    v_mfma_f32_16x16x32_bf16 v[228:231], v[232:235], a[240:243], v[228:231]
    s_waitcnt lgkmcnt(2)
    v_mfma_f32_16x16x32_bf16 v[200:203], v[236:239], a[20:23], v[200:203]
    v_mfma_f32_16x16x32_bf16 v[204:207], v[236:239], a[52:55], v[204:207]
    v_mfma_f32_16x16x32_bf16 v[208:211], v[236:239], a[84:87], v[208:211]
    v_mfma_f32_16x16x32_bf16 v[212:215], v[236:239], a[116:119], v[212:215]
    v_mfma_f32_16x16x32_bf16 v[216:219], v[236:239], a[148:151], v[216:219]
    v_mfma_f32_16x16x32_bf16 v[220:223], v[236:239], a[180:183], v[220:223]
    v_mfma_f32_16x16x32_bf16 v[224:227], v[236:239], a[212:215], v[224:227]
    v_mfma_f32_16x16x32_bf16 v[228:231], v[236:239], a[244:247], v[228:231]
    s_waitcnt lgkmcnt(1)
    v_mfma_f32_16x16x32_bf16 v[200:203], v[240:243], a[24:27], v[200:203]
    v_mfma_f32_16x16x32_bf16 v[204:207], v[240:243], a[56:59], v[204:207]
    buffer_load_dword v11, v15, s[8:11], s36 offen sc1
    v_mfma_f32_16x16x32_bf16 v[208:211], v[240:243], a[88:91], v[208:211]
    v_mfma_f32_16x16x32_bf16 v[212:215], v[240:243], a[120:123], v[212:215]
    v_mfma_f32_16x16x32_bf16 v[216:219], v[240:243], a[152:155], v[216:219]
    v_mfma_f32_16x16x32_bf16 v[220:223], v[240:243], a[184:187], v[220:223]
    v_mfma_f32_16x16x32_bf16 v[224:227], v[240:243], a[216:219], v[224:227]
    v_mfma_f32_16x16x32_bf16 v[228:231], v[240:243], a[248:251], v[228:231]
    s_waitcnt lgkmcnt(0)
    v_mfma_f32_16x16x32_bf16 v[200:203], v[244:247], a[28:31], v[200:203]
    v_mfma_f32_16x16x32_bf16 v[204:207], v[244:247], a[60:63], v[204:207]
    v_mfma_f32_16x16x32_bf16 v[208:211], v[244:247], a[92:95], v[208:211]
    v_mfma_f32_16x16x32_bf16 v[212:215], v[244:247], a[124:127], v[212:215]
    v_mfma_f32_16x16x32_bf16 v[216:219], v[244:247], a[156:159], v[216:219]
    v_mfma_f32_16x16x32_bf16 v[220:223], v[244:247], a[188:191], v[220:223]
    v_mfma_f32_16x16x32_bf16 v[224:227], v[244:247], a[220:223], v[224:227]
    v_mfma_f32_16x16x32_bf16 v[228:231], v[244:247], a[252:255], v[228:231]
    v_xor_b32 v1, 0x4000, v1
    s_nop 0
    v_cvt_pk_bf16_f32 v128, v200, v204
    s_nop 0
    v_cvt_pk_bf16_f32 v129, v208, v212
    v_and_or_b32 v128, v128, -2, s58
    v_cvt_pk_bf16_f32 v130, v216, v220
    s_nop 0
    v_cvt_pk_bf16_f32 v131, v224, v228
    s_add_u32 s57, s38, 262144
    buffer_store_dwordx4 v[128:131], v2, s[8:11], s57 offen sc1
    v_cvt_pk_bf16_f32 v132, v201, v205
    v_cvt_pk_bf16_f32 v133, v209, v213
    v_and_or_b32 v132, v132, -2, s58
    v_cvt_pk_bf16_f32 v134, v217, v221
    v_cvt_pk_bf16_f32 v135, v225, v229
    s_add_u32 s57, s38, 278528
    buffer_store_dwordx4 v[132:135], v2, s[8:11], s57 offen sc1
    v_cvt_pk_bf16_f32 v136, v202, v206
    v_cvt_pk_bf16_f32 v137, v210, v214
    v_and_or_b32 v136, v136, -2, s58
    v_cvt_pk_bf16_f32 v138, v218, v222
    v_cvt_pk_bf16_f32 v139, v226, v230
    s_add_u32 s57, s38, 294912
    buffer_store_dwordx4 v[136:139], v2, s[8:11], s57 offen sc1
    v_cvt_pk_bf16_f32 v140, v203, v207
    v_cvt_pk_bf16_f32 v141, v211, v215
    v_and_or_b32 v140, v140, -2, s58
    v_cvt_pk_bf16_f32 v142, v219, v223
    v_cvt_pk_bf16_f32 v143, v227, v231
    s_add_u32 s57, s38, 311296
    buffer_store_dwordx4 v[140:143], v2, s[8:11], s57 offen sc1
    s_xor_b32 s38, s38, 1048576
    s_add_u32 s32, s32, 1
    s_bfe_u32 s58, s32, 0x10001
    s_xor_b32 s58, s58, 1
    s_cmp_lt_u32 s32, 32
    s_cbranch_scc1 L_oa_slow
    s_branch L_o_end
Loaw_31053:
    buffer_load_dword v10, v7, s[8:11], s37 offen sc1
    s_sub_u32 s62, s62, 1
    s_cbranch_scc0 Ltok_36053
    s_movk_i32 s61, 20
    s_branch L_abort
Ltok_36053:
    s_waitcnt vmcnt(0)
    v_cmp_ne_u32 vcc, 0, v10
    s_nop 0
    s_and_b32 s61, vcc_lo, s28
    s_cmp_lg_u32 s61, s28
    s_cbranch_scc1 Loaw_31053
    s_mov_b32 s28, 783
    s_add_u32 m0, s56, 16384
    s_nop 0
    buffer_load_dwordx4 v5, s[8:11], s33 offen offset:0 lds
    buffer_load_dwordx4 v5, s[8:11], s33 offen offset:1024 lds
    buffer_load_dwordx4 v5, s[8:11], s33 offen offset:2048 lds
    buffer_load_dwordx4 v5, s[8:11], s33 offen offset:3072 lds
    s_add_u32 m0, s56, 20480
    s_nop 0
    buffer_load_dwordx4 v6, s[8:11], s33 offen offset:0 lds
    buffer_load_dwordx4 v6, s[8:11], s33 offen offset:1024 lds
    buffer_load_dwordx4 v6, s[8:11], s33 offen offset:2048 lds
    buffer_load_dwordx4 v6, s[8:11], s33 offen offset:3072 lds
    buffer_load_dwordx4 v[48:51], v5, s[8:11], s34 offen offset:0
    buffer_load_dwordx4 v[52:55], v5, s[8:11], s34 offen offset:1024
    buffer_load_dwordx4 v[56:59], v5, s[8:11], s34 offen offset:2048
    buffer_load_dwordx4 v[60:63], v5, s[8:11], s34 offen offset:3072
    buffer_load_dwordx4 v[64:67], v6, s[8:11], s34 offen offset:0
    buffer_load_dwordx4 v[68:71], v6, s[8:11], s34 offen offset:1024
    buffer_load_dwordx4 v[72:75], v6, s[8:11], s34 offen offset:2048
    buffer_load_dwordx4 v[76:79], v6, s[8:11], s34 offen offset:3072
    buffer_load_dwordx4 v[80:83], v5, s[8:11], s35 offen offset:0
    buffer_load_dwordx4 v[84:87], v5, s[8:11], s35 offen offset:1024
    buffer_load_dwordx4 v[88:91], v5, s[8:11], s35 offen offset:2048
    buffer_load_dwordx4 v[92:95], v5, s[8:11], s35 offen offset:3072
    buffer_load_dwordx4 v[96:99], v6, s[8:11], s35 offen offset:0
    buffer_load_dwordx4 v[100:103], v6, s[8:11], s35 offen offset:1024
    buffer_load_dwordx4 v[104:107], v6, s[8:11], s35 offen offset:2048
    buffer_load_dwordx4 v[108:111], v6, s[8:11], s35 offen offset:3072
    s_add_u32 s33, s33, 524288
    s_add_u32 s34, s34, 524288
    s_add_u32 s35, s35, 524288
    s_branch Loag_31054
Loaoe_31062:
    s_waitcnt vmcnt(11)
    v_cmp_ne_u32 s[44:45], 0, v10
    s_add_u32 s37, s37, 16384
    s_lshr_b32 s61, s44, 16
    s_and_b32 s61, s61, 783
    s_cmp_ge_u32 s32, 31
    s_cselect_b32 s61, 0, s61
    s_cmp_eq_u32 s61, 783
    s_cselect_b32 s42, 1, 0
    s_cselect_b32 s26, 268435456, 0
    s_cselect_b32 s31, 524288, 0
    s_waitcnt vmcnt(3)
    ds_read_b64_tr_b16 v[112:113], v9 offset:0
    ds_read_b64_tr_b16 v[114:115], v9 offset:32
    ds_read_b64_tr_b16 v[116:117], v9 offset:2048
    ds_read_b64_tr_b16 v[118:119], v9 offset:2080
    ds_read_b64_tr_b16 v[120:121], v9 offset:4096
    ds_read_b64_tr_b16 v[122:123], v9 offset:4128
    ds_read_b64_tr_b16 v[124:125], v9 offset:6144
    ds_read_b64_tr_b16 v[126:127], v9 offset:6176
    s_branch Loajn_31063
Loan_31059:
    buffer_load_dword v10, v7, s[8:11], s37 offen sc1
    s_waitcnt vmcnt(0)
    v_cmp_ne_u32 vcc, 0, v10
    s_nop 0
    s_and_b32 s61, vcc_lo, 783
    s_cmp_ge_u32 s32, 31
    s_cselect_b32 s61, 0, s61
    s_cmp_eq_u32 s61, 783
    s_cselect_b32 s42, 1, 0
    s_branch Loaj_31060
Loakr_31067:
    s_mov_b32 m0, s56
    s_nop 0
    buffer_load_dwordx4 v5, s[8:11], s36 offen sc1 lds
    buffer_load_dwordx4 v5, s[8:11], s36 offen offset:2048 sc1 lds
    s_add_u32 m0, s56, 4096
    s_nop 0
    buffer_load_dwordx4 v6, s[8:11], s36 offen sc1 lds
    buffer_load_dwordx4 v6, s[8:11], s36 offen offset:2048 sc1 lds
    s_sub_u32 s62, s62, 1
    s_cbranch_scc0 Ltok_36054
    s_movk_i32 s61, 25
    s_branch L_abort
Ltok_36054:
    s_branch Loar_31061
Loavr_31066:
    buffer_load_dwordx4 v[128:131], v5, s[8:11], s36 offen offset:1024 sc1
    buffer_load_dwordx4 v[132:135], v5, s[8:11], s36 offen offset:3072 sc1
    buffer_load_dwordx4 v[136:139], v6, s[8:11], s36 offen offset:1024 sc1
    buffer_load_dwordx4 v[140:143], v6, s[8:11], s36 offen offset:3072 sc1
    s_sub_u32 s62, s62, 1
    s_cbranch_scc0 Ltok_36055
    s_movk_i32 s61, 26
    s_branch L_abort
Ltok_36055:
    s_waitcnt vmcnt(0)
    s_branch Loav_31065
L_ob_fast:
    s_barrier
    ds_read_b128 v[232:235], v1 offset:0
    ds_read_b128 v[236:239], v1 offset:1024
    ds_read_b128 v[240:243], v1 offset:2048
    ds_read_b128 v[244:247], v1 offset:3072
    ds_read_b128 v[248:251], v1 offset:4096
    ds_read_b128 v[252:255], v1 offset:5120
    s_waitcnt lgkmcnt(5)
    v_mfma_f32_16x16x32_bf16 v[168:171], v[232:235], a[0:3], 0
    buffer_load_dwordx4 v[80:83], v8, s[8:11], s39 offen
    v_mfma_f32_16x16x32_bf16 v[172:175], v[232:235], a[32:35], 0
    v_mfma_f32_16x16x32_bf16 v[176:179], v[232:235], a[64:67], 0
    v_mfma_f32_16x16x32_bf16 v[180:183], v[232:235], a[96:99], 0
    v_mfma_f32_16x16x32_bf16 v[184:187], v[232:235], a[128:131], 0
    v_mfma_f32_16x16x32_bf16 v[188:191], v[232:235], a[160:163], 0
    s_add_u32 s39, s39, 65536
    v_mfma_f32_16x16x32_bf16 v[192:195], v[232:235], a[192:195], 0
    v_mfma_f32_16x16x32_bf16 v[196:199], v[232:235], a[224:227], 0
    ds_read_b128 v[232:235], v1 offset:6144
    s_waitcnt lgkmcnt(5)
    v_mfma_f32_16x16x32_bf16 v[168:171], v[236:239], a[4:7], v[168:171]
    v_mfma_f32_16x16x32_bf16 v[172:175], v[236:239], a[36:39], v[172:175]
    v_mfma_f32_16x16x32_bf16 v[176:179], v[236:239], a[68:71], v[176:179]
    v_mfma_f32_16x16x32_bf16 v[180:183], v[236:239], a[100:103], v[180:183]
    v_mfma_f32_16x16x32_bf16 v[184:187], v[236:239], a[132:135], v[184:187]
    v_mfma_f32_16x16x32_bf16 v[188:191], v[236:239], a[164:167], v[188:191]
    v_mfma_f32_16x16x32_bf16 v[192:195], v[236:239], a[196:199], v[192:195]
    v_mfma_f32_16x16x32_bf16 v[196:199], v[236:239], a[228:231], v[196:199]
    ds_read_b128 v[236:239], v1 offset:7168
    s_waitcnt lgkmcnt(5)
    v_mfma_f32_16x16x32_bf16 v[168:171], v[240:243], a[8:11], v[168:171]
    v_mfma_f32_16x16x32_bf16 v[172:175], v[240:243], a[40:43], v[172:175]
    v_mfma_f32_16x16x32_bf16 v[176:179], v[240:243], a[72:75], v[176:179]
    v_mfma_f32_16x16x32_bf16 v[180:183], v[240:243], a[104:107], v[180:183]
    v_mfma_f32_16x16x32_bf16 v[184:187], v[240:243], a[136:139], v[184:187]
    v_mfma_f32_16x16x32_bf16 v[188:191], v[240:243], a[168:171], v[188:191]
    v_mfma_f32_16x16x32_bf16 v[192:195], v[240:243], a[200:203], v[192:195]
    v_mfma_f32_16x16x32_bf16 v[196:199], v[240:243], a[232:235], v[196:199]
    ds_read_b128 v[240:243], v1 offset:8192
    s_waitcnt lgkmcnt(5)
    v_mfma_f32_16x16x32_bf16 v[168:171], v[244:247], a[12:15], v[168:171]
    v_mfma_f32_16x16x32_bf16 v[172:175], v[244:247], a[44:47], v[172:175]
    v_mfma_f32_16x16x32_bf16 v[176:179], v[244:247], a[76:79], v[176:179]
    v_mfma_f32_16x16x32_bf16 v[180:183], v[244:247], a[108:111], v[180:183]
    v_mfma_f32_16x16x32_bf16 v[184:187], v[244:247], a[140:143], v[184:187]
    v_mfma_f32_16x16x32_bf16 v[188:191], v[244:247], a[172:175], v[188:191]
    v_mfma_f32_16x16x32_bf16 v[192:195], v[244:247], a[204:207], v[192:195]
    v_mfma_f32_16x16x32_bf16 v[196:199], v[244:247], a[236:239], v[196:199]
    ds_read_b128 v[244:247], v1 offset:9216
    s_waitcnt lgkmcnt(5)
    v_mfma_f32_16x16x32_bf16 v[168:171], v[248:251], a[16:19], v[168:171]
    v_mfma_f32_16x16x32_bf16 v[172:175], v[248:251], a[48:51], v[172:175]
    v_mfma_f32_16x16x32_bf16 v[176:179], v[248:251], a[80:83], v[176:179]
    v_mfma_f32_16x16x32_bf16 v[180:183], v[248:251], a[112:115], v[180:183]
    v_mfma_f32_16x16x32_bf16 v[184:187], v[248:251], a[144:147], v[184:187]
    v_mfma_f32_16x16x32_bf16 v[188:191], v[248:251], a[176:179], v[188:191]
    v_mfma_f32_16x16x32_bf16 v[192:195], v[248:251], a[208:211], v[192:195]
    v_mfma_f32_16x16x32_bf16 v[196:199], v[248:251], a[240:243], v[196:199]
    ds_read_b128 v[248:251], v1 offset:10240
    s_waitcnt lgkmcnt(5)
    v_mfma_f32_16x16x32_bf16 v[168:171], v[252:255], a[20:23], v[168:171]
    v_mfma_f32_16x16x32_bf16 v[172:175], v[252:255], a[52:55], v[172:175]
    v_mfma_f32_16x16x32_bf16 v[176:179], v[252:255], a[84:87], v[176:179]
    v_mfma_f32_16x16x32_bf16 v[180:183], v[252:255], a[116:119], v[180:183]
    v_mfma_f32_16x16x32_bf16 v[184:187], v[252:255], a[148:151], v[184:187]
    v_mfma_f32_16x16x32_bf16 v[188:191], v[252:255], a[180:183], v[188:191]
    v_mfma_f32_16x16x32_bf16 v[192:195], v[252:255], a[212:215], v[192:195]
    v_mfma_f32_16x16x32_bf16 v[196:199], v[252:255], a[244:247], v[196:199]
    ds_read_b128 v[252:255], v1 offset:11264
    s_waitcnt lgkmcnt(5)
    v_mfma_f32_16x16x32_bf16 v[168:171], v[232:235], a[24:27], v[168:171]
    v_mfma_f32_16x16x32_bf16 v[172:175], v[232:235], a[56:59], v[172:175]
    v_mfma_f32_16x16x32_bf16 v[176:179], v[232:235], a[88:91], v[176:179]
    v_mfma_f32_16x16x32_bf16 v[180:183], v[232:235], a[120:123], v[180:183]
    v_mfma_f32_16x16x32_bf16 v[184:187], v[232:235], a[152:155], v[184:187]
    v_mfma_f32_16x16x32_bf16 v[188:191], v[232:235], a[184:187], v[188:191]
    v_mfma_f32_16x16x32_bf16 v[192:195], v[232:235], a[216:219], v[192:195]
    v_mfma_f32_16x16x32_bf16 v[196:199], v[232:235], a[248:251], v[196:199]
    ds_read_b128 v[232:235], v1 offset:12288
    s_waitcnt lgkmcnt(5)
    v_mfma_f32_16x16x32_bf16 v[168:171], v[236:239], a[28:31], v[168:171]
    v_mfma_f32_16x16x32_bf16 v[172:175], v[236:239], a[60:63], v[172:175]
    v_mfma_f32_16x16x32_bf16 v[176:179], v[236:239], a[92:95], v[176:179]
    v_mfma_f32_16x16x32_bf16 v[180:183], v[236:239], a[124:127], v[180:183]
    v_mfma_f32_16x16x32_bf16 v[184:187], v[236:239], a[156:159], v[184:187]
    v_mfma_f32_16x16x32_bf16 v[188:191], v[236:239], a[188:191], v[188:191]
    v_mfma_f32_16x16x32_bf16 v[192:195], v[236:239], a[220:223], v[192:195]
    v_mfma_f32_16x16x32_bf16 v[196:199], v[236:239], a[252:255], v[196:199]
    ds_read_b128 v[236:239], v1 offset:13312
    s_waitcnt lgkmcnt(5)
    v_mfma_f32_16x16x32_bf16 v[200:203], v[240:243], a[0:3], 0
    v_mfma_f32_16x16x32_bf16 v[204:207], v[240:243], a[32:35], 0
    v_mfma_f32_16x16x32_bf16 v[208:211], v[240:243], a[64:67], 0
    v_cvt_pk_bf16_f32 v112, v168, v172
    v_mfma_f32_16x16x32_bf16 v[212:215], v[240:243], a[96:99], 0
    v_cvt_pk_bf16_f32 v113, v176, v180
    v_mfma_f32_16x16x32_bf16 v[216:219], v[240:243], a[128:131], 0
    v_and_or_b32 v112, v112, -2, s58
    v_mfma_f32_16x16x32_bf16 v[220:223], v[240:243], a[160:163], 0
    v_cvt_pk_bf16_f32 v114, v184, v188
    v_mfma_f32_16x16x32_bf16 v[224:227], v[240:243], a[192:195], 0
    v_cvt_pk_bf16_f32 v115, v192, v196
    s_add_u32 s57, s38, 0
    v_mfma_f32_16x16x32_bf16 v[228:231], v[240:243], a[224:227], 0
    buffer_store_dwordx4 v[112:115], v2, s[8:11], s57 offen
    ds_read_b128 v[240:243], v1 offset:14336
    s_waitcnt lgkmcnt(5)
    v_mfma_f32_16x16x32_bf16 v[200:203], v[244:247], a[4:7], v[200:203]
    v_cvt_pk_bf16_f32 v116, v169, v173
    v_mfma_f32_16x16x32_bf16 v[204:207], v[244:247], a[36:39], v[204:207]
    v_cvt_pk_bf16_f32 v117, v177, v181
    v_mfma_f32_16x16x32_bf16 v[208:211], v[244:247], a[68:71], v[208:211]
    v_and_or_b32 v116, v116, -2, s58
    v_mfma_f32_16x16x32_bf16 v[212:215], v[244:247], a[100:103], v[212:215]
    v_cvt_pk_bf16_f32 v118, v185, v189
    v_mfma_f32_16x16x32_bf16 v[216:219], v[244:247], a[132:135], v[216:219]
    v_cvt_pk_bf16_f32 v119, v193, v197
    s_add_u32 s57, s38, 16384
    v_mfma_f32_16x16x32_bf16 v[220:223], v[244:247], a[164:167], v[220:223]
    buffer_store_dwordx4 v[116:119], v2, s[8:11], s57 offen
    v_mfma_f32_16x16x32_bf16 v[224:227], v[244:247], a[196:199], v[224:227]
    v_cvt_pk_bf16_f32 v120, v170, v174
    v_mfma_f32_16x16x32_bf16 v[228:231], v[244:247], a[228:231], v[228:231]
    v_cvt_pk_bf16_f32 v121, v178, v182
    ds_read_b128 v[244:247], v1 offset:15360
    s_waitcnt lgkmcnt(5)
    v_mfma_f32_16x16x32_bf16 v[200:203], v[248:251], a[8:11], v[200:203]
    v_and_or_b32 v120, v120, -2, s58
    v_mfma_f32_16x16x32_bf16 v[204:207], v[248:251], a[40:43], v[204:207]
    v_cvt_pk_bf16_f32 v122, v186, v190
    v_mfma_f32_16x16x32_bf16 v[208:211], v[248:251], a[72:75], v[208:211]
    v_cvt_pk_bf16_f32 v123, v194, v198
    s_add_u32 s57, s38, 32768
    v_mfma_f32_16x16x32_bf16 v[212:215], v[248:251], a[104:107], v[212:215]
    buffer_store_dwordx4 v[120:123], v2, s[8:11], s57 offen
    v_mfma_f32_16x16x32_bf16 v[216:219], v[248:251], a[136:139], v[216:219]
    v_cvt_pk_bf16_f32 v124, v171, v175
    v_mfma_f32_16x16x32_bf16 v[220:223], v[248:251], a[168:171], v[220:223]
    v_cvt_pk_bf16_f32 v125, v179, v183
    v_mfma_f32_16x16x32_bf16 v[224:227], v[248:251], a[200:203], v[224:227]
    v_and_or_b32 v124, v124, -2, s58
    v_mfma_f32_16x16x32_bf16 v[228:231], v[248:251], a[232:235], v[228:231]
    v_cvt_pk_bf16_f32 v126, v187, v191
    s_waitcnt lgkmcnt(4)
    v_mfma_f32_16x16x32_bf16 v[200:203], v[252:255], a[12:15], v[200:203]
    v_cvt_pk_bf16_f32 v127, v195, v199
    s_add_u32 s57, s38, 49152
    v_mfma_f32_16x16x32_bf16 v[204:207], v[252:255], a[44:47], v[204:207]
    buffer_store_dwordx4 v[124:127], v2, s[8:11], s57 offen
    v_mfma_f32_16x16x32_bf16 v[208:211], v[252:255], a[76:79], v[208:211]
    v_mfma_f32_16x16x32_bf16 v[212:215], v[252:255], a[108:111], v[212:215]
    v_mfma_f32_16x16x32_bf16 v[216:219], v[252:255], a[140:143], v[216:219]
    v_mfma_f32_16x16x32_bf16 v[220:223], v[252:255], a[172:175], v[220:223]
    v_mfma_f32_16x16x32_bf16 v[224:227], v[252:255], a[204:207], v[224:227]
    v_mfma_f32_16x16x32_bf16 v[228:231], v[252:255], a[236:239], v[228:231]
    s_waitcnt lgkmcnt(3)
    v_mfma_f32_16x16x32_bf16 v[200:203], v[232:235], a[16:19], v[200:203]
    v_mfma_f32_16x16x32_bf16 v[204:207], v[232:235], a[48:51], v[204:207]
    v_mfma_f32_16x16x32_bf16 v[208:211], v[232:235], a[80:83], v[208:211]
    v_mfma_f32_16x16x32_bf16 v[212:215], v[232:235], a[112:115], v[212:215]
    v_mfma_f32_16x16x32_bf16 v[216:219], v[232:235], a[144:147], v[216:219]
    v_mfma_f32_16x16x32_bf16 v[220:223], v[232:235], a[176:179], v[220:223]
    v_mfma_f32_16x16x32_bf16 v[224:227], v[232:235], a[208:211], v[224:227]
    v_mfma_f32_16x16x32_bf16 v[228:231], v[232:235], a[240:243], v[228:231]
    s_waitcnt lgkmcnt(2)
    v_mfma_f32_16x16x32_bf16 v[200:203], v[236:239], a[20:23], v[200:203]
    v_mfma_f32_16x16x32_bf16 v[204:207], v[236:239], a[52:55], v[204:207]
    v_mfma_f32_16x16x32_bf16 v[208:211], v[236:239], a[84:87], v[208:211]
    v_mfma_f32_16x16x32_bf16 v[212:215], v[236:239], a[116:119], v[212:215]
    v_mfma_f32_16x16x32_bf16 v[216:219], v[236:239], a[148:151], v[216:219]
    v_mfma_f32_16x16x32_bf16 v[220:223], v[236:239], a[180:183], v[220:223]
    v_mfma_f32_16x16x32_bf16 v[224:227], v[236:239], a[212:215], v[224:227]
    v_mfma_f32_16x16x32_bf16 v[228:231], v[236:239], a[244:247], v[228:231]
    s_waitcnt lgkmcnt(1)
    v_mfma_f32_16x16x32_bf16 v[200:203], v[240:243], a[24:27], v[200:203]
    v_mfma_f32_16x16x32_bf16 v[204:207], v[240:243], a[56:59], v[204:207]
    v_mfma_f32_16x16x32_bf16 v[208:211], v[240:243], a[88:91], v[208:211]
    v_mfma_f32_16x16x32_bf16 v[212:215], v[240:243], a[120:123], v[212:215]
    v_mfma_f32_16x16x32_bf16 v[216:219], v[240:243], a[152:155], v[216:219]
    v_mfma_f32_16x16x32_bf16 v[220:223], v[240:243], a[184:187], v[220:223]
    v_mfma_f32_16x16x32_bf16 v[224:227], v[240:243], a[216:219], v[224:227]
    v_mfma_f32_16x16x32_bf16 v[228:231], v[240:243], a[248:251], v[228:231]
    s_waitcnt lgkmcnt(0)
    v_mfma_f32_16x16x32_bf16 v[200:203], v[244:247], a[28:31], v[200:203]
    v_mfma_f32_16x16x32_bf16 v[204:207], v[244:247], a[60:63], v[204:207]
    v_mfma_f32_16x16x32_bf16 v[208:211], v[244:247], a[92:95], v[208:211]
    v_mfma_f32_16x16x32_bf16 v[212:215], v[244:247], a[124:127], v[212:215]
    v_mfma_f32_16x16x32_bf16 v[216:219], v[244:247], a[156:159], v[216:219]
    v_mfma_f32_16x16x32_bf16 v[220:223], v[244:247], a[188:191], v[220:223]
    v_mfma_f32_16x16x32_bf16 v[224:227], v[244:247], a[220:223], v[224:227]
    v_mfma_f32_16x16x32_bf16 v[228:231], v[244:247], a[252:255], v[228:231]
    v_xor_b32 v1, 0x4000, v1
    s_nop 0
    v_cvt_pk_bf16_f32 v128, v200, v204
    s_nop 0
    v_cvt_pk_bf16_f32 v129, v208, v212
    v_and_or_b32 v128, v128, -2, s58
    v_cvt_pk_bf16_f32 v130, v216, v220
    s_nop 0
    v_cvt_pk_bf16_f32 v131, v224, v228
    s_add_u32 s57, s38, 262144
    buffer_store_dwordx4 v[128:131], v2, s[8:11], s57 offen
    v_cvt_pk_bf16_f32 v132, v201, v205
    v_cvt_pk_bf16_f32 v133, v209, v213
    v_and_or_b32 v132, v132, -2, s58
    v_cvt_pk_bf16_f32 v134, v217, v221
    v_cvt_pk_bf16_f32 v135, v225, v229
    s_add_u32 s57, s38, 278528
    buffer_store_dwordx4 v[132:135], v2, s[8:11], s57 offen
    v_cvt_pk_bf16_f32 v136, v202, v206
    v_cvt_pk_bf16_f32 v137, v210, v214
    v_and_or_b32 v136, v136, -2, s58
    v_cvt_pk_bf16_f32 v138, v218, v222
    v_cvt_pk_bf16_f32 v139, v226, v230
    s_add_u32 s57, s38, 294912
    buffer_store_dwordx4 v[136:139], v2, s[8:11], s57 offen
    v_cvt_pk_bf16_f32 v140, v203, v207
    v_cvt_pk_bf16_f32 v141, v211, v215
    v_and_or_b32 v140, v140, -2, s58
    v_cvt_pk_bf16_f32 v142, v219, v223
    v_cvt_pk_bf16_f32 v143, v227, v231
    s_add_u32 s57, s38, 311296
    buffer_store_dwordx4 v[140:143], v2, s[8:11], s57 offen
    s_cmp_eq_u32 s3, 2
    s_cbranch_scc1 Lof_36056
    s_nop 15
    s_nop 15
    s_nop 15
    s_nop 11
Lof_36056:
    s_add_u32 s61, s38, 0
    buffer_load_dwordx4 v[16:19], v5, s[8:11], s61 offen offset:0 sc1
    buffer_load_dwordx4 v[20:23], v5, s[8:11], s61 offen offset:512 sc1
    buffer_load_dwordx4 v[24:27], v5, s[8:11], s61 offen offset:2048 sc1
    buffer_load_dwordx4 v[28:31], v5, s[8:11], s61 offen offset:2560 sc1
    s_add_u32 s33, s38, 4096
    buffer_load_dwordx4 v[32:35], v5, s[8:11], s33 offen offset:0 sc1
    buffer_load_dwordx4 v[36:39], v5, s[8:11], s33 offen offset:512 sc1
    buffer_load_dwordx4 v[40:43], v5, s[8:11], s33 offen offset:2048 sc1
    buffer_load_dwordx4 v[44:47], v5, s[8:11], s33 offen offset:2560 sc1
    s_add_u32 s61, s38, 8192
    buffer_load_dwordx4 v[48:51], v5, s[8:11], s61 offen offset:0 sc1
    buffer_load_dwordx4 v[52:55], v5, s[8:11], s61 offen offset:512 sc1
    buffer_load_dwordx4 v[56:59], v5, s[8:11], s61 offen offset:2048 sc1
    buffer_load_dwordx4 v[60:63], v5, s[8:11], s61 offen offset:2560 sc1
    s_add_u32 s33, s38, 12288
    buffer_load_dwordx4 v[64:67], v5, s[8:11], s33 offen offset:0 sc1
    buffer_load_dwordx4 v[68:71], v5, s[8:11], s33 offen offset:512 sc1
    buffer_load_dwordx4 v[72:75], v5, s[8:11], s33 offen offset:2048 sc1
    buffer_load_dwordx4 v[76:79], v5, s[8:11], s33 offen offset:2560 sc1
    s_waitcnt vmcnt(24)
    v_lshlrev_b32 v176, 16, v80
    v_and_b32 v177, 0xffff0000, v80
    v_lshlrev_b32 v178, 16, v81
    v_and_b32 v179, 0xffff0000, v81
    v_lshlrev_b32 v180, 16, v82
    v_and_b32 v181, 0xffff0000, v82
    v_lshlrev_b32 v182, 16, v83
    v_and_b32 v183, 0xffff0000, v83
Lol_36057:
    s_waitcnt vmcnt(15)
    v_mfma_f32_16x16x32_bf16 v[168:171], v[12:15], v[16:19], 0
    s_waitcnt vmcnt(14)
    v_mfma_f32_16x16x32_bf16 v[172:175], v[12:15], v[20:23], 0
    v_bitop3_b32 v184, v16, v20, s58 bitop3:0x7e
    s_waitcnt vmcnt(13)
    v_mfma_f32_16x16x32_bf16 v[168:171], v[12:15], v[24:27], v[168:171]
    s_waitcnt vmcnt(12)
    v_mfma_f32_16x16x32_bf16 v[172:175], v[12:15], v[28:31], v[172:175]
    v_bitop3_b32 v185, v24, v28, s58 bitop3:0x7e
    s_waitcnt vmcnt(11)
    v_mfma_f32_16x16x32_bf16 v[168:171], v[12:15], v[32:35], v[168:171]
    s_waitcnt vmcnt(10)
    v_mfma_f32_16x16x32_bf16 v[172:175], v[12:15], v[36:39], v[172:175]
    v_bitop3_b32 v186, v32, v36, s58 bitop3:0x7e
    s_waitcnt vmcnt(9)
    v_mfma_f32_16x16x32_bf16 v[168:171], v[12:15], v[40:43], v[168:171]
    s_waitcnt vmcnt(8)
    v_mfma_f32_16x16x32_bf16 v[172:175], v[12:15], v[44:47], v[172:175]
    v_bitop3_b32 v187, v40, v44, s58 bitop3:0x7e
    v_or3_b32 v192, v184, v185, v186
    s_waitcnt vmcnt(7)
    v_mfma_f32_16x16x32_bf16 v[168:171], v[12:15], v[48:51], v[168:171]
    s_waitcnt vmcnt(6)
    v_mfma_f32_16x16x32_bf16 v[172:175], v[12:15], v[52:55], v[172:175]
    v_bitop3_b32 v188, v48, v52, s58 bitop3:0x7e
    s_waitcnt vmcnt(5)
    v_mfma_f32_16x16x32_bf16 v[168:171], v[12:15], v[56:59], v[168:171]
    s_waitcnt vmcnt(4)
    v_mfma_f32_16x16x32_bf16 v[172:175], v[12:15], v[60:63], v[172:175]
    v_bitop3_b32 v189, v56, v60, s58 bitop3:0x7e
    s_waitcnt vmcnt(3)
    v_mfma_f32_16x16x32_bf16 v[168:171], v[12:15], v[64:67], v[168:171]
    s_waitcnt vmcnt(2)
    v_mfma_f32_16x16x32_bf16 v[172:175], v[12:15], v[68:71], v[172:175]
    v_bitop3_b32 v190, v64, v68, s58 bitop3:0x7e
    v_or3_b32 v193, v187, v188, v189
    s_waitcnt vmcnt(1)
    v_mfma_f32_16x16x32_bf16 v[168:171], v[12:15], v[72:75], v[168:171]
    s_waitcnt vmcnt(0)
    v_mfma_f32_16x16x32_bf16 v[172:175], v[12:15], v[76:79], v[172:175]
    v_bitop3_b32 v191, v72, v76, s58 bitop3:0x7e
    v_or3_b32 v9, v192, v193, v190
    v_or_b32 v9, v9, v191
    v_and_b32 v9, 1, v9
    v_cmp_ne_u32 vcc, 0, v9
    s_nop 0
    s_cbranch_vccnz Lolr_36058
    s_nop 0
    v_permlane16_swap_b32 v168, v172
    v_permlane16_swap_b32 v169, v173
    v_permlane16_swap_b32 v170, v174
    v_permlane16_swap_b32 v171, v175
    v_cvt_pk_bf16_f32 v184, v168, v169
    v_lshlrev_b32 v168, 16, v184
    v_and_b32 v169, 0xffff0000, v184
    v_cvt_pk_bf16_f32 v185, v170, v171
    v_lshlrev_b32 v170, 16, v185
    v_and_b32 v171, 0xffff0000, v185
    v_cvt_pk_bf16_f32 v186, v172, v173
    v_lshlrev_b32 v172, 16, v186
    v_and_b32 v173, 0xffff0000, v186
    v_cvt_pk_bf16_f32 v187, v174, v175
    v_lshlrev_b32 v174, 16, v187
    v_and_b32 v175, 0xffff0000, v187
    v_add_f32 v168, v168, v176
    v_add_f32 v169, v169, v177
    v_add_f32 v170, v170, v178
    v_add_f32 v171, v171, v179
    v_add_f32 v172, v172, v180
    v_add_f32 v173, v173, v181
    v_add_f32 v174, v174, v182
    v_add_f32 v175, v175, v183
    v_cvt_pk_bf16_f32 v184, v168, v169
    v_lshlrev_b32 v168, 16, v184
    v_and_b32 v169, 0xffff0000, v184
    v_cvt_pk_bf16_f32 v185, v170, v171
    v_lshlrev_b32 v170, 16, v185
    v_and_b32 v171, 0xffff0000, v185
    v_cvt_pk_bf16_f32 v186, v172, v173
    v_lshlrev_b32 v172, 16, v186
    v_and_b32 v173, 0xffff0000, v186
    v_cvt_pk_bf16_f32 v187, v174, v175
    v_lshlrev_b32 v174, 16, v187
    v_and_b32 v175, 0xffff0000, v187
    s_cmp_lg_u32 s6, 0
    s_cbranch_scc1 Lol1_36059
    s_add_u32 s61, s40, 159383552
    buffer_store_dwordx4 v[184:187], v6, s[8:11], s61 offen sc1
    v_add_f32 v176, v168, v169
    v_mul_f32 v177, v168, v168
    v_add_f32 v178, v170, v171
    v_mul_f32 v179, v169, v169
    v_fmac_f32 v177, v170, v170
    v_fmac_f32 v179, v171, v171
    v_add_f32 v176, v176, v172
    v_add_f32 v178, v178, v173
    v_fmac_f32 v177, v172, v172
    v_fmac_f32 v179, v173, v173
    v_add_f32 v176, v176, v174
    v_add_f32 v178, v178, v175
    v_fmac_f32 v177, v174, v174
    v_fmac_f32 v179, v175, v175
    v_pk_add_f32 v[176:177], v[176:177], v[178:179]
    s_nop 1
    v_add_f32_dpp v176, v176, v176 quad_perm:[1,0,3,2] row_mask:0xf bank_mask:0xf
    v_add_f32_dpp v177, v177, v177 quad_perm:[1,0,3,2] row_mask:0xf bank_mask:0xf
    s_nop 0
    v_add_f32_dpp v176, v176, v176 quad_perm:[2,3,0,1] row_mask:0xf bank_mask:0xf
    v_add_f32_dpp v177, v177, v177 quad_perm:[2,3,0,1] row_mask:0xf bank_mask:0xf
    s_nop 0
    v_add_f32_dpp v176, v176, v176 row_half_mirror row_mask:0xf bank_mask:0xf
    v_add_f32_dpp v177, v177, v177 row_half_mirror row_mask:0xf bank_mask:0xf
    s_nop 0
    v_add_f32_dpp v176, v176, v176 row_mirror row_mask:0xf bank_mask:0xf
    v_add_f32_dpp v177, v177, v177 row_mirror row_mask:0xf bank_mask:0xf
    v_mov_b32 v178, v176
    v_mov_b32 v179, v177
    s_nop 0
    v_permlane16_swap_b32 v176, v178
    v_permlane16_swap_b32 v177, v179
    v_add_f32 v176, v176, v178
    v_add_f32 v177, v177, v179
    v_mov_b32 v178, v176
    v_mov_b32 v179, v177
    s_nop 0
    v_permlane32_swap_b32 v176, v178
    v_permlane32_swap_b32 v177, v179
    v_add_f32 v176, v176, v178
    v_add_f32 v177, v177, v179
    v_mul_f32 v176, 989855744, v176
    v_mul_f32 v177, 989855744, v177
    v_fma_f32 v177, -v176, v176, v177
    v_max_f32 v177, 0, v177
    v_cvt_pk_bf16_f32 v178, v176, v177
    v_lshlrev_b32 v176, 16, v178
    v_and_b32 v177, 0xffff0000, v178
    v_add_f32 v177, 925353388, v177
    v_cvt_pk_bf16_f32 v178, v177, v177
    v_lshlrev_b32 v177, 16, v178
    v_sqrt_f32 v177, v177
    s_nop 0
    v_cvt_pk_bf16_f32 v178, v177, v177
    v_lshlrev_b32 v177, 16, v178
    v_rcp_f32 v177, v177
    v_sub_f32 v168, v168, v176
    v_sub_f32 v170, v170, v176
    v_sub_f32 v172, v172, v176
    v_sub_f32 v174, v174, v176
    v_sub_f32 v169, v169, v176
    v_sub_f32 v171, v171, v176
    v_sub_f32 v173, v173, v176
    v_sub_f32 v175, v175, v176
    v_cvt_pk_bf16_f32 v192, v168, v169
    v_cvt_pk_bf16_f32 v193, v170, v171
    v_cvt_pk_bf16_f32 v194, v172, v173
    v_cvt_pk_bf16_f32 v195, v174, v175
    v_lshlrev_b32 v168, 16, v192
    v_lshlrev_b32 v170, 16, v193
    v_lshlrev_b32 v172, 16, v194
    v_lshlrev_b32 v174, 16, v195
    v_and_b32 v169, 0xffff0000, v192
    v_and_b32 v171, 0xffff0000, v193
    v_and_b32 v173, 0xffff0000, v194
    v_and_b32 v175, 0xffff0000, v195
    v_mul_f32 v168, v168, v177
    v_mul_f32 v170, v170, v177
    v_mul_f32 v172, v172, v177
    v_mul_f32 v174, v174, v177
    v_mul_f32 v169, v169, v177
    v_mul_f32 v171, v171, v177
    v_mul_f32 v173, v173, v177
    v_mul_f32 v175, v175, v177
    v_cvt_pk_bf16_f32 v192, v168, v169
    v_cvt_pk_bf16_f32 v193, v170, v171
    v_cvt_pk_bf16_f32 v194, v172, v173
    v_cvt_pk_bf16_f32 v195, v174, v175
    v_lshlrev_b32 v168, 16, v192
    v_lshlrev_b32 v170, 16, v193
    v_lshlrev_b32 v172, 16, v194
    v_lshlrev_b32 v174, 16, v195
    v_and_b32 v169, 0xffff0000, v192
    v_and_b32 v171, 0xffff0000, v193
    v_and_b32 v173, 0xffff0000, v194
    v_and_b32 v175, 0xffff0000, v195
    v_cvt_pkrtz_f16_f32 v188, v168, v169
    v_cvt_pkrtz_f16_f32 v189, v170, v171
    v_cvt_pkrtz_f16_f32 v190, v172, v173
    v_cvt_pkrtz_f16_f32 v191, v174, v175
    s_add_u32 s61, s40, 165675008
    buffer_store_dwordx4 v[188:191], v6, s[8:11], s61 offen sc1
    s_add_u32 s40, s40, 65536
    s_mov_b64 exec, 1
    s_waitcnt vmcnt(0)
    buffer_store_dword v4, v3, s[8:11], s41 offen sc1
    s_mov_b64 exec, -1
    s_add_u32 s41, s41, 2048
    s_xor_b32 s38, s38, 1048576
    s_add_u32 s32, s32, 1
    s_bfe_u32 s58, s32, 0x10001
    s_xor_b32 s58, s58, 1
    s_cmp_lt_u32 s32, 32
    s_cbranch_scc1 L_ob_fast
    s_branch L_o_end
Lol1_36059:
    buffer_store_dwordx4 v[184:187], v6, s[20:23], s40 offen
    s_add_u32 s40, s40, 65536
    s_xor_b32 s38, s38, 1048576
    s_add_u32 s32, s32, 1
    s_bfe_u32 s58, s32, 0x10001
    s_xor_b32 s58, s58, 1
    s_cmp_lt_u32 s32, 32
    s_cbranch_scc1 L_ob_fast
    s_branch L_o_end
Lolr_36058:
    v_and_b32 v184, 1, v184
    v_and_b32 v185, 1, v185
    v_and_b32 v186, 1, v186
    v_and_b32 v187, 1, v187
    v_and_b32 v188, 1, v188
    v_and_b32 v189, 1, v189
    v_and_b32 v190, 1, v190
    v_and_b32 v191, 1, v191
    v_cmp_ne_u32 s[44:45], 0, v184
    v_cmp_ne_u32 s[46:47], 0, v185
    v_cmp_ne_u32 s[48:49], 0, v186
    v_cmp_ne_u32 s[50:51], 0, v187
    v_cmp_ne_u32 s[52:53], 0, v188
    v_cmp_ne_u32 s[54:55], 0, v189
    v_cmp_ne_u32 s[34:35], 0, v190
    v_cmp_ne_u32 s[36:37], 0, v191
    s_add_u32 s61, s38, 0
    s_mov_b64 exec, s[44:45]
    buffer_load_dwordx4 v[16:19], v5, s[8:11], s61 offen offset:0 sc1
    buffer_load_dwordx4 v[20:23], v5, s[8:11], s61 offen offset:512 sc1
    s_mov_b64 exec, s[46:47]
    buffer_load_dwordx4 v[24:27], v5, s[8:11], s61 offen offset:2048 sc1
    buffer_load_dwordx4 v[28:31], v5, s[8:11], s61 offen offset:2560 sc1
    s_add_u32 s33, s38, 4096
    s_mov_b64 exec, s[48:49]
    buffer_load_dwordx4 v[32:35], v5, s[8:11], s33 offen offset:0 sc1
    buffer_load_dwordx4 v[36:39], v5, s[8:11], s33 offen offset:512 sc1
    s_mov_b64 exec, s[50:51]
    buffer_load_dwordx4 v[40:43], v5, s[8:11], s33 offen offset:2048 sc1
    buffer_load_dwordx4 v[44:47], v5, s[8:11], s33 offen offset:2560 sc1
    s_add_u32 s61, s38, 8192
    s_mov_b64 exec, s[52:53]
    buffer_load_dwordx4 v[48:51], v5, s[8:11], s61 offen offset:0 sc1
    buffer_load_dwordx4 v[52:55], v5, s[8:11], s61 offen offset:512 sc1
    s_mov_b64 exec, s[54:55]
    buffer_load_dwordx4 v[56:59], v5, s[8:11], s61 offen offset:2048 sc1
    buffer_load_dwordx4 v[60:63], v5, s[8:11], s61 offen offset:2560 sc1
    s_add_u32 s33, s38, 12288
    s_mov_b64 exec, s[34:35]
    buffer_load_dwordx4 v[64:67], v5, s[8:11], s33 offen offset:0 sc1
    buffer_load_dwordx4 v[68:71], v5, s[8:11], s33 offen offset:512 sc1
    s_mov_b64 exec, s[36:37]
    buffer_load_dwordx4 v[72:75], v5, s[8:11], s33 offen offset:2048 sc1
    buffer_load_dwordx4 v[76:79], v5, s[8:11], s33 offen offset:2560 sc1
    s_mov_b64 exec, -1
    s_sub_u32 s62, s62, 1
    s_cbranch_scc0 Ltok_41056
    s_movk_i32 s61, 23
    s_branch L_abort
Ltok_41056:
    s_branch Lol_36057
L_ob_slow:
    s_barrier
    ds_read_b128 v[232:235], v1 offset:0
    ds_read_b128 v[236:239], v1 offset:1024
    ds_read_b128 v[240:243], v1 offset:2048
    ds_read_b128 v[244:247], v1 offset:3072
    ds_read_b128 v[248:251], v1 offset:4096
    ds_read_b128 v[252:255], v1 offset:5120
    s_waitcnt lgkmcnt(5)
    v_mfma_f32_16x16x32_bf16 v[168:171], v[232:235], a[0:3], 0
    buffer_load_dwordx4 v[80:83], v8, s[8:11], s39 offen
    v_mfma_f32_16x16x32_bf16 v[172:175], v[232:235], a[32:35], 0
    v_mfma_f32_16x16x32_bf16 v[176:179], v[232:235], a[64:67], 0
    v_mfma_f32_16x16x32_bf16 v[180:183], v[232:235], a[96:99], 0
    v_mfma_f32_16x16x32_bf16 v[184:187], v[232:235], a[128:131], 0
    v_mfma_f32_16x16x32_bf16 v[188:191], v[232:235], a[160:163], 0
    s_add_u32 s39, s39, 65536
    v_mfma_f32_16x16x32_bf16 v[192:195], v[232:235], a[192:195], 0
    v_mfma_f32_16x16x32_bf16 v[196:199], v[232:235], a[224:227], 0
    ds_read_b128 v[232:235], v1 offset:6144
    s_waitcnt lgkmcnt(5)
    v_mfma_f32_16x16x32_bf16 v[168:171], v[236:239], a[4:7], v[168:171]
    v_mfma_f32_16x16x32_bf16 v[172:175], v[236:239], a[36:39], v[172:175]
    v_mfma_f32_16x16x32_bf16 v[176:179], v[236:239], a[68:71], v[176:179]
    v_mfma_f32_16x16x32_bf16 v[180:183], v[236:239], a[100:103], v[180:183]
    v_mfma_f32_16x16x32_bf16 v[184:187], v[236:239], a[132:135], v[184:187]
    v_mfma_f32_16x16x32_bf16 v[188:191], v[236:239], a[164:167], v[188:191]
    v_mfma_f32_16x16x32_bf16 v[192:195], v[236:239], a[196:199], v[192:195]
    v_mfma_f32_16x16x32_bf16 v[196:199], v[236:239], a[228:231], v[196:199]
    ds_read_b128 v[236:239], v1 offset:7168
    s_waitcnt lgkmcnt(5)
    v_mfma_f32_16x16x32_bf16 v[168:171], v[240:243], a[8:11], v[168:171]
    v_mfma_f32_16x16x32_bf16 v[172:175], v[240:243], a[40:43], v[172:175]
    v_mfma_f32_16x16x32_bf16 v[176:179], v[240:243], a[72:75], v[176:179]
    v_mfma_f32_16x16x32_bf16 v[180:183], v[240:243], a[104:107], v[180:183]
    v_mfma_f32_16x16x32_bf16 v[184:187], v[240:243], a[136:139], v[184:187]
    v_mfma_f32_16x16x32_bf16 v[188:191], v[240:243], a[168:171], v[188:191]
    v_mfma_f32_16x16x32_bf16 v[192:195], v[240:243], a[200:203], v[192:195]
    v_mfma_f32_16x16x32_bf16 v[196:199], v[240:243], a[232:235], v[196:199]
    ds_read_b128 v[240:243], v1 offset:8192
    s_waitcnt lgkmcnt(5)
    v_mfma_f32_16x16x32_bf16 v[168:171], v[244:247], a[12:15], v[168:171]
    v_mfma_f32_16x16x32_bf16 v[172:175], v[244:247], a[44:47], v[172:175]
    v_mfma_f32_16x16x32_bf16 v[176:179], v[244:247], a[76:79], v[176:179]
    v_mfma_f32_16x16x32_bf16 v[180:183], v[244:247], a[108:111], v[180:183]
    v_mfma_f32_16x16x32_bf16 v[184:187], v[244:247], a[140:143], v[184:187]
    v_mfma_f32_16x16x32_bf16 v[188:191], v[244:247], a[172:175], v[188:191]
    v_mfma_f32_16x16x32_bf16 v[192:195], v[244:247], a[204:207], v[192:195]
    v_mfma_f32_16x16x32_bf16 v[196:199], v[244:247], a[236:239], v[196:199]
    ds_read_b128 v[244:247], v1 offset:9216
    s_waitcnt lgkmcnt(5)
    v_mfma_f32_16x16x32_bf16 v[168:171], v[248:251], a[16:19], v[168:171]
    v_mfma_f32_16x16x32_bf16 v[172:175], v[248:251], a[48:51], v[172:175]
    v_mfma_f32_16x16x32_bf16 v[176:179], v[248:251], a[80:83], v[176:179]
    v_mfma_f32_16x16x32_bf16 v[180:183], v[248:251], a[112:115], v[180:183]
    v_mfma_f32_16x16x32_bf16 v[184:187], v[248:251], a[144:147], v[184:187]
    v_mfma_f32_16x16x32_bf16 v[188:191], v[248:251], a[176:179], v[188:191]
    v_mfma_f32_16x16x32_bf16 v[192:195], v[248:251], a[208:211], v[192:195]
    v_mfma_f32_16x16x32_bf16 v[196:199], v[248:251], a[240:243], v[196:199]
    ds_read_b128 v[248:251], v1 offset:10240
    s_waitcnt lgkmcnt(5)
    v_mfma_f32_16x16x32_bf16 v[168:171], v[252:255], a[20:23], v[168:171]
    v_mfma_f32_16x16x32_bf16 v[172:175], v[252:255], a[52:55], v[172:175]
    v_mfma_f32_16x16x32_bf16 v[176:179], v[252:255], a[84:87], v[176:179]
    v_mfma_f32_16x16x32_bf16 v[180:183], v[252:255], a[116:119], v[180:183]
    v_mfma_f32_16x16x32_bf16 v[184:187], v[252:255], a[148:151], v[184:187]
    v_mfma_f32_16x16x32_bf16 v[188:191], v[252:255], a[180:183], v[188:191]
    v_mfma_f32_16x16x32_bf16 v[192:195], v[252:255], a[212:215], v[192:195]
    v_mfma_f32_16x16x32_bf16 v[196:199], v[252:255], a[244:247], v[196:199]
    ds_read_b128 v[252:255], v1 offset:11264
    s_waitcnt lgkmcnt(5)
    v_mfma_f32_16x16x32_bf16 v[168:171], v[232:235], a[24:27], v[168:171]
    v_mfma_f32_16x16x32_bf16 v[172:175], v[232:235], a[56:59], v[172:175]
    v_mfma_f32_16x16x32_bf16 v[176:179], v[232:235], a[88:91], v[176:179]
    v_mfma_f32_16x16x32_bf16 v[180:183], v[232:235], a[120:123], v[180:183]
    v_mfma_f32_16x16x32_bf16 v[184:187], v[232:235], a[152:155], v[184:187]
    v_mfma_f32_16x16x32_bf16 v[188:191], v[232:235], a[184:187], v[188:191]
    v_mfma_f32_16x16x32_bf16 v[192:195], v[232:235], a[216:219], v[192:195]
    v_mfma_f32_16x16x32_bf16 v[196:199], v[232:235], a[248:251], v[196:199]
    ds_read_b128 v[232:235], v1 offset:12288
    s_waitcnt lgkmcnt(5)
    v_mfma_f32_16x16x32_bf16 v[168:171], v[236:239], a[28:31], v[168:171]
    v_mfma_f32_16x16x32_bf16 v[172:175], v[236:239], a[60:63], v[172:175]
    v_mfma_f32_16x16x32_bf16 v[176:179], v[236:239], a[92:95], v[176:179]
    v_mfma_f32_16x16x32_bf16 v[180:183], v[236:239], a[124:127], v[180:183]
    v_mfma_f32_16x16x32_bf16 v[184:187], v[236:239], a[156:159], v[184:187]
    v_mfma_f32_16x16x32_bf16 v[188:191], v[236:239], a[188:191], v[188:191]
    v_mfma_f32_16x16x32_bf16 v[192:195], v[236:239], a[220:223], v[192:195]
    v_mfma_f32_16x16x32_bf16 v[196:199], v[236:239], a[252:255], v[196:199]
    ds_read_b128 v[236:239], v1 offset:13312
    s_waitcnt lgkmcnt(5)
    v_mfma_f32_16x16x32_bf16 v[200:203], v[240:243], a[0:3], 0
    v_mfma_f32_16x16x32_bf16 v[204:207], v[240:243], a[32:35], 0
    v_mfma_f32_16x16x32_bf16 v[208:211], v[240:243], a[64:67], 0
    v_cvt_pk_bf16_f32 v112, v168, v172
    v_mfma_f32_16x16x32_bf16 v[212:215], v[240:243], a[96:99], 0
    v_cvt_pk_bf16_f32 v113, v176, v180
    v_mfma_f32_16x16x32_bf16 v[216:219], v[240:243], a[128:131], 0
    v_and_or_b32 v112, v112, -2, s58
    v_mfma_f32_16x16x32_bf16 v[220:223], v[240:243], a[160:163], 0
    v_cvt_pk_bf16_f32 v114, v184, v188
    v_mfma_f32_16x16x32_bf16 v[224:227], v[240:243], a[192:195], 0
    v_cvt_pk_bf16_f32 v115, v192, v196
    s_add_u32 s57, s38, 0
    v_mfma_f32_16x16x32_bf16 v[228:231], v[240:243], a[224:227], 0
    buffer_store_dwordx4 v[112:115], v2, s[8:11], s57 offen sc1
    ds_read_b128 v[240:243], v1 offset:14336
    s_waitcnt lgkmcnt(5)
    v_mfma_f32_16x16x32_bf16 v[200:203], v[244:247], a[4:7], v[200:203]
    v_cvt_pk_bf16_f32 v116, v169, v173
    v_mfma_f32_16x16x32_bf16 v[204:207], v[244:247], a[36:39], v[204:207]
    v_cvt_pk_bf16_f32 v117, v177, v181
    v_mfma_f32_16x16x32_bf16 v[208:211], v[244:247], a[68:71], v[208:211]
    v_and_or_b32 v116, v116, -2, s58
    v_mfma_f32_16x16x32_bf16 v[212:215], v[244:247], a[100:103], v[212:215]
    v_cvt_pk_bf16_f32 v118, v185, v189
    v_mfma_f32_16x16x32_bf16 v[216:219], v[244:247], a[132:135], v[216:219]
    v_cvt_pk_bf16_f32 v119, v193, v197
    s_add_u32 s57, s38, 16384
    v_mfma_f32_16x16x32_bf16 v[220:223], v[244:247], a[164:167], v[220:223]
    buffer_store_dwordx4 v[116:119], v2, s[8:11], s57 offen sc1
    v_mfma_f32_16x16x32_bf16 v[224:227], v[244:247], a[196:199], v[224:227]
    v_cvt_pk_bf16_f32 v120, v170, v174
    v_mfma_f32_16x16x32_bf16 v[228:231], v[244:247], a[228:231], v[228:231]
    v_cvt_pk_bf16_f32 v121, v178, v182
    ds_read_b128 v[244:247], v1 offset:15360
    s_waitcnt lgkmcnt(5)
    v_mfma_f32_16x16x32_bf16 v[200:203], v[248:251], a[8:11], v[200:203]
    v_and_or_b32 v120, v120, -2, s58
    v_mfma_f32_16x16x32_bf16 v[204:207], v[248:251], a[40:43], v[204:207]
    v_cvt_pk_bf16_f32 v122, v186, v190
    v_mfma_f32_16x16x32_bf16 v[208:211], v[248:251], a[72:75], v[208:211]
    v_cvt_pk_bf16_f32 v123, v194, v198
    s_add_u32 s57, s38, 32768
    v_mfma_f32_16x16x32_bf16 v[212:215], v[248:251], a[104:107], v[212:215]
    buffer_store_dwordx4 v[120:123], v2, s[8:11], s57 offen sc1
    v_mfma_f32_16x16x32_bf16 v[216:219], v[248:251], a[136:139], v[216:219]
    v_cvt_pk_bf16_f32 v124, v171, v175
    v_mfma_f32_16x16x32_bf16 v[220:223], v[248:251], a[168:171], v[220:223]
    v_cvt_pk_bf16_f32 v125, v179, v183
    v_mfma_f32_16x16x32_bf16 v[224:227], v[248:251], a[200:203], v[224:227]
    v_and_or_b32 v124, v124, -2, s58
    v_mfma_f32_16x16x32_bf16 v[228:231], v[248:251], a[232:235], v[228:231]
    v_cvt_pk_bf16_f32 v126, v187, v191
    s_waitcnt lgkmcnt(4)
    v_mfma_f32_16x16x32_bf16 v[200:203], v[252:255], a[12:15], v[200:203]
    v_cvt_pk_bf16_f32 v127, v195, v199
    s_add_u32 s57, s38, 49152
    v_mfma_f32_16x16x32_bf16 v[204:207], v[252:255], a[44:47], v[204:207]
    buffer_store_dwordx4 v[124:127], v2, s[8:11], s57 offen sc1
    v_mfma_f32_16x16x32_bf16 v[208:211], v[252:255], a[76:79], v[208:211]
    v_mfma_f32_16x16x32_bf16 v[212:215], v[252:255], a[108:111], v[212:215]
    v_mfma_f32_16x16x32_bf16 v[216:219], v[252:255], a[140:143], v[216:219]
    v_mfma_f32_16x16x32_bf16 v[220:223], v[252:255], a[172:175], v[220:223]
    v_mfma_f32_16x16x32_bf16 v[224:227], v[252:255], a[204:207], v[224:227]
    v_mfma_f32_16x16x32_bf16 v[228:231], v[252:255], a[236:239], v[228:231]
    s_waitcnt lgkmcnt(3)
    v_mfma_f32_16x16x32_bf16 v[200:203], v[232:235], a[16:19], v[200:203]
    v_mfma_f32_16x16x32_bf16 v[204:207], v[232:235], a[48:51], v[204:207]
    v_mfma_f32_16x16x32_bf16 v[208:211], v[232:235], a[80:83], v[208:211]
    v_mfma_f32_16x16x32_bf16 v[212:215], v[232:235], a[112:115], v[212:215]
    v_mfma_f32_16x16x32_bf16 v[216:219], v[232:235], a[144:147], v[216:219]
    v_mfma_f32_16x16x32_bf16 v[220:223], v[232:235], a[176:179], v[220:223]
    v_mfma_f32_16x16x32_bf16 v[224:227], v[232:235], a[208:211], v[224:227]
    v_mfma_f32_16x16x32_bf16 v[228:231], v[232:235], a[240:243], v[228:231]
    s_waitcnt lgkmcnt(2)
    v_mfma_f32_16x16x32_bf16 v[200:203], v[236:239], a[20:23], v[200:203]
    v_mfma_f32_16x16x32_bf16 v[204:207], v[236:239], a[52:55], v[204:207]
    v_mfma_f32_16x16x32_bf16 v[208:211], v[236:239], a[84:87], v[208:211]
    v_mfma_f32_16x16x32_bf16 v[212:215], v[236:239], a[116:119], v[212:215]
    v_mfma_f32_16x16x32_bf16 v[216:219], v[236:239], a[148:151], v[216:219]
    v_mfma_f32_16x16x32_bf16 v[220:223], v[236:239], a[180:183], v[220:223]
    v_mfma_f32_16x16x32_bf16 v[224:227], v[236:239], a[212:215], v[224:227]
    v_mfma_f32_16x16x32_bf16 v[228:231], v[236:239], a[244:247], v[228:231]
    s_waitcnt lgkmcnt(1)
    v_mfma_f32_16x16x32_bf16 v[200:203], v[240:243], a[24:27], v[200:203]
    v_mfma_f32_16x16x32_bf16 v[204:207], v[240:243], a[56:59], v[204:207]
    v_mfma_f32_16x16x32_bf16 v[208:211], v[240:243], a[88:91], v[208:211]
    v_mfma_f32_16x16x32_bf16 v[212:215], v[240:243], a[120:123], v[212:215]
    v_mfma_f32_16x16x32_bf16 v[216:219], v[240:243], a[152:155], v[216:219]
    v_mfma_f32_16x16x32_bf16 v[220:223], v[240:243], a[184:187], v[220:223]
    v_mfma_f32_16x16x32_bf16 v[224:227], v[240:243], a[216:219], v[224:227]
    v_mfma_f32_16x16x32_bf16 v[228:231], v[240:243], a[248:251], v[228:231]
    s_waitcnt lgkmcnt(0)
    v_mfma_f32_16x16x32_bf16 v[200:203], v[244:247], a[28:31], v[200:203]
    v_mfma_f32_16x16x32_bf16 v[204:207], v[244:247], a[60:63], v[204:207]
    v_mfma_f32_16x16x32_bf16 v[208:211], v[244:247], a[92:95], v[208:211]
    v_mfma_f32_16x16x32_bf16 v[212:215], v[244:247], a[124:127], v[212:215]
    v_mfma_f32_16x16x32_bf16 v[216:219], v[244:247], a[156:159], v[216:219]
    v_mfma_f32_16x16x32_bf16 v[220:223], v[244:247], a[188:191], v[220:223]
    v_mfma_f32_16x16x32_bf16 v[224:227], v[244:247], a[220:223], v[224:227]
    v_mfma_f32_16x16x32_bf16 v[228:231], v[244:247], a[252:255], v[228:231]
    v_xor_b32 v1, 0x4000, v1
    s_nop 0
    v_cvt_pk_bf16_f32 v128, v200, v204
    s_nop 0
    v_cvt_pk_bf16_f32 v129, v208, v212
    v_and_or_b32 v128, v128, -2, s58
    v_cvt_pk_bf16_f32 v130, v216, v220
    s_nop 0
    v_cvt_pk_bf16_f32 v131, v224, v228
    s_add_u32 s57, s38, 262144
    buffer_store_dwordx4 v[128:131], v2, s[8:11], s57 offen sc1
    v_cvt_pk_bf16_f32 v132, v201, v205
    v_cvt_pk_bf16_f32 v133, v209, v213
    v_and_or_b32 v132, v132, -2, s58
    v_cvt_pk_bf16_f32 v134, v217, v221
    v_cvt_pk_bf16_f32 v135, v225, v229
    s_add_u32 s57, s38, 278528
    buffer_store_dwordx4 v[132:135], v2, s[8:11], s57 offen sc1
    v_cvt_pk_bf16_f32 v136, v202, v206
    v_cvt_pk_bf16_f32 v137, v210, v214
    v_and_or_b32 v136, v136, -2, s58
    v_cvt_pk_bf16_f32 v138, v218, v222
    v_cvt_pk_bf16_f32 v139, v226, v230
    s_add_u32 s57, s38, 294912
    buffer_store_dwordx4 v[136:139], v2, s[8:11], s57 offen sc1
    v_cvt_pk_bf16_f32 v140, v203, v207
    v_cvt_pk_bf16_f32 v141, v211, v215
    v_and_or_b32 v140, v140, -2, s58
    v_cvt_pk_bf16_f32 v142, v219, v223
    v_cvt_pk_bf16_f32 v143, v227, v231
    s_add_u32 s57, s38, 311296
    buffer_store_dwordx4 v[140:143], v2, s[8:11], s57 offen sc1
    s_cmp_eq_u32 s3, 2
    s_cbranch_scc1 Lof_41057
    s_nop 15
    s_nop 15
    s_nop 15
    s_nop 11
Lof_41057:
    s_add_u32 s61, s38, 0
    buffer_load_dwordx4 v[16:19], v5, s[8:11], s61 offen offset:0 sc1
    buffer_load_dwordx4 v[20:23], v5, s[8:11], s61 offen offset:512 sc1
    buffer_load_dwordx4 v[24:27], v5, s[8:11], s61 offen offset:2048 sc1
    buffer_load_dwordx4 v[28:31], v5, s[8:11], s61 offen offset:2560 sc1
    s_add_u32 s33, s38, 4096
    buffer_load_dwordx4 v[32:35], v5, s[8:11], s33 offen offset:0 sc1
    buffer_load_dwordx4 v[36:39], v5, s[8:11], s33 offen offset:512 sc1
    buffer_load_dwordx4 v[40:43], v5, s[8:11], s33 offen offset:2048 sc1
    buffer_load_dwordx4 v[44:47], v5, s[8:11], s33 offen offset:2560 sc1
    s_add_u32 s61, s38, 8192
    buffer_load_dwordx4 v[48:51], v5, s[8:11], s61 offen offset:0 sc1
    buffer_load_dwordx4 v[52:55], v5, s[8:11], s61 offen offset:512 sc1
    buffer_load_dwordx4 v[56:59], v5, s[8:11], s61 offen offset:2048 sc1
    buffer_load_dwordx4 v[60:63], v5, s[8:11], s61 offen offset:2560 sc1
    s_add_u32 s33, s38, 12288
    buffer_load_dwordx4 v[64:67], v5, s[8:11], s33 offen offset:0 sc1
    buffer_load_dwordx4 v[68:71], v5, s[8:11], s33 offen offset:512 sc1
    buffer_load_dwordx4 v[72:75], v5, s[8:11], s33 offen offset:2048 sc1
    buffer_load_dwordx4 v[76:79], v5, s[8:11], s33 offen offset:2560 sc1
    s_waitcnt vmcnt(24)
    v_lshlrev_b32 v176, 16, v80
    v_and_b32 v177, 0xffff0000, v80
    v_lshlrev_b32 v178, 16, v81
    v_and_b32 v179, 0xffff0000, v81
    v_lshlrev_b32 v180, 16, v82
    v_and_b32 v181, 0xffff0000, v82
    v_lshlrev_b32 v182, 16, v83
    v_and_b32 v183, 0xffff0000, v83
Lol_41058:
    s_waitcnt vmcnt(15)
    v_mfma_f32_16x16x32_bf16 v[168:171], v[12:15], v[16:19], 0
    s_waitcnt vmcnt(14)
    v_mfma_f32_16x16x32_bf16 v[172:175], v[12:15], v[20:23], 0
    v_bitop3_b32 v184, v16, v20, s58 bitop3:0x7e
    s_waitcnt vmcnt(13)
    v_mfma_f32_16x16x32_bf16 v[168:171], v[12:15], v[24:27], v[168:171]
    s_waitcnt vmcnt(12)
    v_mfma_f32_16x16x32_bf16 v[172:175], v[12:15], v[28:31], v[172:175]
    v_bitop3_b32 v185, v24, v28, s58 bitop3:0x7e
    s_waitcnt vmcnt(11)
    v_mfma_f32_16x16x32_bf16 v[168:171], v[12:15], v[32:35], v[168:171]
    s_waitcnt vmcnt(10)
    v_mfma_f32_16x16x32_bf16 v[172:175], v[12:15], v[36:39], v[172:175]
    v_bitop3_b32 v186, v32, v36, s58 bitop3:0x7e
    s_waitcnt vmcnt(9)
    v_mfma_f32_16x16x32_bf16 v[168:171], v[12:15], v[40:43], v[168:171]
    s_waitcnt vmcnt(8)
    v_mfma_f32_16x16x32_bf16 v[172:175], v[12:15], v[44:47], v[172:175]
    v_bitop3_b32 v187, v40, v44, s58 bitop3:0x7e
    v_or3_b32 v192, v184, v185, v186
    s_waitcnt vmcnt(7)
    v_mfma_f32_16x16x32_bf16 v[168:171], v[12:15], v[48:51], v[168:171]
    s_waitcnt vmcnt(6)
    v_mfma_f32_16x16x32_bf16 v[172:175], v[12:15], v[52:55], v[172:175]
    v_bitop3_b32 v188, v48, v52, s58 bitop3:0x7e
    s_waitcnt vmcnt(5)
    v_mfma_f32_16x16x32_bf16 v[168:171], v[12:15], v[56:59], v[168:171]
    s_waitcnt vmcnt(4)
    v_mfma_f32_16x16x32_bf16 v[172:175], v[12:15], v[60:63], v[172:175]
    v_bitop3_b32 v189, v56, v60, s58 bitop3:0x7e
    s_waitcnt vmcnt(3)
    v_mfma_f32_16x16x32_bf16 v[168:171], v[12:15], v[64:67], v[168:171]
    s_waitcnt vmcnt(2)
    v_mfma_f32_16x16x32_bf16 v[172:175], v[12:15], v[68:71], v[172:175]
    v_bitop3_b32 v190, v64, v68, s58 bitop3:0x7e
    v_or3_b32 v193, v187, v188, v189
    s_waitcnt vmcnt(1)
    v_mfma_f32_16x16x32_bf16 v[168:171], v[12:15], v[72:75], v[168:171]
    s_waitcnt vmcnt(0)
    v_mfma_f32_16x16x32_bf16 v[172:175], v[12:15], v[76:79], v[172:175]
    v_bitop3_b32 v191, v72, v76, s58 bitop3:0x7e
    v_or3_b32 v9, v192, v193, v190
    v_or_b32 v9, v9, v191
    v_and_b32 v9, 1, v9
    v_cmp_ne_u32 vcc, 0, v9
    s_nop 0
    s_cbranch_vccnz Lolr_41059
    s_nop 0
    v_permlane16_swap_b32 v168, v172
    v_permlane16_swap_b32 v169, v173
    v_permlane16_swap_b32 v170, v174
    v_permlane16_swap_b32 v171, v175
    v_cvt_pk_bf16_f32 v184, v168, v169
    v_lshlrev_b32 v168, 16, v184
    v_and_b32 v169, 0xffff0000, v184
    v_cvt_pk_bf16_f32 v185, v170, v171
    v_lshlrev_b32 v170, 16, v185
    v_and_b32 v171, 0xffff0000, v185
    v_cvt_pk_bf16_f32 v186, v172, v173
    v_lshlrev_b32 v172, 16, v186
    v_and_b32 v173, 0xffff0000, v186
    v_cvt_pk_bf16_f32 v187, v174, v175
    v_lshlrev_b32 v174, 16, v187
    v_and_b32 v175, 0xffff0000, v187
    v_add_f32 v168, v168, v176
    v_add_f32 v169, v169, v177
    v_add_f32 v170, v170, v178
    v_add_f32 v171, v171, v179
    v_add_f32 v172, v172, v180
    v_add_f32 v173, v173, v181
    v_add_f32 v174, v174, v182
    v_add_f32 v175, v175, v183
    v_cvt_pk_bf16_f32 v184, v168, v169
    v_lshlrev_b32 v168, 16, v184
    v_and_b32 v169, 0xffff0000, v184
    v_cvt_pk_bf16_f32 v185, v170, v171
    v_lshlrev_b32 v170, 16, v185
    v_and_b32 v171, 0xffff0000, v185
    v_cvt_pk_bf16_f32 v186, v172, v173
    v_lshlrev_b32 v172, 16, v186
    v_and_b32 v173, 0xffff0000, v186
    v_cvt_pk_bf16_f32 v187, v174, v175
    v_lshlrev_b32 v174, 16, v187
    v_and_b32 v175, 0xffff0000, v187
    s_cmp_lg_u32 s6, 0
    s_cbranch_scc1 Lol1_41060
    s_add_u32 s61, s40, 159383552
    buffer_store_dwordx4 v[184:187], v6, s[8:11], s61 offen sc1
    v_add_f32 v176, v168, v169
    v_mul_f32 v177, v168, v168
    v_add_f32 v178, v170, v171
    v_mul_f32 v179, v169, v169
    v_fmac_f32 v177, v170, v170
    v_fmac_f32 v179, v171, v171
    v_add_f32 v176, v176, v172
    v_add_f32 v178, v178, v173
    v_fmac_f32 v177, v172, v172
    v_fmac_f32 v179, v173, v173
    v_add_f32 v176, v176, v174
    v_add_f32 v178, v178, v175
    v_fmac_f32 v177, v174, v174
    v_fmac_f32 v179, v175, v175
    v_pk_add_f32 v[176:177], v[176:177], v[178:179]
    s_nop 1
    v_add_f32_dpp v176, v176, v176 quad_perm:[1,0,3,2] row_mask:0xf bank_mask:0xf
    v_add_f32_dpp v177, v177, v177 quad_perm:[1,0,3,2] row_mask:0xf bank_mask:0xf
    s_nop 0
    v_add_f32_dpp v176, v176, v176 quad_perm:[2,3,0,1] row_mask:0xf bank_mask:0xf
    v_add_f32_dpp v177, v177, v177 quad_perm:[2,3,0,1] row_mask:0xf bank_mask:0xf
    s_nop 0
    v_add_f32_dpp v176, v176, v176 row_half_mirror row_mask:0xf bank_mask:0xf
    v_add_f32_dpp v177, v177, v177 row_half_mirror row_mask:0xf bank_mask:0xf
    s_nop 0
    v_add_f32_dpp v176, v176, v176 row_mirror row_mask:0xf bank_mask:0xf
    v_add_f32_dpp v177, v177, v177 row_mirror row_mask:0xf bank_mask:0xf
    v_mov_b32 v178, v176
    v_mov_b32 v179, v177
    s_nop 0
    v_permlane16_swap_b32 v176, v178
    v_permlane16_swap_b32 v177, v179
    v_add_f32 v176, v176, v178
    v_add_f32 v177, v177, v179
    v_mov_b32 v178, v176
    v_mov_b32 v179, v177
    s_nop 0
    v_permlane32_swap_b32 v176, v178
    v_permlane32_swap_b32 v177, v179
    v_add_f32 v176, v176, v178
    v_add_f32 v177, v177, v179
    v_mul_f32 v176, 989855744, v176
    v_mul_f32 v177, 989855744, v177
    v_fma_f32 v177, -v176, v176, v177
    v_max_f32 v177, 0, v177
    v_cvt_pk_bf16_f32 v178, v176, v177
    v_lshlrev_b32 v176, 16, v178
    v_and_b32 v177, 0xffff0000, v178
    v_add_f32 v177, 925353388, v177
    v_cvt_pk_bf16_f32 v178, v177, v177
    v_lshlrev_b32 v177, 16, v178
    v_sqrt_f32 v177, v177
    s_nop 0
    v_cvt_pk_bf16_f32 v178, v177, v177
    v_lshlrev_b32 v177, 16, v178
    v_rcp_f32 v177, v177
    v_sub_f32 v168, v168, v176
    v_sub_f32 v170, v170, v176
    v_sub_f32 v172, v172, v176
    v_sub_f32 v174, v174, v176
    v_sub_f32 v169, v169, v176
    v_sub_f32 v171, v171, v176
    v_sub_f32 v173, v173, v176
    v_sub_f32 v175, v175, v176
    v_cvt_pk_bf16_f32 v192, v168, v169
    v_cvt_pk_bf16_f32 v193, v170, v171
    v_cvt_pk_bf16_f32 v194, v172, v173
    v_cvt_pk_bf16_f32 v195, v174, v175
    v_lshlrev_b32 v168, 16, v192
    v_lshlrev_b32 v170, 16, v193
    v_lshlrev_b32 v172, 16, v194
    v_lshlrev_b32 v174, 16, v195
    v_and_b32 v169, 0xffff0000, v192
    v_and_b32 v171, 0xffff0000, v193
    v_and_b32 v173, 0xffff0000, v194
    v_and_b32 v175, 0xffff0000, v195
    v_mul_f32 v168, v168, v177
    v_mul_f32 v170, v170, v177
    v_mul_f32 v172, v172, v177
    v_mul_f32 v174, v174, v177
    v_mul_f32 v169, v169, v177
    v_mul_f32 v171, v171, v177
    v_mul_f32 v173, v173, v177
    v_mul_f32 v175, v175, v177
    v_cvt_pk_bf16_f32 v192, v168, v169
    v_cvt_pk_bf16_f32 v193, v170, v171
    v_cvt_pk_bf16_f32 v194, v172, v173
    v_cvt_pk_bf16_f32 v195, v174, v175
    v_lshlrev_b32 v168, 16, v192
    v_lshlrev_b32 v170, 16, v193
    v_lshlrev_b32 v172, 16, v194
    v_lshlrev_b32 v174, 16, v195
    v_and_b32 v169, 0xffff0000, v192
    v_and_b32 v171, 0xffff0000, v193
    v_and_b32 v173, 0xffff0000, v194
    v_and_b32 v175, 0xffff0000, v195
    v_cvt_pkrtz_f16_f32 v188, v168, v169
    v_cvt_pkrtz_f16_f32 v189, v170, v171
    v_cvt_pkrtz_f16_f32 v190, v172, v173
    v_cvt_pkrtz_f16_f32 v191, v174, v175
    s_add_u32 s61, s40, 165675008
    buffer_store_dwordx4 v[188:191], v6, s[8:11], s61 offen sc1
    s_add_u32 s40, s40, 65536
    s_mov_b64 exec, 1
    s_waitcnt vmcnt(0)
    buffer_store_dword v4, v3, s[8:11], s41 offen sc1
    s_mov_b64 exec, -1
    s_add_u32 s41, s41, 2048
    s_xor_b32 s38, s38, 1048576
    s_add_u32 s32, s32, 1
    s_bfe_u32 s58, s32, 0x10001
    s_xor_b32 s58, s58, 1
    s_cmp_lt_u32 s32, 32
    s_cbranch_scc1 L_ob_slow
    s_branch L_o_end
Lol1_41060:
    buffer_store_dwordx4 v[184:187], v6, s[20:23], s40 offen
    s_add_u32 s40, s40, 65536
    s_xor_b32 s38, s38, 1048576
    s_add_u32 s32, s32, 1
    s_bfe_u32 s58, s32, 0x10001
    s_xor_b32 s58, s58, 1
    s_cmp_lt_u32 s32, 32
    s_cbranch_scc1 L_ob_slow
    s_branch L_o_end
Lolr_41059:
    v_and_b32 v184, 1, v184
    v_and_b32 v185, 1, v185
    v_and_b32 v186, 1, v186
    v_and_b32 v187, 1, v187
    v_and_b32 v188, 1, v188
    v_and_b32 v189, 1, v189
    v_and_b32 v190, 1, v190
    v_and_b32 v191, 1, v191
    v_cmp_ne_u32 s[44:45], 0, v184
    v_cmp_ne_u32 s[46:47], 0, v185
    v_cmp_ne_u32 s[48:49], 0, v186
    v_cmp_ne_u32 s[50:51], 0, v187
    v_cmp_ne_u32 s[52:53], 0, v188
    v_cmp_ne_u32 s[54:55], 0, v189
    v_cmp_ne_u32 s[34:35], 0, v190
    v_cmp_ne_u32 s[36:37], 0, v191
    s_add_u32 s61, s38, 0
    s_mov_b64 exec, s[44:45]
    buffer_load_dwordx4 v[16:19], v5, s[8:11], s61 offen offset:0 sc1
    buffer_load_dwordx4 v[20:23], v5, s[8:11], s61 offen offset:512 sc1
    s_mov_b64 exec, s[46:47]
    buffer_load_dwordx4 v[24:27], v5, s[8:11], s61 offen offset:2048 sc1
    buffer_load_dwordx4 v[28:31], v5, s[8:11], s61 offen offset:2560 sc1
    s_add_u32 s33, s38, 4096
    s_mov_b64 exec, s[48:49]
    buffer_load_dwordx4 v[32:35], v5, s[8:11], s33 offen offset:0 sc1
    buffer_load_dwordx4 v[36:39], v5, s[8:11], s33 offen offset:512 sc1
    s_mov_b64 exec, s[50:51]
    buffer_load_dwordx4 v[40:43], v5, s[8:11], s33 offen offset:2048 sc1
    buffer_load_dwordx4 v[44:47], v5, s[8:11], s33 offen offset:2560 sc1
    s_add_u32 s61, s38, 8192
    s_mov_b64 exec, s[52:53]
    buffer_load_dwordx4 v[48:51], v5, s[8:11], s61 offen offset:0 sc1
    buffer_load_dwordx4 v[52:55], v5, s[8:11], s61 offen offset:512 sc1
    s_mov_b64 exec, s[54:55]
    buffer_load_dwordx4 v[56:59], v5, s[8:11], s61 offen offset:2048 sc1
    buffer_load_dwordx4 v[60:63], v5, s[8:11], s61 offen offset:2560 sc1
    s_add_u32 s33, s38, 12288
    s_mov_b64 exec, s[34:35]
    buffer_load_dwordx4 v[64:67], v5, s[8:11], s33 offen offset:0 sc1
    buffer_load_dwordx4 v[68:71], v5, s[8:11], s33 offen offset:512 sc1
    s_mov_b64 exec, s[36:37]
    buffer_load_dwordx4 v[72:75], v5, s[8:11], s33 offen offset:2048 sc1
    buffer_load_dwordx4 v[76:79], v5, s[8:11], s33 offen offset:2560 sc1
    s_mov_b64 exec, -1
    s_sub_u32 s62, s62, 1
    s_cbranch_scc0 Ltok_46057
    s_movk_i32 s61, 23
    s_branch L_abort
Ltok_46057:
    s_branch Lol_41058
L_o_end:
    s_branch L_end
L_conv:
    s_cmp_ge_i32 s63, 0
    s_cbranch_scc1 Lanns_46060
    v_and_b32 v16, 63, v0
    v_lshlrev_b32 v16, 2, v16
Lann_46058:
    buffer_load_dword v17, v16, s[12:15], 0 offen sc1
Lannc_46061:
    s_waitcnt vmcnt(0)
    v_and_b32 v19, 0x0f0f0f0f, v17
    v_subrev_u32 v18, 0x01010101, v19
    v_and_b32 v18, 0x80808080, v18
    v_cmp_ne_u32 vcc, 0, v18
    s_nop 0
    s_cbranch_vccz Lannd_46059
    s_sub_u32 s62, s62, 1
    s_cbranch_scc0 Ltok_46062
    s_movk_i32 s61, 1
    s_branch L_abort
Ltok_46062:
    s_sleep 4
    s_branch Lann_46058
Lannd_46059:
    s_getreg_b32 s32, hwreg(HW_REG_XCC_ID)
    s_and_b32 s32, s32, 15
    s_min_u32 s32, s32, 14
    s_add_u32 s32, s32, 1
    s_mul_i32 s32, s32, 0x11111111
    v_cmp_ne_u32 vcc, s32, v17
    s_not_b32 s33, s63
    s_lshl_b32 s33, s33, 3
    s_lshr_b64 s[34:35], vcc, s33
    s_and_b32 s34, s34, 0xff
    s_cmp_lg_u32 s34, 0
    s_cselect_b32 s63, 1, 0
Lanns_46060:
    s_lshr_b32 s6, s5, 4
    s_and_b32 s42, s5, 15
    v_and_b32 v40, 63, v0
    v_and_b32 v41, 31, v40
    v_lshrrev_b32 v42, 5, v40
    v_mov_b32 v13, -1
    v_lshlrev_b32 v6, 5, v41
    s_lshl_b32 s50, s42, 5
    s_lshl_b32 s51, s3, 3
    s_add_u32 s50, s50, s51
    v_lshlrev_b32 v43, 2, v42
    v_add_u32 v43, s50, v43
    v_and_b32 v44, 7, v40
    v_add_u32 v44, s50, v44
    v_lshlrev_b32 v44, 5, v44
    s_mov_b32 s51, 5701632
    buffer_load_dword v8, v44, s[8:11], s51 offen sc1
    s_mul_i32 s52, s3, 33280
    s_add_u32 s52, s52, 1024
    v_lshlrev_b32 v45, 1, v43
    v_lshlrev_b32 v46, 10, v41
    v_add_u32 v4, v46, v45
    s_lshl_b32 s53, s50, 6
    v_lshlrev_b32 v46, 4, v41
    v_lshlrev_b32 v47, 3, v42
    v_add_u32 v46, v46, v47
    v_add_u32 v5, s53, v46
    v_mul_u32_u24 v46, 1040, v42
    v_lshlrev_b32 v47, 4, v41
    v_add_u32 v46, v46, v47
    v_add_u32 v1, s52, v46
    v_sub_u32 v46, 32, v41
    v_and_b32 v47, 3, v46
    v_sub_u32 v46, v46, v47
    v_lshl_add_u32 v46, v42, 3, v46
    v_lshlrev_b32 v46, 1, v46
    v_mul_u32_u24 v47, 4160, v47
    v_add_u32 v46, v46, v47
    s_lshl_b32 s53, s3, 10
    s_add_u32 s53, s53, 134144
    v_add_u32 v2, s53, v46
    v_sub_u32 v46, 61, v41
    v_lshlrev_b32 v46, 1, v46
    v_lshl_add_u32 v46, v42, 9, v46
    v_add_u32 v3, s53, v46
    v_lshlrev_b32 v46, 3, v41
    v_lshl_add_u32 v10, v42, 2, v46
    s_lshl_b32 s53, s3, 8
    v_add_u32 v9, s53, v10
    s_lshl_b32 s53, s42, 8
    v_add_u32 v11, s53, v10
    s_lshl_b32 s53, s3, 3
    s_lshl_b32 s48, 0xff, s53
    s_mov_b32 s49, s48
    s_lshl_b32 s53, s6, 16
    s_add_u32 s33, s53, 5505024
    s_lshl_b32 s53, s6, 17
    s_lshl_b32 s54, s42, 7
    s_add_u32 s54, s54, s53
    s_lshl_b32 s55, s3, 5
    s_add_u32 s54, s54, s55
    s_add_u32 s38, s54, 5242880
    s_lshl_b32 s53, s6, 21
    s_add_u32 s34, s53, 163577856
    s_add_u32 s39, s53, 150994944
    s_add_u32 s37, s53, 155189248
    s_mov_b32 s32, 0
    s_mov_b32 s40, 1
    s_mov_b32 s41, 0
    s_cmp_lg_u32 s6, 0
    s_cbranch_scc1 L_conv_x1
    s_mov_b32 s35, 0
    s_mov_b32 s16, s64
    s_and_b32 s17, s65, 0xffff
    s_mov_b32 s18, 2097152
    s_mov_b32 s19, 0x20000
    s_branch L_conv_x2
L_conv_x1:
    s_mov_b32 s35, 159383552
    s_mov_b32 s16, s96
    s_and_b32 s17, s97, 0xffff
    s_mov_b32 s18, 268435456
    s_mov_b32 s19, 0x20000
L_conv_x2:
    buffer_load_dword v60, v6, s[8:11], s33 offen sc1
    v_mov_b32 v61, 0
    v_mov_b32 v62, 0
Lck_46063:
    s_waitcnt vmcnt(0)
    v_cmp_eq_u32 vcc, 0, v8
    s_nop 0
    s_cbranch_vccz Lckok_46064
    s_sleep 6
    buffer_load_dword v8, v44, s[8:11], s51 offen sc1
    s_sub_u32 s62, s62, 1
    s_cbranch_scc0 Ltok_46066
    s_movk_i32 s61, 30
    s_branch L_abort
Ltok_46066:
    s_branch Lck_46063
Lckok_46064:
    s_mul_i32 s51, s50, 4160
    s_add_u32 s51, s51, 167772160
    v_lshlrev_b32 v44, 4, v40
    s_add_u32 m0, s52, 0
    s_add_u32 s53, s51, 0
    buffer_load_dwordx4 v44, s[8:11], s53 offen offset:0 lds
    buffer_load_dwordx4 v44, s[8:11], s53 offen offset:1024 lds
    buffer_load_dwordx4 v44, s[8:11], s53 offen offset:2048 lds
    buffer_load_dwordx4 v44, s[8:11], s53 offen offset:3072 lds
    s_add_u32 m0, s52, 4096
    s_add_u32 s53, s51, 4096
    buffer_load_dwordx4 v44, s[8:11], s53 offen offset:0 lds
    buffer_load_dwordx4 v44, s[8:11], s53 offen offset:1024 lds
    buffer_load_dwordx4 v44, s[8:11], s53 offen offset:2048 lds
    buffer_load_dwordx4 v44, s[8:11], s53 offen offset:3072 lds
    s_add_u32 m0, s52, 8192
    s_add_u32 s53, s51, 8192
    buffer_load_dwordx4 v44, s[8:11], s53 offen offset:0 lds
    buffer_load_dwordx4 v44, s[8:11], s53 offen offset:1024 lds
    buffer_load_dwordx4 v44, s[8:11], s53 offen offset:2048 lds
    buffer_load_dwordx4 v44, s[8:11], s53 offen offset:3072 lds
    s_add_u32 m0, s52, 12288
    s_add_u32 s53, s51, 12288
    buffer_load_dwordx4 v44, s[8:11], s53 offen offset:0 lds
    buffer_load_dwordx4 v44, s[8:11], s53 offen offset:1024 lds
    buffer_load_dwordx4 v44, s[8:11], s53 offen offset:2048 lds
    buffer_load_dwordx4 v44, s[8:11], s53 offen offset:3072 lds
    s_add_u32 m0, s52, 16384
    s_add_u32 s53, s51, 16384
    buffer_load_dwordx4 v44, s[8:11], s53 offen offset:0 lds
    buffer_load_dwordx4 v44, s[8:11], s53 offen offset:1024 lds
    buffer_load_dwordx4 v44, s[8:11], s53 offen offset:2048 lds
    buffer_load_dwordx4 v44, s[8:11], s53 offen offset:3072 lds
    s_add_u32 m0, s52, 20480
    s_add_u32 s53, s51, 20480
    buffer_load_dwordx4 v44, s[8:11], s53 offen offset:0 lds
    buffer_load_dwordx4 v44, s[8:11], s53 offen offset:1024 lds
    buffer_load_dwordx4 v44, s[8:11], s53 offen offset:2048 lds
    buffer_load_dwordx4 v44, s[8:11], s53 offen offset:3072 lds
    s_add_u32 m0, s52, 24576
    s_add_u32 s53, s51, 24576
    buffer_load_dwordx4 v44, s[8:11], s53 offen offset:0 lds
    buffer_load_dwordx4 v44, s[8:11], s53 offen offset:1024 lds
    buffer_load_dwordx4 v44, s[8:11], s53 offen offset:2048 lds
    buffer_load_dwordx4 v44, s[8:11], s53 offen offset:3072 lds
    s_add_u32 m0, s52, 28672
    s_add_u32 s53, s51, 28672
    buffer_load_dwordx4 v44, s[8:11], s53 offen offset:0 lds
    buffer_load_dwordx4 v44, s[8:11], s53 offen offset:1024 lds
    buffer_load_dwordx4 v44, s[8:11], s53 offen offset:2048 lds
    buffer_load_dwordx4 v44, s[8:11], s53 offen offset:3072 lds
    s_add_u32 m0, s52, 32768
    s_add_u32 s53, s51, 32768
    s_mov_b32 exec_hi, 0
    buffer_load_dwordx4 v44, s[8:11], s53 offen offset:0 lds
    s_mov_b32 exec_hi, -1
    s_mov_b32 s20, s76
    s_and_b32 s21, s77, 0xffff
    s_mov_b32 s22, 1024
    s_mov_b32 s23, 0x20000
    v_lshlrev_b32 v46, 2, v43
    s_mov_b32 s53, 170917888
    buffer_load_dwordx4 v[16:19], v46, s[8:11], s53 offen sc1
    buffer_load_dwordx2 v[46:47], v45, s[20:23], 0 offen
    s_waitcnt vmcnt(35)
    v_cmp_eq_u32 vcc, 0, v60
    s_nop 0
    s_cbranch_vccnz Lcni_46065
    buffer_load_dwordx2 v[28:29], v4, s[8:11], s34 offen
    buffer_load_dwordx2 v[30:31], v4, s[16:19], s35 offen
    s_add_u32 s34, s34, 32768
    s_add_u32 s35, s35, 32768
    s_add_u32 s33, s33, 1024
    s_add_u32 s41, s41, 1
    s_cmp_ge_u32 s41, 64
    s_cselect_b32 s33, 5636096, s33
Lcni_46065:
    v_mov_b32 v48, 0
    v_mov_b32 v49, 0
    v_mov_b32 v50, 0
    v_mov_b32 v51, 0
    v_lshlrev_b32 v52, 4, v0
    v_add_u32 v52, 134144, v52
    ds_write_b128 v52, v[48:51] offset:0
    ds_write_b128 v52, v[48:51] offset:4096
    ds_write_b128 v52, v[48:51] offset:8192
    ds_write_b128 v52, v[48:51] offset:12288
    ds_write_b128 v52, v[48:51] offset:16384
    v_accvgpr_write_b32 a0, 0
    v_mov_b32 v128, 0
    v_accvgpr_write_b32 a1, 0
    v_mov_b32 v129, 0
    v_accvgpr_write_b32 a2, 0
    v_mov_b32 v130, 0
    v_accvgpr_write_b32 a3, 0
    v_mov_b32 v131, 0
    v_accvgpr_write_b32 a4, 0
    v_mov_b32 v132, 0
    v_accvgpr_write_b32 a5, 0
    v_mov_b32 v133, 0
    v_accvgpr_write_b32 a6, 0
    v_mov_b32 v134, 0
    v_accvgpr_write_b32 a7, 0
    v_mov_b32 v135, 0
    v_accvgpr_write_b32 a8, 0
    v_mov_b32 v136, 0
    v_accvgpr_write_b32 a9, 0
    v_mov_b32 v137, 0
    v_accvgpr_write_b32 a10, 0
    v_mov_b32 v138, 0
    v_accvgpr_write_b32 a11, 0
    v_mov_b32 v139, 0
    v_accvgpr_write_b32 a12, 0
    v_mov_b32 v140, 0
    v_accvgpr_write_b32 a13, 0
    v_mov_b32 v141, 0
    v_accvgpr_write_b32 a14, 0
    v_mov_b32 v142, 0
    v_accvgpr_write_b32 a15, 0
    v_mov_b32 v143, 0
    v_accvgpr_write_b32 a16, 0
    v_mov_b32 v144, 0
    v_accvgpr_write_b32 a17, 0
    v_mov_b32 v145, 0
    v_accvgpr_write_b32 a18, 0
    v_mov_b32 v146, 0
    v_accvgpr_write_b32 a19, 0
    v_mov_b32 v147, 0
    v_accvgpr_write_b32 a20, 0
    v_mov_b32 v148, 0
    v_accvgpr_write_b32 a21, 0
    v_mov_b32 v149, 0
    v_accvgpr_write_b32 a22, 0
    v_mov_b32 v150, 0
    v_accvgpr_write_b32 a23, 0
    v_mov_b32 v151, 0
    v_accvgpr_write_b32 a24, 0
    v_mov_b32 v152, 0
    v_accvgpr_write_b32 a25, 0
    v_mov_b32 v153, 0
    v_accvgpr_write_b32 a26, 0
    v_mov_b32 v154, 0
    v_accvgpr_write_b32 a27, 0
    v_mov_b32 v155, 0
    v_accvgpr_write_b32 a28, 0
    v_mov_b32 v156, 0
    v_accvgpr_write_b32 a29, 0
    v_mov_b32 v157, 0
    v_accvgpr_write_b32 a30, 0
    v_mov_b32 v158, 0
    v_accvgpr_write_b32 a31, 0
    v_mov_b32 v159, 0
    v_accvgpr_write_b32 a32, 0
    v_mov_b32 v160, 0
    v_accvgpr_write_b32 a33, 0
    v_mov_b32 v161, 0
    v_accvgpr_write_b32 a34, 0
    v_mov_b32 v162, 0
    v_accvgpr_write_b32 a35, 0
    v_mov_b32 v163, 0
    v_accvgpr_write_b32 a36, 0
    v_mov_b32 v164, 0
    v_accvgpr_write_b32 a37, 0
    v_mov_b32 v165, 0
    v_accvgpr_write_b32 a38, 0
    v_mov_b32 v166, 0
    v_accvgpr_write_b32 a39, 0
    v_mov_b32 v167, 0
    v_accvgpr_write_b32 a40, 0
    v_mov_b32 v168, 0
    v_accvgpr_write_b32 a41, 0
    v_mov_b32 v169, 0
    v_accvgpr_write_b32 a42, 0
    v_mov_b32 v170, 0
    v_accvgpr_write_b32 a43, 0
    v_mov_b32 v171, 0
    v_accvgpr_write_b32 a44, 0
    v_mov_b32 v172, 0
    v_accvgpr_write_b32 a45, 0
    v_mov_b32 v173, 0
    v_accvgpr_write_b32 a46, 0
    v_mov_b32 v174, 0
    v_accvgpr_write_b32 a47, 0
    v_mov_b32 v175, 0
    v_accvgpr_write_b32 a48, 0
    v_mov_b32 v176, 0
    v_accvgpr_write_b32 a49, 0
    v_mov_b32 v177, 0
    v_accvgpr_write_b32 a50, 0
    v_mov_b32 v178, 0
    v_accvgpr_write_b32 a51, 0
    v_mov_b32 v179, 0
    v_accvgpr_write_b32 a52, 0
    v_mov_b32 v180, 0
    v_accvgpr_write_b32 a53, 0
    v_mov_b32 v181, 0
    v_accvgpr_write_b32 a54, 0
    v_mov_b32 v182, 0
    v_accvgpr_write_b32 a55, 0
    v_mov_b32 v183, 0
    v_accvgpr_write_b32 a56, 0
    v_mov_b32 v184, 0
    v_accvgpr_write_b32 a57, 0
    v_mov_b32 v185, 0
    v_accvgpr_write_b32 a58, 0
    v_mov_b32 v186, 0
    v_accvgpr_write_b32 a59, 0
    v_mov_b32 v187, 0
    v_accvgpr_write_b32 a60, 0
    v_mov_b32 v188, 0
    v_accvgpr_write_b32 a61, 0
    v_mov_b32 v189, 0
    v_accvgpr_write_b32 a62, 0
    v_mov_b32 v190, 0
    v_accvgpr_write_b32 a63, 0
    v_mov_b32 v191, 0
    v_accvgpr_write_b32 a64, 0
    v_mov_b32 v192, 0
    v_accvgpr_write_b32 a65, 0
    v_mov_b32 v193, 0
    v_accvgpr_write_b32 a66, 0
    v_mov_b32 v194, 0
    v_accvgpr_write_b32 a67, 0
    v_mov_b32 v195, 0
    v_accvgpr_write_b32 a68, 0
    v_mov_b32 v196, 0
    v_accvgpr_write_b32 a69, 0
    v_mov_b32 v197, 0
    v_accvgpr_write_b32 a70, 0
    v_mov_b32 v198, 0
    v_accvgpr_write_b32 a71, 0
    v_mov_b32 v199, 0
    v_accvgpr_write_b32 a72, 0
    v_mov_b32 v200, 0
    v_accvgpr_write_b32 a73, 0
    v_mov_b32 v201, 0
    v_accvgpr_write_b32 a74, 0
    v_mov_b32 v202, 0
    v_accvgpr_write_b32 a75, 0
    v_mov_b32 v203, 0
    v_accvgpr_write_b32 a76, 0
    v_mov_b32 v204, 0
    v_accvgpr_write_b32 a77, 0
    v_mov_b32 v205, 0
    v_accvgpr_write_b32 a78, 0
    v_mov_b32 v206, 0
    v_accvgpr_write_b32 a79, 0
    v_mov_b32 v207, 0
    v_accvgpr_write_b32 a80, 0
    v_mov_b32 v208, 0
    v_accvgpr_write_b32 a81, 0
    v_mov_b32 v209, 0
    v_accvgpr_write_b32 a82, 0
    v_mov_b32 v210, 0
    v_accvgpr_write_b32 a83, 0
    v_mov_b32 v211, 0
    v_accvgpr_write_b32 a84, 0
    v_mov_b32 v212, 0
    v_accvgpr_write_b32 a85, 0
    v_mov_b32 v213, 0
    v_accvgpr_write_b32 a86, 0
    v_mov_b32 v214, 0
    v_accvgpr_write_b32 a87, 0
    v_mov_b32 v215, 0
    v_accvgpr_write_b32 a88, 0
    v_mov_b32 v216, 0
    v_accvgpr_write_b32 a89, 0
    v_mov_b32 v217, 0
    v_accvgpr_write_b32 a90, 0
    v_mov_b32 v218, 0
    v_accvgpr_write_b32 a91, 0
    v_mov_b32 v219, 0
    v_accvgpr_write_b32 a92, 0
    v_mov_b32 v220, 0
    v_accvgpr_write_b32 a93, 0
    v_mov_b32 v221, 0
    v_accvgpr_write_b32 a94, 0
    v_mov_b32 v222, 0
    v_accvgpr_write_b32 a95, 0
    v_mov_b32 v223, 0
    v_accvgpr_write_b32 a96, 0
    v_mov_b32 v224, 0
    v_accvgpr_write_b32 a97, 0
    v_mov_b32 v225, 0
    v_accvgpr_write_b32 a98, 0
    v_mov_b32 v226, 0
    v_accvgpr_write_b32 a99, 0
    v_mov_b32 v227, 0
    v_accvgpr_write_b32 a100, 0
    v_mov_b32 v228, 0
    v_accvgpr_write_b32 a101, 0
    v_mov_b32 v229, 0
    v_accvgpr_write_b32 a102, 0
    v_mov_b32 v230, 0
    v_accvgpr_write_b32 a103, 0
    v_mov_b32 v231, 0
    v_accvgpr_write_b32 a104, 0
    v_mov_b32 v232, 0
    v_accvgpr_write_b32 a105, 0
    v_mov_b32 v233, 0
    v_accvgpr_write_b32 a106, 0
    v_mov_b32 v234, 0
    v_accvgpr_write_b32 a107, 0
    v_mov_b32 v235, 0
    v_accvgpr_write_b32 a108, 0
    v_mov_b32 v236, 0
    v_accvgpr_write_b32 a109, 0
    v_mov_b32 v237, 0
    v_accvgpr_write_b32 a110, 0
    v_mov_b32 v238, 0
    v_accvgpr_write_b32 a111, 0
    v_mov_b32 v239, 0
    v_accvgpr_write_b32 a112, 0
    v_mov_b32 v240, 0
    v_accvgpr_write_b32 a113, 0
    v_mov_b32 v241, 0
    v_accvgpr_write_b32 a114, 0
    v_mov_b32 v242, 0
    v_accvgpr_write_b32 a115, 0
    v_mov_b32 v243, 0
    v_accvgpr_write_b32 a116, 0
    v_mov_b32 v244, 0
    v_accvgpr_write_b32 a117, 0
    v_mov_b32 v245, 0
    v_accvgpr_write_b32 a118, 0
    v_mov_b32 v246, 0
    v_accvgpr_write_b32 a119, 0
    v_mov_b32 v247, 0
    v_accvgpr_write_b32 a120, 0
    v_mov_b32 v248, 0
    v_accvgpr_write_b32 a121, 0
    v_mov_b32 v249, 0
    v_accvgpr_write_b32 a122, 0
    v_mov_b32 v250, 0
    v_accvgpr_write_b32 a123, 0
    v_mov_b32 v251, 0
    v_accvgpr_write_b32 a124, 0
    v_mov_b32 v252, 0
    v_accvgpr_write_b32 a125, 0
    v_mov_b32 v253, 0
    v_accvgpr_write_b32 a126, 0
    v_mov_b32 v254, 0
    v_accvgpr_write_b32 a127, 0
    v_mov_b32 v255, 0
    s_waitcnt vmcnt(0) lgkmcnt(0)
    v_lshlrev_b32 v20, 16, v46
    v_and_b32 v21, 0xffff0000, v46
    v_lshlrev_b32 v22, 16, v47
    v_and_b32 v23, 0xffff0000, v47
    s_barrier
    ds_read_b128 v[64:67], v1 offset:16
    ds_read_b128 v[68:71], v1 offset:2096
    ds_read_b128 v[72:75], v1 offset:16656
    ds_read_b128 v[76:79], v1 offset:18736
    ds_read_b128 v[80:83], v1 offset:4176
    ds_read_b128 v[84:87], v1 offset:6256
    ds_read_b128 v[88:91], v1 offset:20816
    ds_read_b128 v[92:95], v1 offset:22896
    ds_read_b128 v[96:99], v1 offset:8336
    ds_read_b128 v[100:103], v1 offset:10416
    ds_read_b128 v[104:107], v1 offset:24976
    ds_read_b128 v[108:111], v1 offset:27056
    ds_read_b128 v[112:115], v1 offset:12496
    ds_read_b128 v[116:119], v1 offset:14576
    ds_read_b128 v[120:123], v1 offset:29136
    ds_read_b128 v[124:127], v1 offset:31216
    s_cmp_eq_u32 s41, 0
    s_cbranch_scc1 L_conv_in
L_conv_t0:
    s_waitcnt vmcnt(2)
    ds_write_b16 v3, v28 offset:6
    ds_write_b16 v3, v28 offset:4164
    ds_write_b16 v3, v28 offset:8322
    ds_write_b16 v3, v28 offset:12480
    ds_read_b64 a[128:129], v2 offset:64
    ds_read_b64 a[130:131], v2 offset:72
    ds_read_b64 a[132:133], v2 offset:96
    ds_read_b64 a[134:135], v2 offset:104
    ds_read_b64 a[136:137], v2 offset:576
    ds_read_b64 a[138:139], v2 offset:584
    ds_read_b64 a[140:141], v2 offset:608
    ds_read_b64 a[142:143], v2 offset:616
    ds_write_b16_d16_hi v3, v28 offset:134
    ds_write_b16_d16_hi v3, v28 offset:4292
    ds_write_b16_d16_hi v3, v28 offset:8450
    ds_write_b16_d16_hi v3, v28 offset:12608
    s_bfe_u32 s44, s32, 0x20003
    s_lshl_b32 s44, s44, 2
    s_and_b32 s61, s32, 3
    s_add_u32 s44, s44, s61
    s_bitcmp1_b32 s32, 2
    s_cselect_b64 s[46:47], -1, 0
    buffer_load_dword v8, v6, s[8:11], s33 offen sc1
    s_waitcnt lgkmcnt(10)
    v_mfma_f32_32x32x16_f16 v[128:143], v[64:67], a[128:131], v[128:143]
    ds_read_b64 a[144:145], v2 offset:192
    ds_read_b64 a[146:147], v2 offset:200
    ds_read_b64 a[148:149], v2 offset:224
    ds_read_b64 a[150:151], v2 offset:232
    v_mov_b32 v24, v28
    v_mov_b32 v25, v29
    v_cvt_f32_f16 v52, v28
    s_waitcnt lgkmcnt(12)
    v_mfma_f32_32x32x16_f16 v[128:143], v[68:71], a[132:135], v[128:143]
    ds_read_b64 a[152:153], v2 offset:704
    ds_read_b64 a[154:155], v2 offset:712
    ds_read_b64 a[156:157], v2 offset:736
    ds_read_b64 a[158:159], v2 offset:744
    v_cvt_f32_f16_sdwa v53, v28 dst_sel:DWORD dst_unused:UNUSED_PAD src0_sel:WORD_1
    v_cvt_f32_f16 v54, v29
    v_cvt_f32_f16_sdwa v55, v29 dst_sel:DWORD dst_unused:UNUSED_PAD src0_sel:WORD_1
    s_waitcnt lgkmcnt(14)
    v_mfma_f32_32x32x16_f16 v[192:207], v[72:75], a[136:139], v[192:207]
    ds_write_b16 v3, v29 offset:262
    ds_write_b16 v3, v29 offset:4420
    ds_write_b16 v3, v29 offset:8578
    ds_write_b16 v3, v29 offset:12736
    v_mul_f32 v52, v52, v20
    v_mul_f32 v53, v53, v21
    v_mul_f32 v54, v54, v22
    s_waitcnt lgkmcnt(15)
    v_mfma_f32_32x32x16_f16 v[192:207], v[76:79], a[140:143], v[192:207]
    ds_read_b64 a[160:161], v2 offset:320
    ds_read_b64 a[162:163], v2 offset:328
    ds_read_b64 a[164:165], v2 offset:352
    ds_read_b64 a[166:167], v2 offset:360
    v_mul_f32 v55, v55, v23
    v_cvt_pk_bf16_f32 v40, v52, v53
    v_lshlrev_b32 v52, 16, v40
    s_waitcnt lgkmcnt(14)
    v_mfma_f32_32x32x16_f16 v[144:159], v[80:83], a[144:147], v[144:159]
    ds_read_b64 a[168:169], v2 offset:832
    ds_read_b64 a[170:171], v2 offset:840
    ds_read_b64 a[172:173], v2 offset:864
    ds_read_b64 a[174:175], v2 offset:872
    v_and_b32 v53, 0xffff0000, v40
    v_cvt_pk_bf16_f32 v40, v54, v55
    v_lshlrev_b32 v54, 16, v40
    s_waitcnt lgkmcnt(15)
    v_mfma_f32_32x32x16_f16 v[144:159], v[84:87], a[148:151], v[144:159]
    ds_write_b16_d16_hi v3, v29 offset:390
    ds_write_b16_d16_hi v3, v29 offset:4548
    ds_write_b16_d16_hi v3, v29 offset:8706
    ds_write_b16_d16_hi v3, v29 offset:12864
    v_and_b32 v55, 0xffff0000, v40
    s_waitcnt vmcnt(2)
    v_lshlrev_b32 v56, 16, v30
    v_and_b32 v57, 0xffff0000, v30
    s_waitcnt lgkmcnt(15)
    v_mfma_f32_32x32x16_f16 v[208:223], v[88:91], a[152:155], v[208:223]
    ds_read_b64 a[176:177], v2 offset:448
    ds_read_b64 a[178:179], v2 offset:456
    ds_read_b64 a[180:181], v2 offset:480
    ds_read_b64 a[182:183], v2 offset:488
    v_lshlrev_b32 v58, 16, v31
    v_and_b32 v59, 0xffff0000, v31
    v_mfma_f32_32x32x16_f16 v[208:223], v[92:95], a[156:159], v[208:223]
    ds_read_b64 a[184:185], v2 offset:960
    ds_read_b64 a[186:187], v2 offset:968
    ds_read_b64 a[188:189], v2 offset:992
    ds_read_b64 a[190:191], v2 offset:1000
    s_waitcnt lgkmcnt(15)
    v_mfma_f32_32x32x16_f16 v[160:175], v[96:99], a[160:163], v[160:175]
    ds_read_b128 v[64:67], v1 offset:528
    ds_read_b128 v[68:71], v1 offset:2608
    v_mfma_f32_32x32x16_f16 v[160:175], v[100:103], a[164:167], v[160:175]
    ds_read_b128 v[72:75], v1 offset:17168
    ds_read_b128 v[76:79], v1 offset:19248
    s_waitcnt lgkmcnt(15)
    v_mfma_f32_32x32x16_f16 v[224:239], v[104:107], a[168:171], v[224:239]
    ds_read_b128 v[80:83], v1 offset:4688
    ds_read_b128 v[84:87], v1 offset:6768
    s_set_gpr_idx_on s44, gpr_idx(SRC0)
    v_mov_b32 v32, v128
    v_mov_b32 v48, v192
    v_mov_b32 v33, v144
    v_mov_b32 v49, v208
    s_set_gpr_idx_off
    v_mfma_f32_32x32x16_f16 v[224:239], v[108:111], a[172:175], v[224:239]
    ds_read_b128 v[88:91], v1 offset:21328
    ds_read_b128 v[92:95], v1 offset:23408
    v_permlane32_swap_b32 v32, v48
    v_permlane32_swap_b32 v33, v49
    v_cndmask_b32 v32, v32, v48, s[46:47]
    v_cndmask_b32 v33, v33, v49, s[46:47]
    v_mul_f32 v32, v32, v16
    s_waitcnt lgkmcnt(14)
    v_mfma_f32_32x32x16_f16 v[176:191], v[112:115], a[176:179], v[176:191]
    ds_read_b128 v[96:99], v1 offset:8848
    ds_read_b128 v[100:103], v1 offset:10928
    v_mul_f32 v33, v33, v17
    v_cvt_pk_bf16_f32 v40, v32, v33
    v_lshlrev_b32 v32, 16, v40
    v_and_b32 v33, 0xffff0000, v40
    v_add_f32 v32, v32, v52
    s_waitcnt lgkmcnt(14)
    v_mfma_f32_32x32x16_f16 v[176:191], v[116:119], a[180:183], v[176:191]
    ds_read_b128 v[104:107], v1 offset:25488
    ds_read_b128 v[108:111], v1 offset:27568
    v_add_f32 v33, v33, v53
    v_cvt_pk_bf16_f32 v40, v32, v33
    v_lshlrev_b32 v32, 16, v40
    v_and_b32 v33, 0xffff0000, v40
    v_add_f32 v32, v32, v56
    s_waitcnt lgkmcnt(14)
    v_mfma_f32_32x32x16_f16 v[240:255], v[120:123], a[184:187], v[240:255]
    ds_read_b128 v[112:115], v1 offset:13008
    ds_read_b128 v[116:119], v1 offset:15088
    v_add_f32 v33, v33, v57
    v_cvt_pk_bf16_f32 v36, v32, v33
    v_lshlrev_b32 v32, 16, v36
    v_and_b32 v33, 0xffff0000, v36
    v_add_f32 v42, v32, v33
    s_waitcnt lgkmcnt(14)
    v_mfma_f32_32x32x16_f16 v[240:255], v[124:127], a[188:191], v[240:255]
    ds_read_b128 v[120:123], v1 offset:29648
    ds_read_b128 v[124:127], v1 offset:31728
    v_mul_f32 v43, v32, v32
    v_fmac_f32 v43, v33, v33
    s_set_gpr_idx_on s44, gpr_idx(SRC0)
    v_mov_b32 v34, v160
    v_mov_b32 v50, v224
    v_mov_b32 v35, v176
    s_nop 3
    v_mov_b32 v51, v240
    s_set_gpr_idx_off
    v_permlane32_swap_b32 v34, v50
    v_permlane32_swap_b32 v35, v51
    v_cndmask_b32 v34, v34, v50, s[46:47]
    v_cndmask_b32 v35, v35, v51, s[46:47]
    v_mul_f32 v34, v34, v18
    v_mul_f32 v35, v35, v19
    v_cvt_pk_bf16_f32 v40, v34, v35
    v_lshlrev_b32 v34, 16, v40
    v_and_b32 v35, 0xffff0000, v40
    v_add_f32 v34, v34, v54
    v_add_f32 v35, v35, v55
    v_cvt_pk_bf16_f32 v40, v34, v35
    v_lshlrev_b32 v34, 16, v40
    v_and_b32 v35, 0xffff0000, v40
    v_add_f32 v34, v34, v58
    v_add_f32 v35, v35, v59
    v_cvt_pk_bf16_f32 v37, v34, v35
    v_lshlrev_b32 v34, 16, v37
    v_and_b32 v35, 0xffff0000, v37
    buffer_store_dwordx2 v[36:37], v5, s[8:11], s37 offen sc1
    v_add_f32 v42, v42, v34
    v_fmac_f32 v43, v34, v34
    v_add_f32 v42, v42, v35
    v_fmac_f32 v43, v35, v35
    s_nop 1
    v_permlane32_swap_b32 v42, v43
    v_add_f32 v42, v42, v43
    ds_write_b32 v9, v42 offset:0
    s_add_u32 s32, s32, 1
    s_add_u32 s37, s37, 32768
    s_waitcnt lgkmcnt(0)
    s_barrier
    ds_read_b32 v44, v10 offset:0
    ds_read_b32 v45, v10 offset:256
    ds_read_b32 v46, v10 offset:512
    ds_read_b32 v47, v10 offset:768
    v_xor_b32 v9, 159744, v9
    v_xor_b32 v10, 159744, v10
    s_waitcnt vmcnt(1)
    v_cmp_eq_u32 vcc, 0, v8
    s_waitcnt lgkmcnt(2)
    v_add_f32 v44, v44, v45
    s_waitcnt lgkmcnt(0)
    v_add_f32 v46, v46, v47
    v_add_f32 v44, v44, v46
    s_mov_b64 exec, s[48:49]
    buffer_store_dword v44, v11, s[8:11], s39 offen sc1
    s_mov_b64 exec, -1
    s_add_u32 s39, s39, 4096
    s_cbranch_vccnz Lcw_46067
    buffer_load_dwordx2 v[28:29], v4, s[8:11], s34 offen
    buffer_load_dwordx2 v[30:31], v4, s[16:19], s35 offen
    s_add_u32 s34, s34, 32768
    s_add_u32 s35, s35, 32768
    s_add_u32 s33, s33, 1024
    s_add_u32 s41, s41, 1
    s_cmp_ge_u32 s41, 64
    s_cselect_b32 s33, 5636096, s33
    v_mfma_f32_32x32x16_f16 a[0:15], v[64:67], a[128:131], a[0:15]
    ds_read_b128 v[64:67], v1 offset:0
    ds_write_b16 v3, v24 offset:70
    v_mfma_f32_32x32x16_f16 a[0:15], v[68:71], a[132:135], a[0:15]
    ds_read_b128 v[68:71], v1 offset:2080
    ds_write_b16 v3, v24 offset:4228
    v_mfma_f32_32x32x16_f16 a[64:79], v[72:75], a[136:139], a[64:79]
    ds_read_b128 v[72:75], v1 offset:16640
    ds_write_b16 v3, v24 offset:8386
    v_mfma_f32_32x32x16_f16 a[64:79], v[76:79], a[140:143], a[64:79]
    ds_read_b128 v[76:79], v1 offset:18720
    ds_write_b16 v3, v24 offset:12544
    v_mfma_f32_32x32x16_f16 a[16:31], v[80:83], a[144:147], a[16:31]
    ds_read_b128 v[80:83], v1 offset:4160
    ds_write_b16_d16_hi v3, v24 offset:198
    v_mfma_f32_32x32x16_f16 a[16:31], v[84:87], a[148:151], a[16:31]
    ds_read_b128 v[84:87], v1 offset:6240
    ds_write_b16_d16_hi v3, v24 offset:4356
    v_mfma_f32_32x32x16_f16 a[80:95], v[88:91], a[152:155], a[80:95]
    ds_read_b128 v[88:91], v1 offset:20800
    ds_write_b16_d16_hi v3, v24 offset:8514
    v_mfma_f32_32x32x16_f16 a[80:95], v[92:95], a[156:159], a[80:95]
    ds_read_b128 v[92:95], v1 offset:22880
    ds_write_b16_d16_hi v3, v24 offset:12672
    v_mfma_f32_32x32x16_f16 a[32:47], v[96:99], a[160:163], a[32:47]
    ds_read_b128 v[96:99], v1 offset:8320
    ds_write_b16 v3, v25 offset:326
    v_mfma_f32_32x32x16_f16 a[32:47], v[100:103], a[164:167], a[32:47]
    ds_read_b128 v[100:103], v1 offset:10400
    ds_write_b16 v3, v25 offset:4484
    v_mfma_f32_32x32x16_f16 a[96:111], v[104:107], a[168:171], a[96:111]
    ds_read_b128 v[104:107], v1 offset:24960
    ds_write_b16 v3, v25 offset:8642
    v_mfma_f32_32x32x16_f16 a[96:111], v[108:111], a[172:175], a[96:111]
    ds_read_b128 v[108:111], v1 offset:27040
    ds_write_b16 v3, v25 offset:12800
    v_mfma_f32_32x32x16_f16 a[48:63], v[112:115], a[176:179], a[48:63]
    ds_read_b128 v[112:115], v1 offset:12480
    ds_write_b16_d16_hi v3, v25 offset:454
    v_mfma_f32_32x32x16_f16 a[48:63], v[116:119], a[180:183], a[48:63]
    ds_read_b128 v[116:119], v1 offset:14560
    ds_write_b16_d16_hi v3, v25 offset:4612
    v_mfma_f32_32x32x16_f16 a[112:127], v[120:123], a[184:187], a[112:127]
    ds_read_b128 v[120:123], v1 offset:29120
    ds_write_b16_d16_hi v3, v25 offset:8770
    v_mfma_f32_32x32x16_f16 a[112:127], v[124:127], a[188:191], a[112:127]
    ds_read_b128 v[124:127], v1 offset:31200
    ds_write_b16_d16_hi v3, v25 offset:12928
    v_subrev_u32 v1, 16, v1
    s_waitcnt vmcnt(2)
    s_mov_b64 exec, 1
    buffer_store_dword v13, off, s[8:11], s38 sc1
    s_mov_b64 exec, -1
    s_add_u32 s38, s38, 2048
L_conv_n0:
    s_cmp_lt_u32 s32, 32
    s_cbranch_scc1 L_conv_t0
    ds_read_b128 v[64:67], v1 offset:528
    ds_read_b128 v[68:71], v1 offset:2608
    ds_read_b128 v[72:75], v1 offset:17168
    ds_read_b128 v[76:79], v1 offset:19248
    ds_read_b128 v[80:83], v1 offset:4688
    ds_read_b128 v[84:87], v1 offset:6768
    ds_read_b128 v[88:91], v1 offset:21328
    ds_read_b128 v[92:95], v1 offset:23408
    ds_read_b128 v[96:99], v1 offset:8848
    ds_read_b128 v[100:103], v1 offset:10928
    ds_read_b128 v[104:107], v1 offset:25488
    ds_read_b128 v[108:111], v1 offset:27568
    ds_read_b128 v[112:115], v1 offset:13008
    ds_read_b128 v[116:119], v1 offset:15088
    ds_read_b128 v[120:123], v1 offset:29648
    ds_read_b128 v[124:127], v1 offset:31728
    v_accvgpr_read_b32 v128, a0
    v_accvgpr_read_b32 v129, a1
    v_accvgpr_read_b32 v130, a2
    v_accvgpr_read_b32 v131, a3
    v_accvgpr_read_b32 v132, a4
    v_accvgpr_read_b32 v133, a5
    v_accvgpr_read_b32 v134, a6
    v_accvgpr_read_b32 v135, a7
    v_accvgpr_read_b32 v136, a8
    v_accvgpr_read_b32 v137, a9
    v_accvgpr_read_b32 v138, a10
    v_accvgpr_read_b32 v139, a11
    v_accvgpr_read_b32 v140, a12
    v_accvgpr_read_b32 v141, a13
    v_accvgpr_read_b32 v142, a14
    v_accvgpr_read_b32 v143, a15
    v_accvgpr_read_b32 v144, a16
    v_accvgpr_read_b32 v145, a17
    v_accvgpr_read_b32 v146, a18
    v_accvgpr_read_b32 v147, a19
    v_accvgpr_read_b32 v148, a20
    v_accvgpr_read_b32 v149, a21
    v_accvgpr_read_b32 v150, a22
    v_accvgpr_read_b32 v151, a23
    v_accvgpr_read_b32 v152, a24
    v_accvgpr_read_b32 v153, a25
    v_accvgpr_read_b32 v154, a26
    v_accvgpr_read_b32 v155, a27
    v_accvgpr_read_b32 v156, a28
    v_accvgpr_read_b32 v157, a29
    v_accvgpr_read_b32 v158, a30
    v_accvgpr_read_b32 v159, a31
    v_accvgpr_read_b32 v160, a32
    v_accvgpr_read_b32 v161, a33
    v_accvgpr_read_b32 v162, a34
    v_accvgpr_read_b32 v163, a35
    v_accvgpr_read_b32 v164, a36
    v_accvgpr_read_b32 v165, a37
    v_accvgpr_read_b32 v166, a38
    v_accvgpr_read_b32 v167, a39
    v_accvgpr_read_b32 v168, a40
    v_accvgpr_read_b32 v169, a41
    v_accvgpr_read_b32 v170, a42
    v_accvgpr_read_b32 v171, a43
    v_accvgpr_read_b32 v172, a44
    v_accvgpr_read_b32 v173, a45
    v_accvgpr_read_b32 v174, a46
    v_accvgpr_read_b32 v175, a47
    v_accvgpr_read_b32 v176, a48
    v_accvgpr_read_b32 v177, a49
    v_accvgpr_read_b32 v178, a50
    v_accvgpr_read_b32 v179, a51
    v_accvgpr_read_b32 v180, a52
    v_accvgpr_read_b32 v181, a53
    v_accvgpr_read_b32 v182, a54
    v_accvgpr_read_b32 v183, a55
    v_accvgpr_read_b32 v184, a56
    v_accvgpr_read_b32 v185, a57
    v_accvgpr_read_b32 v186, a58
    v_accvgpr_read_b32 v187, a59
    v_accvgpr_read_b32 v188, a60
    v_accvgpr_read_b32 v189, a61
    v_accvgpr_read_b32 v190, a62
    v_accvgpr_read_b32 v191, a63
    v_accvgpr_read_b32 v192, a64
    v_accvgpr_read_b32 v193, a65
    v_accvgpr_read_b32 v194, a66
    v_accvgpr_read_b32 v195, a67
    v_accvgpr_read_b32 v196, a68
    v_accvgpr_read_b32 v197, a69
    v_accvgpr_read_b32 v198, a70
    v_accvgpr_read_b32 v199, a71
    v_accvgpr_read_b32 v200, a72
    v_accvgpr_read_b32 v201, a73
    v_accvgpr_read_b32 v202, a74
    v_accvgpr_read_b32 v203, a75
    v_accvgpr_read_b32 v204, a76
    v_accvgpr_read_b32 v205, a77
    v_accvgpr_read_b32 v206, a78
    v_accvgpr_read_b32 v207, a79
    v_accvgpr_read_b32 v208, a80
    v_accvgpr_read_b32 v209, a81
    v_accvgpr_read_b32 v210, a82
    v_accvgpr_read_b32 v211, a83
    v_accvgpr_read_b32 v212, a84
    v_accvgpr_read_b32 v213, a85
    v_accvgpr_read_b32 v214, a86
    v_accvgpr_read_b32 v215, a87
    v_accvgpr_read_b32 v216, a88
    v_accvgpr_read_b32 v217, a89
    v_accvgpr_read_b32 v218, a90
    v_accvgpr_read_b32 v219, a91
    v_accvgpr_read_b32 v220, a92
    v_accvgpr_read_b32 v221, a93
    v_accvgpr_read_b32 v222, a94
    v_accvgpr_read_b32 v223, a95
    v_accvgpr_read_b32 v224, a96
    v_accvgpr_read_b32 v225, a97
    v_accvgpr_read_b32 v226, a98
    v_accvgpr_read_b32 v227, a99
    v_accvgpr_read_b32 v228, a100
    v_accvgpr_read_b32 v229, a101
    v_accvgpr_read_b32 v230, a102
    v_accvgpr_read_b32 v231, a103
    v_accvgpr_read_b32 v232, a104
    v_accvgpr_read_b32 v233, a105
    v_accvgpr_read_b32 v234, a106
    v_accvgpr_read_b32 v235, a107
    v_accvgpr_read_b32 v236, a108
    v_accvgpr_read_b32 v237, a109
    v_accvgpr_read_b32 v238, a110
    v_accvgpr_read_b32 v239, a111
    v_accvgpr_read_b32 v240, a112
    v_accvgpr_read_b32 v241, a113
    v_accvgpr_read_b32 v242, a114
    v_accvgpr_read_b32 v243, a115
    v_accvgpr_read_b32 v244, a116
    v_accvgpr_read_b32 v245, a117
    v_accvgpr_read_b32 v246, a118
    v_accvgpr_read_b32 v247, a119
    v_accvgpr_read_b32 v248, a120
    v_accvgpr_read_b32 v249, a121
    v_accvgpr_read_b32 v250, a122
    v_accvgpr_read_b32 v251, a123
    v_accvgpr_read_b32 v252, a124
    v_accvgpr_read_b32 v253, a125
    v_accvgpr_read_b32 v254, a126
    v_accvgpr_read_b32 v255, a127
L_conv_t1:
    s_waitcnt vmcnt(2)
    ds_write_b16 v3, v28 offset:6
    ds_write_b16 v3, v28 offset:4164
    ds_write_b16 v3, v28 offset:8322
    ds_write_b16 v3, v28 offset:12480
    ds_read_b64 a[128:129], v2 offset:64
    ds_read_b64 a[130:131], v2 offset:72
    ds_read_b64 a[132:133], v2 offset:96
    ds_read_b64 a[134:135], v2 offset:104
    ds_read_b64 a[136:137], v2 offset:576
    ds_read_b64 a[138:139], v2 offset:584
    ds_read_b64 a[140:141], v2 offset:608
    ds_read_b64 a[142:143], v2 offset:616
    ds_write_b16_d16_hi v3, v28 offset:134
    ds_write_b16_d16_hi v3, v28 offset:4292
    ds_write_b16_d16_hi v3, v28 offset:8450
    ds_write_b16_d16_hi v3, v28 offset:12608
    s_bfe_u32 s44, s32, 0x20003
    s_lshl_b32 s44, s44, 2
    s_and_b32 s61, s32, 3
    s_add_u32 s44, s44, s61
    s_bitcmp1_b32 s32, 2
    s_cselect_b64 s[46:47], -1, 0
    buffer_load_dword v8, v6, s[8:11], s33 offen sc1
    s_waitcnt lgkmcnt(10)
    v_mfma_f32_32x32x16_f16 v[128:143], v[64:67], a[128:131], v[128:143]
    ds_read_b64 a[144:145], v2 offset:192
    ds_read_b64 a[146:147], v2 offset:200
    ds_read_b64 a[148:149], v2 offset:224
    ds_read_b64 a[150:151], v2 offset:232
    v_mov_b32 v24, v28
    v_mov_b32 v25, v29
    v_cvt_f32_f16 v52, v28
    s_waitcnt lgkmcnt(12)
    v_mfma_f32_32x32x16_f16 v[128:143], v[68:71], a[132:135], v[128:143]
    ds_read_b64 a[152:153], v2 offset:704
    ds_read_b64 a[154:155], v2 offset:712
    ds_read_b64 a[156:157], v2 offset:736
    ds_read_b64 a[158:159], v2 offset:744
    v_cvt_f32_f16_sdwa v53, v28 dst_sel:DWORD dst_unused:UNUSED_PAD src0_sel:WORD_1
    v_cvt_f32_f16 v54, v29
    v_cvt_f32_f16_sdwa v55, v29 dst_sel:DWORD dst_unused:UNUSED_PAD src0_sel:WORD_1
    s_waitcnt lgkmcnt(14)
    v_mfma_f32_32x32x16_f16 v[192:207], v[72:75], a[136:139], v[192:207]
    ds_write_b16 v3, v29 offset:262
    ds_write_b16 v3, v29 offset:4420
    ds_write_b16 v3, v29 offset:8578
    ds_write_b16 v3, v29 offset:12736
    v_mul_f32 v52, v52, v20
    v_mul_f32 v53, v53, v21
    v_mul_f32 v54, v54, v22
    s_waitcnt lgkmcnt(15)
    v_mfma_f32_32x32x16_f16 v[192:207], v[76:79], a[140:143], v[192:207]
    ds_read_b64 a[160:161], v2 offset:320
    ds_read_b64 a[162:163], v2 offset:328
    ds_read_b64 a[164:165], v2 offset:352
    ds_read_b64 a[166:167], v2 offset:360
    v_mul_f32 v55, v55, v23
    v_cvt_pk_bf16_f32 v40, v52, v53
    v_lshlrev_b32 v52, 16, v40
    s_waitcnt lgkmcnt(14)
    v_mfma_f32_32x32x16_f16 v[144:159], v[80:83], a[144:147], v[144:159]
    ds_read_b64 a[168:169], v2 offset:832
    ds_read_b64 a[170:171], v2 offset:840
    ds_read_b64 a[172:173], v2 offset:864
    ds_read_b64 a[174:175], v2 offset:872
    v_and_b32 v53, 0xffff0000, v40
    v_cvt_pk_bf16_f32 v40, v54, v55
    v_lshlrev_b32 v54, 16, v40
    s_waitcnt lgkmcnt(15)
    v_mfma_f32_32x32x16_f16 v[144:159], v[84:87], a[148:151], v[144:159]
    ds_write_b16_d16_hi v3, v29 offset:390
    ds_write_b16_d16_hi v3, v29 offset:4548
    ds_write_b16_d16_hi v3, v29 offset:8706
    ds_write_b16_d16_hi v3, v29 offset:12864
    v_and_b32 v55, 0xffff0000, v40
    s_waitcnt vmcnt(2)
    v_lshlrev_b32 v56, 16, v30
    v_and_b32 v57, 0xffff0000, v30
    s_waitcnt lgkmcnt(15)
    v_mfma_f32_32x32x16_f16 v[208:223], v[88:91], a[152:155], v[208:223]
    ds_read_b64 a[176:177], v2 offset:448
    ds_read_b64 a[178:179], v2 offset:456
    ds_read_b64 a[180:181], v2 offset:480
    ds_read_b64 a[182:183], v2 offset:488
    v_lshlrev_b32 v58, 16, v31
    v_and_b32 v59, 0xffff0000, v31
    v_mfma_f32_32x32x16_f16 v[208:223], v[92:95], a[156:159], v[208:223]
    ds_read_b64 a[184:185], v2 offset:960
    ds_read_b64 a[186:187], v2 offset:968
    ds_read_b64 a[188:189], v2 offset:992
    ds_read_b64 a[190:191], v2 offset:1000
    s_waitcnt lgkmcnt(15)
    v_mfma_f32_32x32x16_f16 v[160:175], v[96:99], a[160:163], v[160:175]
    ds_read_b128 v[64:67], v1 offset:512
    ds_read_b128 v[68:71], v1 offset:2592
    v_mfma_f32_32x32x16_f16 v[160:175], v[100:103], a[164:167], v[160:175]
    ds_read_b128 v[72:75], v1 offset:17152
    ds_read_b128 v[76:79], v1 offset:19232
    s_waitcnt lgkmcnt(15)
    v_mfma_f32_32x32x16_f16 v[224:239], v[104:107], a[168:171], v[224:239]
    ds_read_b128 v[80:83], v1 offset:4672
    ds_read_b128 v[84:87], v1 offset:6752
    s_set_gpr_idx_on s44, gpr_idx(SRC0)
    v_mov_b32 v32, v128
    v_mov_b32 v48, v192
    v_mov_b32 v33, v144
    v_mov_b32 v49, v208
    s_set_gpr_idx_off
    v_mfma_f32_32x32x16_f16 v[224:239], v[108:111], a[172:175], v[224:239]
    ds_read_b128 v[88:91], v1 offset:21312
    ds_read_b128 v[92:95], v1 offset:23392
    v_permlane32_swap_b32 v32, v48
    v_permlane32_swap_b32 v33, v49
    v_cndmask_b32 v32, v32, v48, s[46:47]
    v_cndmask_b32 v33, v33, v49, s[46:47]
    v_mul_f32 v32, v32, v16
    s_waitcnt lgkmcnt(14)
    v_mfma_f32_32x32x16_f16 v[176:191], v[112:115], a[176:179], v[176:191]
    ds_read_b128 v[96:99], v1 offset:8832
    ds_read_b128 v[100:103], v1 offset:10912
    v_mul_f32 v33, v33, v17
    v_cvt_pk_bf16_f32 v40, v32, v33
    v_lshlrev_b32 v32, 16, v40
    v_and_b32 v33, 0xffff0000, v40
    v_add_f32 v32, v32, v52
    s_waitcnt lgkmcnt(14)
    v_mfma_f32_32x32x16_f16 v[176:191], v[116:119], a[180:183], v[176:191]
    ds_read_b128 v[104:107], v1 offset:25472
    ds_read_b128 v[108:111], v1 offset:27552
    v_add_f32 v33, v33, v53
    v_cvt_pk_bf16_f32 v40, v32, v33
    v_lshlrev_b32 v32, 16, v40
    v_and_b32 v33, 0xffff0000, v40
    v_add_f32 v32, v32, v56
    s_waitcnt lgkmcnt(14)
    v_mfma_f32_32x32x16_f16 v[240:255], v[120:123], a[184:187], v[240:255]
    ds_read_b128 v[112:115], v1 offset:12992
    ds_read_b128 v[116:119], v1 offset:15072
    v_add_f32 v33, v33, v57
    v_cvt_pk_bf16_f32 v36, v32, v33
    v_lshlrev_b32 v32, 16, v36
    v_and_b32 v33, 0xffff0000, v36
    v_add_f32 v42, v32, v33
    s_waitcnt lgkmcnt(14)
    v_mfma_f32_32x32x16_f16 v[240:255], v[124:127], a[188:191], v[240:255]
    ds_read_b128 v[120:123], v1 offset:29632
    ds_read_b128 v[124:127], v1 offset:31712
    v_mul_f32 v43, v32, v32
    v_fmac_f32 v43, v33, v33
    s_set_gpr_idx_on s44, gpr_idx(SRC0)
    v_mov_b32 v34, v160
    v_mov_b32 v50, v224
    v_mov_b32 v35, v176
    s_nop 3
    v_mov_b32 v51, v240
    s_set_gpr_idx_off
    v_permlane32_swap_b32 v34, v50
    v_permlane32_swap_b32 v35, v51
    v_cndmask_b32 v34, v34, v50, s[46:47]
    v_cndmask_b32 v35, v35, v51, s[46:47]
    v_mul_f32 v34, v34, v18
    v_mul_f32 v35, v35, v19
    v_cvt_pk_bf16_f32 v40, v34, v35
    v_lshlrev_b32 v34, 16, v40
    v_and_b32 v35, 0xffff0000, v40
    v_add_f32 v34, v34, v54
    v_add_f32 v35, v35, v55
    v_cvt_pk_bf16_f32 v40, v34, v35
    v_lshlrev_b32 v34, 16, v40
    v_and_b32 v35, 0xffff0000, v40
    v_add_f32 v34, v34, v58
    v_add_f32 v35, v35, v59
    v_cvt_pk_bf16_f32 v37, v34, v35
    v_lshlrev_b32 v34, 16, v37
    v_and_b32 v35, 0xffff0000, v37
    buffer_store_dwordx2 v[36:37], v5, s[8:11], s37 offen sc1
    v_add_f32 v42, v42, v34
    v_fmac_f32 v43, v34, v34
    v_add_f32 v42, v42, v35
    v_fmac_f32 v43, v35, v35
    s_nop 1
    v_permlane32_swap_b32 v42, v43
    v_add_f32 v42, v42, v43
    ds_write_b32 v9, v42 offset:0
    s_add_u32 s32, s32, 1
    s_add_u32 s37, s37, 32768
    s_waitcnt lgkmcnt(0)
    s_barrier
    ds_read_b32 v44, v10 offset:0
    ds_read_b32 v45, v10 offset:256
    ds_read_b32 v46, v10 offset:512
    ds_read_b32 v47, v10 offset:768
    v_xor_b32 v9, 159744, v9
    v_xor_b32 v10, 159744, v10
    s_waitcnt vmcnt(1)
    v_cmp_eq_u32 vcc, 0, v8
    s_waitcnt lgkmcnt(2)
    v_add_f32 v44, v44, v45
    s_waitcnt lgkmcnt(0)
    v_add_f32 v46, v46, v47
    v_add_f32 v44, v44, v46
    s_mov_b64 exec, s[48:49]
    buffer_store_dword v44, v11, s[8:11], s39 offen sc1
    s_mov_b64 exec, -1
    s_add_u32 s39, s39, 4096
    s_cbranch_vccnz Lcw_46070
    buffer_load_dwordx2 v[28:29], v4, s[8:11], s34 offen
    buffer_load_dwordx2 v[30:31], v4, s[16:19], s35 offen
    s_add_u32 s34, s34, 32768
    s_add_u32 s35, s35, 32768
    s_add_u32 s33, s33, 1024
    s_add_u32 s41, s41, 1
    s_cmp_ge_u32 s41, 64
    s_cselect_b32 s33, 5636096, s33
    ds_write_b16 v3, v24 offset:70
    ds_write_b16 v3, v24 offset:4228
    ds_write_b16 v3, v24 offset:8386
    ds_write_b16 v3, v24 offset:12544
    ds_write_b16_d16_hi v3, v24 offset:198
    ds_write_b16_d16_hi v3, v24 offset:4356
    ds_write_b16_d16_hi v3, v24 offset:8514
    ds_write_b16_d16_hi v3, v24 offset:12672
    ds_write_b16 v3, v25 offset:326
    ds_write_b16 v3, v25 offset:4484
    ds_write_b16 v3, v25 offset:8642
    ds_write_b16 v3, v25 offset:12800
    ds_write_b16_d16_hi v3, v25 offset:454
    ds_write_b16_d16_hi v3, v25 offset:4612
    ds_write_b16_d16_hi v3, v25 offset:8770
    ds_write_b16_d16_hi v3, v25 offset:12928
    v_subrev_u32 v1, 16, v1
    s_waitcnt vmcnt(2)
    s_mov_b64 exec, 1
    buffer_store_dword v13, off, s[8:11], s38 sc1
    s_mov_b64 exec, -1
    s_add_u32 s38, s38, 2048
L_conv_n1:
    s_cmp_lt_u32 s32, 64
    s_cbranch_scc1 L_conv_t1
    s_branch L_conv_end
Lcw_46067:
    buffer_load_dword v60, v6, s[8:11], s33 offen sc1
    v_mfma_f32_32x32x16_f16 a[0:15], v[64:67], a[128:131], a[0:15]
    ds_read_b128 v[64:67], v1 offset:0
    ds_write_b16 v3, v24 offset:70
    v_mfma_f32_32x32x16_f16 a[0:15], v[68:71], a[132:135], a[0:15]
    ds_read_b128 v[68:71], v1 offset:2080
    ds_write_b16 v3, v24 offset:4228
    v_mfma_f32_32x32x16_f16 a[64:79], v[72:75], a[136:139], a[64:79]
    ds_read_b128 v[72:75], v1 offset:16640
    ds_write_b16 v3, v24 offset:8386
    v_mfma_f32_32x32x16_f16 a[64:79], v[76:79], a[140:143], a[64:79]
    ds_read_b128 v[76:79], v1 offset:18720
    ds_write_b16 v3, v24 offset:12544
    v_mfma_f32_32x32x16_f16 a[16:31], v[80:83], a[144:147], a[16:31]
    ds_read_b128 v[80:83], v1 offset:4160
    ds_write_b16_d16_hi v3, v24 offset:198
    v_mfma_f32_32x32x16_f16 a[16:31], v[84:87], a[148:151], a[16:31]
    ds_read_b128 v[84:87], v1 offset:6240
    ds_write_b16_d16_hi v3, v24 offset:4356
    v_mfma_f32_32x32x16_f16 a[80:95], v[88:91], a[152:155], a[80:95]
    ds_read_b128 v[88:91], v1 offset:20800
    ds_write_b16_d16_hi v3, v24 offset:8514
    buffer_load_dword v61, v6, s[8:11], s33 offen sc1
    v_mfma_f32_32x32x16_f16 a[80:95], v[92:95], a[156:159], a[80:95]
    ds_read_b128 v[92:95], v1 offset:22880
    ds_write_b16_d16_hi v3, v24 offset:12672
    v_mfma_f32_32x32x16_f16 a[32:47], v[96:99], a[160:163], a[32:47]
    ds_read_b128 v[96:99], v1 offset:8320
    ds_write_b16 v3, v25 offset:326
    v_mfma_f32_32x32x16_f16 a[32:47], v[100:103], a[164:167], a[32:47]
    ds_read_b128 v[100:103], v1 offset:10400
    ds_write_b16 v3, v25 offset:4484
    v_mfma_f32_32x32x16_f16 a[96:111], v[104:107], a[168:171], a[96:111]
    ds_read_b128 v[104:107], v1 offset:24960
    ds_write_b16 v3, v25 offset:8642
    v_mfma_f32_32x32x16_f16 a[96:111], v[108:111], a[172:175], a[96:111]
    ds_read_b128 v[108:111], v1 offset:27040
    ds_write_b16 v3, v25 offset:12800
    v_mfma_f32_32x32x16_f16 a[48:63], v[112:115], a[176:179], a[48:63]
    ds_read_b128 v[112:115], v1 offset:12480
    ds_write_b16_d16_hi v3, v25 offset:454
    v_mfma_f32_32x32x16_f16 a[48:63], v[116:119], a[180:183], a[48:63]
    ds_read_b128 v[116:119], v1 offset:14560
    ds_write_b16_d16_hi v3, v25 offset:4612
    v_mfma_f32_32x32x16_f16 a[112:127], v[120:123], a[184:187], a[112:127]
    ds_read_b128 v[120:123], v1 offset:29120
    ds_write_b16_d16_hi v3, v25 offset:8770
    buffer_load_dword v62, v6, s[8:11], s33 offen sc1
    v_mfma_f32_32x32x16_f16 a[112:127], v[124:127], a[188:191], a[112:127]
    ds_read_b128 v[124:127], v1 offset:31200
    ds_write_b16_d16_hi v3, v25 offset:12928
    v_subrev_u32 v1, 16, v1
    s_waitcnt vmcnt(3)
    s_mov_b64 exec, 1
    buffer_store_dword v13, off, s[8:11], s38 sc1
    s_mov_b64 exec, -1
    s_add_u32 s38, s38, 2048
    s_cmp_ge_u32 s32, 64
    s_cbranch_scc1 L_conv_end
L_conv_in:
Lcp_46068:
    s_waitcnt vmcnt(2)
    v_cmp_eq_u32 vcc, 0, v60
    s_nop 0
    s_cbranch_vccz Lcok_46069
    buffer_load_dword v60, v6, s[8:11], s33 offen sc1
    s_waitcnt vmcnt(2)
    v_cmp_eq_u32 vcc, 0, v61
    s_nop 0
    s_cbranch_vccz Lcok_46069
    buffer_load_dword v61, v6, s[8:11], s33 offen sc1
    s_waitcnt vmcnt(2)
    v_cmp_eq_u32 vcc, 0, v62
    s_nop 0
    s_cbranch_vccz Lcok_46069
    buffer_load_dword v62, v6, s[8:11], s33 offen sc1
    s_sub_u32 s62, s62, 1
    s_cbranch_scc0 Ltok_51067
    s_movk_i32 s61, 31
    s_branch L_abort
Ltok_51067:
    s_branch Lcp_46068
Lcok_46069:
    buffer_load_dwordx2 v[28:29], v4, s[8:11], s34 offen
    buffer_load_dwordx2 v[30:31], v4, s[16:19], s35 offen
    s_add_u32 s34, s34, 32768
    s_add_u32 s35, s35, 32768
    s_add_u32 s33, s33, 1024
    s_add_u32 s41, s41, 1
    s_cmp_ge_u32 s41, 64
    s_cselect_b32 s33, 5636096, s33
    s_waitcnt vmcnt(0)
    s_branch L_conv_n0
Lcw_46070:
    buffer_load_dword v60, v6, s[8:11], s33 offen sc1
    ds_write_b16 v3, v24 offset:70
    s_nop 5
    ds_write_b16 v3, v24 offset:4228
    s_nop 5
    ds_write_b16 v3, v24 offset:8386
    s_nop 5
    ds_write_b16 v3, v24 offset:12544
    s_nop 5
    ds_write_b16_d16_hi v3, v24 offset:198
    s_nop 5
    ds_write_b16_d16_hi v3, v24 offset:4356
    s_nop 5
    ds_write_b16_d16_hi v3, v24 offset:8514
    s_nop 5
    buffer_load_dword v61, v6, s[8:11], s33 offen sc1
    ds_write_b16_d16_hi v3, v24 offset:12672
    s_nop 5
    ds_write_b16 v3, v25 offset:326
    s_nop 5
    ds_write_b16 v3, v25 offset:4484
    s_nop 5
    ds_write_b16 v3, v25 offset:8642
    s_nop 5
    ds_write_b16 v3, v25 offset:12800
    s_nop 5
    ds_write_b16_d16_hi v3, v25 offset:454
    s_nop 5
    ds_write_b16_d16_hi v3, v25 offset:4612
    s_nop 5
    ds_write_b16_d16_hi v3, v25 offset:8770
    s_nop 5
    buffer_load_dword v62, v6, s[8:11], s33 offen sc1
    ds_write_b16_d16_hi v3, v25 offset:12928
    s_nop 5
    v_subrev_u32 v1, 16, v1
    s_waitcnt vmcnt(3)
    s_mov_b64 exec, 1
    buffer_store_dword v13, off, s[8:11], s38 sc1
    s_mov_b64 exec, -1
    s_add_u32 s38, s38, 2048
    s_cmp_ge_u32 s32, 64
    s_cbranch_scc1 L_conv_end
Lcp_46071:
    s_waitcnt vmcnt(2)
    v_cmp_eq_u32 vcc, 0, v60
    s_nop 0
    s_cbranch_vccz Lcok_46072
    buffer_load_dword v60, v6, s[8:11], s33 offen sc1
    s_waitcnt vmcnt(2)
    v_cmp_eq_u32 vcc, 0, v61
    s_nop 0
    s_cbranch_vccz Lcok_46072
    buffer_load_dword v61, v6, s[8:11], s33 offen sc1
    s_waitcnt vmcnt(2)
    v_cmp_eq_u32 vcc, 0, v62
    s_nop 0
    s_cbranch_vccz Lcok_46072
    buffer_load_dword v62, v6, s[8:11], s33 offen sc1
    s_sub_u32 s62, s62, 1
    s_cbranch_scc0 Ltok_51068
    s_movk_i32 s61, 31
    s_branch L_abort
Ltok_51068:
    s_branch Lcp_46071
Lcok_46072:
    buffer_load_dwordx2 v[28:29], v4, s[8:11], s34 offen
    buffer_load_dwordx2 v[30:31], v4, s[16:19], s35 offen
    s_add_u32 s34, s34, 32768
    s_add_u32 s35, s35, 32768
    s_add_u32 s33, s33, 1024
    s_add_u32 s41, s41, 1
    s_cmp_ge_u32 s41, 64
    s_cselect_b32 s33, 5636096, s33
    s_waitcnt vmcnt(0)
    s_branch L_conv_n1
L_conv_end:
    s_branch L_end
L_abort:
    s_mov_b64 exec, -1
    s_lshl_b32 s33, s2, 4
    s_lshl_b32 s34, s3, 2
    s_add_u32 s33, s33, s34
    s_add_u32 s33, s33, 3211264
    v_mov_b32 v2, s61
    v_mov_b32 v3, 0
    buffer_store_dword v2, v3, s[8:11], s33 offen sc1
L_end:
    s_endpgm
.section .rodata,"a"
.p2align 6
.amdhsa_kernel interleave_layers__ssm_conv_s4d__memory_aug_recurrent_mem_tr__prompt_kernel
  .amdhsa_next_free_vgpr 512
  .amdhsa_next_free_sgpr 102
  .amdhsa_accum_offset 256
  .amdhsa_group_segment_fixed_size 0
  .amdhsa_kernarg_size 136
  .amdhsa_user_sgpr_count 2
  .amdhsa_user_sgpr_kernarg_segment_ptr 1
  .amdhsa_system_sgpr_workgroup_id_x 1
  .amdhsa_float_denorm_mode_32 3
.end_amdhsa_kernel
```
